```python
import torch

def _softmax(x, axis=-1):
    return torch.softmax(x, dim=axis)

def _gelu(x):
    return torch.nn.functional.gelu(x, approximate='tanh')

def _silu(x):
    return torch.nn.functional.silu(x)

def _sigmoid(x):
    return torch.sigmoid(x)

def _layernorm(x, axis=-1, eps=1e-05):
    m = x.mean(dim=axis, keepdim=True)
    v = x.var(dim=axis, keepdim=True, unbiased=False)
    return (x - m) / torch.sqrt(v + eps)

def _scatter_add(tgt, idx, src, axis=0):
    return tgt.clone().index_add_(axis, idx, src)

def _segment_sum(src, seg, n):
    out = torch.zeros((n,) + src.shape[1:], dtype=src.dtype)
    return out.index_add_(0, seg, src)

def _pad(x, pw):
    flat = tuple((v for pair in reversed(pw) for v in pair))
    return torch.nn.functional.pad(x, flat)
kernel_name = 'interleave_layers__memory_aug_recurrent_mem_tr__softmax_full_mha__prompt'

def setup_inputs():

    _w = lambda a: (lambda t: t.to(torch.bfloat16) if t.is_floating_point() else t)(torch.as_tensor(a))

    def _A_setup():
        B, S, Dm = (1, 2048, 576)
        H, Dh = (32, 128)
        M, seg = (8, 32)
        seg = min(seg, S)
        S = S // seg * seg
        return {'x': _w((lambda *s: torch.randn(*s, dtype=torch.bfloat16) * 0.05)(B, S, Dm)), 'mem0': _w((lambda *s: torch.randn(*s, dtype=torch.bfloat16) * 0.2)(B, M, Dm)), 'Wq': _w((lambda *s: torch.randn(*s, dtype=torch.bfloat16) * 1.6)(Dm, H, Dh) * Dm ** (-0.5)), 'Wk': _w((lambda *s: torch.randn(*s, dtype=torch.bfloat16) * 1.6)(Dm, H, Dh) * Dm ** (-0.5)), 'Wv': _w((lambda *s: torch.randn(*s, dtype=torch.bfloat16) * 0.2)(Dm, H, Dh) * Dm ** (-0.5)), 'Wo': _w((lambda *s: torch.randn(*s, dtype=torch.bfloat16) * 0.2)(H, Dh, Dm) * (H * Dh) ** (-0.5)), 'seg_len': seg}
    _A_in = _A_setup()

    def _B_setup():
        B, S, D = (1, 2048, 576)
        return {'x': _w((lambda *s: torch.randn(*s, dtype=torch.bfloat16) * 0.05)(B, S, D)), 'wqkv': _w((lambda *s: torch.randn(*s, dtype=torch.bfloat16) * 0.05)(D, 3 * D)), 'wo': _w((lambda *s: torch.randn(*s, dtype=torch.bfloat16) * 0.05)(D, D))}
    _B_in = _B_setup()
    return {'A_x': _A_in['x'], 'A_mem0': _A_in['mem0'], 'A_Wq': _A_in['Wq'], 'A_Wk': _A_in['Wk'], 'A_Wv': _A_in['Wv'], 'A_Wo': _A_in['Wo'], 'A_seg_len': _A_in['seg_len'], 'B_x': _B_in['x'], 'B_wqkv': _B_in['wqkv'], 'B_wo': _B_in['wo']}

def reference(A_x, A_mem0, A_Wq, A_Wk, A_Wv, A_Wo, A_seg_len, B_x, B_wqkv, B_wo):

    def _A_ref(x, mem0, Wq, Wk, Wv, Wo, seg_len):
        B, S, Dm = x.shape
        H, Dh = (Wq.shape[1], Wq.shape[2])
        M = mem0.shape[1]
        scale = Dh ** (-0.5)
        n_seg = S // seg_len
        L = M + seg_len
        idx = torch.arange(L)
        mask = (idx[:, None] < M) | (idx[:, None] >= idx[None, :])
        mem = mem0
        outs = []
        for s in range(n_seg):
            xs = x[:, s * seg_len:(s + 1) * seg_len, :].clone()
            h = torch.concatenate([mem, xs], axis=1)
            q = torch.einsum('btd,dhe->bhte', h, Wq)
            k = torch.einsum('btd,dhe->bhte', h, Wk)
            v = torch.einsum('btd,dhe->bhte', h, Wv)
            scores = torch.einsum('bhqe,bhke->bhqk', q, k) * scale
            scores = torch.where(mask[None, None], scores, -1000000000.0)
            p = _softmax(scores, axis=-1)
            o = torch.einsum('bhqk,bhke->bhqe', p, v)
            o = torch.einsum('bhte,hed->btd', o, Wo)
            mem = o[:, :M, :].clone()
            outs.append(o[:, M:, :])
        return torch.concatenate(outs, axis=1)

    def _B_ref(x, wqkv, wo):
        B, S, D = x.shape
        H = 32
        Dh = D // H
        qkv = (lambda x, *d: x.permute(*d))((x @ wqkv).reshape(B, S, 3, H, Dh), 2, 0, 3, 1, 4)
        q, k, v = (qkv[0], qkv[1], qkv[2])
        scale = Dh ** (-0.5)
        scores = torch.einsum('bhqd,bhkd->bhqk', q, k) * scale
        p = _softmax(scores, axis=-1)
        o = torch.einsum('bhqk,bhkd->bhqd', p, v)
        return (lambda x, *d: x.permute(*d))(o, 0, 2, 1, 3).reshape(B, S, D) @ wo
    x = A_x
    x = x + _A_ref(_layernorm(x, axis=-1), A_mem0, A_Wq, A_Wk, A_Wv, A_Wo, A_seg_len)
    x = x + _B_ref(_layernorm(x, axis=-1), B_wqkv, B_wo)
    x = x + _A_ref(_layernorm(x, axis=-1), A_mem0, A_Wq, A_Wk, A_Wv, A_Wo, A_seg_len)
    x = x + _B_ref(_layernorm(x, axis=-1), B_wqkv, B_wo)
    return x
```

```asm
; @launch grid=(256,1,1) block=(256,1,1) lds=163840
.amdgcn_target "amdgcn-amd-amdhsa--gfx950"
.text
.globl interleave_layers__memory_aug_recurrent_mem_tr__softmax_full_mha__prompt_kernel
.p2align 8
.type interleave_layers__memory_aug_recurrent_mem_tr__softmax_full_mha__prompt_kernel,@function
interleave_layers__memory_aug_recurrent_mem_tr__softmax_full_mha__prompt_kernel:
    s_cmp_ge_u32 s2, 256
    s_cbranch_scc1 L_end0
    s_load_dwordx16 s[64:79], s[0:1], 0
    s_load_dwordx8 s[80:87], s[0:1], 64
    s_load_dwordx2 s[88:89], s[0:1], 96
    s_getreg_b32 s4, hwreg(HW_REG_XCC_ID)
    s_and_b32 s4, s4, 15
    s_getreg_b32 s5, hwreg(HW_REG_HW_ID, 4, 2)
    v_lshrrev_b32 v1, 6, v0
    s_nop 0
    v_readfirstlane_b32 s20, v1
    v_lshlrev_b32 v1, 2, v1
    s_lshl_b32 s6, 1, s5
    v_mov_b32 v2, s6
    ds_write_b32 v1, v2 offset:16
    s_mov_b32 s37, 0
    s_mov_b32 s39, 0x3f803f80
    s_waitcnt lgkmcnt(0)
    s_mov_b32 s12, s88
    s_mov_b32 s13, s89
    s_mov_b32 s14, 130908160
    s_mov_b32 s15, 0x20000
    s_cmp_lg_u32 s20, 0
    s_cbranch_scc1 L_e_pre
    s_mov_b64 exec, 1
    v_mov_b64 v[2:3], 0
    s_mul_i32 s6, s2, 384
    s_add_u32 s6, s6, 393216
    buffer_store_dword v2, off, s[12:15], s6 sc1
    buffer_store_dword v2, off, s[12:15], s6 offset:128 sc1
    buffer_store_dword v2, off, s[12:15], s6 offset:256 sc1
    v_mov_b32 v4, 1
    s_cmp_lg_u32 s4, 0
    s_cbranch_scc1 L_e_worker
    global_atomic_add v5, v2, v4, s[86:87] offset:0 sc0
    s_waitcnt vmcnt(0)
    v_readfirstlane_b32 s6, v5
    s_nop 0
    s_add_u32 s7, s6, 224
    s_cmp_lt_u32 s6, 32
    s_cbranch_scc1 L_e_got
L_e_worker:
    s_waitcnt vmcnt(0)
    global_atomic_add v5, v2, v4, s[86:87] offset:128 sc0
    s_waitcnt vmcnt(0)
    v_readfirstlane_b32 s7, v5
    s_nop 0
    s_cmp_lt_u32 s7, 224
    s_cbranch_scc1 L_e_got
    s_sub_u32 s7, 479, s7
    global_atomic_add v2, v4, s[86:87] offset:8
L_e_got:
    s_waitcnt vmcnt(0)
    v_mov_b32 v5, s7
    ds_write_b32 v2, v5
    s_waitcnt lgkmcnt(0)
    s_mov_b64 exec, -1
L_e_bar:
    s_barrier
    v_mov_b32 v2, 0
    ds_read_b32 v3, v2
    ds_read_b128 v[4:7], v2 offset:16
    s_waitcnt lgkmcnt(0)
    v_or3_b32 v4, v4, v5, v6
    v_or_b32 v4, v4, v7
    v_readfirstlane_b32 s21, v3
    v_readfirstlane_b32 s6, v4
    s_barrier
    s_cmp_eq_u32 s6, 15
    s_cselect_b32 s20, s5, s20
    s_lshl_b32 s6, s20, 6
    v_and_b32 v0, 63, v0
    v_or_b32 v0, s6, v0
    s_cmp_lt_u32 s21, 96
    s_cbranch_scc1 L_j_hw
    s_sub_u32 s21, s21, 96
    s_cmp_lt_u32 s21, 48
    s_cbranch_scc1 L_j_ow
    s_sub_u32 s21, s21, 48
    s_cmp_lt_u32 s21, 16
    s_cbranch_scc1 L_j_qw
    s_sub_u32 s21, s21, 16
    s_cmp_lt_u32 s21, 64
    s_cbranch_scc1 L_j_bw
    s_sub_u32 s21, s21, 64
    s_and_b32 s21, s21, 31
    s_branch L_team
L_end0:
    s_endpgm
L_e_pre:
    s_getpc_b64 s[8:9]
L_e_pc:
    s_lshr_b32 s6, s2, 3
    s_lshl_b32 s6, s6, 12
    v_and_b32 v3, 31, v0
    v_lshl_add_u32 v3, v3, 7, s6
    v_min_u32 v3, L_end-L_e_pc, v3
    s_cmp_lg_u32 s20, 1
    s_cbranch_scc1 L_e_pc1
    global_load_dword v9, v3, s[8:9]
L_e_pc1:
    s_waitcnt vmcnt(0)
    s_branch L_e_bar
L_j_hw:
    s_branch L_hw
L_j_ow:
    s_branch L_ow
L_j_qw:
    s_branch L_qw
L_j_bw:
    s_branch L_bw
L_team:
    s_mov_b32 s60, 0
    s_mov_b32 s61, 0
    s_mov_b32 s62, 0
    s_mov_b32 s63, 0
    s_mov_b32 s12, s88
    s_mov_b32 s13, s89
    s_mov_b32 s14, 491520
    s_mov_b32 s15, 0x20000
    s_lshl_b32 s34, s20, 14
    s_lshl_b32 s35, s21, 9
    s_add_u32 s24, s34, s35
    s_lshl_b32 s34, s20, 5
    s_add_u32 s34, s34, s21
    s_lshr_b32 s27, s34, 2
    s_lshl_b32 s27, s27, 14
    s_and_b32 s35, s34, 3
    s_lshl_b32 s35, s35, 7
    s_add_u32 s27, s27, s35
    s_lshr_b32 s28, s34, 4
    s_lshl_b32 s28, s28, 11
    s_and_b32 s35, s34, 15
    s_lshl_b32 s35, s35, 6
    s_add_u32 s28, s28, s35
    s_mov_b32 s32, 0x3e0293ee
    s_and_b32 s33, s21, 15
    s_mul_i32 s33, s33, 576
    s_mov_b32 s9, 0
    s_mov_b32 s10, 0
    s_lshl_b32 s34, s21, 7
    s_add_u32 s34, s34, 393216
    s_add_u32 s48, s88, s34
    s_addc_u32 s49, s89, 0
    s_cmp_ge_u32 s21, 16
    s_cselect_b32 s50, 4, 0
    s_mov_b32 s51, 0x20000
    s_mul_i32 s34, s9, 33554432
    s_add_u32 s34, s34, 61702144
    s_add_u32 s16, s88, s34
    s_addc_u32 s17, s89, 0
    s_mov_b32 s18, 33554432
    s_mov_b32 s19, 0x20000
    s_mul_i32 s34, s9, 589824
    s_add_u32 s34, s34, s33
    s_add_u32 s34, s34, 491520
    s_add_u32 s44, s88, s34
    s_addc_u32 s45, s89, 0
    s_mov_b32 s46, 576
    s_mov_b32 s47, 0x20000
    s_cmp_ge_u32 s21, 16
    s_cselect_b32 s46, 576, 0
    s_mov_b32 s29, 327680
    s_mov_b32 s30, 327680
    s_lshl_b32 s31, s21, 14
    s_lshl_b32 s34, s20, 12
    s_add_u32 s31, s31, s34
    s_sub_u32 s31, s31, 524288
    s_mov_b32 s22, 0
    s_mov_b32 s5, 0
    s_mov_b32 s4, 0
    s_mov_b32 s23, 0
    s_lshl_b32 s25, s9, 6
    s_add_u32 s25, s25, 1
    s_lshl_b32 s8, s21, 7
    s_add_u32 s8, s8, 397312
    s_mul_i32 s34, s21, 18
    v_add_u32 v77, s34, v0
    v_bfe_u32 v59, v77, 1, 3
    v_mul_u32_u24 v59, 1152, v59
    v_lshrrev_b32 v64, 4, v77
    v_lshl_add_u32 v59, v64, 5, v59
    v_and_b32 v64, 1, v77
    v_lshl_add_u32 v59, v64, 4, v59
    v_lshlrev_b32 v77, 4, v77
    v_mov_b32 v64, 0x40000000
    v_cmp_gt_u32 vcc, 18, v0
    s_nop 1
    v_cndmask_b32 v77, v64, v77, vcc
    v_cndmask_b32 v59, v64, v59, vcc
    s_mov_b32 s52, s66
    s_mov_b32 s53, s67
    s_mov_b32 s54, 9216
    s_mov_b32 s55, 0x20000
    buffer_load_dwordx4 v[68:71], v59, s[52:55], 0 offen
    v_and_b32 v24, 63, v0
    v_lshrrev_b32 v25, 4, v24
    s_lshl_b32 s34, s20, 4
    v_add_u32 v26, s34, v25
    v_lshlrev_b32 v26, 13, v26
    s_lshl_b32 s34, s21, 8
    v_add_u32 v26, s34, v26
    v_and_b32 v27, 1, v25
    v_lshlrev_b32 v27, 1, v27
    v_and_b32 v40, 15, v24
    v_xor_b32 v27, v27, v40
    v_xor_b32 v41, 0, v27
    v_lshlrev_b32 v41, 4, v41
    v_add_u32 v41, v41, v26
    v_add_u32 v28, 0, v41
    v_xor_b32 v41, 4, v27
    v_lshlrev_b32 v41, 4, v41
    v_add_u32 v41, v41, v26
    v_add_u32 v29, 32768, v41
    v_xor_b32 v41, 8, v27
    v_lshlrev_b32 v41, 4, v41
    v_add_u32 v41, v41, v26
    v_add_u32 v30, 65536, v41
    v_xor_b32 v41, 12, v27
    v_lshlrev_b32 v41, 4, v41
    v_add_u32 v41, v41, v26
    v_add_u32 v31, 98304, v41
    v_lshrrev_b32 v25, 3, v24
    s_lshl_b32 s34, s20, 5
    v_add_u32 v26, s34, v25
    v_mul_u32_u24 v26, 1152, v26
    s_mul_i32 s34, s21, 147456
    v_add_u32 v26, s34, v26
    v_lshrrev_b32 v27, 5, v24
    v_lshlrev_b32 v27, 1, v27
    v_and_b32 v40, 7, v24
    v_xor_b32 v27, v27, v40
    v_xor_b32 v41, 0, v27
    v_lshlrev_b32 v41, 4, v41
    v_add_u32 v41, v41, v26
    v_add_u32 v32, 0, v41
    v_xor_b32 v41, 0, v27
    v_lshlrev_b32 v41, 4, v41
    v_add_u32 v41, v41, v26
    v_add_u32 v33, 9216, v41
    v_xor_b32 v41, 4, v27
    v_lshlrev_b32 v41, 4, v41
    v_add_u32 v41, v41, v26
    v_add_u32 v34, 18432, v41
    v_xor_b32 v41, 4, v27
    v_lshlrev_b32 v41, 4, v41
    v_add_u32 v41, v41, v26
    v_add_u32 v35, 27648, v41
    v_bfe_u32 v40, v24, 2, 1
    v_bfe_u32 v41, v24, 3, 1
    v_bfe_u32 v42, v24, 4, 1
    v_bfe_u32 v43, v24, 5, 1
    v_and_b32 v44, 3, v24
    v_lshlrev_b32 v44, 3, v44
    v_add_u32 v44, 16384, v44
    v_lshlrev_b32 v45, 3, v41
    v_lshl_add_u32 v45, v42, 2, v45
    v_add_u32 v45, v45, v40
    v_lshl_add_u32 v45, v45, 8, v44
    v_lshl_add_u32 v46, v42, 1, v40
    v_lshl_add_u32 v46, v41, 2, v46
    v_mul_u32_u24 v47, 36864, v43
    v_add_u32 v45, v45, v47
    s_lshl_b32 s34, s20, 1
    v_xor_b32 v46, s34, v46
    v_lshl_add_u32 v48, v46, 5, v45
    v_xor_b32 v46, 1, v46
    v_lshl_add_u32 v50, v46, 5, v45
    v_add_u32 v49, 73728, v48
    v_add_u32 v51, 73728, v50
    v_lshlrev_b32 v45, 4, v42
    v_lshl_add_u32 v45, v43, 3, v45
    v_lshl_add_u32 v45, v41, 2, v45
    v_add_u32 v45, v45, v40
    v_lshl_add_u32 v45, v45, 7, v44
    v_lshl_add_u32 v46, v42, 1, v41
    v_xor_b32 v46, s20, v46
    v_lshl_add_u32 v52, v46, 5, v45
    v_add_u32 v53, 36864, v52
    v_add_u32 v54, 73728, v52
    v_add_u32 v55, 110592, v52
    s_mul_i32 s36, s20, 36864
    s_add_u32 s36, s36, 16384
    v_lshlrev_b32 v1, 4, v24
    v_add_u32 v1, s36, v1
    s_mov_b32 s42, 4718592
    s_mov_b32 s43, 0x20000
    s_mov_b32 s40, s70
    s_mov_b32 s41, s71
    s_mov_b32 s34, 0
    s_add_u32 m0, s36, 0
    s_nop 0
    buffer_load_dwordx4 v28, s[40:43], s34 offen lds
    s_add_u32 m0, s36, 1024
    s_nop 0
    buffer_load_dwordx4 v29, s[40:43], s34 offen lds
    s_add_u32 m0, s36, 2048
    s_nop 0
    buffer_load_dwordx4 v30, s[40:43], s34 offen lds
    s_add_u32 m0, s36, 3072
    s_nop 0
    buffer_load_dwordx4 v31, s[40:43], s34 offen lds
    s_mov_b32 s40, s68
    s_mov_b32 s41, s69
    s_mov_b32 s34, 524288
    s_add_u32 m0, s36, 4096
    s_nop 0
    buffer_load_dwordx4 v28, s[40:43], s34 offen lds
    s_add_u32 m0, s36, 5120
    s_nop 0
    buffer_load_dwordx4 v29, s[40:43], s34 offen lds
    s_add_u32 m0, s36, 6144
    s_nop 0
    buffer_load_dwordx4 v30, s[40:43], s34 offen lds
    s_add_u32 m0, s36, 7168
    s_nop 0
    buffer_load_dwordx4 v31, s[40:43], s34 offen lds
    s_mov_b32 s40, s70
    s_mov_b32 s41, s71
    s_mov_b32 s34, 524288
    s_add_u32 m0, s36, 8192
    s_nop 0
    buffer_load_dwordx4 v28, s[40:43], s34 offen lds
    s_add_u32 m0, s36, 9216
    s_nop 0
    buffer_load_dwordx4 v29, s[40:43], s34 offen lds
    s_add_u32 m0, s36, 10240
    s_nop 0
    buffer_load_dwordx4 v30, s[40:43], s34 offen lds
    s_add_u32 m0, s36, 11264
    s_nop 0
    buffer_load_dwordx4 v31, s[40:43], s34 offen lds
    s_mov_b32 s34, 1048576
    s_add_u32 m0, s36, 12288
    s_nop 0
    buffer_load_dwordx4 v28, s[40:43], s34 offen lds
    s_add_u32 m0, s36, 13312
    s_nop 0
    buffer_load_dwordx4 v29, s[40:43], s34 offen lds
    s_add_u32 m0, s36, 14336
    s_nop 0
    buffer_load_dwordx4 v30, s[40:43], s34 offen lds
    s_add_u32 m0, s36, 15360
    s_nop 0
    buffer_load_dwordx4 v31, s[40:43], s34 offen lds
    s_mov_b32 s40, s68
    s_mov_b32 s41, s69
    s_mov_b32 s34, 1572864
    s_add_u32 m0, s36, 16384
    s_nop 0
    buffer_load_dwordx4 v28, s[40:43], s34 offen lds
    s_add_u32 m0, s36, 17408
    s_nop 0
    buffer_load_dwordx4 v29, s[40:43], s34 offen lds
    s_add_u32 m0, s36, 18432
    s_nop 0
    buffer_load_dwordx4 v30, s[40:43], s34 offen lds
    s_add_u32 m0, s36, 19456
    s_nop 0
    buffer_load_dwordx4 v31, s[40:43], s34 offen lds
    s_mov_b32 s34, 4194304
    s_add_u32 m0, s36, 20480
    s_nop 0
    buffer_load_dwordx4 v28, s[40:43], s34 offen lds
    s_add_u32 m0, s36, 21504
    s_nop 0
    buffer_load_dwordx4 v29, s[40:43], s34 offen lds
    s_add_u32 m0, s36, 22528
    s_nop 0
    buffer_load_dwordx4 v30, s[40:43], s34 offen lds
    s_add_u32 m0, s36, 23552
    s_nop 0
    buffer_load_dwordx4 v31, s[40:43], s34 offen lds
    s_mov_b32 s40, s70
    s_mov_b32 s41, s71
    s_mov_b32 s34, 4194304
    s_add_u32 m0, s36, 24576
    s_nop 0
    buffer_load_dwordx4 v28, s[40:43], s34 offen lds
    s_add_u32 m0, s36, 25600
    s_nop 0
    buffer_load_dwordx4 v29, s[40:43], s34 offen lds
    s_add_u32 m0, s36, 26624
    s_nop 0
    buffer_load_dwordx4 v30, s[40:43], s34 offen lds
    s_add_u32 m0, s36, 27648
    s_nop 0
    buffer_load_dwordx4 v31, s[40:43], s34 offen lds
    s_mov_b32 s40, s68
    s_mov_b32 s41, s69
    s_mov_b32 s34, 2097152
    s_add_u32 m0, s36, 28672
    s_nop 0
    buffer_load_dwordx4 v28, s[40:43], s34 offen lds
    s_add_u32 m0, s36, 29696
    s_nop 0
    buffer_load_dwordx4 v29, s[40:43], s34 offen lds
    s_add_u32 m0, s36, 30720
    s_nop 0
    buffer_load_dwordx4 v30, s[40:43], s34 offen lds
    s_add_u32 m0, s36, 31744
    s_nop 0
    buffer_load_dwordx4 v31, s[40:43], s34 offen lds
    s_mov_b32 s34, 2621440
    s_add_u32 m0, s36, 32768
    s_nop 0
    buffer_load_dwordx4 v28, s[40:43], s34 offen lds
    s_add_u32 m0, s36, 33792
    s_nop 0
    buffer_load_dwordx4 v29, s[40:43], s34 offen lds
    s_add_u32 m0, s36, 34816
    s_nop 0
    buffer_load_dwordx4 v30, s[40:43], s34 offen lds
    s_add_u32 m0, s36, 35840
    s_nop 0
    buffer_load_dwordx4 v31, s[40:43], s34 offen lds
    v_and_b32 v57, 63, v0
    v_lshlrev_b32 v57, 3, v57
    v_mov_b32 v60, 0
    v_mov_b32 v61, 0
    s_mov_b32 s26, s24
    buffer_store_dwordx2 v[60:61], v57, s[12:15], s26 offen sc1
    s_add_u32 s26, s26, 65536
    buffer_store_dwordx2 v[60:61], v57, s[12:15], s26 offen sc1
    s_add_u32 s26, s26, 65536
    buffer_store_dwordx2 v[60:61], v57, s[12:15], s26 offen sc1
    s_add_u32 s26, s26, 65536
    buffer_store_dwordx2 v[60:61], v57, s[12:15], s26 offen sc1
    s_add_u32 s26, s26, 65536
    buffer_store_dwordx2 v[60:61], v57, s[12:15], s26 offen sc1
    s_add_u32 s26, s26, 65536
    v_lshlrev_b32 v58, 7, v0
    s_lshl_b32 s34, s21, 2
    s_add_u32 s34, s34, 355328
    v_mov_b32 v64, 0x40000000
    v_cmp_gt_u32 vcc, 4, v0
    s_nop 1
    v_cndmask_b32 v58, v64, v58, vcc
    buffer_store_dword v60, v58, s[12:15], s34 offen sc1
    v_mov_b64 v[64:65], -1
    v_mov_b64 v[66:67], -1
    s_mov_b32 s34, 336896
    s_mov_b32 s35, 346112
    buffer_store_dwordx4 v[64:67], v77, s[12:15], s34 offen sc1
    buffer_store_dwordx4 v[64:67], v77, s[12:15], s35 offen sc1
    s_waitcnt vmcnt(44)
    buffer_store_dwordx4 v[68:71], v77, s[12:15], s29 offen sc1
    s_waitcnt vmcnt(32) lgkmcnt(0)
    s_barrier
    ds_read_b64_tr_b16 a[0:1], v48 offset:0
    ds_read_b64_tr_b16 a[2:3], v48 offset:512
    ds_read_b64_tr_b16 a[4:5], v49 offset:0
    ds_read_b64_tr_b16 a[6:7], v49 offset:512
    ds_read_b64_tr_b16 a[8:9], v50 offset:0
    ds_read_b64_tr_b16 a[10:11], v50 offset:512
    ds_read_b64_tr_b16 a[12:13], v51 offset:0
    ds_read_b64_tr_b16 a[14:15], v51 offset:512
    s_waitcnt vmcnt(28) lgkmcnt(0)
    s_barrier
    s_mov_b32 s40, s68
    s_mov_b32 s41, s69
    s_mov_b32 s34, 3670016
    s_add_u32 m0, s36, 0
    s_nop 0
    buffer_load_dwordx4 v28, s[40:43], s34 offen lds
    s_add_u32 m0, s36, 1024
    s_nop 0
    buffer_load_dwordx4 v29, s[40:43], s34 offen lds
    s_add_u32 m0, s36, 2048
    s_nop 0
    buffer_load_dwordx4 v30, s[40:43], s34 offen lds
    s_add_u32 m0, s36, 3072
    s_nop 0
    buffer_load_dwordx4 v31, s[40:43], s34 offen lds
    ds_read_b64_tr_b16 a[16:17], v48 offset:4096
    ds_read_b64_tr_b16 a[18:19], v48 offset:4608
    ds_read_b64_tr_b16 a[20:21], v49 offset:4096
    ds_read_b64_tr_b16 a[22:23], v49 offset:4608
    ds_read_b64_tr_b16 a[24:25], v50 offset:4096
    ds_read_b64_tr_b16 a[26:27], v50 offset:4608
    ds_read_b64_tr_b16 a[28:29], v51 offset:4096
    ds_read_b64_tr_b16 a[30:31], v51 offset:4608
    s_waitcnt vmcnt(28) lgkmcnt(0)
    s_barrier
    s_mov_b32 s40, s70
    s_mov_b32 s41, s71
    s_mov_b32 s34, 2097152
    s_add_u32 m0, s36, 4096
    s_nop 0
    buffer_load_dwordx4 v28, s[40:43], s34 offen lds
    s_add_u32 m0, s36, 5120
    s_nop 0
    buffer_load_dwordx4 v29, s[40:43], s34 offen lds
    s_add_u32 m0, s36, 6144
    s_nop 0
    buffer_load_dwordx4 v30, s[40:43], s34 offen lds
    s_add_u32 m0, s36, 7168
    s_nop 0
    buffer_load_dwordx4 v31, s[40:43], s34 offen lds
    ds_read_b64_tr_b16 a[32:33], v48 offset:8192
    ds_read_b64_tr_b16 a[34:35], v48 offset:8704
    ds_read_b64_tr_b16 a[36:37], v49 offset:8192
    ds_read_b64_tr_b16 a[38:39], v49 offset:8704
    ds_read_b64_tr_b16 a[40:41], v50 offset:8192
    ds_read_b64_tr_b16 a[42:43], v50 offset:8704
    ds_read_b64_tr_b16 a[44:45], v51 offset:8192
    ds_read_b64_tr_b16 a[46:47], v51 offset:8704
    s_waitcnt vmcnt(28) lgkmcnt(0)
    s_barrier
    s_mov_b32 s34, 2621440
    s_add_u32 m0, s36, 8192
    s_nop 0
    buffer_load_dwordx4 v28, s[40:43], s34 offen lds
    s_add_u32 m0, s36, 9216
    s_nop 0
    buffer_load_dwordx4 v29, s[40:43], s34 offen lds
    s_add_u32 m0, s36, 10240
    s_nop 0
    buffer_load_dwordx4 v30, s[40:43], s34 offen lds
    s_add_u32 m0, s36, 11264
    s_nop 0
    buffer_load_dwordx4 v31, s[40:43], s34 offen lds
    ds_read_b64_tr_b16 a[48:49], v48 offset:12288
    ds_read_b64_tr_b16 a[50:51], v48 offset:12800
    ds_read_b64_tr_b16 a[52:53], v49 offset:12288
    ds_read_b64_tr_b16 a[54:55], v49 offset:12800
    ds_read_b64_tr_b16 a[56:57], v50 offset:12288
    ds_read_b64_tr_b16 a[58:59], v50 offset:12800
    ds_read_b64_tr_b16 a[60:61], v51 offset:12288
    ds_read_b64_tr_b16 a[62:63], v51 offset:12800
    s_waitcnt vmcnt(28) lgkmcnt(0)
    s_barrier
    s_mov_b32 s34, 3670016
    s_add_u32 m0, s36, 12288
    s_nop 0
    buffer_load_dwordx4 v28, s[40:43], s34 offen lds
    s_add_u32 m0, s36, 13312
    s_nop 0
    buffer_load_dwordx4 v29, s[40:43], s34 offen lds
    s_add_u32 m0, s36, 14336
    s_nop 0
    buffer_load_dwordx4 v30, s[40:43], s34 offen lds
    s_add_u32 m0, s36, 15360
    s_nop 0
    buffer_load_dwordx4 v31, s[40:43], s34 offen lds
    ds_read_b64_tr_b16 a[64:65], v48 offset:16384
    ds_read_b64_tr_b16 a[66:67], v48 offset:16896
    ds_read_b64_tr_b16 a[68:69], v49 offset:16384
    ds_read_b64_tr_b16 a[70:71], v49 offset:16896
    ds_read_b64_tr_b16 a[72:73], v50 offset:16384
    ds_read_b64_tr_b16 a[74:75], v50 offset:16896
    ds_read_b64_tr_b16 a[76:77], v51 offset:16384
    ds_read_b64_tr_b16 a[78:79], v51 offset:16896
    s_waitcnt vmcnt(28) lgkmcnt(0)
    s_barrier
    s_mov_b32 s40, s72
    s_mov_b32 s41, s73
    s_mov_b32 s34, 2097152
    s_add_u32 m0, s36, 16384
    s_nop 0
    buffer_load_dwordx4 v28, s[40:43], s34 offen lds
    s_add_u32 m0, s36, 17408
    s_nop 0
    buffer_load_dwordx4 v29, s[40:43], s34 offen lds
    s_add_u32 m0, s36, 18432
    s_nop 0
    buffer_load_dwordx4 v30, s[40:43], s34 offen lds
    s_add_u32 m0, s36, 19456
    s_nop 0
    buffer_load_dwordx4 v31, s[40:43], s34 offen lds
    ds_read_b64_tr_b16 a[80:81], v48 offset:20480
    ds_read_b64_tr_b16 a[82:83], v48 offset:20992
    ds_read_b64_tr_b16 a[84:85], v49 offset:20480
    ds_read_b64_tr_b16 a[86:87], v49 offset:20992
    ds_read_b64_tr_b16 a[88:89], v50 offset:20480
    ds_read_b64_tr_b16 a[90:91], v50 offset:20992
    ds_read_b64_tr_b16 a[92:93], v51 offset:20480
    ds_read_b64_tr_b16 a[94:95], v51 offset:20992
    s_waitcnt vmcnt(28) lgkmcnt(0)
    s_barrier
    s_mov_b32 s34, 2621440
    s_add_u32 m0, s36, 20480
    s_nop 0
    buffer_load_dwordx4 v28, s[40:43], s34 offen lds
    s_add_u32 m0, s36, 21504
    s_nop 0
    buffer_load_dwordx4 v29, s[40:43], s34 offen lds
    s_add_u32 m0, s36, 22528
    s_nop 0
    buffer_load_dwordx4 v30, s[40:43], s34 offen lds
    s_add_u32 m0, s36, 23552
    s_nop 0
    buffer_load_dwordx4 v31, s[40:43], s34 offen lds
    ds_read_b64_tr_b16 a[96:97], v48 offset:24576
    ds_read_b64_tr_b16 a[98:99], v48 offset:25088
    ds_read_b64_tr_b16 a[100:101], v49 offset:24576
    ds_read_b64_tr_b16 a[102:103], v49 offset:25088
    ds_read_b64_tr_b16 a[104:105], v50 offset:24576
    ds_read_b64_tr_b16 a[106:107], v50 offset:25088
    ds_read_b64_tr_b16 a[108:109], v51 offset:24576
    ds_read_b64_tr_b16 a[110:111], v51 offset:25088
    s_waitcnt vmcnt(28) lgkmcnt(0)
    s_barrier
    s_mov_b32 s34, 3145728
    s_add_u32 m0, s36, 24576
    s_nop 0
    buffer_load_dwordx4 v28, s[40:43], s34 offen lds
    s_add_u32 m0, s36, 25600
    s_nop 0
    buffer_load_dwordx4 v29, s[40:43], s34 offen lds
    s_add_u32 m0, s36, 26624
    s_nop 0
    buffer_load_dwordx4 v30, s[40:43], s34 offen lds
    s_add_u32 m0, s36, 27648
    s_nop 0
    buffer_load_dwordx4 v31, s[40:43], s34 offen lds
    ds_read_b64_tr_b16 a[112:113], v48 offset:28672
    ds_read_b64_tr_b16 a[114:115], v48 offset:29184
    ds_read_b64_tr_b16 a[116:117], v49 offset:28672
    ds_read_b64_tr_b16 a[118:119], v49 offset:29184
    ds_read_b64_tr_b16 a[120:121], v50 offset:28672
    ds_read_b64_tr_b16 a[122:123], v50 offset:29184
    ds_read_b64_tr_b16 a[124:125], v51 offset:28672
    ds_read_b64_tr_b16 a[126:127], v51 offset:29184
    s_waitcnt vmcnt(28) lgkmcnt(0)
    s_barrier
    s_mov_b32 s34, 3670016
    s_add_u32 m0, s36, 28672
    s_nop 0
    buffer_load_dwordx4 v28, s[40:43], s34 offen lds
    s_add_u32 m0, s36, 29696
    s_nop 0
    buffer_load_dwordx4 v29, s[40:43], s34 offen lds
    s_add_u32 m0, s36, 30720
    s_nop 0
    buffer_load_dwordx4 v30, s[40:43], s34 offen lds
    s_add_u32 m0, s36, 31744
    s_nop 0
    buffer_load_dwordx4 v31, s[40:43], s34 offen lds
    ds_read_b64_tr_b16 a[128:129], v48 offset:32768
    ds_read_b64_tr_b16 a[130:131], v48 offset:33280
    ds_read_b64_tr_b16 a[132:133], v49 offset:32768
    ds_read_b64_tr_b16 a[134:135], v49 offset:33280
    ds_read_b64_tr_b16 a[136:137], v50 offset:32768
    ds_read_b64_tr_b16 a[138:139], v50 offset:33280
    ds_read_b64_tr_b16 a[140:141], v51 offset:32768
    ds_read_b64_tr_b16 a[142:143], v51 offset:33280
    s_waitcnt vmcnt(28) lgkmcnt(0)
    s_barrier
    s_mov_b32 s34, 0
    s_add_u32 m0, s36, 32768
    s_nop 0
    buffer_load_dwordx4 v28, s[40:43], s34 offen lds
    s_add_u32 m0, s36, 33792
    s_nop 0
    buffer_load_dwordx4 v29, s[40:43], s34 offen lds
    s_add_u32 m0, s36, 34816
    s_nop 0
    buffer_load_dwordx4 v30, s[40:43], s34 offen lds
    s_add_u32 m0, s36, 35840
    s_nop 0
    buffer_load_dwordx4 v31, s[40:43], s34 offen lds
    s_add_u32 s10, s10, 32
    s_cmp_lg_u32 s20, 0
    s_cbranch_scc1 L_ta1
    v_mov_b32 v58, 12
    v_mov_b32 v59, 1
    s_mov_b64 exec, 1
    global_atomic_add v58, v59, s[86:87]
    s_mov_b64 exec, -1
L_ta1:
    ds_read_b64_tr_b16 a[144:145], v48 offset:0
    ds_read_b64_tr_b16 a[146:147], v48 offset:512
    ds_read_b64_tr_b16 a[148:149], v49 offset:0
    ds_read_b64_tr_b16 a[150:151], v49 offset:512
    ds_read_b64_tr_b16 a[152:153], v50 offset:0
    ds_read_b64_tr_b16 a[154:155], v50 offset:512
    ds_read_b64_tr_b16 a[156:157], v51 offset:0
    ds_read_b64_tr_b16 a[158:159], v51 offset:512
    s_waitcnt vmcnt(28) lgkmcnt(0)
    s_barrier
    s_mov_b32 s34, 524288
    s_add_u32 m0, s36, 0
    s_nop 0
    buffer_load_dwordx4 v28, s[40:43], s34 offen lds
    s_add_u32 m0, s36, 1024
    s_nop 0
    buffer_load_dwordx4 v29, s[40:43], s34 offen lds
    s_add_u32 m0, s36, 2048
    s_nop 0
    buffer_load_dwordx4 v30, s[40:43], s34 offen lds
    s_add_u32 m0, s36, 3072
    s_nop 0
    buffer_load_dwordx4 v31, s[40:43], s34 offen lds
    ds_read_b64_tr_b16 a[160:161], v48 offset:4096
    ds_read_b64_tr_b16 a[162:163], v48 offset:4608
    ds_read_b64_tr_b16 a[164:165], v49 offset:4096
    ds_read_b64_tr_b16 a[166:167], v49 offset:4608
    ds_read_b64_tr_b16 a[168:169], v50 offset:4096
    ds_read_b64_tr_b16 a[170:171], v50 offset:4608
    ds_read_b64_tr_b16 a[172:173], v51 offset:4096
    ds_read_b64_tr_b16 a[174:175], v51 offset:4608
    s_waitcnt vmcnt(28) lgkmcnt(0)
    s_barrier
    s_mov_b32 s34, 1048576
    s_add_u32 m0, s36, 4096
    s_nop 0
    buffer_load_dwordx4 v28, s[40:43], s34 offen lds
    s_add_u32 m0, s36, 5120
    s_nop 0
    buffer_load_dwordx4 v29, s[40:43], s34 offen lds
    s_add_u32 m0, s36, 6144
    s_nop 0
    buffer_load_dwordx4 v30, s[40:43], s34 offen lds
    s_add_u32 m0, s36, 7168
    s_nop 0
    buffer_load_dwordx4 v31, s[40:43], s34 offen lds
    ds_read_b64_tr_b16 a[176:177], v48 offset:8192
    ds_read_b64_tr_b16 a[178:179], v48 offset:8704
    ds_read_b64_tr_b16 a[180:181], v49 offset:8192
    ds_read_b64_tr_b16 a[182:183], v49 offset:8704
    ds_read_b64_tr_b16 a[184:185], v50 offset:8192
    ds_read_b64_tr_b16 a[186:187], v50 offset:8704
    ds_read_b64_tr_b16 a[188:189], v51 offset:8192
    ds_read_b64_tr_b16 a[190:191], v51 offset:8704
    s_waitcnt vmcnt(28) lgkmcnt(0)
    s_barrier
    s_mov_b32 s34, 1572864
    s_add_u32 m0, s36, 8192
    s_nop 0
    buffer_load_dwordx4 v28, s[40:43], s34 offen lds
    s_add_u32 m0, s36, 9216
    s_nop 0
    buffer_load_dwordx4 v29, s[40:43], s34 offen lds
    s_add_u32 m0, s36, 10240
    s_nop 0
    buffer_load_dwordx4 v30, s[40:43], s34 offen lds
    s_add_u32 m0, s36, 11264
    s_nop 0
    buffer_load_dwordx4 v31, s[40:43], s34 offen lds
    ds_read_b64_tr_b16 a[192:193], v48 offset:12288
    ds_read_b64_tr_b16 a[194:195], v48 offset:12800
    ds_read_b64_tr_b16 a[196:197], v49 offset:12288
    ds_read_b64_tr_b16 a[198:199], v49 offset:12800
    ds_read_b64_tr_b16 a[200:201], v50 offset:12288
    ds_read_b64_tr_b16 a[202:203], v50 offset:12800
    ds_read_b64_tr_b16 a[204:205], v51 offset:12288
    ds_read_b64_tr_b16 a[206:207], v51 offset:12800
    s_waitcnt vmcnt(28) lgkmcnt(0)
    s_barrier
    s_mov_b32 s40, s74
    s_mov_b32 s41, s75
    s_mov_b32 s34, 128
    s_add_u32 m0, s36, 12288
    s_nop 0
    buffer_load_dwordx4 v32, s[40:43], s34 offen lds
    s_add_u32 m0, s36, 13312
    s_nop 0
    buffer_load_dwordx4 v33, s[40:43], s34 offen lds
    s_add_u32 m0, s36, 14336
    s_nop 0
    buffer_load_dwordx4 v34, s[40:43], s34 offen lds
    s_add_u32 m0, s36, 15360
    s_nop 0
    buffer_load_dwordx4 v35, s[40:43], s34 offen lds
    ds_read_b64_tr_b16 a[208:209], v48 offset:16384
    ds_read_b64_tr_b16 a[210:211], v48 offset:16896
    ds_read_b64_tr_b16 a[212:213], v49 offset:16384
    ds_read_b64_tr_b16 a[214:215], v49 offset:16896
    ds_read_b64_tr_b16 a[216:217], v50 offset:16384
    ds_read_b64_tr_b16 a[218:219], v50 offset:16896
    ds_read_b64_tr_b16 a[220:221], v51 offset:16384
    ds_read_b64_tr_b16 a[222:223], v51 offset:16896
    s_waitcnt vmcnt(28) lgkmcnt(0)
    s_barrier
    s_mov_b32 s34, 256
    s_add_u32 m0, s36, 16384
    s_nop 0
    buffer_load_dwordx4 v32, s[40:43], s34 offen lds
    s_add_u32 m0, s36, 17408
    s_nop 0
    buffer_load_dwordx4 v33, s[40:43], s34 offen lds
    s_add_u32 m0, s36, 18432
    s_nop 0
    buffer_load_dwordx4 v34, s[40:43], s34 offen lds
    s_add_u32 m0, s36, 19456
    s_nop 0
    buffer_load_dwordx4 v35, s[40:43], s34 offen lds
    ds_read_b64_tr_b16 a[224:225], v48 offset:20480
    ds_read_b64_tr_b16 a[226:227], v48 offset:20992
    ds_read_b64_tr_b16 a[228:229], v49 offset:20480
    ds_read_b64_tr_b16 a[230:231], v49 offset:20992
    ds_read_b64_tr_b16 a[232:233], v50 offset:20480
    ds_read_b64_tr_b16 a[234:235], v50 offset:20992
    ds_read_b64_tr_b16 a[236:237], v51 offset:20480
    ds_read_b64_tr_b16 a[238:239], v51 offset:20992
    s_waitcnt vmcnt(28) lgkmcnt(0)
    s_barrier
    s_mov_b32 s34, 384
    s_add_u32 m0, s36, 20480
    s_nop 0
    buffer_load_dwordx4 v32, s[40:43], s34 offen lds
    s_add_u32 m0, s36, 21504
    s_nop 0
    buffer_load_dwordx4 v33, s[40:43], s34 offen lds
    s_add_u32 m0, s36, 22528
    s_nop 0
    buffer_load_dwordx4 v34, s[40:43], s34 offen lds
    s_add_u32 m0, s36, 23552
    s_nop 0
    buffer_load_dwordx4 v35, s[40:43], s34 offen lds
    ds_read_b64_tr_b16 a[240:241], v48 offset:24576
    ds_read_b64_tr_b16 a[242:243], v48 offset:25088
    ds_read_b64_tr_b16 a[244:245], v49 offset:24576
    ds_read_b64_tr_b16 a[246:247], v49 offset:25088
    ds_read_b64_tr_b16 a[248:249], v50 offset:24576
    ds_read_b64_tr_b16 a[250:251], v50 offset:25088
    ds_read_b64_tr_b16 a[252:253], v51 offset:24576
    ds_read_b64_tr_b16 a[254:255], v51 offset:25088
    s_waitcnt vmcnt(28) lgkmcnt(0)
    s_barrier
    s_mov_b32 s34, 512
    s_add_u32 m0, s36, 24576
    s_nop 0
    buffer_load_dwordx4 v32, s[40:43], s34 offen lds
    s_add_u32 m0, s36, 25600
    s_nop 0
    buffer_load_dwordx4 v33, s[40:43], s34 offen lds
    s_add_u32 m0, s36, 26624
    s_nop 0
    buffer_load_dwordx4 v34, s[40:43], s34 offen lds
    s_add_u32 m0, s36, 27648
    s_nop 0
    buffer_load_dwordx4 v35, s[40:43], s34 offen lds
    ds_read_b64_tr_b16 v[80:81], v48 offset:28672
    ds_read_b64_tr_b16 v[82:83], v48 offset:29184
    ds_read_b64_tr_b16 v[84:85], v49 offset:28672
    ds_read_b64_tr_b16 v[86:87], v49 offset:29184
    ds_read_b64_tr_b16 v[88:89], v50 offset:28672
    ds_read_b64_tr_b16 v[90:91], v50 offset:29184
    ds_read_b64_tr_b16 v[92:93], v51 offset:28672
    ds_read_b64_tr_b16 v[94:95], v51 offset:29184
    s_waitcnt vmcnt(28) lgkmcnt(0)
    s_barrier
    s_mov_b32 s34, 640
    s_add_u32 m0, s36, 28672
    s_nop 0
    buffer_load_dwordx4 v32, s[40:43], s34 offen lds
    s_add_u32 m0, s36, 29696
    s_nop 0
    buffer_load_dwordx4 v33, s[40:43], s34 offen lds
    s_add_u32 m0, s36, 30720
    s_nop 0
    buffer_load_dwordx4 v34, s[40:43], s34 offen lds
    s_add_u32 m0, s36, 31744
    s_nop 0
    buffer_load_dwordx4 v35, s[40:43], s34 offen lds
    ds_read_b64_tr_b16 v[96:97], v48 offset:32768
    ds_read_b64_tr_b16 v[98:99], v48 offset:33280
    ds_read_b64_tr_b16 v[100:101], v49 offset:32768
    ds_read_b64_tr_b16 v[102:103], v49 offset:33280
    ds_read_b64_tr_b16 v[104:105], v50 offset:32768
    ds_read_b64_tr_b16 v[106:107], v50 offset:33280
    ds_read_b64_tr_b16 v[108:109], v51 offset:32768
    ds_read_b64_tr_b16 v[110:111], v51 offset:33280
    s_waitcnt vmcnt(28) lgkmcnt(0)
    s_barrier
    s_mov_b32 s34, 768
    s_add_u32 m0, s36, 32768
    s_nop 0
    buffer_load_dwordx4 v32, s[40:43], s34 offen lds
    s_add_u32 m0, s36, 33792
    s_nop 0
    buffer_load_dwordx4 v33, s[40:43], s34 offen lds
    s_add_u32 m0, s36, 34816
    s_nop 0
    buffer_load_dwordx4 v34, s[40:43], s34 offen lds
    s_add_u32 m0, s36, 35840
    s_nop 0
    buffer_load_dwordx4 v35, s[40:43], s34 offen lds
    ds_read_b64_tr_b16 v[112:113], v48 offset:0
    ds_read_b64_tr_b16 v[114:115], v48 offset:512
    ds_read_b64_tr_b16 v[116:117], v49 offset:0
    ds_read_b64_tr_b16 v[118:119], v49 offset:512
    ds_read_b64_tr_b16 v[120:121], v50 offset:0
    ds_read_b64_tr_b16 v[122:123], v50 offset:512
    ds_read_b64_tr_b16 v[124:125], v51 offset:0
    ds_read_b64_tr_b16 v[126:127], v51 offset:512
    s_waitcnt vmcnt(28) lgkmcnt(0)
    s_barrier
    v_mov_b32 v77, 0
    global_load_dwordx2 v[72:73], v77, s[86:87] offset:8 sc1
    global_load_dword v74, v77, s[86:87] offset:128 sc1
    s_mov_b32 s40, s68
    s_mov_b32 s41, s69
    s_mov_b32 s34, 0
    s_add_u32 m0, s36, 0
    s_nop 0
    buffer_load_dwordx4 v28, s[40:43], s34 offen lds
    s_add_u32 m0, s36, 1024
    s_nop 0
    buffer_load_dwordx4 v29, s[40:43], s34 offen lds
    s_add_u32 m0, s36, 2048
    s_nop 0
    buffer_load_dwordx4 v30, s[40:43], s34 offen lds
    s_add_u32 m0, s36, 3072
    s_nop 0
    buffer_load_dwordx4 v31, s[40:43], s34 offen lds
    ds_read_b64_tr_b16 v[128:129], v48 offset:4096
    ds_read_b64_tr_b16 v[130:131], v48 offset:4608
    ds_read_b64_tr_b16 v[132:133], v49 offset:4096
    ds_read_b64_tr_b16 v[134:135], v49 offset:4608
    ds_read_b64_tr_b16 v[136:137], v50 offset:4096
    ds_read_b64_tr_b16 v[138:139], v50 offset:4608
    ds_read_b64_tr_b16 v[140:141], v51 offset:4096
    ds_read_b64_tr_b16 v[142:143], v51 offset:4608
    s_waitcnt vmcnt(28) lgkmcnt(0)
    s_barrier
    s_mov_b32 s34, 1048576
    s_add_u32 m0, s36, 4096
    s_nop 0
    buffer_load_dwordx4 v28, s[40:43], s34 offen lds
    s_add_u32 m0, s36, 5120
    s_nop 0
    buffer_load_dwordx4 v29, s[40:43], s34 offen lds
    s_add_u32 m0, s36, 6144
    s_nop 0
    buffer_load_dwordx4 v30, s[40:43], s34 offen lds
    s_add_u32 m0, s36, 7168
    s_nop 0
    buffer_load_dwordx4 v31, s[40:43], s34 offen lds
    ds_read_b64_tr_b16 v[144:145], v48 offset:8192
    ds_read_b64_tr_b16 v[146:147], v48 offset:8704
    ds_read_b64_tr_b16 v[148:149], v49 offset:8192
    ds_read_b64_tr_b16 v[150:151], v49 offset:8704
    ds_read_b64_tr_b16 v[152:153], v50 offset:8192
    ds_read_b64_tr_b16 v[154:155], v50 offset:8704
    ds_read_b64_tr_b16 v[156:157], v51 offset:8192
    ds_read_b64_tr_b16 v[158:159], v51 offset:8704
    s_waitcnt vmcnt(28) lgkmcnt(0)
    s_barrier
    s_mov_b32 s40, s70
    s_mov_b32 s41, s71
    s_mov_b32 s34, 1572864
    s_add_u32 m0, s36, 8192
    s_nop 0
    buffer_load_dwordx4 v28, s[40:43], s34 offen lds
    s_add_u32 m0, s36, 9216
    s_nop 0
    buffer_load_dwordx4 v29, s[40:43], s34 offen lds
    s_add_u32 m0, s36, 10240
    s_nop 0
    buffer_load_dwordx4 v30, s[40:43], s34 offen lds
    s_add_u32 m0, s36, 11264
    s_nop 0
    buffer_load_dwordx4 v31, s[40:43], s34 offen lds
    ds_read_b64_tr_b16 v[160:161], v52 offset:12288
    ds_read_b64_tr_b16 v[162:163], v52 offset:12544
    ds_read_b64_tr_b16 v[164:165], v53 offset:12288
    ds_read_b64_tr_b16 v[166:167], v53 offset:12544
    ds_read_b64_tr_b16 v[168:169], v54 offset:12288
    ds_read_b64_tr_b16 v[170:171], v54 offset:12544
    ds_read_b64_tr_b16 v[172:173], v55 offset:12288
    ds_read_b64_tr_b16 v[174:175], v55 offset:12544
    s_waitcnt vmcnt(28) lgkmcnt(0)
    s_barrier
    s_mov_b32 s40, s68
    s_mov_b32 s41, s69
    s_mov_b32 s34, 3145728
    s_add_u32 m0, s36, 12288
    s_nop 0
    buffer_load_dwordx4 v28, s[40:43], s34 offen lds
    s_add_u32 m0, s36, 13312
    s_nop 0
    buffer_load_dwordx4 v29, s[40:43], s34 offen lds
    s_add_u32 m0, s36, 14336
    s_nop 0
    buffer_load_dwordx4 v30, s[40:43], s34 offen lds
    s_add_u32 m0, s36, 15360
    s_nop 0
    buffer_load_dwordx4 v31, s[40:43], s34 offen lds
    ds_read_b64_tr_b16 v[176:177], v52 offset:16384
    ds_read_b64_tr_b16 v[178:179], v52 offset:16640
    ds_read_b64_tr_b16 v[180:181], v53 offset:16384
    ds_read_b64_tr_b16 v[182:183], v53 offset:16640
    ds_read_b64_tr_b16 v[184:185], v54 offset:16384
    ds_read_b64_tr_b16 v[186:187], v54 offset:16640
    ds_read_b64_tr_b16 v[188:189], v55 offset:16384
    ds_read_b64_tr_b16 v[190:191], v55 offset:16640
    s_waitcnt vmcnt(28) lgkmcnt(0)
    s_barrier
    s_mov_b32 s40, s70
    s_mov_b32 s41, s71
    s_mov_b32 s34, 3145728
    s_add_u32 m0, s36, 16384
    s_nop 0
    buffer_load_dwordx4 v28, s[40:43], s34 offen lds
    s_add_u32 m0, s36, 17408
    s_nop 0
    buffer_load_dwordx4 v29, s[40:43], s34 offen lds
    s_add_u32 m0, s36, 18432
    s_nop 0
    buffer_load_dwordx4 v30, s[40:43], s34 offen lds
    s_add_u32 m0, s36, 19456
    s_nop 0
    buffer_load_dwordx4 v31, s[40:43], s34 offen lds
    ds_read_b64_tr_b16 v[192:193], v52 offset:20480
    ds_read_b64_tr_b16 v[194:195], v52 offset:20736
    ds_read_b64_tr_b16 v[196:197], v53 offset:20480
    ds_read_b64_tr_b16 v[198:199], v53 offset:20736
    ds_read_b64_tr_b16 v[200:201], v54 offset:20480
    ds_read_b64_tr_b16 v[202:203], v54 offset:20736
    ds_read_b64_tr_b16 v[204:205], v55 offset:20480
    ds_read_b64_tr_b16 v[206:207], v55 offset:20736
    s_waitcnt vmcnt(28) lgkmcnt(0)
    s_barrier
    s_mov_b32 s40, s72
    s_mov_b32 s41, s73
    s_mov_b32 s34, 4194304
    s_add_u32 m0, s36, 20480
    s_nop 0
    buffer_load_dwordx4 v28, s[40:43], s34 offen lds
    s_add_u32 m0, s36, 21504
    s_nop 0
    buffer_load_dwordx4 v29, s[40:43], s34 offen lds
    s_add_u32 m0, s36, 22528
    s_nop 0
    buffer_load_dwordx4 v30, s[40:43], s34 offen lds
    s_add_u32 m0, s36, 23552
    s_nop 0
    buffer_load_dwordx4 v31, s[40:43], s34 offen lds
    ds_read_b64_tr_b16 v[208:209], v52 offset:24576
    ds_read_b64_tr_b16 v[210:211], v52 offset:24832
    ds_read_b64_tr_b16 v[212:213], v53 offset:24576
    ds_read_b64_tr_b16 v[214:215], v53 offset:24832
    ds_read_b64_tr_b16 v[216:217], v54 offset:24576
    ds_read_b64_tr_b16 v[218:219], v54 offset:24832
    ds_read_b64_tr_b16 v[220:221], v55 offset:24576
    ds_read_b64_tr_b16 v[222:223], v55 offset:24832
    s_waitcnt vmcnt(28) lgkmcnt(0)
    s_barrier
    s_mov_b32 s40, s74
    s_mov_b32 s41, s75
    s_mov_b32 s34, 0
    s_add_u32 m0, s36, 24576
    s_nop 0
    buffer_load_dwordx4 v32, s[40:43], s34 offen lds
    s_add_u32 m0, s36, 25600
    s_nop 0
    buffer_load_dwordx4 v33, s[40:43], s34 offen lds
    s_add_u32 m0, s36, 26624
    s_nop 0
    buffer_load_dwordx4 v34, s[40:43], s34 offen lds
    s_add_u32 m0, s36, 27648
    s_nop 0
    buffer_load_dwordx4 v35, s[40:43], s34 offen lds
    ds_read_b64_tr_b16 v[224:225], v52 offset:28672
    ds_read_b64_tr_b16 v[226:227], v52 offset:28928
    ds_read_b64_tr_b16 v[228:229], v53 offset:28672
    ds_read_b64_tr_b16 v[230:231], v53 offset:28928
    ds_read_b64_tr_b16 v[232:233], v54 offset:28672
    ds_read_b64_tr_b16 v[234:235], v54 offset:28928
    ds_read_b64_tr_b16 v[236:237], v55 offset:28672
    ds_read_b64_tr_b16 v[238:239], v55 offset:28928
    s_waitcnt vmcnt(28) lgkmcnt(0)
    s_barrier
    s_mov_b32 s34, 1024
    s_add_u32 m0, s36, 28672
    s_nop 0
    buffer_load_dwordx4 v32, s[40:43], s34 offen lds
    s_add_u32 m0, s36, 29696
    s_nop 0
    buffer_load_dwordx4 v33, s[40:43], s34 offen lds
    s_add_u32 m0, s36, 30720
    s_nop 0
    buffer_load_dwordx4 v34, s[40:43], s34 offen lds
    s_add_u32 m0, s36, 31744
    s_nop 0
    buffer_load_dwordx4 v35, s[40:43], s34 offen lds
    ds_read_b64_tr_b16 v[240:241], v52 offset:32768
    ds_read_b64_tr_b16 v[242:243], v52 offset:33024
    ds_read_b64_tr_b16 v[244:245], v53 offset:32768
    ds_read_b64_tr_b16 v[246:247], v53 offset:33024
    ds_read_b64_tr_b16 v[248:249], v54 offset:32768
    ds_read_b64_tr_b16 v[250:251], v54 offset:33024
    ds_read_b64_tr_b16 v[252:253], v55 offset:32768
    ds_read_b64_tr_b16 v[254:255], v55 offset:33024
    s_waitcnt vmcnt(28) lgkmcnt(0)
    s_barrier
    s_getpc_b64 s[6:7]
L_team_pc:
    s_add_u32 s6, s6, L_loop_f_w0-L_team_pc
    s_addc_u32 s7, s7, 0
    v_lshlrev_b32 v76, 7, v0
    v_min_u32 v76, L_loop_s_w0-L_loop_f_w0, v76
    global_load_dword v76, v76, s[6:7]
    v_lshlrev_b32 v77, 7, v0
    s_mov_b32 s34, 327680
    buffer_load_dword v78, v77, s[12:15], s34 offen sc1
    buffer_load_dword v75, off, s[12:15], s8 sc1
    v_lshlrev_b32 v77, 6, v0
    s_lshl_b32 s34, s21, 14
    buffer_load_dword v78, v77, s[16:19], s34 offen
    s_mov_b32 s34, 896
    s_add_u32 m0, s36, 32768
    s_nop 0
    buffer_load_dwordx4 v32, s[40:43], s34 offen lds
    s_add_u32 m0, s36, 33792
    s_nop 0
    buffer_load_dwordx4 v33, s[40:43], s34 offen lds
    s_add_u32 m0, s36, 34816
    s_nop 0
    buffer_load_dwordx4 v34, s[40:43], s34 offen lds
    s_add_u32 m0, s36, 35840
    s_nop 0
    buffer_load_dwordx4 v35, s[40:43], s34 offen lds
    ds_read_b64_tr_b16 v[8:9], v48 offset:0
    ds_read_b64_tr_b16 v[10:11], v48 offset:512
    ds_read_b64_tr_b16 v[12:13], v49 offset:0
    ds_read_b64_tr_b16 v[14:15], v49 offset:512
    ds_read_b64_tr_b16 v[16:17], v50 offset:0
    ds_read_b64_tr_b16 v[18:19], v50 offset:512
    ds_read_b64_tr_b16 v[20:21], v51 offset:0
    ds_read_b64_tr_b16 v[22:23], v51 offset:512
    s_waitcnt vmcnt(28) lgkmcnt(0)
    s_barrier
    ds_write_b128 v1, v[8:11] offset:0
    ds_write_b128 v1, v[12:15] offset:1024
    ds_write_b128 v1, v[16:19] offset:2048
    ds_write_b128 v1, v[20:23] offset:3072
    ds_read_b64_tr_b16 v[56:57], v48 offset:4096
    ds_read_b64_tr_b16 v[58:59], v48 offset:4608
    ds_read_b64_tr_b16 v[60:61], v49 offset:4096
    ds_read_b64_tr_b16 v[62:63], v49 offset:4608
    ds_read_b64_tr_b16 v[64:65], v50 offset:4096
    ds_read_b64_tr_b16 v[66:67], v50 offset:4608
    ds_read_b64_tr_b16 v[68:69], v51 offset:4096
    ds_read_b64_tr_b16 v[70:71], v51 offset:4608
    s_waitcnt vmcnt(24) lgkmcnt(0)
    s_barrier
    ds_write_b128 v1, v[56:59] offset:4096
    ds_write_b128 v1, v[60:63] offset:5120
    ds_write_b128 v1, v[64:67] offset:6144
    ds_write_b128 v1, v[68:71] offset:7168
    ds_read_b64_tr_b16 v[8:9], v48 offset:8192
    ds_read_b64_tr_b16 v[10:11], v48 offset:8704
    ds_read_b64_tr_b16 v[12:13], v49 offset:8192
    ds_read_b64_tr_b16 v[14:15], v49 offset:8704
    ds_read_b64_tr_b16 v[16:17], v50 offset:8192
    ds_read_b64_tr_b16 v[18:19], v50 offset:8704
    ds_read_b64_tr_b16 v[20:21], v51 offset:8192
    ds_read_b64_tr_b16 v[22:23], v51 offset:8704
    s_waitcnt vmcnt(20) lgkmcnt(0)
    s_barrier
    ds_write_b128 v1, v[8:11] offset:8192
    ds_write_b128 v1, v[12:15] offset:9216
    ds_write_b128 v1, v[16:19] offset:10240
    ds_write_b128 v1, v[20:23] offset:11264
    ds_read_b64_tr_b16 v[56:57], v48 offset:12288
    ds_read_b64_tr_b16 v[58:59], v48 offset:12800
    ds_read_b64_tr_b16 v[60:61], v49 offset:12288
    ds_read_b64_tr_b16 v[62:63], v49 offset:12800
    ds_read_b64_tr_b16 v[64:65], v50 offset:12288
    ds_read_b64_tr_b16 v[66:67], v50 offset:12800
    ds_read_b64_tr_b16 v[68:69], v51 offset:12288
    ds_read_b64_tr_b16 v[70:71], v51 offset:12800
    s_waitcnt vmcnt(16) lgkmcnt(0)
    s_barrier
    ds_write_b128 v1, v[56:59] offset:12288
    ds_write_b128 v1, v[60:63] offset:13312
    ds_write_b128 v1, v[64:67] offset:14336
    ds_write_b128 v1, v[68:71] offset:15360
    ds_read_b64_tr_b16 v[8:9], v48 offset:16384
    ds_read_b64_tr_b16 v[10:11], v48 offset:16896
    ds_read_b64_tr_b16 v[12:13], v49 offset:16384
    ds_read_b64_tr_b16 v[14:15], v49 offset:16896
    ds_read_b64_tr_b16 v[16:17], v50 offset:16384
    ds_read_b64_tr_b16 v[18:19], v50 offset:16896
    ds_read_b64_tr_b16 v[20:21], v51 offset:16384
    ds_read_b64_tr_b16 v[22:23], v51 offset:16896
    s_waitcnt vmcnt(12) lgkmcnt(0)
    s_barrier
    ds_write_b128 v1, v[8:11] offset:16384
    ds_write_b128 v1, v[12:15] offset:17408
    ds_write_b128 v1, v[16:19] offset:18432
    ds_write_b128 v1, v[20:23] offset:19456
    ds_read_b64_tr_b16 v[56:57], v48 offset:20480
    ds_read_b64_tr_b16 v[58:59], v48 offset:20992
    ds_read_b64_tr_b16 v[60:61], v49 offset:20480
    ds_read_b64_tr_b16 v[62:63], v49 offset:20992
    ds_read_b64_tr_b16 v[64:65], v50 offset:20480
    ds_read_b64_tr_b16 v[66:67], v50 offset:20992
    ds_read_b64_tr_b16 v[68:69], v51 offset:20480
    ds_read_b64_tr_b16 v[70:71], v51 offset:20992
    s_waitcnt vmcnt(8) lgkmcnt(0)
    s_barrier
    ds_write_b128 v1, v[56:59] offset:20480
    ds_write_b128 v1, v[60:63] offset:21504
    ds_write_b128 v1, v[64:67] offset:22528
    ds_write_b128 v1, v[68:71] offset:23552
    ds_read_b64_tr_b16 v[8:9], v52 offset:24576
    ds_read_b64_tr_b16 v[10:11], v52 offset:24832
    ds_read_b64_tr_b16 v[12:13], v53 offset:24576
    ds_read_b64_tr_b16 v[14:15], v53 offset:24832
    ds_read_b64_tr_b16 v[16:17], v54 offset:24576
    ds_read_b64_tr_b16 v[18:19], v54 offset:24832
    ds_read_b64_tr_b16 v[20:21], v55 offset:24576
    ds_read_b64_tr_b16 v[22:23], v55 offset:24832
    s_waitcnt vmcnt(4) lgkmcnt(0)
    s_barrier
    ds_write_b128 v1, v[8:11] offset:24576
    ds_write_b128 v1, v[12:15] offset:25600
    ds_write_b128 v1, v[16:19] offset:26624
    ds_write_b128 v1, v[20:23] offset:27648
    ds_read_b64_tr_b16 v[56:57], v52 offset:28672
    ds_read_b64_tr_b16 v[58:59], v52 offset:28928
    ds_read_b64_tr_b16 v[60:61], v53 offset:28672
    ds_read_b64_tr_b16 v[62:63], v53 offset:28928
    ds_read_b64_tr_b16 v[64:65], v54 offset:28672
    ds_read_b64_tr_b16 v[66:67], v54 offset:28928
    ds_read_b64_tr_b16 v[68:69], v55 offset:28672
    ds_read_b64_tr_b16 v[70:71], v55 offset:28928
    s_waitcnt vmcnt(0) lgkmcnt(0)
    s_barrier
    ds_write_b128 v1, v[56:59] offset:28672
    ds_write_b128 v1, v[60:63] offset:29696
    ds_write_b128 v1, v[64:67] offset:30720
    ds_write_b128 v1, v[68:71] offset:31744
    ds_read_b64_tr_b16 v[8:9], v52 offset:32768
    ds_read_b64_tr_b16 v[10:11], v52 offset:33024
    ds_read_b64_tr_b16 v[12:13], v53 offset:32768
    ds_read_b64_tr_b16 v[14:15], v53 offset:33024
    ds_read_b64_tr_b16 v[16:17], v54 offset:32768
    ds_read_b64_tr_b16 v[18:19], v54 offset:33024
    ds_read_b64_tr_b16 v[20:21], v55 offset:32768
    ds_read_b64_tr_b16 v[22:23], v55 offset:33024
    s_waitcnt lgkmcnt(0)
    s_barrier
    ds_write_b128 v1, v[8:11] offset:32768
    ds_write_b128 v1, v[12:15] offset:33792
    ds_write_b128 v1, v[16:19] offset:34816
    ds_write_b128 v1, v[20:23] offset:35840
    s_waitcnt lgkmcnt(0)
    v_and_b32 v24, 63, v0
    v_lshlrev_b32 v0, 4, v24
    v_and_b32 v25, 1, v24
    v_mov_b32 v2, 0x4444
    v_mov_b32 v26, 0xeeee
    v_cmp_eq_u32 vcc, 1, v25
    s_nop 1
    v_cndmask_b32 v2, v2, v26, vcc
    v_bfe_u32 v26, v24, 2, 2
    v_lshrrev_b32 v27, 4, v24
    v_cmp_eq_u32 vcc, v26, v27
    v_mov_b32 v28, 0x3f803f80
    s_nop 0
    v_cndmask_b32 v28, 0, v28, vcc
    v_cmp_eq_u32 vcc, 1, v25
    s_nop 1
    v_cndmask_b32 v4, v28, 0, vcc
    v_cndmask_b32 v5, 0, v28, vcc
    v_and_b32 v6, 0xffffffdf, v0
    v_lshlrev_b32 v28, 6, v26
    v_lshl_add_u32 v28, v25, 5, v28
    v_bfe_u32 v29, v24, 4, 1
    v_lshl_add_u32 v28, v29, 4, v28
    v_bfe_u32 v29, v24, 5, 1
    v_lshl_add_u32 v28, v29, 8, v28
    s_lshl_b32 s34, s20, 9
    s_add_u32 s34, s34, 14336
    v_add_u32 v29, s34, v28
    v_add_u32 v28, 163840, v28
    v_bfe_u32 v30, v24, 1, 1
    v_cmp_eq_u32 vcc, 1, v30
    s_nop 1
    v_cndmask_b32 v7, v29, v28, vcc
    v_lshrrev_b32 v26, 7, v0
    v_lshlrev_b32 v26, 11, v26
    v_and_b32 v27, 127, v0
    v_add_u32 v3, v26, v27
    s_cmp_eq_u32 s20, 3
    s_cbranch_scc0 L_tc2
    v_add_u32 v3, s33, v0
L_tc2:
    s_mov_b32 s11, 355328
    s_mov_b32 s2, 0x3f803f80
    s_mov_b32 s3, 0x3f803f80
    s_mov_b32 s0, 0x3f80
    s_mov_b32 s1, 0x3f80
    s_mov_b32 s38, 1602224128
    s_mov_b32 s39, 0x3f803f80
    s_mov_b32 s56, 0x55555555
    s_mov_b32 s57, 0x55555555
    s_mov_b32 s58, 0xcccccccc
    s_mov_b32 s59, 0xcccccccc
L_team_go:
    s_lshl_b32 s34, s20, 5
    s_add_u32 s34, s34, s21
    s_add_u32 s34, s34, 355584
    s_add_u32 s40, s88, s34
    s_addc_u32 s41, s89, 0
    s_mov_b32 s42, 4
    s_mov_b32 s43, 0x20000
    s_lshr_b32 s35, s20, 1
    s_lshl_b32 s35, s35, 7
    s_lshl_b32 s34, s21, 2
    s_add_u32 s34, s34, s35
    s_add_u32 s34, s34, 355328
    s_add_u32 s52, s88, s34
    s_addc_u32 s53, s89, 0
    s_mov_b32 s54, 4
    s_mov_b32 s55, 0x20000
    s_mul_i32 s34, s20, 36864
    s_add_u32 s34, s34, 16384
    v_add_u32 v1, s34, v0
    ds_read_b128 v[8:11], v1 offset:0
    ds_read_b128 v[12:15], v1 offset:1024
    ds_read_b128 v[16:19], v1 offset:2048
    ds_read_b128 v[20:23], v1 offset:3072
    s_waitcnt vmcnt(0)
    v_min_u32 v73, 32, v73
    v_min_u32 v74, 224, v74
    v_add_u32 v73, v73, v74
    v_cmp_gt_u32 vcc, 256, v73
    s_nop 0
    s_cbranch_vccnz L_tg3w
    v_cmp_le_u32 vcc, s25, v75
    s_nop 0
    s_cbranch_vccz L_tg3x
    s_mov_b32 s5, 63
    s_branch L_tg3x
L_tg3w:
L_i4:
    v_mov_b32 v26, 0
    global_load_dword v27, v26, s[86:87] offset:12 sc1
    global_load_dword v26, v26, s[86:87] offset:128 sc1
    s_add_u32 s37, s37, 1
    s_waitcnt vmcnt(0)
    v_min_u32 v27, 32, v27
    v_min_u32 v26, 224, v26
    v_add_u32 v27, v27, v26
    v_cmp_gt_u32 vcc, 256, v27
    s_nop 0
    s_cbranch_vccz L_i4_d
    s_sleep 4
    s_cmp_lt_u32 s37, 400000
    s_cbranch_scc1 L_i4
L_i4_d:
    v_mov_b32 v26, 12
L_tw5:
    global_load_dword v27, v26, s[86:87] sc1
    s_add_u32 s37, s37, 1
    s_cmp_gt_u32 s37, 400000
    s_waitcnt vmcnt(0)
    s_cbranch_scc1 L_tw5_d
    v_cmp_gt_u32 vcc, s10, v27
    s_nop 0
    s_cbranch_vccnz L_tw5
L_tw5_d:
    v_lshlrev_b32 v28, 3, v0
    s_lshl_b32 s34, s20, 13
    s_add_u32 s34, s34, 327680
    buffer_load_dword v28, v28, s[12:15], s34 offen sc1
    v_mov_b32 v26, 8
    global_load_dword v72, v26, s[86:87] sc1
    s_waitcnt vmcnt(0)
L_tg3x:
    v_cmp_ne_u32 vcc, 0, v72
    v_mov_b64 v[48:49], 0
    v_mov_b64 v[50:51], 0
    v_mov_b64 v[52:53], 0
    v_mov_b64 v[54:55], 0
    v_mov_b64 v[56:57], 0
    v_mov_b64 v[58:59], 0
    v_mov_b64 v[60:61], 0
    v_mov_b64 v[62:63], 0
    s_waitcnt vmcnt(0) lgkmcnt(0)
    s_cbranch_vccnz L_tg3
    s_cmp_eq_u32 s20, 1
    s_cbranch_scc1 L_loop_f_w1
    s_cmp_eq_u32 s20, 2
    s_cbranch_scc1 L_loop_f_w2
    s_cmp_eq_u32 s20, 3
    s_cbranch_scc1 L_loop_f_w3
    v_mov_b32 v1, -1
    s_branch L_loop_f_w0
L_tg3:
    s_cmp_eq_u32 s20, 1
    s_cbranch_scc1 L_loop_s_w1
    s_cmp_eq_u32 s20, 2
    s_cbranch_scc1 L_loop_s_w2
    s_cmp_eq_u32 s20, 3
    s_cbranch_scc1 L_loop_s_w3
    v_mov_b32 v1, -1
    s_branch L_loop_s_w0
.p2align 6
L_loop_f_w0:
    s_add_u32 s31, s31, 524288
    v_cmp_gt_u32 vcc, s25, v1
    s_nop 0
    s_cbranch_vccnz L_kw_f_w0
L_kw_f_w0_ok:
    s_add_u32 s8, s8, 4096
    s_sub_u32 s34, s8, 12288
    s_cmp_ge_u32 s34, 397312
    s_cselect_b32 s8, s34, s8
    s_mov_b32 m0, 4096
    s_add_u32 s34, s29, 4096
    s_waitcnt lgkmcnt(0)
    s_barrier
L_pa_f_w0:
    ds_read_b128 v[24:27], v0 offset:0
    ds_read_b128 v[28:31], v0 offset:1024
    buffer_load_dwordx4 v0, s[12:15], s34 offen sc1 lds
    s_waitcnt lgkmcnt(1)
    v_smfmac_f32_16x16x64_bf16 v[48:51], v[24:27], v[8:15], v2
    ds_read_b128 v[8:11], v0 offset:20480
    v_smfmac_f32_16x16x64_bf16 v[52:55], v[24:27], v[16:23], v2
    ds_read_b128 v[12:15], v0 offset:21504
    buffer_load_dwordx4 v[64:67], v0, s[16:19], s31 offen offset:0 sc1
    v_smfmac_f32_16x16x64_bf16 v[56:59], v[24:27], a[0:7], v2
    ds_read_b128 v[16:19], v0 offset:22528
    v_smfmac_f32_16x16x64_bf16 v[60:63], v[24:27], a[8:15], v2
    ds_read_b128 v[20:23], v0 offset:23552
    s_barrier
    s_waitcnt lgkmcnt(4)
    v_smfmac_f32_16x16x64_bf16 v[48:51], v[28:31], a[16:23], v2
    ds_read_b128 v[32:35], v0 offset:2048
    v_smfmac_f32_16x16x64_bf16 v[52:55], v[28:31], a[24:31], v2
    buffer_load_dwordx4 v[68:71], v0, s[16:19], s31 offen offset:1024 sc1
    v_smfmac_f32_16x16x64_bf16 v[56:59], v[28:31], a[32:39], v2
    ds_read_b128 v[36:39], v0 offset:3072
    v_smfmac_f32_16x16x64_bf16 v[60:63], v[28:31], a[40:47], v2
    ds_read_b128 v[24:27], v0 offset:8192
    s_waitcnt lgkmcnt(2)
    v_smfmac_f32_16x16x64_bf16 v[48:51], v[32:35], v[8:15], v2
    ds_read_b128 v[8:11], v0 offset:24576
    v_smfmac_f32_16x16x64_bf16 v[52:55], v[32:35], v[16:23], v2
    ds_read_b128 v[12:15], v0 offset:25600
    buffer_load_dwordx4 v[40:43], v0, s[16:19], s31 offen offset:2048 sc1
    v_smfmac_f32_16x16x64_bf16 v[56:59], v[32:35], a[48:55], v2
    ds_read_b128 v[16:19], v0 offset:26624
    v_smfmac_f32_16x16x64_bf16 v[60:63], v[32:35], a[56:63], v2
    ds_read_b128 v[20:23], v0 offset:27648
    s_waitcnt lgkmcnt(5)
    v_smfmac_f32_16x16x64_bf16 v[48:51], v[36:39], a[64:71], v2
    v_smfmac_f32_16x16x64_bf16 v[52:55], v[36:39], a[72:79], v2
    buffer_load_dwordx4 v[44:47], v0, s[16:19], s31 offen offset:3072 sc1
    s_waitcnt lgkmcnt(2)
    v_smfmac_f32_16x16x64_bf16 v[56:59], v[36:39], v[8:15], v2
    ds_read_b128 v[8:11], v0 offset:28672
    s_waitcnt lgkmcnt(1)
    v_smfmac_f32_16x16x64_bf16 v[60:63], v[36:39], v[16:23], v2
    ds_read_b128 v[12:15], v0 offset:29696
    s_waitcnt vmcnt(4)
    s_barrier
    v_smfmac_f32_16x16x64_bf16 v[48:51], v[24:27], a[80:87], v2
    ds_read_b128 v[28:31], v0 offset:4096
    v_smfmac_f32_16x16x64_bf16 v[52:55], v[24:27], a[88:95], v2
    ds_read_b128 v[16:19], v0 offset:30720
    s_add_u32 s35, s31, 524288
    v_lshlrev_b32 v1, 3, v0
    v_smfmac_f32_16x16x64_bf16 v[56:59], v[24:27], a[96:103], v2
    ds_read_b128 v[32:35], v0 offset:5120
    buffer_load_dword v1, v1, s[16:19], s35 offen
    v_smfmac_f32_16x16x64_bf16 v[60:63], v[24:27], a[104:111], v2
    ds_read_b128 v[20:23], v0 offset:31744
    s_add_u32 s35, s35, 8192
    s_waitcnt lgkmcnt(3)
    v_smfmac_f32_16x16x64_bf16 v[48:51], v[28:31], a[112:119], v2
    ds_read_b128 v[36:39], v0 offset:6144
    buffer_load_dword v1, v1, s[16:19], s35 offen
    v_smfmac_f32_16x16x64_bf16 v[52:55], v[28:31], a[120:127], v2
    s_waitcnt lgkmcnt(2)
    v_smfmac_f32_16x16x64_bf16 v[48:51], v[32:35], a[128:135], v2
    ds_read_b128 v[24:27], v0 offset:7168
    buffer_load_dword v1, off, s[12:15], s8 sc1
    v_smfmac_f32_16x16x64_bf16 v[52:55], v[32:35], a[136:143], v2
    s_waitcnt lgkmcnt(1)
    v_smfmac_f32_16x16x64_bf16 v[48:51], v[36:39], v[8:15], v2
    ds_read_b128 v[8:11], v0 offset:32768
    v_smfmac_f32_16x16x64_bf16 v[52:55], v[36:39], v[16:23], v2
    ds_read_b128 v[12:15], v0 offset:33792
    s_waitcnt lgkmcnt(2)
    v_smfmac_f32_16x16x64_bf16 v[48:51], v[24:27], a[144:151], v2
    ds_read_b128 v[16:19], v0 offset:34816
    v_smfmac_f32_16x16x64_bf16 v[52:55], v[24:27], a[152:159], v2
    ds_read_b128 v[20:23], v0 offset:35840
    v_smfmac_f32_16x16x64_bf16 v[56:59], v[28:31], a[160:167], v2
    v_cvt_pk_bf16_f32 v72, v48, v49
    v_smfmac_f32_16x16x64_bf16 v[60:63], v[28:31], a[168:175], v2
    v_cvt_pk_bf16_f32 v73, v50, v51
    v_smfmac_f32_16x16x64_bf16 v[56:59], v[32:35], a[176:183], v2
    v_cvt_pk_bf16_f32 v74, v52, v53
    v_mfma_f32_16x16x16_bf16 v[48:51], v[72:73], v[4:5], 0
    s_waitcnt lgkmcnt(0)
    v_cvt_pk_bf16_f32 v75, v54, v55
    v_smfmac_f32_16x16x64_bf16 v[60:63], v[32:35], a[184:191], v2
    s_cmp_eq_u32 s22, s5
    s_cselect_b64 s[6:7], -1, 0
    v_mfma_f32_16x16x16_bf16 v[52:55], v[74:75], v[4:5], 0
    s_waitcnt vmcnt(5)
    v_cvt_pk_bf16_f32 v76, v48, v49
    v_cvt_pk_bf16_f32 v77, v50, v51
    v_smfmac_f32_16x16x64_bf16 v[56:59], v[36:39], v[8:15], v2
    ds_read_b128 v[8:11], v0 offset:36864
    v_cmp_u_f32 vcc, v48, v48
    v_smfmac_f32_16x16x64_bf16 v[60:63], v[36:39], v[16:23], v2
    ds_read_b128 v[12:15], v0 offset:37888
    v_cvt_pk_bf16_f32 v78, v52, v53
    v_smfmac_f32_16x16x64_bf16 v[56:59], v[24:27], a[192:199], v2
    ds_read_b128 v[16:19], v0 offset:38912
    s_or_b64 vcc, vcc, s[6:7]
    v_cvt_pk_bf16_f32 v79, v54, v55
    v_smfmac_f32_16x16x64_bf16 v[60:63], v[24:27], a[200:207], v2
    ds_read_b128 v[20:23], v0 offset:39936
    s_cbranch_scc1 L_redo_f_w0
L_xsb_f_w0:
    v_mov_b64 v[48:49], 0
    v_mfma_f32_16x16x32_bf16 v[64:67], v[64:67], v[76:79], 0
    v_cvt_pk_bf16_f32 v72, v56, v57
    v_cvt_pk_bf16_f32 v73, v58, v59
    v_mfma_f32_16x16x32_bf16 v[68:71], v[68:71], v[76:79], 0
    v_cvt_pk_bf16_f32 v74, v60, v61
    v_cvt_pk_bf16_f32 v75, v62, v63
    v_mfma_f32_16x16x16_bf16 v[56:59], v[72:73], v[4:5], 0
    s_mov_b32 s30, s29
    v_mov_b64 v[50:51], 0
    v_mov_b64 v[52:53], 0
    v_mfma_f32_16x16x16_bf16 v[60:63], v[74:75], v[4:5], 0
    s_add_u32 s29, s29, 9216
    v_mov_b64 v[54:55], 0
    v_cndmask_b32 v64, v64, v68, s[58:59]
    v_smfmac_f32_16x16x64_bf16 v[48:51], v[28:31], a[208:215], v2
    s_add_u32 s22, s22, 1
    s_add_u32 s23, s23, 1
    v_cvt_pk_bf16_f32 v72, v56, v57
    v_cvt_pk_bf16_f32 v73, v58, v59
    v_cvt_pk_bf16_f32 v74, v60, v61
    v_cvt_pk_bf16_f32 v75, v62, v63
    v_smfmac_f32_16x16x64_bf16 v[52:55], v[28:31], a[216:223], v2
    ds_read_b128 v[28:31], v0 offset:0
    s_add_u32 s25, s25, 1
    v_cndmask_b32 v65, v65, v69, s[58:59]
    v_mfma_f32_16x16x32_bf16 v[56:59], v[72:75], v[76:79], 0
    s_cmp_eq_u32 s29, 355328
    v_cndmask_b32 v66, v66, v70, s[58:59]
    v_cndmask_b32 v67, v67, v71, s[58:59]
    v_smfmac_f32_16x16x64_bf16 v[48:51], v[32:35], a[224:231], v2
    ds_write_b128 v0, v[64:67] offset:9216
    s_cselect_b32 s29, 327680, s29
    v_smfmac_f32_16x16x64_bf16 v[52:55], v[32:35], a[232:239], v2
    ds_read_b128 v[32:35], v0 offset:1024
    v_smfmac_f32_16x16x64_bf16 v[48:51], v[36:39], a[240:247], v2
    ds_write_b64 v6, v[56:57] offset:13312
    v_smfmac_f32_16x16x64_bf16 v[52:55], v[36:39], a[248:255], v2
    ds_read_b128 v[36:39], v0 offset:2048
    v_smfmac_f32_16x16x64_bf16 v[48:51], v[24:27], v[80:87], v2
    v_smfmac_f32_16x16x64_bf16 v[52:55], v[24:27], v[88:95], v2
    ds_read_b128 v[24:27], v0 offset:3072
    s_waitcnt lgkmcnt(5)
    v_smfmac_f32_16x16x64_bf16 v[48:51], v[28:31], v[96:103], v2
    s_waitcnt lgkmcnt(2)
    s_barrier
    ds_read_b128 v[60:63], v0 offset:10240
    v_smfmac_f32_16x16x64_bf16 v[52:55], v[28:31], v[104:111], v2
    ds_read_b128 v[72:75], v0 offset:11264
    v_smfmac_f32_16x16x64_bf16 v[48:51], v[32:35], v[112:119], v2
    ds_read_b128 v[76:79], v0 offset:12288
    v_smfmac_f32_16x16x64_bf16 v[52:55], v[32:35], v[120:127], v2
    ds_read_b128 v[28:31], v0 offset:8192
    s_waitcnt lgkmcnt(5)
    v_smfmac_f32_16x16x64_bf16 v[48:51], v[36:39], v[128:135], v2
    ds_read_b128 v[68:71], v6 offset:13312
    v_mov_b64 v[32:33], s[2:3]
    v_smfmac_f32_16x16x64_bf16 v[52:55], v[36:39], v[136:143], v2
    ds_read_b128 v[56:59], v6 offset:13344
    v_mov_b64 v[34:35], s[2:3]
    s_waitcnt lgkmcnt(6)
    v_smfmac_f32_16x16x64_bf16 v[48:51], v[24:27], v[144:151], v2
    v_mov_b64 v[36:37], s[0:1]
    v_smfmac_f32_16x16x64_bf16 v[52:55], v[24:27], v[152:159], v2
    s_waitcnt lgkmcnt(5)
    v_add_f32 v64, v64, v60
    s_waitcnt lgkmcnt(2)
    v_smfmac_f32_16x16x64_bf16 v[48:51], v[28:31], v[8:15], v2
    ds_read_b128 v[8:11], v0 offset:40960
    v_add_f32 v65, v65, v61
    v_smfmac_f32_16x16x64_bf16 v[52:55], v[28:31], v[16:23], v2
    ds_read_b128 v[12:15], v0 offset:41984
    v_add_f32 v66, v66, v62
    v_add_f32 v67, v67, v63
    v_pk_add_f32 v[72:73], v[72:73], v[76:77]
    v_pk_add_f32 v[74:75], v[74:75], v[78:79]
    v_pk_add_f32 v[64:65], v[64:65], v[72:73]
    v_pk_add_f32 v[66:67], v[66:67], v[74:75]
    s_waitcnt lgkmcnt(2)
    v_pk_add_f32 v[68:69], v[68:69], v[56:57]
    v_pk_add_f32 v[70:71], v[70:71], v[58:59]
    v_pk_add_f32 v[68:69], v[68:69], v[70:71]
    v_pk_mul_f32 v[68:69], v[68:69], s[32:33] op_sel_hi:[1,0]
    v_exp_f32 v64, v64
    v_exp_f32 v65, v65
    v_exp_f32 v66, v66
    v_exp_f32 v67, v67
    v_exp_f32 v68, v68
    v_exp_f32 v69, v69
L_maxback_f_w0:
    v_cvt_pk_bf16_f32 v72, v64, v65
    v_cvt_pk_bf16_f32 v73, v66, v67
    v_cvt_pk_bf16_f32 v76, v68, v68
    v_mov_b32_dpp v74, v72 quad_perm:[2,3,0,1] row_mask:0xf bank_mask:0xf
    v_mov_b32_dpp v75, v73 quad_perm:[2,3,0,1] row_mask:0xf bank_mask:0xf
    v_cvt_pk_bf16_f32 v77, v69, v69
    v_cvt_pk_bf16_f32 v24, v48, v49
    v_mfma_f32_16x16x32_bf16 v[28:31], v[32:35], v[72:75], 0
    s_waitcnt vmcnt(3)
    v_cvt_pk_bf16_f32 v25, v50, v51
    v_cvt_pk_bf16_f32 v26, v52, v53
    v_mfma_f32_16x16x32_bf16 v[56:59], v[40:43], v[72:75], 0
    ds_read_b128 v[16:19], v0 offset:43008
    v_cvt_pk_bf16_f32 v27, v54, v55
    v_mfma_f32_16x16x16_bf16 v[28:31], v[36:37], v[76:77], v[28:31]
    ds_read_b128 v[20:23], v0 offset:44032
    v_mfma_f32_16x16x32_bf16 v[68:71], v[44:47], v[72:75], 0
    v_mfma_f32_16x16x16_bf16 v[56:59], v[24:25], v[76:77], v[56:59]
    v_rcp_f32 v30, v28
    v_mfma_f32_16x16x16_bf16 v[68:71], v[26:27], v[76:77], v[68:71]
    v_max_f32 v28, v28, v30
    v_cmp_ngt_f32 vcc, s38, v28
    v_mov_b64 v[38:39], 0
    v_mov_b32 v78, s23
    v_pk_mul_f32 v[56:57], v[56:57], v[30:31] op_sel_hi:[1,0]
    v_pk_mul_f32 v[58:59], v[58:59], v[30:31] op_sel_hi:[1,0]
    v_cvt_pk_bf16_f32 v64, v56, v57
    v_cvt_pk_bf16_f32 v65, v58, v59
    v_pk_mul_f32 v[68:69], v[68:69], v[30:31] op_sel_hi:[1,0]
    v_pk_mul_f32 v[70:71], v[70:71], v[30:31] op_sel_hi:[1,0]
    s_cbranch_vccnz L_max_f_w0
L_maxskip_f_w0:
    v_cvt_pk_bf16_f32 v66, v68, v69
    v_cvt_pk_bf16_f32 v67, v70, v71
    v_mfma_f32_16x16x16_bf16 v[48:51], v[38:39], v[38:39], 0
    ds_write_b128 v7, v[64:67]
    v_mov_b64 v[34:35], 0
    v_mov_b64 v[36:37], 0
    v_mov_b64 v[40:41], 0
    v_mov_b64 v[42:43], 0
    v_mov_b64 v[44:45], 0
    v_mov_b64 v[46:47], 0
    v_mov_b64 v[56:57], 0
    v_mov_b64 v[58:59], 0
    v_mov_b64 v[24:25], 0
    v_mov_b64 v[26:27], 0
    v_mov_b64 v[28:29], 0
    v_mov_b64 v[30:31], 0
    v_mfma_f32_16x16x16_bf16 v[52:55], v[38:39], v[38:39], 0
    s_waitcnt lgkmcnt(0)
    s_barrier
    ds_read_b128 v[64:67], v0 offset:14336
    v_mov_b32 v32, 0
    ds_read_b128 v[68:71], v0 offset:15360
    v_mov_b32 v33, 0
    v_cndmask_b32 v62, 0, 1, s[56:57]
    v_lshrrev_b32 v63, 1, v0
    s_waitcnt lgkmcnt(1)
    v_smfmac_f32_16x16x64_bf16 v[24:27], v[64:67], v[8:15], v2
    ds_read_b128 v[8:11], v0 offset:45056
    s_waitcnt lgkmcnt(1)
    v_smfmac_f32_16x16x64_bf16 v[24:27], v[68:71], v[16:23], v2
    ds_read_b128 v[12:15], v0 offset:46080
    v_smfmac_f32_16x16x64_bf16 v[28:31], v[64:67], v[160:167], v2
    ds_read_b128 v[16:19], v0 offset:47104
    v_smfmac_f32_16x16x64_bf16 v[28:31], v[68:71], v[168:175], v2
    ds_read_b128 v[20:23], v0 offset:48128
    v_add_f32 v24, v24, v25
    v_add_f32 v26, v26, v27
    v_smfmac_f32_16x16x64_bf16 v[32:35], v[64:67], v[176:183], v2
    v_cvt_pk_bf16_f32 v24, v24, v26
    v_bfi_b32 v72, v62, s23, v24
    v_smfmac_f32_16x16x64_bf16 v[32:35], v[68:71], v[184:191], v2
    v_add_f32 v28, v28, v29
    v_add_f32 v30, v30, v31
    v_smfmac_f32_16x16x64_bf16 v[36:39], v[64:67], v[192:199], v2
    v_cvt_pk_bf16_f32 v73, v28, v30
    v_smfmac_f32_16x16x64_bf16 v[36:39], v[68:71], v[200:207], v2
    buffer_store_dwordx2 v[72:73], v63, s[12:15], s24 offen
    s_add_u32 s26, s24, 65536
    v_add_f32 v32, v32, v33
    v_add_f32 v34, v34, v35
    s_waitcnt lgkmcnt(2)
    v_smfmac_f32_16x16x64_bf16 v[40:43], v[64:67], v[8:15], v2
    ds_read_b128 v[8:11], v0 offset:49152
    v_cvt_pk_bf16_f32 v32, v32, v34
    v_bfi_b32 v74, v62, s23, v32
    s_waitcnt lgkmcnt(1)
    v_smfmac_f32_16x16x64_bf16 v[40:43], v[68:71], v[16:23], v2
    ds_read_b128 v[12:15], v0 offset:50176
    v_add_f32 v36, v36, v37
    v_add_f32 v38, v38, v39
    v_smfmac_f32_16x16x64_bf16 v[44:47], v[64:67], v[208:215], v2
    ds_read_b128 v[16:19], v0 offset:51200
    v_cvt_pk_bf16_f32 v75, v36, v38
    v_smfmac_f32_16x16x64_bf16 v[44:47], v[68:71], v[216:223], v2
    ds_read_b128 v[20:23], v0 offset:52224
    buffer_store_dwordx2 v[74:75], v63, s[12:15], s26 offen
    s_add_u32 s26, s24, 262144
    v_add_f32 v40, v40, v41
    v_add_f32 v42, v42, v43
    v_smfmac_f32_16x16x64_bf16 v[48:51], v[64:67], v[224:231], v2
    v_cvt_pk_bf16_f32 v40, v40, v42
    v_bfi_b32 v72, v62, s23, v40
    v_smfmac_f32_16x16x64_bf16 v[48:51], v[68:71], v[232:239], v2
    buffer_store_dwordx2 v[72:73], v63, s[12:15], s26 offen
    s_add_u32 s26, s24, 131072
    v_add_f32 v44, v44, v45
    v_add_f32 v46, v46, v47
    v_smfmac_f32_16x16x64_bf16 v[52:55], v[64:67], v[240:247], v2
    v_cvt_pk_bf16_f32 v44, v44, v46
    v_bfi_b32 v76, v62, s23, v44
    v_smfmac_f32_16x16x64_bf16 v[52:55], v[68:71], v[248:255], v2
    v_add_f32 v48, v48, v49
    v_add_f32 v50, v50, v51
    s_waitcnt lgkmcnt(2)
    v_smfmac_f32_16x16x64_bf16 v[56:59], v[64:67], v[8:15], v2
    ds_read_b128 v[8:11], v0 offset:16384
    v_cvt_pk_bf16_f32 v77, v48, v50
    s_waitcnt lgkmcnt(1)
    v_smfmac_f32_16x16x64_bf16 v[56:59], v[68:71], v[16:23], v2
    ds_read_b128 v[12:15], v0 offset:17408
    buffer_store_dwordx2 v[76:77], v63, s[12:15], s26 offen
    s_add_u32 s26, s24, 196608
    v_add_f32 v52, v52, v53
    v_add_f32 v54, v54, v55
    v_cvt_pk_bf16_f32 v52, v52, v54
    v_bfi_b32 v78, v62, s23, v52
    s_nop 0
    v_add_f32 v56, v56, v57
    v_add_f32 v58, v58, v59
    v_cvt_pk_bf16_f32 v79, v56, v58
    buffer_store_dwordx2 v[78:79], v63, s[12:15], s26 offen
    s_barrier
    ds_read_b128 v[16:19], v0 offset:18432
    ds_read_b128 v[20:23], v0 offset:19456
    buffer_load_dwordx4 v[24:27], v3, s[12:15], s27 offen offset:0 sc1
    buffer_load_dwordx4 v[28:31], v3, s[12:15], s27 offen offset:512 sc1
    buffer_load_dwordx4 v[32:35], v3, s[12:15], s27 offen offset:1024 sc1
    buffer_load_dwordx4 v[36:39], v3, s[12:15], s27 offen offset:1536 sc1
    v_bfe_u32 v66, v0, 6, 1
    v_lshlrev_b32 v66, 4, v66
    v_mov_b32 v67, 0x3f80
    v_lshlrev_b32 v67, v66, v67
    v_and_b32 v66, 0xb0, v0
    v_cmp_eq_u32 vcc, 0, v66
    v_cmp_eq_u32 s[34:35], 16, v66
    v_lshrrev_b32 v68, 9, v0
    v_cndmask_b32 v44, 0, v67, vcc
    v_cndmask_b32 v46, 0, v67, s[34:35]
    v_cmp_eq_u32 vcc, 0x80, v66
    v_lshlrev_b32 v68, 10, v68
    v_bfe_u32 v69, v0, 8, 1
    v_cndmask_b32 v45, 0, v67, vcc
    v_cmp_eq_u32 vcc, 0x90, v66
    v_lshl_add_u32 v68, v69, 5, v68
    v_bfe_u32 v69, v0, 4, 3
    v_cndmask_b32 v47, 0, v67, vcc
    v_lshl_add_u32 v68, v69, 2, v68
    v_and_b32 v69, 128, v0
    v_cmp_eq_u32 vcc, 0, v69
    v_mov_b32 v69, 0x40000000
    s_nop 0
    v_cndmask_b32 v65, v69, v68, vcc
    v_mov_b32 v70, -1
    v_mov_b32 v64, s23
    s_add_u32 s34, s28, s29
    s_add_u32 s35, s28, s30
    v_mov_b64 v[48:49], 0
    v_mov_b64 v[50:51], 0
    v_mov_b64 v[52:53], 0
    v_mov_b64 v[54:55], 0
    v_mov_b64 v[56:57], 0
    v_mov_b64 v[58:59], 0
    v_mov_b64 v[60:61], 0
    v_mov_b64 v[62:63], 0
    s_waitcnt vmcnt(3)
    v_mfma_f32_16x16x32_bf16 v[40:43], v[44:47], v[24:27], 0
    v_xor_b32 v66, v64, v24
    s_waitcnt vmcnt(2)
    v_mfma_f32_16x16x32_bf16 v[40:43], v[44:47], v[28:31], v[40:43]
    v_bitop3_b32 v66, v66, v64, v28 bitop3:0xf6
    s_waitcnt vmcnt(1)
    v_mfma_f32_16x16x32_bf16 v[40:43], v[44:47], v[32:35], v[40:43]
    v_bitop3_b32 v66, v66, v64, v32 bitop3:0xf6
    s_waitcnt vmcnt(0)
    v_mfma_f32_16x16x32_bf16 v[40:43], v[44:47], v[36:39], v[40:43]
    v_bitop3_b32 v66, v66, v64, v36 bitop3:0xf6
    v_and_b32 v66, 1, v66
    v_cmp_ne_u32 vcc, 0, v66
    s_nop 0
    s_cbranch_vccnz L_redslow_f_w0
    s_nop 2
    v_add_f32_dpp v40, v40, v40 row_ror:8 row_mask:0xf bank_mask:0xf
    v_add_f32_dpp v41, v41, v41 row_ror:8 row_mask:0xf bank_mask:0xf
    v_cvt_pk_bf16_f32 v40, v40, v41
    buffer_store_dword v40, v65, s[12:15], s34 offen
    buffer_store_dword v70, v65, s[12:15], s35 offen
L_redend_f_w0:
    s_branch L_loop_f_w0
L_kw_f_w0:
    buffer_load_dword v1, off, s[12:15], s8 sc1
    s_add_u32 s63, s63, 1
    s_add_u32 s37, s37, 1
    s_cmp_gt_u32 s37, 400000
    s_waitcnt vmcnt(0)
    s_cbranch_scc1 L_kw_f_w0_ok
    v_cmp_gt_u32 vcc, s25, v1
    s_nop 0
    s_cbranch_vccnz L_kw_f_w0
    s_branch L_kw_f_w0_ok
L_xs_f_w0:
    s_cmp_lg_u32 s5, 0
    s_cbranch_scc1 L_team_exit
    s_mov_b32 s5, 63
    s_lshl_b32 s35, s21, 7
    s_add_u32 s35, s35, 397312
L_xl_f_w0:
    buffer_load_dword v72, off, s[12:15], s35 sc1
    s_add_u32 s37, s37, 1
    s_cmp_gt_u32 s37, 400000
    s_waitcnt vmcnt(0)
    s_cbranch_scc1 L_xg_f_w0
    v_cmp_gt_u32 vcc, s25, v72
    s_nop 0
    s_cbranch_vccnz L_xl_f_w0
L_xg_f_w0:
    buffer_load_dwordx4 v[64:67], v0, s[16:19], s31 offen offset:0 sc1
    buffer_load_dwordx4 v[68:71], v0, s[16:19], s31 offen offset:1024 sc1
    buffer_load_dwordx4 v[40:43], v0, s[16:19], s31 offen offset:2048 sc1
    buffer_load_dwordx4 v[44:47], v0, s[16:19], s31 offen offset:3072 sc1
    s_add_u32 s35, s31, 524288
    v_lshlrev_b32 v1, 3, v0
    buffer_load_dword v1, v1, s[16:19], s35 offen
    s_add_u32 s35, s35, 8192
    buffer_load_dword v1, v1, s[16:19], s35 offen
    buffer_load_dword v1, off, s[12:15], s8 sc1
    s_waitcnt vmcnt(3)
    s_branch L_xsb_f_w0
L_redo_f_w0:
    v_cmp_u_f32 vcc, v48, v48
    s_nop 0
    s_cbranch_vccz L_xs_f_w0
    s_add_u32 s61, s61, 1
    s_add_u32 s37, s37, 64
    s_cmp_gt_u32 s37, 400000
    s_cbranch_scc0 L_redo2_f_w0
    s_cmp_eq_u32 s22, s5
    s_cbranch_scc1 L_xs_f_w0
    s_branch L_xsb_f_w0
L_redo2_f_w0:
    s_waitcnt vmcnt(0) lgkmcnt(0)
    s_barrier
    s_mov_b32 m0, 0
    s_add_u32 s34, s29, 0
    buffer_load_dwordx4 v0, s[12:15], s34 offen offset:0 sc1 lds
    buffer_load_dwordx4 v0, s[12:15], s34 offen offset:1024 sc1 lds
    buffer_load_dwordx4 v0, s[12:15], s34 offen offset:2048 sc1 lds
    buffer_load_dwordx4 v0, s[12:15], s34 offen offset:3072 sc1 lds
    s_mov_b32 m0, 4096
    s_add_u32 s34, s29, 4096
    s_nop 7
    v_mov_b64 v[48:49], 0
    v_mov_b64 v[50:51], 0
    v_mov_b64 v[52:53], 0
    v_mov_b64 v[54:55], 0
    v_mov_b64 v[56:57], 0
    v_mov_b64 v[58:59], 0
    v_mov_b64 v[60:61], 0
    v_mov_b64 v[62:63], 0
    ds_read_b128 v[8:11], v0 offset:16384
    ds_read_b128 v[12:15], v0 offset:17408
    ds_read_b128 v[16:19], v0 offset:18432
    ds_read_b128 v[20:23], v0 offset:19456
    s_waitcnt vmcnt(0) lgkmcnt(0)
    s_barrier
    s_branch L_pa_f_w0
L_max_f_w0:
    s_cmp_eq_u32 s4, s23
    s_cbranch_scc1 L_maxskip_f_w0
    s_mov_b32 s4, s23
    s_nop 7
    ds_read_b128 v[60:63], v0 offset:10240
    ds_read_b128 v[72:75], v0 offset:11264
    ds_read_b128 v[76:79], v0 offset:12288
    ds_read_b128 v[64:67], v0 offset:9216
    ds_read_b128 v[68:71], v6 offset:13312
    ds_read_b128 v[56:59], v6 offset:13344
    s_waitcnt lgkmcnt(2)
    v_add_f32 v64, v64, v60
    v_add_f32 v65, v65, v61
    v_add_f32 v66, v66, v62
    v_add_f32 v67, v67, v63
    v_add_f32 v72, v72, v76
    v_add_f32 v73, v73, v77
    v_add_f32 v74, v74, v78
    v_add_f32 v75, v75, v79
    v_add_f32 v64, v64, v72
    v_add_f32 v65, v65, v73
    v_add_f32 v66, v66, v74
    v_add_f32 v67, v67, v75
    s_waitcnt lgkmcnt(0)
    v_add_f32 v68, v68, v56
    v_add_f32 v69, v69, v57
    v_add_f32 v70, v70, v58
    v_add_f32 v71, v71, v59
    v_add_f32 v68, v68, v70
    v_add_f32 v69, v69, v71
    v_pk_mul_f32 v[68:69], v[68:69], s[32:33] op_sel_hi:[1,0]
    v_max3_f32 v60, v64, v65, v66
    v_max3_f32 v61, v67, v68, v69
    v_max_f32 v60, v60, v61
    s_nop 1
    v_max_f32_dpp v60, v60, v60 quad_perm:[2,3,0,1] row_mask:0xf bank_mask:0xf
    v_mov_b32 v61, v60
    s_nop 1
    v_permlane16_swap_b32 v60, v61
    v_max_f32 v60, v60, v61
    v_mov_b32 v61, v60
    s_nop 1
    v_permlane32_swap_b32 v60, v61
    v_max_f32 v60, v60, v61
    v_sub_f32 v64, v64, v60
    v_sub_f32 v65, v65, v60
    v_sub_f32 v66, v66, v60
    v_sub_f32 v67, v67, v60
    v_sub_f32 v68, v68, v60
    v_sub_f32 v69, v69, v60
    v_exp_f32 v64, v64
    v_exp_f32 v65, v65
    v_exp_f32 v66, v66
    v_exp_f32 v67, v67
    v_exp_f32 v68, v68
    v_exp_f32 v69, v69
    s_add_u32 s62, s62, 1
    s_waitcnt lgkmcnt(0)
    s_branch L_maxback_f_w0
L_redslow_f_w0:
    buffer_store_byte v70, v0, s[40:43], 0 offen
L_redslow2_f_w0:
    buffer_load_dwordx4 v[24:27], v3, s[12:15], s27 offen offset:0 sc1
    buffer_load_dwordx4 v[28:31], v3, s[12:15], s27 offen offset:512 sc1
    buffer_load_dwordx4 v[32:35], v3, s[12:15], s27 offen offset:1024 sc1
    buffer_load_dwordx4 v[36:39], v3, s[12:15], s27 offen offset:1536 sc1
    s_add_u32 s60, s60, 1
    s_add_u32 s37, s37, 1
    s_cmp_gt_u32 s37, 400000
    s_cbranch_scc1 L_redgo_f_w0
    s_waitcnt vmcnt(3)
    v_mfma_f32_16x16x32_bf16 v[40:43], v[44:47], v[24:27], 0
    v_xor_b32 v66, v64, v24
    s_waitcnt vmcnt(2)
    v_mfma_f32_16x16x32_bf16 v[40:43], v[44:47], v[28:31], v[40:43]
    v_bitop3_b32 v66, v66, v64, v28 bitop3:0xf6
    s_waitcnt vmcnt(1)
    v_mfma_f32_16x16x32_bf16 v[40:43], v[44:47], v[32:35], v[40:43]
    v_bitop3_b32 v66, v66, v64, v32 bitop3:0xf6
    s_waitcnt vmcnt(0)
    v_mfma_f32_16x16x32_bf16 v[40:43], v[44:47], v[36:39], v[40:43]
    v_bitop3_b32 v66, v66, v64, v36 bitop3:0xf6
    v_and_b32 v66, 1, v66
    v_cmp_ne_u32 vcc, 0, v66
    s_nop 0
    s_cbranch_vccnz L_redslow2_f_w0
L_redgo_f_w0:
    s_waitcnt vmcnt(0)
    v_mov_b32 v71, 0
    s_nop 0
    v_add_f32_dpp v40, v40, v40 row_ror:8 row_mask:0xf bank_mask:0xf
    v_add_f32_dpp v41, v41, v41 row_ror:8 row_mask:0xf bank_mask:0xf
    v_cvt_pk_bf16_f32 v40, v40, v41
    buffer_store_dword v40, v65, s[12:15], s34 offen
    buffer_store_dword v70, v65, s[12:15], s35 offen
    buffer_store_byte v71, v0, s[40:43], 0 offen
    s_branch L_redend_f_w0
.p2align 6
L_loop_f_w1:
    s_add_u32 s31, s31, 524288
    s_mov_b32 m0, 5120
    s_add_u32 s34, s29, 5120
    s_waitcnt lgkmcnt(0)
    s_barrier
L_pa_f_w1:
    ds_read_b128 v[24:27], v0 offset:0
    ds_read_b128 v[28:31], v0 offset:1024
    buffer_load_dwordx4 v0, s[12:15], s34 offen sc1 lds
    s_waitcnt lgkmcnt(1)
    v_smfmac_f32_16x16x64_bf16 v[48:51], v[24:27], v[8:15], v2
    ds_read_b128 v[8:11], v1 offset:4096
    v_smfmac_f32_16x16x64_bf16 v[52:55], v[24:27], v[16:23], v2
    ds_read_b128 v[12:15], v1 offset:5120
    v_smfmac_f32_16x16x64_bf16 v[56:59], v[24:27], a[0:7], v2
    ds_read_b128 v[16:19], v1 offset:6144
    buffer_load_dwordx4 v[64:67], v0, s[16:19], s31 offen offset:0 sc1
    v_smfmac_f32_16x16x64_bf16 v[60:63], v[24:27], a[8:15], v2
    ds_read_b128 v[20:23], v1 offset:7168
    s_barrier
    s_waitcnt lgkmcnt(4)
    v_smfmac_f32_16x16x64_bf16 v[48:51], v[28:31], a[16:23], v2
    ds_read_b128 v[32:35], v0 offset:2048
    v_smfmac_f32_16x16x64_bf16 v[52:55], v[28:31], a[24:31], v2
    v_smfmac_f32_16x16x64_bf16 v[56:59], v[28:31], a[32:39], v2
    ds_read_b128 v[36:39], v0 offset:3072
    buffer_load_dwordx4 v[68:71], v0, s[16:19], s31 offen offset:1024 sc1
    v_smfmac_f32_16x16x64_bf16 v[60:63], v[28:31], a[40:47], v2
    ds_read_b128 v[24:27], v0 offset:8192
    s_waitcnt lgkmcnt(2)
    v_smfmac_f32_16x16x64_bf16 v[48:51], v[32:35], v[8:15], v2
    ds_read_b128 v[8:11], v1 offset:8192
    v_smfmac_f32_16x16x64_bf16 v[52:55], v[32:35], v[16:23], v2
    ds_read_b128 v[12:15], v1 offset:9216
    v_smfmac_f32_16x16x64_bf16 v[56:59], v[32:35], a[48:55], v2
    ds_read_b128 v[16:19], v1 offset:10240
    buffer_load_dwordx4 v[40:43], v0, s[16:19], s31 offen offset:2048 sc1
    v_smfmac_f32_16x16x64_bf16 v[60:63], v[32:35], a[56:63], v2
    ds_read_b128 v[20:23], v1 offset:11264
    s_waitcnt lgkmcnt(5)
    v_smfmac_f32_16x16x64_bf16 v[48:51], v[36:39], a[64:71], v2
    v_smfmac_f32_16x16x64_bf16 v[52:55], v[36:39], a[72:79], v2
    s_waitcnt lgkmcnt(2)
    v_smfmac_f32_16x16x64_bf16 v[56:59], v[36:39], v[8:15], v2
    ds_read_b128 v[8:11], v1 offset:12288
    buffer_load_dwordx4 v[44:47], v0, s[16:19], s31 offen offset:3072 sc1
    s_waitcnt lgkmcnt(1)
    v_smfmac_f32_16x16x64_bf16 v[60:63], v[36:39], v[16:23], v2
    ds_read_b128 v[12:15], v1 offset:13312
    s_waitcnt vmcnt(4)
    s_barrier
    v_smfmac_f32_16x16x64_bf16 v[48:51], v[24:27], a[80:87], v2
    ds_read_b128 v[28:31], v0 offset:4096
    v_smfmac_f32_16x16x64_bf16 v[52:55], v[24:27], a[88:95], v2
    ds_read_b128 v[16:19], v1 offset:14336
    v_smfmac_f32_16x16x64_bf16 v[56:59], v[24:27], a[96:103], v2
    ds_read_b128 v[32:35], v0 offset:5120
    v_smfmac_f32_16x16x64_bf16 v[60:63], v[24:27], a[104:111], v2
    ds_read_b128 v[20:23], v1 offset:15360
    s_waitcnt lgkmcnt(3)
    v_smfmac_f32_16x16x64_bf16 v[48:51], v[28:31], a[112:119], v2
    ds_read_b128 v[36:39], v0 offset:6144
    v_smfmac_f32_16x16x64_bf16 v[52:55], v[28:31], a[120:127], v2
    s_waitcnt lgkmcnt(2)
    v_smfmac_f32_16x16x64_bf16 v[48:51], v[32:35], a[128:135], v2
    ds_read_b128 v[24:27], v0 offset:7168
    v_smfmac_f32_16x16x64_bf16 v[52:55], v[32:35], a[136:143], v2
    s_waitcnt lgkmcnt(1)
    v_smfmac_f32_16x16x64_bf16 v[48:51], v[36:39], v[8:15], v2
    ds_read_b128 v[8:11], v1 offset:16384
    v_smfmac_f32_16x16x64_bf16 v[52:55], v[36:39], v[16:23], v2
    ds_read_b128 v[12:15], v1 offset:17408
    s_waitcnt lgkmcnt(2)
    v_smfmac_f32_16x16x64_bf16 v[48:51], v[24:27], a[144:151], v2
    ds_read_b128 v[16:19], v1 offset:18432
    v_smfmac_f32_16x16x64_bf16 v[52:55], v[24:27], a[152:159], v2
    ds_read_b128 v[20:23], v1 offset:19456
    v_smfmac_f32_16x16x64_bf16 v[56:59], v[28:31], a[160:167], v2
    v_cvt_pk_bf16_f32 v72, v48, v49
    v_smfmac_f32_16x16x64_bf16 v[60:63], v[28:31], a[168:175], v2
    v_cvt_pk_bf16_f32 v73, v50, v51
    v_smfmac_f32_16x16x64_bf16 v[56:59], v[32:35], a[176:183], v2
    v_cvt_pk_bf16_f32 v74, v52, v53
    v_mfma_f32_16x16x16_bf16 v[48:51], v[72:73], v[4:5], 0
    s_waitcnt lgkmcnt(0)
    v_cvt_pk_bf16_f32 v75, v54, v55
    v_smfmac_f32_16x16x64_bf16 v[60:63], v[32:35], a[184:191], v2
    s_cmp_eq_u32 s22, s5
    s_cselect_b64 s[6:7], -1, 0
    v_mfma_f32_16x16x16_bf16 v[52:55], v[74:75], v[4:5], 0
    s_waitcnt vmcnt(2)
    v_cvt_pk_bf16_f32 v76, v48, v49
    v_cvt_pk_bf16_f32 v77, v50, v51
    v_smfmac_f32_16x16x64_bf16 v[56:59], v[36:39], v[8:15], v2
    ds_read_b128 v[8:11], v1 offset:20480
    v_cmp_u_f32 vcc, v48, v48
    v_smfmac_f32_16x16x64_bf16 v[60:63], v[36:39], v[16:23], v2
    ds_read_b128 v[12:15], v1 offset:21504
    v_cvt_pk_bf16_f32 v78, v52, v53
    v_smfmac_f32_16x16x64_bf16 v[56:59], v[24:27], a[192:199], v2
    ds_read_b128 v[16:19], v1 offset:22528
    s_or_b64 vcc, vcc, s[6:7]
    v_cvt_pk_bf16_f32 v79, v54, v55
    v_smfmac_f32_16x16x64_bf16 v[60:63], v[24:27], a[200:207], v2
    ds_read_b128 v[20:23], v1 offset:23552
    s_cbranch_scc1 L_redo_f_w1
L_xsb_f_w1:
    v_mov_b64 v[48:49], 0
    v_mfma_f32_16x16x32_bf16 v[64:67], v[64:67], v[76:79], 0
    v_cvt_pk_bf16_f32 v72, v56, v57
    v_cvt_pk_bf16_f32 v73, v58, v59
    v_mfma_f32_16x16x32_bf16 v[68:71], v[68:71], v[76:79], 0
    v_cvt_pk_bf16_f32 v74, v60, v61
    v_cvt_pk_bf16_f32 v75, v62, v63
    v_mfma_f32_16x16x16_bf16 v[56:59], v[72:73], v[4:5], 0
    s_mov_b32 s30, s29
    v_mov_b64 v[50:51], 0
    v_mov_b64 v[52:53], 0
    v_mfma_f32_16x16x16_bf16 v[60:63], v[74:75], v[4:5], 0
    s_add_u32 s29, s29, 9216
    v_mov_b64 v[54:55], 0
    v_cndmask_b32 v64, v64, v68, s[58:59]
    v_smfmac_f32_16x16x64_bf16 v[48:51], v[28:31], a[208:215], v2
    s_add_u32 s22, s22, 1
    s_add_u32 s23, s23, 1
    v_cvt_pk_bf16_f32 v72, v56, v57
    v_cvt_pk_bf16_f32 v73, v58, v59
    v_cvt_pk_bf16_f32 v74, v60, v61
    v_cvt_pk_bf16_f32 v75, v62, v63
    v_smfmac_f32_16x16x64_bf16 v[52:55], v[28:31], a[216:223], v2
    ds_read_b128 v[28:31], v0 offset:0
    s_add_u32 s25, s25, 1
    v_cndmask_b32 v65, v65, v69, s[58:59]
    v_mfma_f32_16x16x32_bf16 v[56:59], v[72:75], v[76:79], 0
    s_cmp_eq_u32 s29, 355328
    v_cndmask_b32 v66, v66, v70, s[58:59]
    v_cndmask_b32 v67, v67, v71, s[58:59]
    v_smfmac_f32_16x16x64_bf16 v[48:51], v[32:35], a[224:231], v2
    s_cselect_b32 s29, 327680, s29
    v_smfmac_f32_16x16x64_bf16 v[52:55], v[32:35], a[232:239], v2
    ds_write_b128 v0, v[64:67] offset:10240
    v_smfmac_f32_16x16x64_bf16 v[48:51], v[36:39], a[240:247], v2
    ds_read_b128 v[32:35], v0 offset:1024
    v_smfmac_f32_16x16x64_bf16 v[52:55], v[36:39], a[248:255], v2
    ds_write_b64 v6, v[56:57] offset:13320
    v_smfmac_f32_16x16x64_bf16 v[48:51], v[24:27], v[80:87], v2
    ds_read_b128 v[36:39], v0 offset:2048
    v_smfmac_f32_16x16x64_bf16 v[52:55], v[24:27], v[88:95], v2
    ds_read_b128 v[24:27], v0 offset:3072
    s_waitcnt lgkmcnt(5)
    v_smfmac_f32_16x16x64_bf16 v[48:51], v[28:31], v[96:103], v2
    s_waitcnt lgkmcnt(2)
    s_barrier
    ds_read_b128 v[60:63], v0 offset:9216
    v_smfmac_f32_16x16x64_bf16 v[52:55], v[28:31], v[104:111], v2
    ds_read_b128 v[72:75], v0 offset:11264
    v_smfmac_f32_16x16x64_bf16 v[48:51], v[32:35], v[112:119], v2
    ds_read_b128 v[76:79], v0 offset:12288
    v_smfmac_f32_16x16x64_bf16 v[52:55], v[32:35], v[120:127], v2
    ds_read_b128 v[28:31], v0 offset:8192
    s_waitcnt lgkmcnt(5)
    v_smfmac_f32_16x16x64_bf16 v[48:51], v[36:39], v[128:135], v2
    ds_read_b128 v[68:71], v6 offset:13312
    v_mov_b64 v[32:33], s[2:3]
    v_smfmac_f32_16x16x64_bf16 v[52:55], v[36:39], v[136:143], v2
    ds_read_b128 v[56:59], v6 offset:13344
    v_mov_b64 v[34:35], s[2:3]
    s_waitcnt lgkmcnt(6)
    v_smfmac_f32_16x16x64_bf16 v[48:51], v[24:27], v[144:151], v2
    v_mov_b64 v[36:37], s[0:1]
    v_smfmac_f32_16x16x64_bf16 v[52:55], v[24:27], v[152:159], v2
    s_waitcnt lgkmcnt(5)
    v_add_f32 v60, v60, v64
    s_waitcnt lgkmcnt(2)
    v_smfmac_f32_16x16x64_bf16 v[48:51], v[28:31], v[8:15], v2
    ds_read_b128 v[8:11], v1 offset:24576
    v_add_f32 v61, v61, v65
    v_smfmac_f32_16x16x64_bf16 v[52:55], v[28:31], v[16:23], v2
    ds_read_b128 v[12:15], v1 offset:25600
    v_add_f32 v62, v62, v66
    v_add_f32 v63, v63, v67
    v_pk_add_f32 v[72:73], v[72:73], v[76:77]
    v_pk_add_f32 v[74:75], v[74:75], v[78:79]
    v_pk_add_f32 v[60:61], v[60:61], v[72:73]
    v_pk_add_f32 v[62:63], v[62:63], v[74:75]
    s_waitcnt lgkmcnt(2)
    v_pk_add_f32 v[68:69], v[68:69], v[56:57]
    v_pk_add_f32 v[70:71], v[70:71], v[58:59]
    v_pk_add_f32 v[68:69], v[68:69], v[70:71]
    v_pk_mul_f32 v[68:69], v[68:69], s[32:33] op_sel_hi:[1,0]
    v_exp_f32 v60, v60
    v_exp_f32 v61, v61
    v_exp_f32 v62, v62
    v_exp_f32 v63, v63
    v_exp_f32 v68, v68
    v_exp_f32 v69, v69
L_maxback_f_w1:
    v_cvt_pk_bf16_f32 v72, v60, v61
    v_cvt_pk_bf16_f32 v73, v62, v63
    v_cvt_pk_bf16_f32 v76, v68, v68
    v_mov_b32_dpp v74, v72 quad_perm:[2,3,0,1] row_mask:0xf bank_mask:0xf
    v_mov_b32_dpp v75, v73 quad_perm:[2,3,0,1] row_mask:0xf bank_mask:0xf
    v_cvt_pk_bf16_f32 v77, v69, v69
    v_cvt_pk_bf16_f32 v24, v48, v49
    v_mfma_f32_16x16x32_bf16 v[28:31], v[32:35], v[72:75], 0
    s_waitcnt vmcnt(0)
    v_cvt_pk_bf16_f32 v25, v50, v51
    v_cvt_pk_bf16_f32 v26, v52, v53
    v_mfma_f32_16x16x32_bf16 v[56:59], v[40:43], v[72:75], 0
    ds_read_b128 v[16:19], v1 offset:26624
    v_cvt_pk_bf16_f32 v27, v54, v55
    v_mfma_f32_16x16x16_bf16 v[28:31], v[36:37], v[76:77], v[28:31]
    ds_read_b128 v[20:23], v1 offset:27648
    v_mfma_f32_16x16x32_bf16 v[68:71], v[44:47], v[72:75], 0
    v_mfma_f32_16x16x16_bf16 v[56:59], v[24:25], v[76:77], v[56:59]
    v_rcp_f32 v30, v28
    v_mfma_f32_16x16x16_bf16 v[68:71], v[26:27], v[76:77], v[68:71]
    v_max_f32 v28, v28, v30
    v_cmp_ngt_f32 vcc, s38, v28
    v_mov_b64 v[38:39], 0
    v_mov_b32 v78, s23
    v_pk_mul_f32 v[56:57], v[56:57], v[30:31] op_sel_hi:[1,0]
    v_pk_mul_f32 v[58:59], v[58:59], v[30:31] op_sel_hi:[1,0]
    v_cvt_pk_bf16_f32 v64, v56, v57
    v_cvt_pk_bf16_f32 v65, v58, v59
    v_pk_mul_f32 v[68:69], v[68:69], v[30:31] op_sel_hi:[1,0]
    v_pk_mul_f32 v[70:71], v[70:71], v[30:31] op_sel_hi:[1,0]
    s_cbranch_vccnz L_max_f_w1
L_maxskip_f_w1:
    v_cvt_pk_bf16_f32 v66, v68, v69
    v_cvt_pk_bf16_f32 v67, v70, v71
    v_mfma_f32_16x16x16_bf16 v[48:51], v[38:39], v[38:39], 0
    ds_write_b128 v7, v[64:67]
    v_mov_b64 v[34:35], 0
    v_mov_b64 v[36:37], 0
    v_mov_b64 v[40:41], 0
    v_mov_b64 v[42:43], 0
    v_mov_b64 v[44:45], 0
    v_mov_b64 v[46:47], 0
    v_mov_b64 v[56:57], 0
    v_mov_b64 v[58:59], 0
    v_mov_b64 v[24:25], 0
    v_mov_b64 v[26:27], 0
    v_mov_b64 v[28:29], 0
    v_mov_b64 v[30:31], 0
    v_mfma_f32_16x16x16_bf16 v[52:55], v[38:39], v[38:39], 0
    s_waitcnt lgkmcnt(0)
    s_barrier
    ds_read_b128 v[64:67], v0 offset:14336
    v_mov_b32 v32, 0
    ds_read_b128 v[68:71], v0 offset:15360
    v_mov_b32 v33, 0
    v_cndmask_b32 v62, 0, 1, s[56:57]
    v_lshrrev_b32 v63, 1, v0
    s_waitcnt lgkmcnt(1)
    v_smfmac_f32_16x16x64_bf16 v[24:27], v[64:67], v[8:15], v2
    ds_read_b128 v[8:11], v1 offset:28672
    s_waitcnt lgkmcnt(1)
    v_smfmac_f32_16x16x64_bf16 v[24:27], v[68:71], v[16:23], v2
    ds_read_b128 v[12:15], v1 offset:29696
    v_smfmac_f32_16x16x64_bf16 v[28:31], v[64:67], v[160:167], v2
    ds_read_b128 v[16:19], v1 offset:30720
    v_smfmac_f32_16x16x64_bf16 v[28:31], v[68:71], v[168:175], v2
    ds_read_b128 v[20:23], v1 offset:31744
    v_add_f32 v24, v24, v25
    v_add_f32 v26, v26, v27
    v_smfmac_f32_16x16x64_bf16 v[32:35], v[64:67], v[176:183], v2
    v_cvt_pk_bf16_f32 v24, v24, v26
    v_bfi_b32 v72, v62, s23, v24
    v_smfmac_f32_16x16x64_bf16 v[32:35], v[68:71], v[184:191], v2
    v_add_f32 v28, v28, v29
    v_add_f32 v30, v30, v31
    v_smfmac_f32_16x16x64_bf16 v[36:39], v[64:67], v[192:199], v2
    v_cvt_pk_bf16_f32 v73, v28, v30
    v_smfmac_f32_16x16x64_bf16 v[36:39], v[68:71], v[200:207], v2
    buffer_store_dwordx2 v[72:73], v63, s[12:15], s24 offen
    s_add_u32 s26, s24, 65536
    v_add_f32 v32, v32, v33
    v_add_f32 v34, v34, v35
    s_waitcnt lgkmcnt(2)
    v_smfmac_f32_16x16x64_bf16 v[40:43], v[64:67], v[8:15], v2
    ds_read_b128 v[8:11], v1 offset:32768
    v_cvt_pk_bf16_f32 v32, v32, v34
    v_bfi_b32 v74, v62, s23, v32
    s_waitcnt lgkmcnt(1)
    v_smfmac_f32_16x16x64_bf16 v[40:43], v[68:71], v[16:23], v2
    ds_read_b128 v[12:15], v1 offset:33792
    v_add_f32 v36, v36, v37
    v_add_f32 v38, v38, v39
    v_smfmac_f32_16x16x64_bf16 v[44:47], v[64:67], v[208:215], v2
    ds_read_b128 v[16:19], v1 offset:34816
    v_cvt_pk_bf16_f32 v75, v36, v38
    v_smfmac_f32_16x16x64_bf16 v[44:47], v[68:71], v[216:223], v2
    ds_read_b128 v[20:23], v1 offset:35840
    buffer_store_dwordx2 v[74:75], v63, s[12:15], s26 offen
    s_add_u32 s26, s24, 262144
    v_add_f32 v40, v40, v41
    v_add_f32 v42, v42, v43
    v_smfmac_f32_16x16x64_bf16 v[48:51], v[64:67], v[224:231], v2
    v_cvt_pk_bf16_f32 v40, v40, v42
    v_bfi_b32 v72, v62, s23, v40
    v_smfmac_f32_16x16x64_bf16 v[48:51], v[68:71], v[232:239], v2
    buffer_store_dwordx2 v[72:73], v63, s[12:15], s26 offen
    s_add_u32 s26, s24, 131072
    v_add_f32 v44, v44, v45
    v_add_f32 v46, v46, v47
    v_smfmac_f32_16x16x64_bf16 v[52:55], v[64:67], v[240:247], v2
    v_cvt_pk_bf16_f32 v44, v44, v46
    v_bfi_b32 v76, v62, s23, v44
    v_smfmac_f32_16x16x64_bf16 v[52:55], v[68:71], v[248:255], v2
    v_add_f32 v48, v48, v49
    v_add_f32 v50, v50, v51
    s_waitcnt lgkmcnt(2)
    v_smfmac_f32_16x16x64_bf16 v[56:59], v[64:67], v[8:15], v2
    ds_read_b128 v[8:11], v1 offset:0
    v_cvt_pk_bf16_f32 v77, v48, v50
    s_waitcnt lgkmcnt(1)
    v_smfmac_f32_16x16x64_bf16 v[56:59], v[68:71], v[16:23], v2
    ds_read_b128 v[12:15], v1 offset:1024
    buffer_store_dwordx2 v[76:77], v63, s[12:15], s26 offen
    s_add_u32 s26, s24, 196608
    v_add_f32 v52, v52, v53
    v_add_f32 v54, v54, v55
    v_cvt_pk_bf16_f32 v52, v52, v54
    v_bfi_b32 v78, v62, s23, v52
    s_nop 0
    v_add_f32 v56, v56, v57
    v_add_f32 v58, v58, v59
    v_cvt_pk_bf16_f32 v79, v56, v58
    buffer_store_dwordx2 v[78:79], v63, s[12:15], s26 offen
    s_barrier
    v_mov_b32 v72, s23
    ds_read_b128 v[16:19], v1 offset:2048
    ds_read_b128 v[20:23], v1 offset:3072
    v_bfe_u32 v66, v0, 6, 1
    v_lshlrev_b32 v66, 4, v66
    v_mov_b32 v67, 0x3f80
    v_lshlrev_b32 v67, v66, v67
    v_and_b32 v66, 0xb0, v0
    v_cmp_eq_u32 vcc, 0, v66
    v_cmp_eq_u32 s[34:35], 16, v66
    v_lshrrev_b32 v68, 9, v0
    v_cndmask_b32 v44, 0, v67, vcc
    v_cndmask_b32 v46, 0, v67, s[34:35]
    v_cmp_eq_u32 vcc, 0x80, v66
    v_lshlrev_b32 v68, 10, v68
    v_bfe_u32 v69, v0, 8, 1
    v_cndmask_b32 v45, 0, v67, vcc
    v_cmp_eq_u32 vcc, 0x90, v66
    v_lshl_add_u32 v68, v69, 5, v68
    v_bfe_u32 v69, v0, 4, 3
    v_cndmask_b32 v47, 0, v67, vcc
    v_lshl_add_u32 v68, v69, 2, v68
    v_and_b32 v69, 128, v0
    buffer_store_dword v72, v0, s[52:55], 0 offen
    v_cmp_eq_u32 vcc, 0, v69
    v_mov_b32 v69, 0x40000000
    s_nop 0
    v_cndmask_b32 v65, v69, v68, vcc
    v_mov_b32 v70, -1
    v_mov_b32 v64, s23
    s_add_u32 s34, s28, s29
    s_add_u32 s35, s28, s30
    v_mov_b64 v[48:49], 0
    v_mov_b64 v[50:51], 0
    v_mov_b64 v[52:53], 0
    v_mov_b64 v[54:55], 0
    v_mov_b64 v[56:57], 0
    v_mov_b64 v[58:59], 0
    v_mov_b64 v[60:61], 0
    v_mov_b64 v[62:63], 0
    buffer_load_dwordx4 v[24:27], v3, s[12:15], s27 offen offset:0 sc1
    buffer_load_dwordx4 v[28:31], v3, s[12:15], s27 offen offset:512 sc1
    buffer_load_dwordx4 v[32:35], v3, s[12:15], s27 offen offset:1024 sc1
    buffer_load_dwordx4 v[36:39], v3, s[12:15], s27 offen offset:1536 sc1
    s_waitcnt vmcnt(3)
    v_mfma_f32_16x16x32_bf16 v[40:43], v[44:47], v[24:27], 0
    v_xor_b32 v66, v64, v24
    s_waitcnt vmcnt(2)
    v_mfma_f32_16x16x32_bf16 v[40:43], v[44:47], v[28:31], v[40:43]
    v_bitop3_b32 v66, v66, v64, v28 bitop3:0xf6
    s_waitcnt vmcnt(1)
    v_mfma_f32_16x16x32_bf16 v[40:43], v[44:47], v[32:35], v[40:43]
    v_bitop3_b32 v66, v66, v64, v32 bitop3:0xf6
    s_waitcnt vmcnt(0)
    v_mfma_f32_16x16x32_bf16 v[40:43], v[44:47], v[36:39], v[40:43]
    v_bitop3_b32 v66, v66, v64, v36 bitop3:0xf6
    v_and_b32 v66, 1, v66
    v_cmp_ne_u32 vcc, 0, v66
    s_nop 0
    s_cbranch_vccnz L_redslow_f_w1
    s_nop 2
    v_add_f32_dpp v40, v40, v40 row_ror:8 row_mask:0xf bank_mask:0xf
    v_add_f32_dpp v41, v41, v41 row_ror:8 row_mask:0xf bank_mask:0xf
    v_cvt_pk_bf16_f32 v40, v40, v41
    buffer_store_dword v40, v65, s[12:15], s34 offen
    buffer_store_dword v70, v65, s[12:15], s35 offen
L_redend_f_w1:
    s_branch L_loop_f_w1
L_xs_f_w1:
    s_cmp_lg_u32 s5, 0
    s_cbranch_scc1 L_team_exit
    s_mov_b32 s5, 63
    s_lshl_b32 s35, s21, 7
    s_add_u32 s35, s35, 397312
L_xl_f_w1:
    buffer_load_dword v72, off, s[12:15], s35 sc1
    s_add_u32 s37, s37, 1
    s_cmp_gt_u32 s37, 400000
    s_waitcnt vmcnt(0)
    s_cbranch_scc1 L_xg_f_w1
    v_cmp_gt_u32 vcc, s25, v72
    s_nop 0
    s_cbranch_vccnz L_xl_f_w1
L_xg_f_w1:
    buffer_load_dwordx4 v[64:67], v0, s[16:19], s31 offen offset:0 sc1
    buffer_load_dwordx4 v[68:71], v0, s[16:19], s31 offen offset:1024 sc1
    buffer_load_dwordx4 v[40:43], v0, s[16:19], s31 offen offset:2048 sc1
    buffer_load_dwordx4 v[44:47], v0, s[16:19], s31 offen offset:3072 sc1
    s_waitcnt vmcnt(0)
    s_branch L_xsb_f_w1
L_redo_f_w1:
    v_cmp_u_f32 vcc, v48, v48
    s_nop 0
    s_cbranch_vccz L_xs_f_w1
    s_add_u32 s61, s61, 1
    s_add_u32 s37, s37, 64
    s_cmp_gt_u32 s37, 400000
    s_cbranch_scc0 L_redo2_f_w1
    s_cmp_eq_u32 s22, s5
    s_cbranch_scc1 L_xs_f_w1
    s_branch L_xsb_f_w1
L_redo2_f_w1:
    s_waitcnt vmcnt(0) lgkmcnt(0)
    s_barrier
    s_mov_b32 m0, 4096
    s_add_u32 s34, s29, 4096
    buffer_load_dwordx4 v0, s[12:15], s34 offen offset:0 sc1 lds
    buffer_load_dwordx4 v0, s[12:15], s34 offen offset:1024 sc1 lds
    buffer_load_dwordx4 v0, s[12:15], s34 offen offset:2048 sc1 lds
    buffer_load_dwordx4 v0, s[12:15], s34 offen offset:3072 sc1 lds
    s_mov_b32 m0, 5120
    s_add_u32 s34, s29, 5120
    s_nop 7
    v_mov_b64 v[48:49], 0
    v_mov_b64 v[50:51], 0
    v_mov_b64 v[52:53], 0
    v_mov_b64 v[54:55], 0
    v_mov_b64 v[56:57], 0
    v_mov_b64 v[58:59], 0
    v_mov_b64 v[60:61], 0
    v_mov_b64 v[62:63], 0
    ds_read_b128 v[8:11], v1 offset:0
    ds_read_b128 v[12:15], v1 offset:1024
    ds_read_b128 v[16:19], v1 offset:2048
    ds_read_b128 v[20:23], v1 offset:3072
    s_waitcnt vmcnt(0) lgkmcnt(0)
    s_barrier
    s_branch L_pa_f_w1
L_max_f_w1:
    s_cmp_eq_u32 s4, s23
    s_cbranch_scc1 L_maxskip_f_w1
    s_mov_b32 s4, s23
    s_nop 7
    ds_read_b128 v[60:63], v0 offset:9216
    ds_read_b128 v[72:75], v0 offset:11264
    ds_read_b128 v[76:79], v0 offset:12288
    ds_read_b128 v[64:67], v0 offset:10240
    ds_read_b128 v[68:71], v6 offset:13312
    ds_read_b128 v[56:59], v6 offset:13344
    s_waitcnt lgkmcnt(2)
    v_add_f32 v60, v60, v64
    v_add_f32 v61, v61, v65
    v_add_f32 v62, v62, v66
    v_add_f32 v63, v63, v67
    v_add_f32 v72, v72, v76
    v_add_f32 v73, v73, v77
    v_add_f32 v74, v74, v78
    v_add_f32 v75, v75, v79
    v_add_f32 v60, v60, v72
    v_add_f32 v61, v61, v73
    v_add_f32 v62, v62, v74
    v_add_f32 v63, v63, v75
    s_waitcnt lgkmcnt(0)
    v_add_f32 v68, v68, v56
    v_add_f32 v69, v69, v57
    v_add_f32 v70, v70, v58
    v_add_f32 v71, v71, v59
    v_add_f32 v68, v68, v70
    v_add_f32 v69, v69, v71
    v_pk_mul_f32 v[68:69], v[68:69], s[32:33] op_sel_hi:[1,0]
    v_max3_f32 v64, v60, v61, v62
    v_max3_f32 v65, v63, v68, v69
    v_max_f32 v64, v64, v65
    s_nop 1
    v_max_f32_dpp v64, v64, v64 quad_perm:[2,3,0,1] row_mask:0xf bank_mask:0xf
    v_mov_b32 v65, v64
    s_nop 1
    v_permlane16_swap_b32 v64, v65
    v_max_f32 v64, v64, v65
    v_mov_b32 v65, v64
    s_nop 1
    v_permlane32_swap_b32 v64, v65
    v_max_f32 v64, v64, v65
    v_sub_f32 v60, v60, v64
    v_sub_f32 v61, v61, v64
    v_sub_f32 v62, v62, v64
    v_sub_f32 v63, v63, v64
    v_sub_f32 v68, v68, v64
    v_sub_f32 v69, v69, v64
    v_exp_f32 v60, v60
    v_exp_f32 v61, v61
    v_exp_f32 v62, v62
    v_exp_f32 v63, v63
    v_exp_f32 v68, v68
    v_exp_f32 v69, v69
    s_add_u32 s62, s62, 1
    s_waitcnt lgkmcnt(0)
    s_branch L_maxback_f_w1
L_redslow_f_w1:
    buffer_store_byte v70, v0, s[40:43], 0 offen
L_redslow2_f_w1:
    buffer_load_dwordx4 v[24:27], v3, s[12:15], s27 offen offset:0 sc1
    buffer_load_dwordx4 v[28:31], v3, s[12:15], s27 offen offset:512 sc1
    buffer_load_dwordx4 v[32:35], v3, s[12:15], s27 offen offset:1024 sc1
    buffer_load_dwordx4 v[36:39], v3, s[12:15], s27 offen offset:1536 sc1
    s_add_u32 s60, s60, 1
    s_add_u32 s37, s37, 1
    s_cmp_gt_u32 s37, 400000
    s_cbranch_scc1 L_redgo_f_w1
    s_waitcnt vmcnt(3)
    v_mfma_f32_16x16x32_bf16 v[40:43], v[44:47], v[24:27], 0
    v_xor_b32 v66, v64, v24
    s_waitcnt vmcnt(2)
    v_mfma_f32_16x16x32_bf16 v[40:43], v[44:47], v[28:31], v[40:43]
    v_bitop3_b32 v66, v66, v64, v28 bitop3:0xf6
    s_waitcnt vmcnt(1)
    v_mfma_f32_16x16x32_bf16 v[40:43], v[44:47], v[32:35], v[40:43]
    v_bitop3_b32 v66, v66, v64, v32 bitop3:0xf6
    s_waitcnt vmcnt(0)
    v_mfma_f32_16x16x32_bf16 v[40:43], v[44:47], v[36:39], v[40:43]
    v_bitop3_b32 v66, v66, v64, v36 bitop3:0xf6
    v_and_b32 v66, 1, v66
    v_cmp_ne_u32 vcc, 0, v66
    s_nop 0
    s_cbranch_vccnz L_redslow2_f_w1
L_redgo_f_w1:
    s_waitcnt vmcnt(0)
    v_mov_b32 v71, 0
    s_nop 0
    v_add_f32_dpp v40, v40, v40 row_ror:8 row_mask:0xf bank_mask:0xf
    v_add_f32_dpp v41, v41, v41 row_ror:8 row_mask:0xf bank_mask:0xf
    v_cvt_pk_bf16_f32 v40, v40, v41
    buffer_store_dword v40, v65, s[12:15], s34 offen
    buffer_store_dword v70, v65, s[12:15], s35 offen
    buffer_store_byte v71, v0, s[40:43], 0 offen
    s_branch L_redend_f_w1
.p2align 6
L_loop_f_w2:
    s_add_u32 s31, s31, 524288
    s_mov_b32 m0, 6144
    s_add_u32 s34, s29, 6144
    s_waitcnt lgkmcnt(0)
    s_barrier
L_pa_f_w2:
    ds_read_b128 v[24:27], v0 offset:0
    ds_read_b128 v[28:31], v0 offset:1024
    buffer_load_dwordx4 v0, s[12:15], s34 offen sc1 lds
    s_waitcnt lgkmcnt(1)
    v_smfmac_f32_16x16x64_bf16 v[48:51], v[24:27], v[8:15], v2
    ds_read_b128 v[8:11], v1 offset:4096
    v_smfmac_f32_16x16x64_bf16 v[52:55], v[24:27], v[16:23], v2
    ds_read_b128 v[12:15], v1 offset:5120
    v_smfmac_f32_16x16x64_bf16 v[56:59], v[24:27], a[0:7], v2
    ds_read_b128 v[16:19], v1 offset:6144
    v_smfmac_f32_16x16x64_bf16 v[60:63], v[24:27], a[8:15], v2
    ds_read_b128 v[20:23], v1 offset:7168
    buffer_load_dwordx4 v[64:67], v0, s[16:19], s31 offen offset:0 sc1
    s_barrier
    s_waitcnt lgkmcnt(4)
    v_smfmac_f32_16x16x64_bf16 v[48:51], v[28:31], a[16:23], v2
    ds_read_b128 v[32:35], v0 offset:2048
    v_smfmac_f32_16x16x64_bf16 v[52:55], v[28:31], a[24:31], v2
    v_smfmac_f32_16x16x64_bf16 v[56:59], v[28:31], a[32:39], v2
    ds_read_b128 v[36:39], v0 offset:3072
    v_smfmac_f32_16x16x64_bf16 v[60:63], v[28:31], a[40:47], v2
    ds_read_b128 v[24:27], v0 offset:8192
    buffer_load_dwordx4 v[68:71], v0, s[16:19], s31 offen offset:1024 sc1
    s_waitcnt lgkmcnt(2)
    v_smfmac_f32_16x16x64_bf16 v[48:51], v[32:35], v[8:15], v2
    ds_read_b128 v[8:11], v1 offset:8192
    v_smfmac_f32_16x16x64_bf16 v[52:55], v[32:35], v[16:23], v2
    ds_read_b128 v[12:15], v1 offset:9216
    v_smfmac_f32_16x16x64_bf16 v[56:59], v[32:35], a[48:55], v2
    ds_read_b128 v[16:19], v1 offset:10240
    v_smfmac_f32_16x16x64_bf16 v[60:63], v[32:35], a[56:63], v2
    ds_read_b128 v[20:23], v1 offset:11264
    buffer_load_dwordx4 v[40:43], v0, s[16:19], s31 offen offset:2048 sc1
    s_waitcnt lgkmcnt(5)
    v_smfmac_f32_16x16x64_bf16 v[48:51], v[36:39], a[64:71], v2
    v_add_u32 v72, s33, v0
    v_smfmac_f32_16x16x64_bf16 v[52:55], v[36:39], a[72:79], v2
    s_sub_u32 s35, s25, 1
    s_waitcnt lgkmcnt(2)
    v_smfmac_f32_16x16x64_bf16 v[56:59], v[36:39], v[8:15], v2
    ds_read_b128 v[8:11], v1 offset:12288
    v_mov_b32 v76, s35
    s_waitcnt lgkmcnt(1)
    v_smfmac_f32_16x16x64_bf16 v[60:63], v[36:39], v[16:23], v2
    ds_read_b128 v[12:15], v1 offset:13312
    buffer_load_dwordx4 v[44:47], v0, s[16:19], s31 offen offset:3072 sc1
    s_waitcnt vmcnt(4)
    s_barrier
    v_smfmac_f32_16x16x64_bf16 v[48:51], v[24:27], a[80:87], v2
    ds_read_b128 v[28:31], v0 offset:4096
    buffer_store_dword v76, v0, s[48:51], 0 offen sc1
    v_smfmac_f32_16x16x64_bf16 v[52:55], v[24:27], a[88:95], v2
    ds_read_b128 v[72:75], v72 offset:0
    v_smfmac_f32_16x16x64_bf16 v[56:59], v[24:27], a[96:103], v2
    ds_read_b128 v[32:35], v0 offset:5120
    v_smfmac_f32_16x16x64_bf16 v[60:63], v[24:27], a[104:111], v2
    ds_read_b128 v[16:19], v1 offset:14336
    s_waitcnt lgkmcnt(3)
    v_smfmac_f32_16x16x64_bf16 v[48:51], v[28:31], a[112:119], v2
    ds_read_b128 v[36:39], v0 offset:6144
    v_smfmac_f32_16x16x64_bf16 v[52:55], v[28:31], a[120:127], v2
    ds_read_b128 v[20:23], v1 offset:15360
    s_waitcnt lgkmcnt(4)
    buffer_store_dwordx4 v[72:75], v0, s[44:47], 0 offen sc1
    s_waitcnt lgkmcnt(3)
    v_smfmac_f32_16x16x64_bf16 v[48:51], v[32:35], a[128:135], v2
    ds_read_b128 v[24:27], v0 offset:7168
    v_smfmac_f32_16x16x64_bf16 v[52:55], v[32:35], a[136:143], v2
    s_waitcnt lgkmcnt(2)
    v_smfmac_f32_16x16x64_bf16 v[48:51], v[36:39], v[8:15], v2
    ds_read_b128 v[8:11], v1 offset:16384
    s_waitcnt lgkmcnt(2)
    v_smfmac_f32_16x16x64_bf16 v[52:55], v[36:39], v[16:23], v2
    ds_read_b128 v[12:15], v1 offset:17408
    s_waitcnt lgkmcnt(2)
    v_smfmac_f32_16x16x64_bf16 v[48:51], v[24:27], a[144:151], v2
    ds_read_b128 v[16:19], v1 offset:18432
    v_smfmac_f32_16x16x64_bf16 v[52:55], v[24:27], a[152:159], v2
    ds_read_b128 v[20:23], v1 offset:19456
    v_smfmac_f32_16x16x64_bf16 v[56:59], v[28:31], a[160:167], v2
    v_cvt_pk_bf16_f32 v72, v48, v49
    v_smfmac_f32_16x16x64_bf16 v[60:63], v[28:31], a[168:175], v2
    v_cvt_pk_bf16_f32 v73, v50, v51
    v_smfmac_f32_16x16x64_bf16 v[56:59], v[32:35], a[176:183], v2
    v_cvt_pk_bf16_f32 v74, v52, v53
    v_mfma_f32_16x16x16_bf16 v[48:51], v[72:73], v[4:5], 0
    s_waitcnt lgkmcnt(0)
    v_cvt_pk_bf16_f32 v75, v54, v55
    v_smfmac_f32_16x16x64_bf16 v[60:63], v[32:35], a[184:191], v2
    s_cmp_eq_u32 s22, s5
    s_cselect_b64 s[6:7], -1, 0
    v_mfma_f32_16x16x16_bf16 v[52:55], v[74:75], v[4:5], 0
    s_waitcnt vmcnt(4)
    v_cvt_pk_bf16_f32 v76, v48, v49
    v_cvt_pk_bf16_f32 v77, v50, v51
    v_smfmac_f32_16x16x64_bf16 v[56:59], v[36:39], v[8:15], v2
    ds_read_b128 v[8:11], v1 offset:20480
    v_cmp_u_f32 vcc, v48, v48
    v_smfmac_f32_16x16x64_bf16 v[60:63], v[36:39], v[16:23], v2
    ds_read_b128 v[12:15], v1 offset:21504
    v_cvt_pk_bf16_f32 v78, v52, v53
    v_smfmac_f32_16x16x64_bf16 v[56:59], v[24:27], a[192:199], v2
    ds_read_b128 v[16:19], v1 offset:22528
    s_or_b64 vcc, vcc, s[6:7]
    v_cvt_pk_bf16_f32 v79, v54, v55
    v_smfmac_f32_16x16x64_bf16 v[60:63], v[24:27], a[200:207], v2
    ds_read_b128 v[20:23], v1 offset:23552
    s_cbranch_scc1 L_redo_f_w2
L_xsb_f_w2:
    v_mov_b64 v[48:49], 0
    v_mfma_f32_16x16x32_bf16 v[64:67], v[64:67], v[76:79], 0
    v_cvt_pk_bf16_f32 v72, v56, v57
    v_cvt_pk_bf16_f32 v73, v58, v59
    v_mfma_f32_16x16x32_bf16 v[68:71], v[68:71], v[76:79], 0
    v_cvt_pk_bf16_f32 v74, v60, v61
    v_cvt_pk_bf16_f32 v75, v62, v63
    v_mfma_f32_16x16x16_bf16 v[56:59], v[72:73], v[4:5], 0
    s_mov_b32 s30, s29
    v_mov_b64 v[50:51], 0
    v_mov_b64 v[52:53], 0
    v_mfma_f32_16x16x16_bf16 v[60:63], v[74:75], v[4:5], 0
    s_add_u32 s29, s29, 9216
    v_mov_b64 v[54:55], 0
    v_cndmask_b32 v64, v64, v68, s[58:59]
    v_smfmac_f32_16x16x64_bf16 v[48:51], v[28:31], a[208:215], v2
    s_add_u32 s22, s22, 1
    s_add_u32 s23, s23, 1
    v_cvt_pk_bf16_f32 v72, v56, v57
    v_cvt_pk_bf16_f32 v73, v58, v59
    v_cvt_pk_bf16_f32 v74, v60, v61
    v_cvt_pk_bf16_f32 v75, v62, v63
    v_smfmac_f32_16x16x64_bf16 v[52:55], v[28:31], a[216:223], v2
    ds_read_b128 v[28:31], v0 offset:0
    s_add_u32 s25, s25, 1
    v_cndmask_b32 v65, v65, v69, s[58:59]
    v_mfma_f32_16x16x32_bf16 v[56:59], v[72:75], v[76:79], 0
    s_cmp_eq_u32 s29, 355328
    v_cndmask_b32 v66, v66, v70, s[58:59]
    v_cndmask_b32 v67, v67, v71, s[58:59]
    v_smfmac_f32_16x16x64_bf16 v[48:51], v[32:35], a[224:231], v2
    ds_write_b128 v0, v[64:67] offset:11264
    s_cselect_b32 s29, 327680, s29
    v_smfmac_f32_16x16x64_bf16 v[52:55], v[32:35], a[232:239], v2
    ds_read_b128 v[32:35], v0 offset:1024
    v_smfmac_f32_16x16x64_bf16 v[48:51], v[36:39], a[240:247], v2
    ds_write_b64 v6, v[56:57] offset:13344
    v_smfmac_f32_16x16x64_bf16 v[52:55], v[36:39], a[248:255], v2
    ds_read_b128 v[36:39], v0 offset:2048
    v_smfmac_f32_16x16x64_bf16 v[48:51], v[24:27], v[80:87], v2
    v_smfmac_f32_16x16x64_bf16 v[52:55], v[24:27], v[88:95], v2
    ds_read_b128 v[24:27], v0 offset:3072
    s_waitcnt lgkmcnt(5)
    v_smfmac_f32_16x16x64_bf16 v[48:51], v[28:31], v[96:103], v2
    s_waitcnt lgkmcnt(2)
    s_barrier
    ds_read_b128 v[60:63], v0 offset:9216
    v_smfmac_f32_16x16x64_bf16 v[52:55], v[28:31], v[104:111], v2
    ds_read_b128 v[72:75], v0 offset:10240
    s_add_u32 s44, s44, 9216
    v_smfmac_f32_16x16x64_bf16 v[48:51], v[32:35], v[112:119], v2
    ds_read_b128 v[76:79], v0 offset:12288
    s_addc_u32 s45, s45, 0
    v_smfmac_f32_16x16x64_bf16 v[52:55], v[32:35], v[120:127], v2
    ds_read_b128 v[28:31], v0 offset:8192
    s_waitcnt lgkmcnt(5)
    v_smfmac_f32_16x16x64_bf16 v[48:51], v[36:39], v[128:135], v2
    ds_read_b128 v[68:71], v6 offset:13312
    v_mov_b64 v[32:33], s[2:3]
    v_smfmac_f32_16x16x64_bf16 v[52:55], v[36:39], v[136:143], v2
    ds_read_b128 v[56:59], v6 offset:13344
    v_mov_b64 v[34:35], s[2:3]
    s_waitcnt lgkmcnt(6)
    v_smfmac_f32_16x16x64_bf16 v[48:51], v[24:27], v[144:151], v2
    v_mov_b64 v[36:37], s[0:1]
    v_smfmac_f32_16x16x64_bf16 v[52:55], v[24:27], v[152:159], v2
    s_waitcnt lgkmcnt(4)
    v_add_f32 v60, v60, v72
    s_waitcnt lgkmcnt(2)
    v_smfmac_f32_16x16x64_bf16 v[48:51], v[28:31], v[8:15], v2
    ds_read_b128 v[8:11], v1 offset:24576
    v_add_f32 v61, v61, v73
    v_smfmac_f32_16x16x64_bf16 v[52:55], v[28:31], v[16:23], v2
    ds_read_b128 v[12:15], v1 offset:25600
    v_add_f32 v62, v62, v74
    v_add_f32 v63, v63, v75
    v_pk_add_f32 v[64:65], v[64:65], v[76:77]
    v_pk_add_f32 v[66:67], v[66:67], v[78:79]
    v_pk_add_f32 v[60:61], v[60:61], v[64:65]
    v_pk_add_f32 v[62:63], v[62:63], v[66:67]
    s_waitcnt lgkmcnt(2)
    v_pk_add_f32 v[68:69], v[68:69], v[56:57]
    v_pk_add_f32 v[70:71], v[70:71], v[58:59]
    v_pk_add_f32 v[68:69], v[68:69], v[70:71]
    v_pk_mul_f32 v[68:69], v[68:69], s[32:33] op_sel_hi:[1,0]
    v_exp_f32 v60, v60
    v_exp_f32 v61, v61
    v_exp_f32 v62, v62
    v_exp_f32 v63, v63
    v_exp_f32 v68, v68
    v_exp_f32 v69, v69
L_maxback_f_w2:
    v_cvt_pk_bf16_f32 v72, v60, v61
    v_cvt_pk_bf16_f32 v73, v62, v63
    v_cvt_pk_bf16_f32 v76, v68, v68
    v_mov_b32_dpp v74, v72 quad_perm:[2,3,0,1] row_mask:0xf bank_mask:0xf
    v_mov_b32_dpp v75, v73 quad_perm:[2,3,0,1] row_mask:0xf bank_mask:0xf
    v_cvt_pk_bf16_f32 v77, v69, v69
    v_cvt_pk_bf16_f32 v24, v48, v49
    v_mfma_f32_16x16x32_bf16 v[28:31], v[32:35], v[72:75], 0
    s_waitcnt vmcnt(2)
    v_cvt_pk_bf16_f32 v25, v50, v51
    v_cvt_pk_bf16_f32 v26, v52, v53
    v_mfma_f32_16x16x32_bf16 v[56:59], v[40:43], v[72:75], 0
    ds_read_b128 v[16:19], v1 offset:26624
    v_cvt_pk_bf16_f32 v27, v54, v55
    v_mfma_f32_16x16x16_bf16 v[28:31], v[36:37], v[76:77], v[28:31]
    ds_read_b128 v[20:23], v1 offset:27648
    v_mfma_f32_16x16x32_bf16 v[68:71], v[44:47], v[72:75], 0
    v_mfma_f32_16x16x16_bf16 v[56:59], v[24:25], v[76:77], v[56:59]
    v_rcp_f32 v30, v28
    v_mfma_f32_16x16x16_bf16 v[68:71], v[26:27], v[76:77], v[68:71]
    v_max_f32 v28, v28, v30
    v_cmp_ngt_f32 vcc, s38, v28
    v_mov_b64 v[38:39], 0
    v_mov_b32 v78, s23
    v_pk_mul_f32 v[56:57], v[56:57], v[30:31] op_sel_hi:[1,0]
    v_pk_mul_f32 v[58:59], v[58:59], v[30:31] op_sel_hi:[1,0]
    v_cvt_pk_bf16_f32 v64, v56, v57
    v_cvt_pk_bf16_f32 v65, v58, v59
    v_pk_mul_f32 v[68:69], v[68:69], v[30:31] op_sel_hi:[1,0]
    v_pk_mul_f32 v[70:71], v[70:71], v[30:31] op_sel_hi:[1,0]
    s_cbranch_vccnz L_max_f_w2
L_maxskip_f_w2:
    v_cvt_pk_bf16_f32 v66, v68, v69
    v_cvt_pk_bf16_f32 v67, v70, v71
    v_mfma_f32_16x16x16_bf16 v[48:51], v[38:39], v[38:39], 0
    ds_write_b128 v7, v[64:67]
    v_mov_b64 v[34:35], 0
    v_mov_b64 v[36:37], 0
    v_mov_b64 v[40:41], 0
    v_mov_b64 v[42:43], 0
    v_mov_b64 v[44:45], 0
    v_mov_b64 v[46:47], 0
    v_mov_b64 v[56:57], 0
    v_mov_b64 v[58:59], 0
    v_mov_b64 v[24:25], 0
    v_mov_b64 v[26:27], 0
    v_mov_b64 v[28:29], 0
    v_mov_b64 v[30:31], 0
    v_mfma_f32_16x16x16_bf16 v[52:55], v[38:39], v[38:39], 0
    s_waitcnt lgkmcnt(0)
    s_barrier
    ds_read_b128 v[64:67], v0 offset:14336
    v_mov_b32 v32, 0
    ds_read_b128 v[68:71], v0 offset:15360
    v_mov_b32 v33, 0
    v_cndmask_b32 v62, 0, 1, s[56:57]
    v_lshrrev_b32 v63, 1, v0
    s_waitcnt lgkmcnt(1)
    v_smfmac_f32_16x16x64_bf16 v[24:27], v[64:67], v[8:15], v2
    ds_read_b128 v[8:11], v1 offset:28672
    s_waitcnt lgkmcnt(1)
    v_smfmac_f32_16x16x64_bf16 v[24:27], v[68:71], v[16:23], v2
    ds_read_b128 v[12:15], v1 offset:29696
    v_smfmac_f32_16x16x64_bf16 v[28:31], v[64:67], v[160:167], v2
    ds_read_b128 v[16:19], v1 offset:30720
    buffer_store_dword v78, v0, s[52:55], 0 offen
    v_smfmac_f32_16x16x64_bf16 v[28:31], v[68:71], v[168:175], v2
    ds_read_b128 v[20:23], v1 offset:31744
    v_add_f32 v24, v24, v25
    v_add_f32 v26, v26, v27
    v_smfmac_f32_16x16x64_bf16 v[32:35], v[64:67], v[176:183], v2
    v_cvt_pk_bf16_f32 v24, v24, v26
    v_bfi_b32 v72, v62, s23, v24
    v_smfmac_f32_16x16x64_bf16 v[32:35], v[68:71], v[184:191], v2
    v_add_f32 v28, v28, v29
    v_add_f32 v30, v30, v31
    v_smfmac_f32_16x16x64_bf16 v[36:39], v[64:67], v[192:199], v2
    v_cvt_pk_bf16_f32 v73, v28, v30
    v_smfmac_f32_16x16x64_bf16 v[36:39], v[68:71], v[200:207], v2
    v_add_f32 v32, v32, v33
    v_add_f32 v34, v34, v35
    s_waitcnt lgkmcnt(2)
    v_smfmac_f32_16x16x64_bf16 v[40:43], v[64:67], v[8:15], v2
    ds_read_b128 v[8:11], v1 offset:32768
    buffer_store_dwordx2 v[72:73], v63, s[12:15], s24 offen
    s_add_u32 s26, s24, 65536
    v_cvt_pk_bf16_f32 v32, v32, v34
    v_bfi_b32 v74, v62, s23, v32
    s_waitcnt lgkmcnt(1)
    v_smfmac_f32_16x16x64_bf16 v[40:43], v[68:71], v[16:23], v2
    ds_read_b128 v[12:15], v1 offset:33792
    v_add_f32 v36, v36, v37
    v_add_f32 v38, v38, v39
    v_smfmac_f32_16x16x64_bf16 v[44:47], v[64:67], v[208:215], v2
    ds_read_b128 v[16:19], v1 offset:34816
    v_cvt_pk_bf16_f32 v75, v36, v38
    v_smfmac_f32_16x16x64_bf16 v[44:47], v[68:71], v[216:223], v2
    ds_read_b128 v[20:23], v1 offset:35840
    v_add_f32 v40, v40, v41
    v_add_f32 v42, v42, v43
    v_smfmac_f32_16x16x64_bf16 v[48:51], v[64:67], v[224:231], v2
    buffer_store_dwordx2 v[74:75], v63, s[12:15], s26 offen
    s_add_u32 s26, s24, 262144
    v_cvt_pk_bf16_f32 v40, v40, v42
    v_bfi_b32 v72, v62, s23, v40
    v_smfmac_f32_16x16x64_bf16 v[48:51], v[68:71], v[232:239], v2
    v_add_f32 v44, v44, v45
    v_add_f32 v46, v46, v47
    v_smfmac_f32_16x16x64_bf16 v[52:55], v[64:67], v[240:247], v2
    buffer_store_dwordx2 v[72:73], v63, s[12:15], s26 offen
    s_add_u32 s26, s24, 131072
    v_cvt_pk_bf16_f32 v44, v44, v46
    v_bfi_b32 v76, v62, s23, v44
    v_smfmac_f32_16x16x64_bf16 v[52:55], v[68:71], v[248:255], v2
    v_add_f32 v48, v48, v49
    v_add_f32 v50, v50, v51
    s_waitcnt lgkmcnt(2)
    v_smfmac_f32_16x16x64_bf16 v[56:59], v[64:67], v[8:15], v2
    ds_read_b128 v[8:11], v1 offset:0
    v_cvt_pk_bf16_f32 v77, v48, v50
    s_waitcnt lgkmcnt(1)
    v_smfmac_f32_16x16x64_bf16 v[56:59], v[68:71], v[16:23], v2
    ds_read_b128 v[12:15], v1 offset:1024
    buffer_store_dwordx2 v[76:77], v63, s[12:15], s26 offen
    s_add_u32 s26, s24, 196608
    v_add_f32 v52, v52, v53
    v_add_f32 v54, v54, v55
    v_cvt_pk_bf16_f32 v52, v52, v54
    v_bfi_b32 v78, v62, s23, v52
    s_nop 0
    v_add_f32 v56, v56, v57
    v_add_f32 v58, v58, v59
    v_cvt_pk_bf16_f32 v79, v56, v58
    buffer_store_dwordx2 v[78:79], v63, s[12:15], s26 offen
    s_barrier
    ds_read_b128 v[16:19], v1 offset:2048
    ds_read_b128 v[20:23], v1 offset:3072
    s_cmp_ge_u32 s21, 16
    s_cbranch_scc1 L_nored_f_w2
    v_bfe_u32 v66, v0, 6, 1
    v_lshlrev_b32 v66, 4, v66
    v_mov_b32 v67, 0x3f80
    v_lshlrev_b32 v67, v66, v67
    v_and_b32 v66, 0xb0, v0
    v_cmp_eq_u32 vcc, 0, v66
    v_cmp_eq_u32 s[34:35], 16, v66
    v_lshrrev_b32 v68, 9, v0
    v_cndmask_b32 v44, 0, v67, vcc
    v_cndmask_b32 v46, 0, v67, s[34:35]
    v_cmp_eq_u32 vcc, 0x80, v66
    v_lshlrev_b32 v68, 10, v68
    buffer_load_dwordx4 v[24:27], v3, s[12:15], s27 offen offset:0 sc1
    buffer_load_dwordx4 v[28:31], v3, s[12:15], s27 offen offset:512 sc1
    buffer_load_dwordx4 v[32:35], v3, s[12:15], s27 offen offset:1024 sc1
    buffer_load_dwordx4 v[36:39], v3, s[12:15], s27 offen offset:1536 sc1
    v_bfe_u32 v69, v0, 8, 1
    v_cndmask_b32 v45, 0, v67, vcc
    v_cmp_eq_u32 vcc, 0x90, v66
    v_lshl_add_u32 v68, v69, 5, v68
    v_bfe_u32 v69, v0, 4, 3
    v_cndmask_b32 v47, 0, v67, vcc
    v_lshl_add_u32 v68, v69, 2, v68
    v_and_b32 v69, 640, v0
    v_cmp_eq_u32 vcc, 0, v69
    v_mov_b32 v69, 0x40000000
    s_nop 0
    v_cndmask_b32 v65, v69, v68, vcc
    v_mov_b32 v70, -1
    v_mov_b32 v64, s23
    s_add_u32 s34, s28, s29
    s_add_u32 s35, s28, s30
    v_mov_b64 v[48:49], 0
    v_mov_b64 v[50:51], 0
    v_mov_b64 v[52:53], 0
    v_mov_b64 v[54:55], 0
    v_mov_b64 v[56:57], 0
    v_mov_b64 v[58:59], 0
    v_mov_b64 v[60:61], 0
    v_mov_b64 v[62:63], 0
    s_waitcnt vmcnt(3)
    v_mfma_f32_16x16x32_bf16 v[40:43], v[44:47], v[24:27], 0
    v_xor_b32 v66, v64, v24
    s_waitcnt vmcnt(2)
    v_mfma_f32_16x16x32_bf16 v[40:43], v[44:47], v[28:31], v[40:43]
    v_bitop3_b32 v66, v66, v64, v28 bitop3:0xf6
    s_waitcnt vmcnt(1)
    v_mfma_f32_16x16x32_bf16 v[40:43], v[44:47], v[32:35], v[40:43]
    v_bitop3_b32 v66, v66, v64, v32 bitop3:0xf6
    s_waitcnt vmcnt(0)
    v_mfma_f32_16x16x32_bf16 v[40:43], v[44:47], v[36:39], v[40:43]
    v_bitop3_b32 v66, v66, v64, v36 bitop3:0xf6
    v_and_b32 v66, 1, v66
    v_cmp_ne_u32 vcc, 0, v66
    s_nop 0
    s_cbranch_vccnz L_redslow_f_w2
    s_nop 2
    v_add_f32_dpp v40, v40, v40 row_ror:8 row_mask:0xf bank_mask:0xf
    v_add_f32_dpp v41, v41, v41 row_ror:8 row_mask:0xf bank_mask:0xf
    v_cvt_pk_bf16_f32 v40, v40, v41
    buffer_store_dword v40, v65, s[12:15], s34 offen
    buffer_store_dword v70, v65, s[12:15], s35 offen
L_redend_f_w2:
    s_branch L_loop_f_w2
L_xs_f_w2:
    s_cmp_lg_u32 s5, 0
    s_cbranch_scc1 L_team_exit
    s_mov_b32 s5, 63
    s_lshl_b32 s35, s21, 7
    s_add_u32 s35, s35, 397312
L_xl_f_w2:
    buffer_load_dword v72, off, s[12:15], s35 sc1
    s_add_u32 s37, s37, 1
    s_cmp_gt_u32 s37, 400000
    s_waitcnt vmcnt(0)
    s_cbranch_scc1 L_xg_f_w2
    v_cmp_gt_u32 vcc, s25, v72
    s_nop 0
    s_cbranch_vccnz L_xl_f_w2
L_xg_f_w2:
    buffer_load_dwordx4 v[64:67], v0, s[16:19], s31 offen offset:0 sc1
    buffer_load_dwordx4 v[68:71], v0, s[16:19], s31 offen offset:1024 sc1
    buffer_load_dwordx4 v[40:43], v0, s[16:19], s31 offen offset:2048 sc1
    buffer_load_dwordx4 v[44:47], v0, s[16:19], s31 offen offset:3072 sc1
    s_waitcnt vmcnt(0)
    s_branch L_xsb_f_w2
L_redo_f_w2:
    v_cmp_u_f32 vcc, v48, v48
    s_nop 0
    s_cbranch_vccz L_xs_f_w2
    s_add_u32 s61, s61, 1
    s_add_u32 s37, s37, 64
    s_cmp_gt_u32 s37, 400000
    s_cbranch_scc0 L_redo2_f_w2
    s_cmp_eq_u32 s22, s5
    s_cbranch_scc1 L_xs_f_w2
    s_branch L_xsb_f_w2
L_redo2_f_w2:
    s_waitcnt vmcnt(0) lgkmcnt(0)
    s_barrier
    s_mov_b32 m0, 8192
    s_add_u32 s34, s29, 8192
    buffer_load_dwordx4 v0, s[12:15], s34 offen offset:0 sc1 lds
    s_mov_b32 m0, 6144
    s_add_u32 s34, s29, 6144
    s_nop 7
    v_mov_b64 v[48:49], 0
    v_mov_b64 v[50:51], 0
    v_mov_b64 v[52:53], 0
    v_mov_b64 v[54:55], 0
    v_mov_b64 v[56:57], 0
    v_mov_b64 v[58:59], 0
    v_mov_b64 v[60:61], 0
    v_mov_b64 v[62:63], 0
    ds_read_b128 v[8:11], v1 offset:0
    ds_read_b128 v[12:15], v1 offset:1024
    ds_read_b128 v[16:19], v1 offset:2048
    ds_read_b128 v[20:23], v1 offset:3072
    s_waitcnt vmcnt(0) lgkmcnt(0)
    s_barrier
    s_branch L_pa_f_w2
L_max_f_w2:
    s_cmp_eq_u32 s4, s23
    s_cbranch_scc1 L_maxskip_f_w2
    s_mov_b32 s4, s23
    s_nop 7
    ds_read_b128 v[60:63], v0 offset:9216
    ds_read_b128 v[72:75], v0 offset:10240
    ds_read_b128 v[76:79], v0 offset:12288
    ds_read_b128 v[64:67], v0 offset:11264
    ds_read_b128 v[68:71], v6 offset:13312
    ds_read_b128 v[56:59], v6 offset:13344
    s_waitcnt lgkmcnt(4)
    v_add_f32 v60, v60, v72
    v_add_f32 v61, v61, v73
    v_add_f32 v62, v62, v74
    v_add_f32 v63, v63, v75
    s_waitcnt lgkmcnt(2)
    v_add_f32 v64, v64, v76
    v_add_f32 v65, v65, v77
    v_add_f32 v66, v66, v78
    v_add_f32 v67, v67, v79
    v_add_f32 v60, v60, v64
    v_add_f32 v61, v61, v65
    v_add_f32 v62, v62, v66
    v_add_f32 v63, v63, v67
    s_waitcnt lgkmcnt(0)
    v_add_f32 v68, v68, v56
    v_add_f32 v69, v69, v57
    v_add_f32 v70, v70, v58
    v_add_f32 v71, v71, v59
    v_add_f32 v68, v68, v70
    v_add_f32 v69, v69, v71
    v_pk_mul_f32 v[68:69], v[68:69], s[32:33] op_sel_hi:[1,0]
    v_max3_f32 v72, v60, v61, v62
    v_max3_f32 v73, v63, v68, v69
    v_max_f32 v72, v72, v73
    s_nop 1
    v_max_f32_dpp v72, v72, v72 quad_perm:[2,3,0,1] row_mask:0xf bank_mask:0xf
    v_mov_b32 v73, v72
    s_nop 1
    v_permlane16_swap_b32 v72, v73
    v_max_f32 v72, v72, v73
    v_mov_b32 v73, v72
    s_nop 1
    v_permlane32_swap_b32 v72, v73
    v_max_f32 v72, v72, v73
    v_sub_f32 v60, v60, v72
    v_sub_f32 v61, v61, v72
    v_sub_f32 v62, v62, v72
    v_sub_f32 v63, v63, v72
    v_sub_f32 v68, v68, v72
    v_sub_f32 v69, v69, v72
    v_exp_f32 v60, v60
    v_exp_f32 v61, v61
    v_exp_f32 v62, v62
    v_exp_f32 v63, v63
    v_exp_f32 v68, v68
    v_exp_f32 v69, v69
    s_add_u32 s62, s62, 1
    s_waitcnt lgkmcnt(0)
    s_branch L_maxback_f_w2
L_nored_f_w2:
    v_mov_b64 v[48:49], 0
    v_mov_b64 v[50:51], 0
    v_mov_b64 v[52:53], 0
    v_mov_b64 v[54:55], 0
    v_mov_b64 v[56:57], 0
    v_mov_b64 v[58:59], 0
    v_mov_b64 v[60:61], 0
    v_mov_b64 v[62:63], 0
    s_branch L_redend_f_w2
L_redslow_f_w2:
    buffer_store_byte v70, v0, s[40:43], 0 offen
L_redslow2_f_w2:
    buffer_load_dwordx4 v[24:27], v3, s[12:15], s27 offen offset:0 sc1
    buffer_load_dwordx4 v[28:31], v3, s[12:15], s27 offen offset:512 sc1
    buffer_load_dwordx4 v[32:35], v3, s[12:15], s27 offen offset:1024 sc1
    buffer_load_dwordx4 v[36:39], v3, s[12:15], s27 offen offset:1536 sc1
    s_add_u32 s60, s60, 1
    s_add_u32 s37, s37, 1
    s_cmp_gt_u32 s37, 400000
    s_cbranch_scc1 L_redgo_f_w2
    s_waitcnt vmcnt(3)
    v_mfma_f32_16x16x32_bf16 v[40:43], v[44:47], v[24:27], 0
    v_xor_b32 v66, v64, v24
    s_waitcnt vmcnt(2)
    v_mfma_f32_16x16x32_bf16 v[40:43], v[44:47], v[28:31], v[40:43]
    v_bitop3_b32 v66, v66, v64, v28 bitop3:0xf6
    s_waitcnt vmcnt(1)
    v_mfma_f32_16x16x32_bf16 v[40:43], v[44:47], v[32:35], v[40:43]
    v_bitop3_b32 v66, v66, v64, v32 bitop3:0xf6
    s_waitcnt vmcnt(0)
    v_mfma_f32_16x16x32_bf16 v[40:43], v[44:47], v[36:39], v[40:43]
    v_bitop3_b32 v66, v66, v64, v36 bitop3:0xf6
    v_and_b32 v66, 1, v66
    v_cmp_ne_u32 vcc, 0, v66
    s_nop 0
    s_cbranch_vccnz L_redslow2_f_w2
L_redgo_f_w2:
    s_waitcnt vmcnt(0)
    v_mov_b32 v71, 0
    s_nop 0
    v_add_f32_dpp v40, v40, v40 row_ror:8 row_mask:0xf bank_mask:0xf
    v_add_f32_dpp v41, v41, v41 row_ror:8 row_mask:0xf bank_mask:0xf
    v_cvt_pk_bf16_f32 v40, v40, v41
    buffer_store_dword v40, v65, s[12:15], s34 offen
    buffer_store_dword v70, v65, s[12:15], s35 offen
    buffer_store_byte v71, v0, s[40:43], 0 offen
    s_branch L_redend_f_w2
.p2align 6
L_loop_f_w3:
    s_add_u32 s31, s31, 524288
    v_mov_b64 v[48:49], 0
    v_mov_b64 v[50:51], 0
    v_mov_b64 v[52:53], 0
    v_mov_b64 v[54:55], 0
    v_mov_b64 v[56:57], 0
    v_mov_b64 v[58:59], 0
    v_mov_b64 v[60:61], 0
    v_mov_b64 v[62:63], 0
    v_lshrrev_b32 v74, 2, v0
    v_and_b32 v39, 127, v74
    v_min_u32 v74, 92, v74
    v_mov_b64 v[28:29], -1
    v_mov_b64 v[30:31], -1
    v_mov_b64 v[32:33], -1
    s_waitcnt vmcnt(0)
L_pl_f_w3:
    s_waitcnt vmcnt(5)
    v_cmp_gt_i32 vcc, s23, v28
    buffer_load_dword v28, v39, s[12:15], s11 offen sc1
    s_cbranch_vccz L_pl_f_w3_o
    s_waitcnt vmcnt(5)
    v_cmp_gt_i32 vcc, s23, v29
    buffer_load_dword v29, v39, s[12:15], s11 offen sc1
    s_cbranch_vccz L_pl_f_w3_o
    s_waitcnt vmcnt(5)
    v_cmp_gt_i32 vcc, s23, v30
    buffer_load_dword v30, v39, s[12:15], s11 offen sc1
    s_cbranch_vccz L_pl_f_w3_o
    s_waitcnt vmcnt(5)
    v_cmp_gt_i32 vcc, s23, v31
    buffer_load_dword v31, v39, s[12:15], s11 offen sc1
    s_cbranch_vccz L_pl_f_w3_o
    s_waitcnt vmcnt(5)
    v_cmp_gt_i32 vcc, s23, v32
    buffer_load_dword v32, v39, s[12:15], s11 offen sc1
    s_cbranch_vccz L_pl_f_w3_o
    s_waitcnt vmcnt(5)
    v_cmp_gt_i32 vcc, s23, v33
    buffer_load_dword v33, v39, s[12:15], s11 offen sc1
    s_cbranch_vccz L_pl_f_w3_o
    s_add_u32 s60, s60, 1
    s_add_u32 s37, s37, 1
    s_cmp_lt_u32 s37, 400000
    s_cbranch_scc1 L_pl_f_w3
.p2align 3
L_pl_f_w3_o:
    buffer_load_dword v72, v74, s[12:15], s11 offen offset:256 sc1
    s_mov_b32 m0, 0
    s_add_u32 s34, s29, 0
    buffer_load_dwordx4 v0, s[12:15], s34 offen offset:0 sc1 lds
    buffer_load_dwordx4 v0, s[12:15], s34 offen offset:1024 sc1 lds
    buffer_load_dwordx4 v0, s[12:15], s34 offen offset:2048 sc1 lds
    buffer_load_dwordx4 v0, s[12:15], s34 offen offset:3072 sc1 lds
    s_mov_b32 m0, 8192
    s_add_u32 s34, s29, 8192
    buffer_load_dwordx4 v0, s[12:15], s34 offen offset:0 sc1 lds
    s_waitcnt vmcnt(5)
    v_cmp_ne_u32 vcc, 0, v72
    s_nop 0
    s_cbranch_vccnz L_pr0_f_w3_slow
L_pr0_f_w3_ok:
    s_mov_b32 m0, 7168
    s_add_u32 s34, s29, 7168
    s_waitcnt vmcnt(3)
    s_waitcnt lgkmcnt(0)
    s_barrier
L_pa_f_w3:
    ds_read_b128 v[24:27], v0 offset:0
    ds_read_b128 v[28:31], v0 offset:1024
    buffer_load_dwordx4 v0, s[12:15], s34 offen sc1 lds
    s_waitcnt lgkmcnt(1)
    v_smfmac_f32_16x16x64_bf16 v[48:51], v[24:27], v[8:15], v2
    ds_read_b128 v[8:11], v1 offset:4096
    v_smfmac_f32_16x16x64_bf16 v[52:55], v[24:27], v[16:23], v2
    ds_read_b128 v[12:15], v1 offset:5120
    v_smfmac_f32_16x16x64_bf16 v[56:59], v[24:27], a[0:7], v2
    ds_read_b128 v[16:19], v1 offset:6144
    v_smfmac_f32_16x16x64_bf16 v[60:63], v[24:27], a[8:15], v2
    ds_read_b128 v[20:23], v1 offset:7168
    s_waitcnt vmcnt(1)
    s_barrier
    s_waitcnt lgkmcnt(4)
    v_smfmac_f32_16x16x64_bf16 v[48:51], v[28:31], a[16:23], v2
    ds_read_b128 v[32:35], v0 offset:2048
    buffer_load_dwordx4 v[64:67], v0, s[16:19], s31 offen offset:0 sc1
    v_smfmac_f32_16x16x64_bf16 v[52:55], v[28:31], a[24:31], v2
    v_smfmac_f32_16x16x64_bf16 v[56:59], v[28:31], a[32:39], v2
    ds_read_b128 v[36:39], v0 offset:3072
    v_smfmac_f32_16x16x64_bf16 v[60:63], v[28:31], a[40:47], v2
    ds_read_b128 v[24:27], v0 offset:8192
    s_waitcnt lgkmcnt(2)
    v_smfmac_f32_16x16x64_bf16 v[48:51], v[32:35], v[8:15], v2
    ds_read_b128 v[8:11], v1 offset:8192
    buffer_load_dwordx4 v[68:71], v0, s[16:19], s31 offen offset:1024 sc1
    v_smfmac_f32_16x16x64_bf16 v[52:55], v[32:35], v[16:23], v2
    ds_read_b128 v[12:15], v1 offset:9216
    v_smfmac_f32_16x16x64_bf16 v[56:59], v[32:35], a[48:55], v2
    ds_read_b128 v[16:19], v1 offset:10240
    v_smfmac_f32_16x16x64_bf16 v[60:63], v[32:35], a[56:63], v2
    ds_read_b128 v[20:23], v1 offset:11264
    s_waitcnt lgkmcnt(5)
    v_smfmac_f32_16x16x64_bf16 v[48:51], v[36:39], a[64:71], v2
    buffer_load_dwordx4 v[40:43], v0, s[16:19], s31 offen offset:2048 sc1
    v_smfmac_f32_16x16x64_bf16 v[52:55], v[36:39], a[72:79], v2
    s_waitcnt lgkmcnt(2)
    v_smfmac_f32_16x16x64_bf16 v[56:59], v[36:39], v[8:15], v2
    ds_read_b128 v[8:11], v1 offset:12288
    s_waitcnt lgkmcnt(1)
    v_smfmac_f32_16x16x64_bf16 v[60:63], v[36:39], v[16:23], v2
    ds_read_b128 v[12:15], v1 offset:13312
    s_waitcnt vmcnt(3)
    s_barrier
    v_smfmac_f32_16x16x64_bf16 v[48:51], v[24:27], a[80:87], v2
    ds_read_b128 v[28:31], v0 offset:4096
    buffer_load_dwordx4 v[44:47], v0, s[16:19], s31 offen offset:3072 sc1
    v_smfmac_f32_16x16x64_bf16 v[52:55], v[24:27], a[88:95], v2
    ds_read_b128 v[16:19], v1 offset:14336
    v_smfmac_f32_16x16x64_bf16 v[56:59], v[24:27], a[96:103], v2
    ds_read_b128 v[32:35], v0 offset:5120
    v_smfmac_f32_16x16x64_bf16 v[60:63], v[24:27], a[104:111], v2
    ds_read_b128 v[20:23], v1 offset:15360
    s_waitcnt lgkmcnt(3)
    v_smfmac_f32_16x16x64_bf16 v[48:51], v[28:31], a[112:119], v2
    ds_read_b128 v[36:39], v0 offset:6144
    v_smfmac_f32_16x16x64_bf16 v[52:55], v[28:31], a[120:127], v2
    s_waitcnt lgkmcnt(2)
    v_smfmac_f32_16x16x64_bf16 v[48:51], v[32:35], a[128:135], v2
    ds_read_b128 v[24:27], v0 offset:7168
    v_smfmac_f32_16x16x64_bf16 v[52:55], v[32:35], a[136:143], v2
    s_waitcnt lgkmcnt(1)
    v_smfmac_f32_16x16x64_bf16 v[48:51], v[36:39], v[8:15], v2
    ds_read_b128 v[8:11], v1 offset:16384
    v_smfmac_f32_16x16x64_bf16 v[52:55], v[36:39], v[16:23], v2
    ds_read_b128 v[12:15], v1 offset:17408
    s_waitcnt lgkmcnt(2)
    v_smfmac_f32_16x16x64_bf16 v[48:51], v[24:27], a[144:151], v2
    ds_read_b128 v[16:19], v1 offset:18432
    v_smfmac_f32_16x16x64_bf16 v[52:55], v[24:27], a[152:159], v2
    ds_read_b128 v[20:23], v1 offset:19456
    v_smfmac_f32_16x16x64_bf16 v[56:59], v[28:31], a[160:167], v2
    v_cvt_pk_bf16_f32 v72, v48, v49
    v_smfmac_f32_16x16x64_bf16 v[60:63], v[28:31], a[168:175], v2
    v_cvt_pk_bf16_f32 v73, v50, v51
    v_smfmac_f32_16x16x64_bf16 v[56:59], v[32:35], a[176:183], v2
    v_cvt_pk_bf16_f32 v74, v52, v53
    v_mfma_f32_16x16x16_bf16 v[48:51], v[72:73], v[4:5], 0
    s_waitcnt lgkmcnt(0)
    v_cvt_pk_bf16_f32 v75, v54, v55
    v_smfmac_f32_16x16x64_bf16 v[60:63], v[32:35], a[184:191], v2
    s_cmp_eq_u32 s22, s5
    s_cselect_b64 s[6:7], -1, 0
    v_mfma_f32_16x16x16_bf16 v[52:55], v[74:75], v[4:5], 0
    s_waitcnt vmcnt(2)
    v_cvt_pk_bf16_f32 v76, v48, v49
    v_cvt_pk_bf16_f32 v77, v50, v51
    v_smfmac_f32_16x16x64_bf16 v[56:59], v[36:39], v[8:15], v2
    ds_read_b128 v[8:11], v1 offset:20480
    v_cmp_u_f32 vcc, v48, v48
    v_smfmac_f32_16x16x64_bf16 v[60:63], v[36:39], v[16:23], v2
    ds_read_b128 v[12:15], v1 offset:21504
    v_cvt_pk_bf16_f32 v78, v52, v53
    v_smfmac_f32_16x16x64_bf16 v[56:59], v[24:27], a[192:199], v2
    ds_read_b128 v[16:19], v1 offset:22528
    s_or_b64 vcc, vcc, s[6:7]
    v_cvt_pk_bf16_f32 v79, v54, v55
    v_smfmac_f32_16x16x64_bf16 v[60:63], v[24:27], a[200:207], v2
    ds_read_b128 v[20:23], v1 offset:23552
    s_cbranch_scc1 L_redo_f_w3
L_xsb_f_w3:
    v_mov_b64 v[48:49], 0
    v_mfma_f32_16x16x32_bf16 v[64:67], v[64:67], v[76:79], 0
    v_cvt_pk_bf16_f32 v72, v56, v57
    v_cvt_pk_bf16_f32 v73, v58, v59
    v_mfma_f32_16x16x32_bf16 v[68:71], v[68:71], v[76:79], 0
    v_cvt_pk_bf16_f32 v74, v60, v61
    v_cvt_pk_bf16_f32 v75, v62, v63
    v_mfma_f32_16x16x16_bf16 v[56:59], v[72:73], v[4:5], 0
    s_mov_b32 s30, s29
    v_mov_b64 v[50:51], 0
    v_mov_b64 v[52:53], 0
    v_mfma_f32_16x16x16_bf16 v[60:63], v[74:75], v[4:5], 0
    s_add_u32 s29, s29, 9216
    v_mov_b64 v[54:55], 0
    v_cndmask_b32 v64, v64, v68, s[58:59]
    v_smfmac_f32_16x16x64_bf16 v[48:51], v[28:31], a[208:215], v2
    s_add_u32 s22, s22, 1
    s_add_u32 s23, s23, 1
    v_cvt_pk_bf16_f32 v72, v56, v57
    v_cvt_pk_bf16_f32 v73, v58, v59
    v_cvt_pk_bf16_f32 v74, v60, v61
    v_cvt_pk_bf16_f32 v75, v62, v63
    v_smfmac_f32_16x16x64_bf16 v[52:55], v[28:31], a[216:223], v2
    ds_read_b128 v[28:31], v0 offset:0
    s_add_u32 s25, s25, 1
    v_cndmask_b32 v65, v65, v69, s[58:59]
    v_mfma_f32_16x16x32_bf16 v[56:59], v[72:75], v[76:79], 0
    s_cmp_eq_u32 s29, 355328
    v_cndmask_b32 v66, v66, v70, s[58:59]
    v_cndmask_b32 v67, v67, v71, s[58:59]
    v_smfmac_f32_16x16x64_bf16 v[48:51], v[32:35], a[224:231], v2
    s_cselect_b32 s29, 327680, s29
    v_smfmac_f32_16x16x64_bf16 v[52:55], v[32:35], a[232:239], v2
    ds_write_b128 v0, v[64:67] offset:12288
    v_smfmac_f32_16x16x64_bf16 v[48:51], v[36:39], a[240:247], v2
    ds_read_b128 v[32:35], v0 offset:1024
    v_smfmac_f32_16x16x64_bf16 v[52:55], v[36:39], a[248:255], v2
    ds_write_b64 v6, v[56:57] offset:13352
    v_smfmac_f32_16x16x64_bf16 v[48:51], v[24:27], v[80:87], v2
    ds_read_b128 v[36:39], v0 offset:2048
    v_smfmac_f32_16x16x64_bf16 v[52:55], v[24:27], v[88:95], v2
    ds_read_b128 v[24:27], v0 offset:3072
    s_waitcnt lgkmcnt(5)
    v_smfmac_f32_16x16x64_bf16 v[48:51], v[28:31], v[96:103], v2
    s_waitcnt lgkmcnt(2)
    s_barrier
    ds_read_b128 v[60:63], v0 offset:9216
    v_smfmac_f32_16x16x64_bf16 v[52:55], v[28:31], v[104:111], v2
    ds_read_b128 v[72:75], v0 offset:10240
    v_smfmac_f32_16x16x64_bf16 v[48:51], v[32:35], v[112:119], v2
    ds_read_b128 v[76:79], v0 offset:11264
    v_smfmac_f32_16x16x64_bf16 v[52:55], v[32:35], v[120:127], v2
    ds_read_b128 v[28:31], v0 offset:8192
    s_waitcnt lgkmcnt(5)
    v_smfmac_f32_16x16x64_bf16 v[48:51], v[36:39], v[128:135], v2
    ds_read_b128 v[68:71], v6 offset:13312
    v_mov_b64 v[32:33], s[2:3]
    v_smfmac_f32_16x16x64_bf16 v[52:55], v[36:39], v[136:143], v2
    ds_read_b128 v[56:59], v6 offset:13344
    v_mov_b64 v[34:35], s[2:3]
    s_waitcnt lgkmcnt(6)
    v_smfmac_f32_16x16x64_bf16 v[48:51], v[24:27], v[144:151], v2
    v_mov_b64 v[36:37], s[0:1]
    v_smfmac_f32_16x16x64_bf16 v[52:55], v[24:27], v[152:159], v2
    s_waitcnt lgkmcnt(4)
    v_add_f32 v60, v60, v72
    s_waitcnt lgkmcnt(2)
    v_smfmac_f32_16x16x64_bf16 v[48:51], v[28:31], v[8:15], v2
    ds_read_b128 v[8:11], v1 offset:24576
    v_add_f32 v61, v61, v73
    v_smfmac_f32_16x16x64_bf16 v[52:55], v[28:31], v[16:23], v2
    ds_read_b128 v[12:15], v1 offset:25600
    v_add_f32 v62, v62, v74
    v_add_f32 v63, v63, v75
    v_pk_add_f32 v[76:77], v[76:77], v[64:65]
    v_pk_add_f32 v[78:79], v[78:79], v[66:67]
    v_pk_add_f32 v[60:61], v[60:61], v[76:77]
    v_pk_add_f32 v[62:63], v[62:63], v[78:79]
    s_waitcnt lgkmcnt(2)
    v_pk_add_f32 v[68:69], v[68:69], v[56:57]
    v_pk_add_f32 v[70:71], v[70:71], v[58:59]
    v_pk_add_f32 v[68:69], v[68:69], v[70:71]
    v_pk_mul_f32 v[68:69], v[68:69], s[32:33] op_sel_hi:[1,0]
    v_exp_f32 v60, v60
    v_exp_f32 v61, v61
    v_exp_f32 v62, v62
    v_exp_f32 v63, v63
    v_exp_f32 v68, v68
    v_exp_f32 v69, v69
L_maxback_f_w3:
    v_cvt_pk_bf16_f32 v72, v60, v61
    v_cvt_pk_bf16_f32 v73, v62, v63
    v_cvt_pk_bf16_f32 v76, v68, v68
    v_mov_b32_dpp v74, v72 quad_perm:[2,3,0,1] row_mask:0xf bank_mask:0xf
    v_mov_b32_dpp v75, v73 quad_perm:[2,3,0,1] row_mask:0xf bank_mask:0xf
    v_cvt_pk_bf16_f32 v77, v69, v69
    v_cvt_pk_bf16_f32 v24, v48, v49
    v_mfma_f32_16x16x32_bf16 v[28:31], v[32:35], v[72:75], 0
    s_waitcnt vmcnt(0)
    v_cvt_pk_bf16_f32 v25, v50, v51
    v_cvt_pk_bf16_f32 v26, v52, v53
    v_mfma_f32_16x16x32_bf16 v[56:59], v[40:43], v[72:75], 0
    ds_read_b128 v[16:19], v1 offset:26624
    v_cvt_pk_bf16_f32 v27, v54, v55
    v_mfma_f32_16x16x16_bf16 v[28:31], v[36:37], v[76:77], v[28:31]
    ds_read_b128 v[20:23], v1 offset:27648
    v_mfma_f32_16x16x32_bf16 v[68:71], v[44:47], v[72:75], 0
    v_mfma_f32_16x16x16_bf16 v[56:59], v[24:25], v[76:77], v[56:59]
    v_rcp_f32 v30, v28
    v_mfma_f32_16x16x16_bf16 v[68:71], v[26:27], v[76:77], v[68:71]
    v_max_f32 v28, v28, v30
    v_cmp_ngt_f32 vcc, s38, v28
    v_mov_b64 v[38:39], 0
    v_mov_b32 v78, s23
    v_pk_mul_f32 v[56:57], v[56:57], v[30:31] op_sel_hi:[1,0]
    v_pk_mul_f32 v[58:59], v[58:59], v[30:31] op_sel_hi:[1,0]
    v_cvt_pk_bf16_f32 v64, v56, v57
    v_cvt_pk_bf16_f32 v65, v58, v59
    v_pk_mul_f32 v[68:69], v[68:69], v[30:31] op_sel_hi:[1,0]
    v_pk_mul_f32 v[70:71], v[70:71], v[30:31] op_sel_hi:[1,0]
    s_cbranch_vccnz L_max_f_w3
L_maxskip_f_w3:
    v_cvt_pk_bf16_f32 v66, v68, v69
    v_cvt_pk_bf16_f32 v67, v70, v71
    v_mfma_f32_16x16x16_bf16 v[48:51], v[38:39], v[38:39], 0
    ds_write_b128 v7, v[64:67]
    v_mov_b64 v[34:35], 0
    v_mov_b64 v[36:37], 0
    v_mov_b64 v[40:41], 0
    v_mov_b64 v[42:43], 0
    v_mov_b64 v[44:45], 0
    v_mov_b64 v[46:47], 0
    v_mov_b64 v[56:57], 0
    v_mov_b64 v[58:59], 0
    v_mov_b64 v[24:25], 0
    v_mov_b64 v[26:27], 0
    v_mov_b64 v[28:29], 0
    v_mov_b64 v[30:31], 0
    v_mfma_f32_16x16x16_bf16 v[52:55], v[38:39], v[38:39], 0
    s_waitcnt lgkmcnt(0)
    s_barrier
    ds_read_b128 v[64:67], v0 offset:14336
    v_mov_b32 v32, 0
    ds_read_b128 v[68:71], v0 offset:15360
    v_mov_b32 v33, 0
    v_lshrrev_b32 v79, 2, v0
    v_and_b32 v79, 127, v79
    v_cndmask_b32 v62, 0, 1, s[56:57]
    v_lshrrev_b32 v63, 1, v0
    s_waitcnt lgkmcnt(1)
    v_smfmac_f32_16x16x64_bf16 v[24:27], v[64:67], v[8:15], v2
    ds_read_b128 v[8:11], v1 offset:28672
    s_waitcnt lgkmcnt(1)
    v_smfmac_f32_16x16x64_bf16 v[24:27], v[68:71], v[16:23], v2
    ds_read_b128 v[12:15], v1 offset:29696
    v_smfmac_f32_16x16x64_bf16 v[28:31], v[64:67], v[160:167], v2
    ds_read_b128 v[16:19], v1 offset:30720
    v_smfmac_f32_16x16x64_bf16 v[28:31], v[68:71], v[168:175], v2
    ds_read_b128 v[20:23], v1 offset:31744
    v_add_f32 v24, v24, v25
    v_add_f32 v26, v26, v27
    v_smfmac_f32_16x16x64_bf16 v[32:35], v[64:67], v[176:183], v2
    v_cvt_pk_bf16_f32 v24, v24, v26
    v_bfi_b32 v72, v62, s23, v24
    v_smfmac_f32_16x16x64_bf16 v[32:35], v[68:71], v[184:191], v2
    v_add_f32 v28, v28, v29
    v_add_f32 v30, v30, v31
    v_smfmac_f32_16x16x64_bf16 v[36:39], v[64:67], v[192:199], v2
    v_cvt_pk_bf16_f32 v73, v28, v30
    v_smfmac_f32_16x16x64_bf16 v[36:39], v[68:71], v[200:207], v2
    buffer_load_dword v24, v79, s[12:15], s11 offen offset:128 sc1
    v_add_f32 v32, v32, v33
    v_add_f32 v34, v34, v35
    s_waitcnt lgkmcnt(2)
    v_smfmac_f32_16x16x64_bf16 v[40:43], v[64:67], v[8:15], v2
    ds_read_b128 v[8:11], v1 offset:32768
    buffer_store_dwordx2 v[72:73], v63, s[12:15], s24 offen
    s_add_u32 s26, s24, 65536
    v_cvt_pk_bf16_f32 v32, v32, v34
    v_bfi_b32 v74, v62, s23, v32
    s_waitcnt lgkmcnt(1)
    v_smfmac_f32_16x16x64_bf16 v[40:43], v[68:71], v[16:23], v2
    ds_read_b128 v[12:15], v1 offset:33792
    v_add_f32 v36, v36, v37
    v_add_f32 v38, v38, v39
    v_smfmac_f32_16x16x64_bf16 v[44:47], v[64:67], v[208:215], v2
    ds_read_b128 v[16:19], v1 offset:34816
    buffer_load_dword v25, v79, s[12:15], s11 offen offset:128 sc1
    v_cvt_pk_bf16_f32 v75, v36, v38
    v_smfmac_f32_16x16x64_bf16 v[44:47], v[68:71], v[216:223], v2
    ds_read_b128 v[20:23], v1 offset:35840
    v_add_f32 v40, v40, v41
    v_add_f32 v42, v42, v43
    v_smfmac_f32_16x16x64_bf16 v[48:51], v[64:67], v[224:231], v2
    buffer_store_dwordx2 v[74:75], v63, s[12:15], s26 offen
    s_add_u32 s26, s24, 262144
    v_cvt_pk_bf16_f32 v40, v40, v42
    v_bfi_b32 v72, v62, s23, v40
    v_smfmac_f32_16x16x64_bf16 v[48:51], v[68:71], v[232:239], v2
    v_add_f32 v44, v44, v45
    v_add_f32 v46, v46, v47
    v_smfmac_f32_16x16x64_bf16 v[52:55], v[64:67], v[240:247], v2
    buffer_load_dword v26, v79, s[12:15], s11 offen offset:128 sc1
    buffer_store_dwordx2 v[72:73], v63, s[12:15], s26 offen
    s_add_u32 s26, s24, 131072
    v_cvt_pk_bf16_f32 v44, v44, v46
    v_bfi_b32 v76, v62, s23, v44
    v_smfmac_f32_16x16x64_bf16 v[52:55], v[68:71], v[248:255], v2
    v_add_f32 v48, v48, v49
    v_add_f32 v50, v50, v51
    s_waitcnt lgkmcnt(2)
    v_smfmac_f32_16x16x64_bf16 v[56:59], v[64:67], v[8:15], v2
    ds_read_b128 v[8:11], v1 offset:0
    v_cvt_pk_bf16_f32 v77, v48, v50
    s_waitcnt lgkmcnt(1)
    v_smfmac_f32_16x16x64_bf16 v[56:59], v[68:71], v[16:23], v2
    ds_read_b128 v[12:15], v1 offset:1024
    buffer_store_dwordx2 v[76:77], v63, s[12:15], s26 offen
    s_add_u32 s26, s24, 196608
    v_add_f32 v52, v52, v53
    v_add_f32 v54, v54, v55
    v_cvt_pk_bf16_f32 v52, v52, v54
    v_bfi_b32 v78, v62, s23, v52
    s_waitcnt vmcnt(6)
    v_cmp_gt_u32 vcc, s23, v24
    v_add_f32 v56, v56, v57
    v_add_f32 v58, v58, v59
    v_cvt_pk_bf16_f32 v79, v56, v58
    buffer_store_dwordx2 v[78:79], v63, s[12:15], s26 offen
    s_cbranch_vccnz L_gb_f_w3
L_gbok_f_w3:
    s_barrier
    ds_read_b128 v[16:19], v1 offset:2048
    ds_read_b128 v[20:23], v1 offset:3072
    s_branch L_loop_f_w3
L_pr0_f_w3_slow:
    buffer_load_dword v72, v74, s[12:15], s11 offen offset:256 sc1
    s_mov_b32 m0, 0
    s_add_u32 s34, s29, 0
    buffer_load_dwordx4 v0, s[12:15], s34 offen offset:0 sc1 lds
    buffer_load_dwordx4 v0, s[12:15], s34 offen offset:1024 sc1 lds
    buffer_load_dwordx4 v0, s[12:15], s34 offen offset:2048 sc1 lds
    buffer_load_dwordx4 v0, s[12:15], s34 offen offset:3072 sc1 lds
    s_mov_b32 m0, 8192
    s_add_u32 s34, s29, 8192
    buffer_load_dwordx4 v0, s[12:15], s34 offen offset:0 sc1 lds
    s_add_u32 s63, s63, 1
    s_add_u32 s37, s37, 1
    s_cmp_gt_u32 s37, 400000
    s_cbranch_scc1 L_pr0_f_w3_ok
    s_waitcnt vmcnt(5)
    v_cmp_ne_u32 vcc, 0, v72
    s_nop 0
    s_cbranch_vccnz L_pr0_f_w3_slow
    s_branch L_pr0_f_w3_ok
L_xs_f_w3:
    s_cmp_lg_u32 s5, 0
    s_cbranch_scc1 L_team_exit
    s_mov_b32 s5, 63
    s_lshl_b32 s35, s21, 7
    s_add_u32 s35, s35, 397312
L_xl_f_w3:
    buffer_load_dword v72, off, s[12:15], s35 sc1
    s_add_u32 s37, s37, 1
    s_cmp_gt_u32 s37, 400000
    s_waitcnt vmcnt(0)
    s_cbranch_scc1 L_xg_f_w3
    v_cmp_gt_u32 vcc, s25, v72
    s_nop 0
    s_cbranch_vccnz L_xl_f_w3
L_xg_f_w3:
    buffer_load_dwordx4 v[64:67], v0, s[16:19], s31 offen offset:0 sc1
    buffer_load_dwordx4 v[68:71], v0, s[16:19], s31 offen offset:1024 sc1
    buffer_load_dwordx4 v[40:43], v0, s[16:19], s31 offen offset:2048 sc1
    buffer_load_dwordx4 v[44:47], v0, s[16:19], s31 offen offset:3072 sc1
    s_waitcnt vmcnt(0)
    s_branch L_xsb_f_w3
L_redo_f_w3:
    v_cmp_u_f32 vcc, v48, v48
    s_nop 0
    s_cbranch_vccz L_xs_f_w3
    s_add_u32 s61, s61, 1
    s_add_u32 s37, s37, 64
    s_cmp_gt_u32 s37, 400000
    s_cbranch_scc0 L_redo2_f_w3
    s_cmp_eq_u32 s22, s5
    s_cbranch_scc1 L_xs_f_w3
    s_branch L_xsb_f_w3
L_redo2_f_w3:
    s_waitcnt vmcnt(0) lgkmcnt(0)
    s_barrier
    v_mov_b32 v75, 4096
    s_mov_b32 m0, 7168
    s_add_u32 s34, s29, 7168
    s_nop 7
    v_mov_b64 v[48:49], 0
    v_mov_b64 v[50:51], 0
    v_mov_b64 v[52:53], 0
    v_mov_b64 v[54:55], 0
    v_mov_b64 v[56:57], 0
    v_mov_b64 v[58:59], 0
    v_mov_b64 v[60:61], 0
    v_mov_b64 v[62:63], 0
    ds_read_b128 v[8:11], v1 offset:0
    ds_read_b128 v[12:15], v1 offset:1024
    ds_read_b128 v[16:19], v1 offset:2048
    ds_read_b128 v[20:23], v1 offset:3072
    s_waitcnt vmcnt(0) lgkmcnt(0)
    s_barrier
    s_branch L_pa_f_w3
L_max_f_w3:
    s_cmp_eq_u32 s4, s23
    s_cbranch_scc1 L_maxskip_f_w3
    s_mov_b32 s4, s23
    s_nop 7
    ds_read_b128 v[60:63], v0 offset:9216
    ds_read_b128 v[72:75], v0 offset:10240
    ds_read_b128 v[76:79], v0 offset:11264
    ds_read_b128 v[64:67], v0 offset:12288
    ds_read_b128 v[68:71], v6 offset:13312
    ds_read_b128 v[56:59], v6 offset:13344
    s_waitcnt lgkmcnt(4)
    v_add_f32 v60, v60, v72
    v_add_f32 v61, v61, v73
    v_add_f32 v62, v62, v74
    v_add_f32 v63, v63, v75
    s_waitcnt lgkmcnt(2)
    v_add_f32 v76, v76, v64
    v_add_f32 v77, v77, v65
    v_add_f32 v78, v78, v66
    v_add_f32 v79, v79, v67
    v_add_f32 v60, v60, v76
    v_add_f32 v61, v61, v77
    v_add_f32 v62, v62, v78
    v_add_f32 v63, v63, v79
    s_waitcnt lgkmcnt(0)
    v_add_f32 v68, v68, v56
    v_add_f32 v69, v69, v57
    v_add_f32 v70, v70, v58
    v_add_f32 v71, v71, v59
    v_add_f32 v68, v68, v70
    v_add_f32 v69, v69, v71
    v_pk_mul_f32 v[68:69], v[68:69], s[32:33] op_sel_hi:[1,0]
    v_max3_f32 v72, v60, v61, v62
    v_max3_f32 v73, v63, v68, v69
    v_max_f32 v72, v72, v73
    s_nop 1
    v_max_f32_dpp v72, v72, v72 quad_perm:[2,3,0,1] row_mask:0xf bank_mask:0xf
    v_mov_b32 v73, v72
    s_nop 1
    v_permlane16_swap_b32 v72, v73
    v_max_f32 v72, v72, v73
    v_mov_b32 v73, v72
    s_nop 1
    v_permlane32_swap_b32 v72, v73
    v_max_f32 v72, v72, v73
    v_sub_f32 v60, v60, v72
    v_sub_f32 v61, v61, v72
    v_sub_f32 v62, v62, v72
    v_sub_f32 v63, v63, v72
    v_sub_f32 v68, v68, v72
    v_sub_f32 v69, v69, v72
    v_exp_f32 v60, v60
    v_exp_f32 v61, v61
    v_exp_f32 v62, v62
    v_exp_f32 v63, v63
    v_exp_f32 v68, v68
    v_exp_f32 v69, v69
    s_add_u32 s62, s62, 1
    s_waitcnt lgkmcnt(0)
    s_branch L_maxback_f_w3
L_gb_f_w3:
    v_lshrrev_b32 v64, 2, v0
    v_and_b32 v64, 127, v64
    buffer_load_dword v24, v64, s[12:15], s11 offen offset:128 sc1
    s_add_u32 s62, s62, 65536
    s_waitcnt vmcnt(6)
    v_cmp_gt_u32 vcc, s23, v25
    buffer_load_dword v25, v64, s[12:15], s11 offen offset:128 sc1
    s_nop 0
    s_cbranch_vccz L_gbok_f_w3
    s_add_u32 s62, s62, 65536
    s_waitcnt vmcnt(5)
    v_cmp_gt_u32 vcc, s23, v26
    buffer_load_dword v26, v64, s[12:15], s11 offen offset:128 sc1
    s_nop 0
    s_cbranch_vccz L_gbok_f_w3
L_gbl_f_w3:
    s_add_u32 s62, s62, 65536
    s_waitcnt vmcnt(2)
    v_cmp_gt_u32 vcc, s23, v24
    buffer_load_dword v24, v64, s[12:15], s11 offen offset:128 sc1
    s_nop 0
    s_cbranch_vccz L_gbok_f_w3
    s_add_u32 s62, s62, 65536
    s_waitcnt vmcnt(2)
    v_cmp_gt_u32 vcc, s23, v25
    buffer_load_dword v25, v64, s[12:15], s11 offen offset:128 sc1
    s_nop 0
    s_cbranch_vccz L_gbok_f_w3
    s_add_u32 s62, s62, 65536
    s_waitcnt vmcnt(2)
    v_cmp_gt_u32 vcc, s23, v26
    buffer_load_dword v26, v64, s[12:15], s11 offen offset:128 sc1
    s_nop 0
    s_cbranch_vccz L_gbok_f_w3
    s_add_u32 s37, s37, 1
    s_cmp_lt_u32 s37, 400000
    s_cbranch_scc1 L_gbl_f_w3
    s_branch L_gbok_f_w3
.p2align 6
L_loop_s_w0:
    s_add_u32 s31, s31, 524288
    v_cmp_gt_u32 vcc, s25, v1
    s_nop 0
    s_cbranch_vccnz L_kw_s_w0
L_kw_s_w0_ok:
    s_add_u32 s8, s8, 4096
    s_sub_u32 s34, s8, 12288
    s_cmp_ge_u32 s34, 397312
    s_cselect_b32 s8, s34, s8
    s_mov_b32 m0, 4096
    s_add_u32 s34, s29, 4096
    s_waitcnt lgkmcnt(0)
    s_barrier
L_pa_s_w0:
    ds_read_b128 v[24:27], v0 offset:0
    ds_read_b128 v[28:31], v0 offset:1024
    buffer_load_dwordx4 v0, s[12:15], s34 offen sc1 lds
    s_waitcnt lgkmcnt(1)
    v_smfmac_f32_16x16x64_bf16 v[48:51], v[24:27], v[8:15], v2
    ds_read_b128 v[8:11], v0 offset:20480
    v_smfmac_f32_16x16x64_bf16 v[52:55], v[24:27], v[16:23], v2
    ds_read_b128 v[12:15], v0 offset:21504
    buffer_load_dwordx4 v[64:67], v0, s[16:19], s31 offen offset:0 sc1
    v_smfmac_f32_16x16x64_bf16 v[56:59], v[24:27], a[0:7], v2
    ds_read_b128 v[16:19], v0 offset:22528
    v_smfmac_f32_16x16x64_bf16 v[60:63], v[24:27], a[8:15], v2
    ds_read_b128 v[20:23], v0 offset:23552
    s_barrier
    s_waitcnt lgkmcnt(4)
    v_smfmac_f32_16x16x64_bf16 v[48:51], v[28:31], a[16:23], v2
    ds_read_b128 v[32:35], v0 offset:2048
    v_smfmac_f32_16x16x64_bf16 v[52:55], v[28:31], a[24:31], v2
    buffer_load_dwordx4 v[68:71], v0, s[16:19], s31 offen offset:1024 sc1
    v_smfmac_f32_16x16x64_bf16 v[56:59], v[28:31], a[32:39], v2
    ds_read_b128 v[36:39], v0 offset:3072
    v_smfmac_f32_16x16x64_bf16 v[60:63], v[28:31], a[40:47], v2
    ds_read_b128 v[24:27], v0 offset:8192
    s_waitcnt lgkmcnt(2)
    v_smfmac_f32_16x16x64_bf16 v[48:51], v[32:35], v[8:15], v2
    ds_read_b128 v[8:11], v0 offset:24576
    v_smfmac_f32_16x16x64_bf16 v[52:55], v[32:35], v[16:23], v2
    ds_read_b128 v[12:15], v0 offset:25600
    buffer_load_dwordx4 v[40:43], v0, s[16:19], s31 offen offset:2048 sc1
    v_smfmac_f32_16x16x64_bf16 v[56:59], v[32:35], a[48:55], v2
    ds_read_b128 v[16:19], v0 offset:26624
    v_smfmac_f32_16x16x64_bf16 v[60:63], v[32:35], a[56:63], v2
    ds_read_b128 v[20:23], v0 offset:27648
    s_waitcnt lgkmcnt(5)
    v_smfmac_f32_16x16x64_bf16 v[48:51], v[36:39], a[64:71], v2
    v_smfmac_f32_16x16x64_bf16 v[52:55], v[36:39], a[72:79], v2
    buffer_load_dwordx4 v[44:47], v0, s[16:19], s31 offen offset:3072 sc1
    s_waitcnt lgkmcnt(2)
    v_smfmac_f32_16x16x64_bf16 v[56:59], v[36:39], v[8:15], v2
    ds_read_b128 v[8:11], v0 offset:28672
    s_waitcnt lgkmcnt(1)
    v_smfmac_f32_16x16x64_bf16 v[60:63], v[36:39], v[16:23], v2
    ds_read_b128 v[12:15], v0 offset:29696
    s_waitcnt vmcnt(4)
    s_barrier
    v_smfmac_f32_16x16x64_bf16 v[48:51], v[24:27], a[80:87], v2
    ds_read_b128 v[28:31], v0 offset:4096
    v_smfmac_f32_16x16x64_bf16 v[52:55], v[24:27], a[88:95], v2
    ds_read_b128 v[16:19], v0 offset:30720
    s_add_u32 s35, s31, 524288
    v_lshlrev_b32 v1, 3, v0
    v_smfmac_f32_16x16x64_bf16 v[56:59], v[24:27], a[96:103], v2
    ds_read_b128 v[32:35], v0 offset:5120
    buffer_load_dword v1, v1, s[16:19], s35 offen
    v_smfmac_f32_16x16x64_bf16 v[60:63], v[24:27], a[104:111], v2
    ds_read_b128 v[20:23], v0 offset:31744
    s_add_u32 s35, s35, 8192
    s_waitcnt lgkmcnt(3)
    v_smfmac_f32_16x16x64_bf16 v[48:51], v[28:31], a[112:119], v2
    ds_read_b128 v[36:39], v0 offset:6144
    buffer_load_dword v1, v1, s[16:19], s35 offen
    v_smfmac_f32_16x16x64_bf16 v[52:55], v[28:31], a[120:127], v2
    s_waitcnt lgkmcnt(2)
    v_smfmac_f32_16x16x64_bf16 v[48:51], v[32:35], a[128:135], v2
    ds_read_b128 v[24:27], v0 offset:7168
    buffer_load_dword v1, off, s[12:15], s8 sc1
    v_smfmac_f32_16x16x64_bf16 v[52:55], v[32:35], a[136:143], v2
    s_waitcnt lgkmcnt(1)
    v_smfmac_f32_16x16x64_bf16 v[48:51], v[36:39], v[8:15], v2
    ds_read_b128 v[8:11], v0 offset:32768
    v_smfmac_f32_16x16x64_bf16 v[52:55], v[36:39], v[16:23], v2
    ds_read_b128 v[12:15], v0 offset:33792
    s_waitcnt lgkmcnt(2)
    v_smfmac_f32_16x16x64_bf16 v[48:51], v[24:27], a[144:151], v2
    ds_read_b128 v[16:19], v0 offset:34816
    v_smfmac_f32_16x16x64_bf16 v[52:55], v[24:27], a[152:159], v2
    ds_read_b128 v[20:23], v0 offset:35840
    v_smfmac_f32_16x16x64_bf16 v[56:59], v[28:31], a[160:167], v2
    v_cvt_pk_bf16_f32 v72, v48, v49
    v_smfmac_f32_16x16x64_bf16 v[60:63], v[28:31], a[168:175], v2
    v_cvt_pk_bf16_f32 v73, v50, v51
    v_smfmac_f32_16x16x64_bf16 v[56:59], v[32:35], a[176:183], v2
    v_cvt_pk_bf16_f32 v74, v52, v53
    v_mfma_f32_16x16x16_bf16 v[48:51], v[72:73], v[4:5], 0
    s_waitcnt lgkmcnt(0)
    v_cvt_pk_bf16_f32 v75, v54, v55
    v_smfmac_f32_16x16x64_bf16 v[60:63], v[32:35], a[184:191], v2
    s_cmp_eq_u32 s22, s5
    s_cselect_b64 s[6:7], -1, 0
    v_mfma_f32_16x16x16_bf16 v[52:55], v[74:75], v[4:5], 0
    s_waitcnt vmcnt(5)
    v_cvt_pk_bf16_f32 v76, v48, v49
    v_cvt_pk_bf16_f32 v77, v50, v51
    v_smfmac_f32_16x16x64_bf16 v[56:59], v[36:39], v[8:15], v2
    ds_read_b128 v[8:11], v0 offset:36864
    v_cmp_u_f32 vcc, v48, v48
    v_smfmac_f32_16x16x64_bf16 v[60:63], v[36:39], v[16:23], v2
    ds_read_b128 v[12:15], v0 offset:37888
    v_cvt_pk_bf16_f32 v78, v52, v53
    v_smfmac_f32_16x16x64_bf16 v[56:59], v[24:27], a[192:199], v2
    ds_read_b128 v[16:19], v0 offset:38912
    s_or_b64 vcc, vcc, s[6:7]
    v_cvt_pk_bf16_f32 v79, v54, v55
    v_smfmac_f32_16x16x64_bf16 v[60:63], v[24:27], a[200:207], v2
    ds_read_b128 v[20:23], v0 offset:39936
    s_cbranch_scc1 L_redo_s_w0
L_xsb_s_w0:
    v_mov_b64 v[48:49], 0
    v_mfma_f32_16x16x32_bf16 v[64:67], v[64:67], v[76:79], 0
    v_cvt_pk_bf16_f32 v72, v56, v57
    v_cvt_pk_bf16_f32 v73, v58, v59
    v_mfma_f32_16x16x32_bf16 v[68:71], v[68:71], v[76:79], 0
    v_cvt_pk_bf16_f32 v74, v60, v61
    v_cvt_pk_bf16_f32 v75, v62, v63
    v_mfma_f32_16x16x16_bf16 v[56:59], v[72:73], v[4:5], 0
    s_mov_b32 s30, s29
    v_mov_b64 v[50:51], 0
    v_mov_b64 v[52:53], 0
    v_mfma_f32_16x16x16_bf16 v[60:63], v[74:75], v[4:5], 0
    s_add_u32 s29, s29, 9216
    v_mov_b64 v[54:55], 0
    v_cndmask_b32 v64, v64, v68, s[58:59]
    v_smfmac_f32_16x16x64_bf16 v[48:51], v[28:31], a[208:215], v2
    s_add_u32 s22, s22, 1
    s_add_u32 s23, s23, 1
    v_cvt_pk_bf16_f32 v72, v56, v57
    v_cvt_pk_bf16_f32 v73, v58, v59
    v_cvt_pk_bf16_f32 v74, v60, v61
    v_cvt_pk_bf16_f32 v75, v62, v63
    v_smfmac_f32_16x16x64_bf16 v[52:55], v[28:31], a[216:223], v2
    ds_read_b128 v[28:31], v0 offset:0
    s_add_u32 s25, s25, 1
    v_cndmask_b32 v65, v65, v69, s[58:59]
    v_mfma_f32_16x16x32_bf16 v[56:59], v[72:75], v[76:79], 0
    s_cmp_eq_u32 s29, 355328
    v_cndmask_b32 v66, v66, v70, s[58:59]
    v_cndmask_b32 v67, v67, v71, s[58:59]
    v_smfmac_f32_16x16x64_bf16 v[48:51], v[32:35], a[224:231], v2
    ds_write_b128 v0, v[64:67] offset:9216
    s_cselect_b32 s29, 327680, s29
    v_smfmac_f32_16x16x64_bf16 v[52:55], v[32:35], a[232:239], v2
    ds_read_b128 v[32:35], v0 offset:1024
    v_smfmac_f32_16x16x64_bf16 v[48:51], v[36:39], a[240:247], v2
    ds_write_b64 v6, v[56:57] offset:13312
    v_smfmac_f32_16x16x64_bf16 v[52:55], v[36:39], a[248:255], v2
    ds_read_b128 v[36:39], v0 offset:2048
    v_smfmac_f32_16x16x64_bf16 v[48:51], v[24:27], v[80:87], v2
    v_smfmac_f32_16x16x64_bf16 v[52:55], v[24:27], v[88:95], v2
    ds_read_b128 v[24:27], v0 offset:3072
    s_waitcnt lgkmcnt(5)
    v_smfmac_f32_16x16x64_bf16 v[48:51], v[28:31], v[96:103], v2
    s_waitcnt lgkmcnt(2)
    s_barrier
    ds_read_b128 v[60:63], v0 offset:10240
    v_smfmac_f32_16x16x64_bf16 v[52:55], v[28:31], v[104:111], v2
    ds_read_b128 v[72:75], v0 offset:11264
    v_smfmac_f32_16x16x64_bf16 v[48:51], v[32:35], v[112:119], v2
    ds_read_b128 v[76:79], v0 offset:12288
    v_smfmac_f32_16x16x64_bf16 v[52:55], v[32:35], v[120:127], v2
    ds_read_b128 v[28:31], v0 offset:8192
    s_waitcnt lgkmcnt(5)
    v_smfmac_f32_16x16x64_bf16 v[48:51], v[36:39], v[128:135], v2
    ds_read_b128 v[68:71], v6 offset:13312
    v_mov_b64 v[32:33], s[2:3]
    v_smfmac_f32_16x16x64_bf16 v[52:55], v[36:39], v[136:143], v2
    ds_read_b128 v[56:59], v6 offset:13344
    v_mov_b64 v[34:35], s[2:3]
    s_waitcnt lgkmcnt(6)
    v_smfmac_f32_16x16x64_bf16 v[48:51], v[24:27], v[144:151], v2
    v_mov_b64 v[36:37], s[0:1]
    v_smfmac_f32_16x16x64_bf16 v[52:55], v[24:27], v[152:159], v2
    s_waitcnt lgkmcnt(5)
    v_add_f32 v64, v64, v60
    s_waitcnt lgkmcnt(2)
    v_smfmac_f32_16x16x64_bf16 v[48:51], v[28:31], v[8:15], v2
    ds_read_b128 v[8:11], v0 offset:40960
    v_add_f32 v65, v65, v61
    v_smfmac_f32_16x16x64_bf16 v[52:55], v[28:31], v[16:23], v2
    ds_read_b128 v[12:15], v0 offset:41984
    v_add_f32 v66, v66, v62
    v_add_f32 v67, v67, v63
    v_pk_add_f32 v[72:73], v[72:73], v[76:77]
    v_pk_add_f32 v[74:75], v[74:75], v[78:79]
    v_pk_add_f32 v[64:65], v[64:65], v[72:73]
    v_pk_add_f32 v[66:67], v[66:67], v[74:75]
    s_waitcnt lgkmcnt(2)
    v_pk_add_f32 v[68:69], v[68:69], v[56:57]
    v_pk_add_f32 v[70:71], v[70:71], v[58:59]
    v_pk_add_f32 v[68:69], v[68:69], v[70:71]
    v_pk_mul_f32 v[68:69], v[68:69], s[32:33] op_sel_hi:[1,0]
    v_exp_f32 v64, v64
    v_exp_f32 v65, v65
    v_exp_f32 v66, v66
    v_exp_f32 v67, v67
    v_exp_f32 v68, v68
    v_exp_f32 v69, v69
L_maxback_s_w0:
    v_cvt_pk_bf16_f32 v72, v64, v65
    v_cvt_pk_bf16_f32 v73, v66, v67
    v_cvt_pk_bf16_f32 v76, v68, v68
    v_mov_b32_dpp v74, v72 quad_perm:[2,3,0,1] row_mask:0xf bank_mask:0xf
    v_mov_b32_dpp v75, v73 quad_perm:[2,3,0,1] row_mask:0xf bank_mask:0xf
    v_cvt_pk_bf16_f32 v77, v69, v69
    v_cvt_pk_bf16_f32 v24, v48, v49
    v_mfma_f32_16x16x32_bf16 v[28:31], v[32:35], v[72:75], 0
    s_waitcnt vmcnt(3)
    v_cvt_pk_bf16_f32 v25, v50, v51
    v_cvt_pk_bf16_f32 v26, v52, v53
    v_mfma_f32_16x16x32_bf16 v[56:59], v[40:43], v[72:75], 0
    ds_read_b128 v[16:19], v0 offset:43008
    v_cvt_pk_bf16_f32 v27, v54, v55
    v_mfma_f32_16x16x16_bf16 v[28:31], v[36:37], v[76:77], v[28:31]
    ds_read_b128 v[20:23], v0 offset:44032
    v_mfma_f32_16x16x32_bf16 v[68:71], v[44:47], v[72:75], 0
    v_mfma_f32_16x16x16_bf16 v[56:59], v[24:25], v[76:77], v[56:59]
    v_rcp_f32 v30, v28
    v_mfma_f32_16x16x16_bf16 v[68:71], v[26:27], v[76:77], v[68:71]
    v_max_f32 v28, v28, v30
    v_cmp_ngt_f32 vcc, s38, v28
    v_mov_b64 v[38:39], 0
    v_mov_b32 v78, s23
    v_pk_mul_f32 v[56:57], v[56:57], v[30:31] op_sel_hi:[1,0]
    v_pk_mul_f32 v[58:59], v[58:59], v[30:31] op_sel_hi:[1,0]
    v_cvt_pk_bf16_f32 v64, v56, v57
    v_cvt_pk_bf16_f32 v65, v58, v59
    v_pk_mul_f32 v[68:69], v[68:69], v[30:31] op_sel_hi:[1,0]
    v_pk_mul_f32 v[70:71], v[70:71], v[30:31] op_sel_hi:[1,0]
    s_cbranch_vccnz L_max_s_w0
L_maxskip_s_w0:
    v_cvt_pk_bf16_f32 v66, v68, v69
    v_cvt_pk_bf16_f32 v67, v70, v71
    v_mfma_f32_16x16x16_bf16 v[48:51], v[38:39], v[38:39], 0
    ds_write_b128 v7, v[64:67]
    v_mov_b64 v[34:35], 0
    v_mov_b64 v[36:37], 0
    v_mov_b64 v[40:41], 0
    v_mov_b64 v[42:43], 0
    v_mov_b64 v[44:45], 0
    v_mov_b64 v[46:47], 0
    v_mov_b64 v[56:57], 0
    v_mov_b64 v[58:59], 0
    v_mov_b64 v[24:25], 0
    v_mov_b64 v[26:27], 0
    v_mov_b64 v[28:29], 0
    v_mov_b64 v[30:31], 0
    v_mfma_f32_16x16x16_bf16 v[52:55], v[38:39], v[38:39], 0
    s_waitcnt lgkmcnt(0)
    s_barrier
    ds_read_b128 v[64:67], v0 offset:14336
    v_mov_b32 v32, 0
    ds_read_b128 v[68:71], v0 offset:15360
    v_mov_b32 v33, 0
    v_cndmask_b32 v62, 0, 1, s[56:57]
    v_lshrrev_b32 v63, 1, v0
    s_waitcnt lgkmcnt(1)
    v_smfmac_f32_16x16x64_bf16 v[24:27], v[64:67], v[8:15], v2
    ds_read_b128 v[8:11], v0 offset:45056
    s_waitcnt lgkmcnt(1)
    v_smfmac_f32_16x16x64_bf16 v[24:27], v[68:71], v[16:23], v2
    ds_read_b128 v[12:15], v0 offset:46080
    v_smfmac_f32_16x16x64_bf16 v[28:31], v[64:67], v[160:167], v2
    ds_read_b128 v[16:19], v0 offset:47104
    v_smfmac_f32_16x16x64_bf16 v[28:31], v[68:71], v[168:175], v2
    ds_read_b128 v[20:23], v0 offset:48128
    v_add_f32 v24, v24, v25
    v_add_f32 v26, v26, v27
    v_smfmac_f32_16x16x64_bf16 v[32:35], v[64:67], v[176:183], v2
    v_cvt_pk_bf16_f32 v24, v24, v26
    v_bfi_b32 v72, v62, s23, v24
    v_smfmac_f32_16x16x64_bf16 v[32:35], v[68:71], v[184:191], v2
    v_add_f32 v28, v28, v29
    v_add_f32 v30, v30, v31
    v_smfmac_f32_16x16x64_bf16 v[36:39], v[64:67], v[192:199], v2
    v_cvt_pk_bf16_f32 v73, v28, v30
    v_smfmac_f32_16x16x64_bf16 v[36:39], v[68:71], v[200:207], v2
    buffer_store_dwordx2 v[72:73], v63, s[12:15], s24 offen sc1
    s_add_u32 s26, s24, 65536
    v_add_f32 v32, v32, v33
    v_add_f32 v34, v34, v35
    s_waitcnt lgkmcnt(2)
    v_smfmac_f32_16x16x64_bf16 v[40:43], v[64:67], v[8:15], v2
    ds_read_b128 v[8:11], v0 offset:49152
    v_cvt_pk_bf16_f32 v32, v32, v34
    v_bfi_b32 v74, v62, s23, v32
    s_waitcnt lgkmcnt(1)
    v_smfmac_f32_16x16x64_bf16 v[40:43], v[68:71], v[16:23], v2
    ds_read_b128 v[12:15], v0 offset:50176
    v_add_f32 v36, v36, v37
    v_add_f32 v38, v38, v39
    v_smfmac_f32_16x16x64_bf16 v[44:47], v[64:67], v[208:215], v2
    ds_read_b128 v[16:19], v0 offset:51200
    v_cvt_pk_bf16_f32 v75, v36, v38
    v_smfmac_f32_16x16x64_bf16 v[44:47], v[68:71], v[216:223], v2
    ds_read_b128 v[20:23], v0 offset:52224
    buffer_store_dwordx2 v[74:75], v63, s[12:15], s26 offen sc1
    s_add_u32 s26, s24, 262144
    v_add_f32 v40, v40, v41
    v_add_f32 v42, v42, v43
    v_smfmac_f32_16x16x64_bf16 v[48:51], v[64:67], v[224:231], v2
    v_cvt_pk_bf16_f32 v40, v40, v42
    v_bfi_b32 v72, v62, s23, v40
    v_smfmac_f32_16x16x64_bf16 v[48:51], v[68:71], v[232:239], v2
    buffer_store_dwordx2 v[72:73], v63, s[12:15], s26 offen sc1
    s_add_u32 s26, s24, 131072
    v_add_f32 v44, v44, v45
    v_add_f32 v46, v46, v47
    v_smfmac_f32_16x16x64_bf16 v[52:55], v[64:67], v[240:247], v2
    v_cvt_pk_bf16_f32 v44, v44, v46
    v_bfi_b32 v76, v62, s23, v44
    v_smfmac_f32_16x16x64_bf16 v[52:55], v[68:71], v[248:255], v2
    v_add_f32 v48, v48, v49
    v_add_f32 v50, v50, v51
    s_waitcnt lgkmcnt(2)
    v_smfmac_f32_16x16x64_bf16 v[56:59], v[64:67], v[8:15], v2
    ds_read_b128 v[8:11], v0 offset:16384
    v_cvt_pk_bf16_f32 v77, v48, v50
    s_waitcnt lgkmcnt(1)
    v_smfmac_f32_16x16x64_bf16 v[56:59], v[68:71], v[16:23], v2
    ds_read_b128 v[12:15], v0 offset:17408
    buffer_store_dwordx2 v[76:77], v63, s[12:15], s26 offen sc1
    s_add_u32 s26, s24, 196608
    v_add_f32 v52, v52, v53
    v_add_f32 v54, v54, v55
    v_cvt_pk_bf16_f32 v52, v52, v54
    v_bfi_b32 v78, v62, s23, v52
    s_nop 0
    v_add_f32 v56, v56, v57
    v_add_f32 v58, v58, v59
    v_cvt_pk_bf16_f32 v79, v56, v58
    buffer_store_dwordx2 v[78:79], v63, s[12:15], s26 offen sc1
    s_barrier
    ds_read_b128 v[16:19], v0 offset:18432
    ds_read_b128 v[20:23], v0 offset:19456
    buffer_load_dwordx4 v[24:27], v3, s[12:15], s27 offen offset:0 sc1
    buffer_load_dwordx4 v[28:31], v3, s[12:15], s27 offen offset:512 sc1
    buffer_load_dwordx4 v[32:35], v3, s[12:15], s27 offen offset:1024 sc1
    buffer_load_dwordx4 v[36:39], v3, s[12:15], s27 offen offset:1536 sc1
    v_bfe_u32 v66, v0, 6, 1
    v_lshlrev_b32 v66, 4, v66
    v_mov_b32 v67, 0x3f80
    v_lshlrev_b32 v67, v66, v67
    v_and_b32 v66, 0xb0, v0
    v_cmp_eq_u32 vcc, 0, v66
    v_cmp_eq_u32 s[34:35], 16, v66
    v_lshrrev_b32 v68, 9, v0
    v_cndmask_b32 v44, 0, v67, vcc
    v_cndmask_b32 v46, 0, v67, s[34:35]
    v_cmp_eq_u32 vcc, 0x80, v66
    v_lshlrev_b32 v68, 10, v68
    v_bfe_u32 v69, v0, 8, 1
    v_cndmask_b32 v45, 0, v67, vcc
    v_cmp_eq_u32 vcc, 0x90, v66
    v_lshl_add_u32 v68, v69, 5, v68
    v_bfe_u32 v69, v0, 4, 3
    v_cndmask_b32 v47, 0, v67, vcc
    v_lshl_add_u32 v68, v69, 2, v68
    v_and_b32 v69, 128, v0
    v_cmp_eq_u32 vcc, 0, v69
    v_mov_b32 v69, 0x40000000
    s_nop 0
    v_cndmask_b32 v65, v69, v68, vcc
    v_mov_b32 v70, -1
    v_mov_b32 v64, s23
    s_add_u32 s34, s28, s29
    s_add_u32 s35, s28, s30
    v_mov_b64 v[48:49], 0
    v_mov_b64 v[50:51], 0
    v_mov_b64 v[52:53], 0
    v_mov_b64 v[54:55], 0
    v_mov_b64 v[56:57], 0
    v_mov_b64 v[58:59], 0
    v_mov_b64 v[60:61], 0
    v_mov_b64 v[62:63], 0
    s_waitcnt vmcnt(3)
    v_mfma_f32_16x16x32_bf16 v[40:43], v[44:47], v[24:27], 0
    v_xor_b32 v66, v64, v24
    s_waitcnt vmcnt(2)
    v_mfma_f32_16x16x32_bf16 v[40:43], v[44:47], v[28:31], v[40:43]
    v_bitop3_b32 v66, v66, v64, v28 bitop3:0xf6
    s_waitcnt vmcnt(1)
    v_mfma_f32_16x16x32_bf16 v[40:43], v[44:47], v[32:35], v[40:43]
    v_bitop3_b32 v66, v66, v64, v32 bitop3:0xf6
    s_waitcnt vmcnt(0)
    v_mfma_f32_16x16x32_bf16 v[40:43], v[44:47], v[36:39], v[40:43]
    v_bitop3_b32 v66, v66, v64, v36 bitop3:0xf6
    v_and_b32 v66, 1, v66
    v_cmp_ne_u32 vcc, 0, v66
    s_nop 0
    s_cbranch_vccnz L_redslow_s_w0
    s_nop 2
    v_add_f32_dpp v40, v40, v40 row_ror:8 row_mask:0xf bank_mask:0xf
    v_add_f32_dpp v41, v41, v41 row_ror:8 row_mask:0xf bank_mask:0xf
    v_cvt_pk_bf16_f32 v40, v40, v41
    buffer_store_dword v40, v65, s[12:15], s34 offen sc1
    buffer_store_dword v70, v65, s[12:15], s35 offen sc1
L_redend_s_w0:
    s_branch L_loop_s_w0
L_kw_s_w0:
    buffer_load_dword v1, off, s[12:15], s8 sc1
    s_add_u32 s63, s63, 1
    s_add_u32 s37, s37, 1
    s_cmp_gt_u32 s37, 400000
    s_waitcnt vmcnt(0)
    s_cbranch_scc1 L_kw_s_w0_ok
    v_cmp_gt_u32 vcc, s25, v1
    s_nop 0
    s_cbranch_vccnz L_kw_s_w0
    s_branch L_kw_s_w0_ok
L_xs_s_w0:
    s_cmp_lg_u32 s5, 0
    s_cbranch_scc1 L_team_exit
    s_mov_b32 s5, 63
    s_lshl_b32 s35, s21, 7
    s_add_u32 s35, s35, 397312
L_xl_s_w0:
    buffer_load_dword v72, off, s[12:15], s35 sc1
    s_add_u32 s37, s37, 1
    s_cmp_gt_u32 s37, 400000
    s_waitcnt vmcnt(0)
    s_cbranch_scc1 L_xg_s_w0
    v_cmp_gt_u32 vcc, s25, v72
    s_nop 0
    s_cbranch_vccnz L_xl_s_w0
L_xg_s_w0:
    buffer_load_dwordx4 v[64:67], v0, s[16:19], s31 offen offset:0 sc1
    buffer_load_dwordx4 v[68:71], v0, s[16:19], s31 offen offset:1024 sc1
    buffer_load_dwordx4 v[40:43], v0, s[16:19], s31 offen offset:2048 sc1
    buffer_load_dwordx4 v[44:47], v0, s[16:19], s31 offen offset:3072 sc1
    s_add_u32 s35, s31, 524288
    v_lshlrev_b32 v1, 3, v0
    buffer_load_dword v1, v1, s[16:19], s35 offen
    s_add_u32 s35, s35, 8192
    buffer_load_dword v1, v1, s[16:19], s35 offen
    buffer_load_dword v1, off, s[12:15], s8 sc1
    s_waitcnt vmcnt(3)
    s_branch L_xsb_s_w0
L_redo_s_w0:
    v_cmp_u_f32 vcc, v48, v48
    s_nop 0
    s_cbranch_vccz L_xs_s_w0
    s_add_u32 s61, s61, 1
    s_add_u32 s37, s37, 64
    s_cmp_gt_u32 s37, 400000
    s_cbranch_scc0 L_redo2_s_w0
    s_cmp_eq_u32 s22, s5
    s_cbranch_scc1 L_xs_s_w0
    s_branch L_xsb_s_w0
L_redo2_s_w0:
    s_waitcnt vmcnt(0) lgkmcnt(0)
    s_barrier
    s_mov_b32 m0, 0
    s_add_u32 s34, s29, 0
    buffer_load_dwordx4 v0, s[12:15], s34 offen offset:0 sc1 lds
    buffer_load_dwordx4 v0, s[12:15], s34 offen offset:1024 sc1 lds
    buffer_load_dwordx4 v0, s[12:15], s34 offen offset:2048 sc1 lds
    buffer_load_dwordx4 v0, s[12:15], s34 offen offset:3072 sc1 lds
    s_mov_b32 m0, 4096
    s_add_u32 s34, s29, 4096
    s_nop 7
    v_mov_b64 v[48:49], 0
    v_mov_b64 v[50:51], 0
    v_mov_b64 v[52:53], 0
    v_mov_b64 v[54:55], 0
    v_mov_b64 v[56:57], 0
    v_mov_b64 v[58:59], 0
    v_mov_b64 v[60:61], 0
    v_mov_b64 v[62:63], 0
    ds_read_b128 v[8:11], v0 offset:16384
    ds_read_b128 v[12:15], v0 offset:17408
    ds_read_b128 v[16:19], v0 offset:18432
    ds_read_b128 v[20:23], v0 offset:19456
    s_waitcnt vmcnt(0) lgkmcnt(0)
    s_barrier
    s_branch L_pa_s_w0
L_max_s_w0:
    s_cmp_eq_u32 s4, s23
    s_cbranch_scc1 L_maxskip_s_w0
    s_mov_b32 s4, s23
    s_nop 7
    ds_read_b128 v[60:63], v0 offset:10240
    ds_read_b128 v[72:75], v0 offset:11264
    ds_read_b128 v[76:79], v0 offset:12288
    ds_read_b128 v[64:67], v0 offset:9216
    ds_read_b128 v[68:71], v6 offset:13312
    ds_read_b128 v[56:59], v6 offset:13344
    s_waitcnt lgkmcnt(2)
    v_add_f32 v64, v64, v60
    v_add_f32 v65, v65, v61
    v_add_f32 v66, v66, v62
    v_add_f32 v67, v67, v63
    v_add_f32 v72, v72, v76
    v_add_f32 v73, v73, v77
    v_add_f32 v74, v74, v78
    v_add_f32 v75, v75, v79
    v_add_f32 v64, v64, v72
    v_add_f32 v65, v65, v73
    v_add_f32 v66, v66, v74
    v_add_f32 v67, v67, v75
    s_waitcnt lgkmcnt(0)
    v_add_f32 v68, v68, v56
    v_add_f32 v69, v69, v57
    v_add_f32 v70, v70, v58
    v_add_f32 v71, v71, v59
    v_add_f32 v68, v68, v70
    v_add_f32 v69, v69, v71
    v_pk_mul_f32 v[68:69], v[68:69], s[32:33] op_sel_hi:[1,0]
    v_max3_f32 v60, v64, v65, v66
    v_max3_f32 v61, v67, v68, v69
    v_max_f32 v60, v60, v61
    s_nop 1
    v_max_f32_dpp v60, v60, v60 quad_perm:[2,3,0,1] row_mask:0xf bank_mask:0xf
    v_mov_b32 v61, v60
    s_nop 1
    v_permlane16_swap_b32 v60, v61
    v_max_f32 v60, v60, v61
    v_mov_b32 v61, v60
    s_nop 1
    v_permlane32_swap_b32 v60, v61
    v_max_f32 v60, v60, v61
    v_sub_f32 v64, v64, v60
    v_sub_f32 v65, v65, v60
    v_sub_f32 v66, v66, v60
    v_sub_f32 v67, v67, v60
    v_sub_f32 v68, v68, v60
    v_sub_f32 v69, v69, v60
    v_exp_f32 v64, v64
    v_exp_f32 v65, v65
    v_exp_f32 v66, v66
    v_exp_f32 v67, v67
    v_exp_f32 v68, v68
    v_exp_f32 v69, v69
    s_add_u32 s62, s62, 1
    s_waitcnt lgkmcnt(0)
    s_branch L_maxback_s_w0
L_redslow_s_w0:
    buffer_store_byte v70, v0, s[40:43], 0 offen sc1
L_redslow2_s_w0:
    buffer_load_dwordx4 v[24:27], v3, s[12:15], s27 offen offset:0 sc1
    buffer_load_dwordx4 v[28:31], v3, s[12:15], s27 offen offset:512 sc1
    buffer_load_dwordx4 v[32:35], v3, s[12:15], s27 offen offset:1024 sc1
    buffer_load_dwordx4 v[36:39], v3, s[12:15], s27 offen offset:1536 sc1
    s_add_u32 s60, s60, 1
    s_add_u32 s37, s37, 1
    s_cmp_gt_u32 s37, 400000
    s_cbranch_scc1 L_redgo_s_w0
    s_waitcnt vmcnt(3)
    v_mfma_f32_16x16x32_bf16 v[40:43], v[44:47], v[24:27], 0
    v_xor_b32 v66, v64, v24
    s_waitcnt vmcnt(2)
    v_mfma_f32_16x16x32_bf16 v[40:43], v[44:47], v[28:31], v[40:43]
    v_bitop3_b32 v66, v66, v64, v28 bitop3:0xf6
    s_waitcnt vmcnt(1)
    v_mfma_f32_16x16x32_bf16 v[40:43], v[44:47], v[32:35], v[40:43]
    v_bitop3_b32 v66, v66, v64, v32 bitop3:0xf6
    s_waitcnt vmcnt(0)
    v_mfma_f32_16x16x32_bf16 v[40:43], v[44:47], v[36:39], v[40:43]
    v_bitop3_b32 v66, v66, v64, v36 bitop3:0xf6
    v_and_b32 v66, 1, v66
    v_cmp_ne_u32 vcc, 0, v66
    s_nop 0
    s_cbranch_vccnz L_redslow2_s_w0
L_redgo_s_w0:
    s_waitcnt vmcnt(0)
    v_mov_b32 v71, 0
    s_nop 0
    v_add_f32_dpp v40, v40, v40 row_ror:8 row_mask:0xf bank_mask:0xf
    v_add_f32_dpp v41, v41, v41 row_ror:8 row_mask:0xf bank_mask:0xf
    v_cvt_pk_bf16_f32 v40, v40, v41
    buffer_store_dword v40, v65, s[12:15], s34 offen sc1
    buffer_store_dword v70, v65, s[12:15], s35 offen sc1
    buffer_store_byte v71, v0, s[40:43], 0 offen sc1
    s_branch L_redend_s_w0
.p2align 6
L_loop_s_w1:
    s_add_u32 s31, s31, 524288
    s_mov_b32 m0, 5120
    s_add_u32 s34, s29, 5120
    s_waitcnt lgkmcnt(0)
    s_barrier
L_pa_s_w1:
    ds_read_b128 v[24:27], v0 offset:0
    ds_read_b128 v[28:31], v0 offset:1024
    buffer_load_dwordx4 v0, s[12:15], s34 offen sc1 lds
    s_waitcnt lgkmcnt(1)
    v_smfmac_f32_16x16x64_bf16 v[48:51], v[24:27], v[8:15], v2
    ds_read_b128 v[8:11], v1 offset:4096
    v_smfmac_f32_16x16x64_bf16 v[52:55], v[24:27], v[16:23], v2
    ds_read_b128 v[12:15], v1 offset:5120
    v_smfmac_f32_16x16x64_bf16 v[56:59], v[24:27], a[0:7], v2
    ds_read_b128 v[16:19], v1 offset:6144
    buffer_load_dwordx4 v[64:67], v0, s[16:19], s31 offen offset:0 sc1
    v_smfmac_f32_16x16x64_bf16 v[60:63], v[24:27], a[8:15], v2
    ds_read_b128 v[20:23], v1 offset:7168
    s_barrier
    s_waitcnt lgkmcnt(4)
    v_smfmac_f32_16x16x64_bf16 v[48:51], v[28:31], a[16:23], v2
    ds_read_b128 v[32:35], v0 offset:2048
    v_smfmac_f32_16x16x64_bf16 v[52:55], v[28:31], a[24:31], v2
    v_smfmac_f32_16x16x64_bf16 v[56:59], v[28:31], a[32:39], v2
    ds_read_b128 v[36:39], v0 offset:3072
    buffer_load_dwordx4 v[68:71], v0, s[16:19], s31 offen offset:1024 sc1
    v_smfmac_f32_16x16x64_bf16 v[60:63], v[28:31], a[40:47], v2
    ds_read_b128 v[24:27], v0 offset:8192
    s_waitcnt lgkmcnt(2)
    v_smfmac_f32_16x16x64_bf16 v[48:51], v[32:35], v[8:15], v2
    ds_read_b128 v[8:11], v1 offset:8192
    v_smfmac_f32_16x16x64_bf16 v[52:55], v[32:35], v[16:23], v2
    ds_read_b128 v[12:15], v1 offset:9216
    v_smfmac_f32_16x16x64_bf16 v[56:59], v[32:35], a[48:55], v2
    ds_read_b128 v[16:19], v1 offset:10240
    buffer_load_dwordx4 v[40:43], v0, s[16:19], s31 offen offset:2048 sc1
    v_smfmac_f32_16x16x64_bf16 v[60:63], v[32:35], a[56:63], v2
    ds_read_b128 v[20:23], v1 offset:11264
    s_waitcnt lgkmcnt(5)
    v_smfmac_f32_16x16x64_bf16 v[48:51], v[36:39], a[64:71], v2
    v_smfmac_f32_16x16x64_bf16 v[52:55], v[36:39], a[72:79], v2
    s_waitcnt lgkmcnt(2)
    v_smfmac_f32_16x16x64_bf16 v[56:59], v[36:39], v[8:15], v2
    ds_read_b128 v[8:11], v1 offset:12288
    buffer_load_dwordx4 v[44:47], v0, s[16:19], s31 offen offset:3072 sc1
    s_waitcnt lgkmcnt(1)
    v_smfmac_f32_16x16x64_bf16 v[60:63], v[36:39], v[16:23], v2
    ds_read_b128 v[12:15], v1 offset:13312
    s_waitcnt vmcnt(4)
    s_barrier
    v_smfmac_f32_16x16x64_bf16 v[48:51], v[24:27], a[80:87], v2
    ds_read_b128 v[28:31], v0 offset:4096
    v_smfmac_f32_16x16x64_bf16 v[52:55], v[24:27], a[88:95], v2
    ds_read_b128 v[16:19], v1 offset:14336
    v_smfmac_f32_16x16x64_bf16 v[56:59], v[24:27], a[96:103], v2
    ds_read_b128 v[32:35], v0 offset:5120
    v_smfmac_f32_16x16x64_bf16 v[60:63], v[24:27], a[104:111], v2
    ds_read_b128 v[20:23], v1 offset:15360
    s_waitcnt lgkmcnt(3)
    v_smfmac_f32_16x16x64_bf16 v[48:51], v[28:31], a[112:119], v2
    ds_read_b128 v[36:39], v0 offset:6144
    v_smfmac_f32_16x16x64_bf16 v[52:55], v[28:31], a[120:127], v2
    s_waitcnt lgkmcnt(2)
    v_smfmac_f32_16x16x64_bf16 v[48:51], v[32:35], a[128:135], v2
    ds_read_b128 v[24:27], v0 offset:7168
    v_smfmac_f32_16x16x64_bf16 v[52:55], v[32:35], a[136:143], v2
    s_waitcnt lgkmcnt(1)
    v_smfmac_f32_16x16x64_bf16 v[48:51], v[36:39], v[8:15], v2
    ds_read_b128 v[8:11], v1 offset:16384
    v_smfmac_f32_16x16x64_bf16 v[52:55], v[36:39], v[16:23], v2
    ds_read_b128 v[12:15], v1 offset:17408
    s_waitcnt lgkmcnt(2)
    v_smfmac_f32_16x16x64_bf16 v[48:51], v[24:27], a[144:151], v2
    ds_read_b128 v[16:19], v1 offset:18432
    v_smfmac_f32_16x16x64_bf16 v[52:55], v[24:27], a[152:159], v2
    ds_read_b128 v[20:23], v1 offset:19456
    v_smfmac_f32_16x16x64_bf16 v[56:59], v[28:31], a[160:167], v2
    v_cvt_pk_bf16_f32 v72, v48, v49
    v_smfmac_f32_16x16x64_bf16 v[60:63], v[28:31], a[168:175], v2
    v_cvt_pk_bf16_f32 v73, v50, v51
    v_smfmac_f32_16x16x64_bf16 v[56:59], v[32:35], a[176:183], v2
    v_cvt_pk_bf16_f32 v74, v52, v53
    v_mfma_f32_16x16x16_bf16 v[48:51], v[72:73], v[4:5], 0
    s_waitcnt lgkmcnt(0)
    v_cvt_pk_bf16_f32 v75, v54, v55
    v_smfmac_f32_16x16x64_bf16 v[60:63], v[32:35], a[184:191], v2
    s_cmp_eq_u32 s22, s5
    s_cselect_b64 s[6:7], -1, 0
    v_mfma_f32_16x16x16_bf16 v[52:55], v[74:75], v[4:5], 0
    s_waitcnt vmcnt(2)
    v_cvt_pk_bf16_f32 v76, v48, v49
    v_cvt_pk_bf16_f32 v77, v50, v51
    v_smfmac_f32_16x16x64_bf16 v[56:59], v[36:39], v[8:15], v2
    ds_read_b128 v[8:11], v1 offset:20480
    v_cmp_u_f32 vcc, v48, v48
    v_smfmac_f32_16x16x64_bf16 v[60:63], v[36:39], v[16:23], v2
    ds_read_b128 v[12:15], v1 offset:21504
    v_cvt_pk_bf16_f32 v78, v52, v53
    v_smfmac_f32_16x16x64_bf16 v[56:59], v[24:27], a[192:199], v2
    ds_read_b128 v[16:19], v1 offset:22528
    s_or_b64 vcc, vcc, s[6:7]
    v_cvt_pk_bf16_f32 v79, v54, v55
    v_smfmac_f32_16x16x64_bf16 v[60:63], v[24:27], a[200:207], v2
    ds_read_b128 v[20:23], v1 offset:23552
    s_cbranch_scc1 L_redo_s_w1
L_xsb_s_w1:
    v_mov_b64 v[48:49], 0
    v_mfma_f32_16x16x32_bf16 v[64:67], v[64:67], v[76:79], 0
    v_cvt_pk_bf16_f32 v72, v56, v57
    v_cvt_pk_bf16_f32 v73, v58, v59
    v_mfma_f32_16x16x32_bf16 v[68:71], v[68:71], v[76:79], 0
    v_cvt_pk_bf16_f32 v74, v60, v61
    v_cvt_pk_bf16_f32 v75, v62, v63
    v_mfma_f32_16x16x16_bf16 v[56:59], v[72:73], v[4:5], 0
    s_mov_b32 s30, s29
    v_mov_b64 v[50:51], 0
    v_mov_b64 v[52:53], 0
    v_mfma_f32_16x16x16_bf16 v[60:63], v[74:75], v[4:5], 0
    s_add_u32 s29, s29, 9216
    v_mov_b64 v[54:55], 0
    v_cndmask_b32 v64, v64, v68, s[58:59]
    v_smfmac_f32_16x16x64_bf16 v[48:51], v[28:31], a[208:215], v2
    s_add_u32 s22, s22, 1
    s_add_u32 s23, s23, 1
    v_cvt_pk_bf16_f32 v72, v56, v57
    v_cvt_pk_bf16_f32 v73, v58, v59
    v_cvt_pk_bf16_f32 v74, v60, v61
    v_cvt_pk_bf16_f32 v75, v62, v63
    v_smfmac_f32_16x16x64_bf16 v[52:55], v[28:31], a[216:223], v2
    ds_read_b128 v[28:31], v0 offset:0
    s_add_u32 s25, s25, 1
    v_cndmask_b32 v65, v65, v69, s[58:59]
    v_mfma_f32_16x16x32_bf16 v[56:59], v[72:75], v[76:79], 0
    s_cmp_eq_u32 s29, 355328
    v_cndmask_b32 v66, v66, v70, s[58:59]
    v_cndmask_b32 v67, v67, v71, s[58:59]
    v_smfmac_f32_16x16x64_bf16 v[48:51], v[32:35], a[224:231], v2
    s_cselect_b32 s29, 327680, s29
    v_smfmac_f32_16x16x64_bf16 v[52:55], v[32:35], a[232:239], v2
    ds_write_b128 v0, v[64:67] offset:10240
    v_smfmac_f32_16x16x64_bf16 v[48:51], v[36:39], a[240:247], v2
    ds_read_b128 v[32:35], v0 offset:1024
    v_smfmac_f32_16x16x64_bf16 v[52:55], v[36:39], a[248:255], v2
    ds_write_b64 v6, v[56:57] offset:13320
    v_smfmac_f32_16x16x64_bf16 v[48:51], v[24:27], v[80:87], v2
    ds_read_b128 v[36:39], v0 offset:2048
    v_smfmac_f32_16x16x64_bf16 v[52:55], v[24:27], v[88:95], v2
    ds_read_b128 v[24:27], v0 offset:3072
    s_waitcnt lgkmcnt(5)
    v_smfmac_f32_16x16x64_bf16 v[48:51], v[28:31], v[96:103], v2
    s_waitcnt lgkmcnt(2)
    s_barrier
    ds_read_b128 v[60:63], v0 offset:9216
    v_smfmac_f32_16x16x64_bf16 v[52:55], v[28:31], v[104:111], v2
    ds_read_b128 v[72:75], v0 offset:11264
    v_smfmac_f32_16x16x64_bf16 v[48:51], v[32:35], v[112:119], v2
    ds_read_b128 v[76:79], v0 offset:12288
    v_smfmac_f32_16x16x64_bf16 v[52:55], v[32:35], v[120:127], v2
    ds_read_b128 v[28:31], v0 offset:8192
    s_waitcnt lgkmcnt(5)
    v_smfmac_f32_16x16x64_bf16 v[48:51], v[36:39], v[128:135], v2
    ds_read_b128 v[68:71], v6 offset:13312
    v_mov_b64 v[32:33], s[2:3]
    v_smfmac_f32_16x16x64_bf16 v[52:55], v[36:39], v[136:143], v2
    ds_read_b128 v[56:59], v6 offset:13344
    v_mov_b64 v[34:35], s[2:3]
    s_waitcnt lgkmcnt(6)
    v_smfmac_f32_16x16x64_bf16 v[48:51], v[24:27], v[144:151], v2
    v_mov_b64 v[36:37], s[0:1]
    v_smfmac_f32_16x16x64_bf16 v[52:55], v[24:27], v[152:159], v2
    s_waitcnt lgkmcnt(5)
    v_add_f32 v60, v60, v64
    s_waitcnt lgkmcnt(2)
    v_smfmac_f32_16x16x64_bf16 v[48:51], v[28:31], v[8:15], v2
    ds_read_b128 v[8:11], v1 offset:24576
    v_add_f32 v61, v61, v65
    v_smfmac_f32_16x16x64_bf16 v[52:55], v[28:31], v[16:23], v2
    ds_read_b128 v[12:15], v1 offset:25600
    v_add_f32 v62, v62, v66
    v_add_f32 v63, v63, v67
    v_pk_add_f32 v[72:73], v[72:73], v[76:77]
    v_pk_add_f32 v[74:75], v[74:75], v[78:79]
    v_pk_add_f32 v[60:61], v[60:61], v[72:73]
    v_pk_add_f32 v[62:63], v[62:63], v[74:75]
    s_waitcnt lgkmcnt(2)
    v_pk_add_f32 v[68:69], v[68:69], v[56:57]
    v_pk_add_f32 v[70:71], v[70:71], v[58:59]
    v_pk_add_f32 v[68:69], v[68:69], v[70:71]
    v_pk_mul_f32 v[68:69], v[68:69], s[32:33] op_sel_hi:[1,0]
    v_exp_f32 v60, v60
    v_exp_f32 v61, v61
    v_exp_f32 v62, v62
    v_exp_f32 v63, v63
    v_exp_f32 v68, v68
    v_exp_f32 v69, v69
L_maxback_s_w1:
    v_cvt_pk_bf16_f32 v72, v60, v61
    v_cvt_pk_bf16_f32 v73, v62, v63
    v_cvt_pk_bf16_f32 v76, v68, v68
    v_mov_b32_dpp v74, v72 quad_perm:[2,3,0,1] row_mask:0xf bank_mask:0xf
    v_mov_b32_dpp v75, v73 quad_perm:[2,3,0,1] row_mask:0xf bank_mask:0xf
    v_cvt_pk_bf16_f32 v77, v69, v69
    v_cvt_pk_bf16_f32 v24, v48, v49
    v_mfma_f32_16x16x32_bf16 v[28:31], v[32:35], v[72:75], 0
    s_waitcnt vmcnt(0)
    v_cvt_pk_bf16_f32 v25, v50, v51
    v_cvt_pk_bf16_f32 v26, v52, v53
    v_mfma_f32_16x16x32_bf16 v[56:59], v[40:43], v[72:75], 0
    ds_read_b128 v[16:19], v1 offset:26624
    v_cvt_pk_bf16_f32 v27, v54, v55
    v_mfma_f32_16x16x16_bf16 v[28:31], v[36:37], v[76:77], v[28:31]
    ds_read_b128 v[20:23], v1 offset:27648
    v_mfma_f32_16x16x32_bf16 v[68:71], v[44:47], v[72:75], 0
    v_mfma_f32_16x16x16_bf16 v[56:59], v[24:25], v[76:77], v[56:59]
    v_rcp_f32 v30, v28
    v_mfma_f32_16x16x16_bf16 v[68:71], v[26:27], v[76:77], v[68:71]
    v_max_f32 v28, v28, v30
    v_cmp_ngt_f32 vcc, s38, v28
    v_mov_b64 v[38:39], 0
    v_mov_b32 v78, s23
    v_pk_mul_f32 v[56:57], v[56:57], v[30:31] op_sel_hi:[1,0]
    v_pk_mul_f32 v[58:59], v[58:59], v[30:31] op_sel_hi:[1,0]
    v_cvt_pk_bf16_f32 v64, v56, v57
    v_cvt_pk_bf16_f32 v65, v58, v59
    v_pk_mul_f32 v[68:69], v[68:69], v[30:31] op_sel_hi:[1,0]
    v_pk_mul_f32 v[70:71], v[70:71], v[30:31] op_sel_hi:[1,0]
    s_cbranch_vccnz L_max_s_w1
L_maxskip_s_w1:
    v_cvt_pk_bf16_f32 v66, v68, v69
    v_cvt_pk_bf16_f32 v67, v70, v71
    v_mfma_f32_16x16x16_bf16 v[48:51], v[38:39], v[38:39], 0
    ds_write_b128 v7, v[64:67]
    v_mov_b64 v[34:35], 0
    v_mov_b64 v[36:37], 0
    v_mov_b64 v[40:41], 0
    v_mov_b64 v[42:43], 0
    v_mov_b64 v[44:45], 0
    v_mov_b64 v[46:47], 0
    v_mov_b64 v[56:57], 0
    v_mov_b64 v[58:59], 0
    v_mov_b64 v[24:25], 0
    v_mov_b64 v[26:27], 0
    v_mov_b64 v[28:29], 0
    v_mov_b64 v[30:31], 0
    v_mfma_f32_16x16x16_bf16 v[52:55], v[38:39], v[38:39], 0
    s_waitcnt lgkmcnt(0)
    s_barrier
    ds_read_b128 v[64:67], v0 offset:14336
    v_mov_b32 v32, 0
    ds_read_b128 v[68:71], v0 offset:15360
    v_mov_b32 v33, 0
    v_cndmask_b32 v62, 0, 1, s[56:57]
    v_lshrrev_b32 v63, 1, v0
    s_waitcnt lgkmcnt(1)
    v_smfmac_f32_16x16x64_bf16 v[24:27], v[64:67], v[8:15], v2
    ds_read_b128 v[8:11], v1 offset:28672
    s_waitcnt lgkmcnt(1)
    v_smfmac_f32_16x16x64_bf16 v[24:27], v[68:71], v[16:23], v2
    ds_read_b128 v[12:15], v1 offset:29696
    v_smfmac_f32_16x16x64_bf16 v[28:31], v[64:67], v[160:167], v2
    ds_read_b128 v[16:19], v1 offset:30720
    v_smfmac_f32_16x16x64_bf16 v[28:31], v[68:71], v[168:175], v2
    ds_read_b128 v[20:23], v1 offset:31744
    v_add_f32 v24, v24, v25
    v_add_f32 v26, v26, v27
    v_smfmac_f32_16x16x64_bf16 v[32:35], v[64:67], v[176:183], v2
    v_cvt_pk_bf16_f32 v24, v24, v26
    v_bfi_b32 v72, v62, s23, v24
    v_smfmac_f32_16x16x64_bf16 v[32:35], v[68:71], v[184:191], v2
    v_add_f32 v28, v28, v29
    v_add_f32 v30, v30, v31
    v_smfmac_f32_16x16x64_bf16 v[36:39], v[64:67], v[192:199], v2
    v_cvt_pk_bf16_f32 v73, v28, v30
    v_smfmac_f32_16x16x64_bf16 v[36:39], v[68:71], v[200:207], v2
    buffer_store_dwordx2 v[72:73], v63, s[12:15], s24 offen sc1
    s_add_u32 s26, s24, 65536
    v_add_f32 v32, v32, v33
    v_add_f32 v34, v34, v35
    s_waitcnt lgkmcnt(2)
    v_smfmac_f32_16x16x64_bf16 v[40:43], v[64:67], v[8:15], v2
    ds_read_b128 v[8:11], v1 offset:32768
    v_cvt_pk_bf16_f32 v32, v32, v34
    v_bfi_b32 v74, v62, s23, v32
    s_waitcnt lgkmcnt(1)
    v_smfmac_f32_16x16x64_bf16 v[40:43], v[68:71], v[16:23], v2
    ds_read_b128 v[12:15], v1 offset:33792
    v_add_f32 v36, v36, v37
    v_add_f32 v38, v38, v39
    v_smfmac_f32_16x16x64_bf16 v[44:47], v[64:67], v[208:215], v2
    ds_read_b128 v[16:19], v1 offset:34816
    v_cvt_pk_bf16_f32 v75, v36, v38
    v_smfmac_f32_16x16x64_bf16 v[44:47], v[68:71], v[216:223], v2
    ds_read_b128 v[20:23], v1 offset:35840
    buffer_store_dwordx2 v[74:75], v63, s[12:15], s26 offen sc1
    s_add_u32 s26, s24, 262144
    v_add_f32 v40, v40, v41
    v_add_f32 v42, v42, v43
    v_smfmac_f32_16x16x64_bf16 v[48:51], v[64:67], v[224:231], v2
    v_cvt_pk_bf16_f32 v40, v40, v42
    v_bfi_b32 v72, v62, s23, v40
    v_smfmac_f32_16x16x64_bf16 v[48:51], v[68:71], v[232:239], v2
    buffer_store_dwordx2 v[72:73], v63, s[12:15], s26 offen sc1
    s_add_u32 s26, s24, 131072
    v_add_f32 v44, v44, v45
    v_add_f32 v46, v46, v47
    v_smfmac_f32_16x16x64_bf16 v[52:55], v[64:67], v[240:247], v2
    v_cvt_pk_bf16_f32 v44, v44, v46
    v_bfi_b32 v76, v62, s23, v44
    v_smfmac_f32_16x16x64_bf16 v[52:55], v[68:71], v[248:255], v2
    v_add_f32 v48, v48, v49
    v_add_f32 v50, v50, v51
    s_waitcnt lgkmcnt(2)
    v_smfmac_f32_16x16x64_bf16 v[56:59], v[64:67], v[8:15], v2
    ds_read_b128 v[8:11], v1 offset:0
    v_cvt_pk_bf16_f32 v77, v48, v50
    s_waitcnt lgkmcnt(1)
    v_smfmac_f32_16x16x64_bf16 v[56:59], v[68:71], v[16:23], v2
    ds_read_b128 v[12:15], v1 offset:1024
    buffer_store_dwordx2 v[76:77], v63, s[12:15], s26 offen sc1
    s_add_u32 s26, s24, 196608
    v_add_f32 v52, v52, v53
    v_add_f32 v54, v54, v55
    v_cvt_pk_bf16_f32 v52, v52, v54
    v_bfi_b32 v78, v62, s23, v52
    s_nop 0
    v_add_f32 v56, v56, v57
    v_add_f32 v58, v58, v59
    v_cvt_pk_bf16_f32 v79, v56, v58
    buffer_store_dwordx2 v[78:79], v63, s[12:15], s26 offen sc1
    s_barrier
    v_mov_b32 v72, s23
    ds_read_b128 v[16:19], v1 offset:2048
    ds_read_b128 v[20:23], v1 offset:3072
    v_bfe_u32 v66, v0, 6, 1
    v_lshlrev_b32 v66, 4, v66
    v_mov_b32 v67, 0x3f80
    v_lshlrev_b32 v67, v66, v67
    v_and_b32 v66, 0xb0, v0
    v_cmp_eq_u32 vcc, 0, v66
    v_cmp_eq_u32 s[34:35], 16, v66
    v_lshrrev_b32 v68, 9, v0
    v_cndmask_b32 v44, 0, v67, vcc
    v_cndmask_b32 v46, 0, v67, s[34:35]
    v_cmp_eq_u32 vcc, 0x80, v66
    v_lshlrev_b32 v68, 10, v68
    v_bfe_u32 v69, v0, 8, 1
    v_cndmask_b32 v45, 0, v67, vcc
    v_cmp_eq_u32 vcc, 0x90, v66
    v_lshl_add_u32 v68, v69, 5, v68
    v_bfe_u32 v69, v0, 4, 3
    v_cndmask_b32 v47, 0, v67, vcc
    v_lshl_add_u32 v68, v69, 2, v68
    v_and_b32 v69, 128, v0
    buffer_store_dword v72, v0, s[52:55], 0 offen sc1
    v_cmp_eq_u32 vcc, 0, v69
    v_mov_b32 v69, 0x40000000
    s_nop 0
    v_cndmask_b32 v65, v69, v68, vcc
    v_mov_b32 v70, -1
    v_mov_b32 v64, s23
    s_add_u32 s34, s28, s29
    s_add_u32 s35, s28, s30
    v_mov_b64 v[48:49], 0
    v_mov_b64 v[50:51], 0
    v_mov_b64 v[52:53], 0
    v_mov_b64 v[54:55], 0
    v_mov_b64 v[56:57], 0
    v_mov_b64 v[58:59], 0
    v_mov_b64 v[60:61], 0
    v_mov_b64 v[62:63], 0
    buffer_load_dwordx4 v[24:27], v3, s[12:15], s27 offen offset:0 sc1
    buffer_load_dwordx4 v[28:31], v3, s[12:15], s27 offen offset:512 sc1
    buffer_load_dwordx4 v[32:35], v3, s[12:15], s27 offen offset:1024 sc1
    buffer_load_dwordx4 v[36:39], v3, s[12:15], s27 offen offset:1536 sc1
    s_waitcnt vmcnt(3)
    v_mfma_f32_16x16x32_bf16 v[40:43], v[44:47], v[24:27], 0
    v_xor_b32 v66, v64, v24
    s_waitcnt vmcnt(2)
    v_mfma_f32_16x16x32_bf16 v[40:43], v[44:47], v[28:31], v[40:43]
    v_bitop3_b32 v66, v66, v64, v28 bitop3:0xf6
    s_waitcnt vmcnt(1)
    v_mfma_f32_16x16x32_bf16 v[40:43], v[44:47], v[32:35], v[40:43]
    v_bitop3_b32 v66, v66, v64, v32 bitop3:0xf6
    s_waitcnt vmcnt(0)
    v_mfma_f32_16x16x32_bf16 v[40:43], v[44:47], v[36:39], v[40:43]
    v_bitop3_b32 v66, v66, v64, v36 bitop3:0xf6
    v_and_b32 v66, 1, v66
    v_cmp_ne_u32 vcc, 0, v66
    s_nop 0
    s_cbranch_vccnz L_redslow_s_w1
    s_nop 2
    v_add_f32_dpp v40, v40, v40 row_ror:8 row_mask:0xf bank_mask:0xf
    v_add_f32_dpp v41, v41, v41 row_ror:8 row_mask:0xf bank_mask:0xf
    v_cvt_pk_bf16_f32 v40, v40, v41
    buffer_store_dword v40, v65, s[12:15], s34 offen sc1
    buffer_store_dword v70, v65, s[12:15], s35 offen sc1
L_redend_s_w1:
    s_branch L_loop_s_w1
L_xs_s_w1:
    s_cmp_lg_u32 s5, 0
    s_cbranch_scc1 L_team_exit
    s_mov_b32 s5, 63
    s_lshl_b32 s35, s21, 7
    s_add_u32 s35, s35, 397312
L_xl_s_w1:
    buffer_load_dword v72, off, s[12:15], s35 sc1
    s_add_u32 s37, s37, 1
    s_cmp_gt_u32 s37, 400000
    s_waitcnt vmcnt(0)
    s_cbranch_scc1 L_xg_s_w1
    v_cmp_gt_u32 vcc, s25, v72
    s_nop 0
    s_cbranch_vccnz L_xl_s_w1
L_xg_s_w1:
    buffer_load_dwordx4 v[64:67], v0, s[16:19], s31 offen offset:0 sc1
    buffer_load_dwordx4 v[68:71], v0, s[16:19], s31 offen offset:1024 sc1
    buffer_load_dwordx4 v[40:43], v0, s[16:19], s31 offen offset:2048 sc1
    buffer_load_dwordx4 v[44:47], v0, s[16:19], s31 offen offset:3072 sc1
    s_waitcnt vmcnt(0)
    s_branch L_xsb_s_w1
L_redo_s_w1:
    v_cmp_u_f32 vcc, v48, v48
    s_nop 0
    s_cbranch_vccz L_xs_s_w1
    s_add_u32 s61, s61, 1
    s_add_u32 s37, s37, 64
    s_cmp_gt_u32 s37, 400000
    s_cbranch_scc0 L_redo2_s_w1
    s_cmp_eq_u32 s22, s5
    s_cbranch_scc1 L_xs_s_w1
    s_branch L_xsb_s_w1
L_redo2_s_w1:
    s_waitcnt vmcnt(0) lgkmcnt(0)
    s_barrier
    s_mov_b32 m0, 4096
    s_add_u32 s34, s29, 4096
    buffer_load_dwordx4 v0, s[12:15], s34 offen offset:0 sc1 lds
    buffer_load_dwordx4 v0, s[12:15], s34 offen offset:1024 sc1 lds
    buffer_load_dwordx4 v0, s[12:15], s34 offen offset:2048 sc1 lds
    buffer_load_dwordx4 v0, s[12:15], s34 offen offset:3072 sc1 lds
    s_mov_b32 m0, 5120
    s_add_u32 s34, s29, 5120
    s_nop 7
    v_mov_b64 v[48:49], 0
    v_mov_b64 v[50:51], 0
    v_mov_b64 v[52:53], 0
    v_mov_b64 v[54:55], 0
    v_mov_b64 v[56:57], 0
    v_mov_b64 v[58:59], 0
    v_mov_b64 v[60:61], 0
    v_mov_b64 v[62:63], 0
    ds_read_b128 v[8:11], v1 offset:0
    ds_read_b128 v[12:15], v1 offset:1024
    ds_read_b128 v[16:19], v1 offset:2048
    ds_read_b128 v[20:23], v1 offset:3072
    s_waitcnt vmcnt(0) lgkmcnt(0)
    s_barrier
    s_branch L_pa_s_w1
L_max_s_w1:
    s_cmp_eq_u32 s4, s23
    s_cbranch_scc1 L_maxskip_s_w1
    s_mov_b32 s4, s23
    s_nop 7
    ds_read_b128 v[60:63], v0 offset:9216
    ds_read_b128 v[72:75], v0 offset:11264
    ds_read_b128 v[76:79], v0 offset:12288
    ds_read_b128 v[64:67], v0 offset:10240
    ds_read_b128 v[68:71], v6 offset:13312
    ds_read_b128 v[56:59], v6 offset:13344
    s_waitcnt lgkmcnt(2)
    v_add_f32 v60, v60, v64
    v_add_f32 v61, v61, v65
    v_add_f32 v62, v62, v66
    v_add_f32 v63, v63, v67
    v_add_f32 v72, v72, v76
    v_add_f32 v73, v73, v77
    v_add_f32 v74, v74, v78
    v_add_f32 v75, v75, v79
    v_add_f32 v60, v60, v72
    v_add_f32 v61, v61, v73
    v_add_f32 v62, v62, v74
    v_add_f32 v63, v63, v75
    s_waitcnt lgkmcnt(0)
    v_add_f32 v68, v68, v56
    v_add_f32 v69, v69, v57
    v_add_f32 v70, v70, v58
    v_add_f32 v71, v71, v59
    v_add_f32 v68, v68, v70
    v_add_f32 v69, v69, v71
    v_pk_mul_f32 v[68:69], v[68:69], s[32:33] op_sel_hi:[1,0]
    v_max3_f32 v64, v60, v61, v62
    v_max3_f32 v65, v63, v68, v69
    v_max_f32 v64, v64, v65
    s_nop 1
    v_max_f32_dpp v64, v64, v64 quad_perm:[2,3,0,1] row_mask:0xf bank_mask:0xf
    v_mov_b32 v65, v64
    s_nop 1
    v_permlane16_swap_b32 v64, v65
    v_max_f32 v64, v64, v65
    v_mov_b32 v65, v64
    s_nop 1
    v_permlane32_swap_b32 v64, v65
    v_max_f32 v64, v64, v65
    v_sub_f32 v60, v60, v64
    v_sub_f32 v61, v61, v64
    v_sub_f32 v62, v62, v64
    v_sub_f32 v63, v63, v64
    v_sub_f32 v68, v68, v64
    v_sub_f32 v69, v69, v64
    v_exp_f32 v60, v60
    v_exp_f32 v61, v61
    v_exp_f32 v62, v62
    v_exp_f32 v63, v63
    v_exp_f32 v68, v68
    v_exp_f32 v69, v69
    s_add_u32 s62, s62, 1
    s_waitcnt lgkmcnt(0)
    s_branch L_maxback_s_w1
L_redslow_s_w1:
    buffer_store_byte v70, v0, s[40:43], 0 offen sc1
L_redslow2_s_w1:
    buffer_load_dwordx4 v[24:27], v3, s[12:15], s27 offen offset:0 sc1
    buffer_load_dwordx4 v[28:31], v3, s[12:15], s27 offen offset:512 sc1
    buffer_load_dwordx4 v[32:35], v3, s[12:15], s27 offen offset:1024 sc1
    buffer_load_dwordx4 v[36:39], v3, s[12:15], s27 offen offset:1536 sc1
    s_add_u32 s60, s60, 1
    s_add_u32 s37, s37, 1
    s_cmp_gt_u32 s37, 400000
    s_cbranch_scc1 L_redgo_s_w1
    s_waitcnt vmcnt(3)
    v_mfma_f32_16x16x32_bf16 v[40:43], v[44:47], v[24:27], 0
    v_xor_b32 v66, v64, v24
    s_waitcnt vmcnt(2)
    v_mfma_f32_16x16x32_bf16 v[40:43], v[44:47], v[28:31], v[40:43]
    v_bitop3_b32 v66, v66, v64, v28 bitop3:0xf6
    s_waitcnt vmcnt(1)
    v_mfma_f32_16x16x32_bf16 v[40:43], v[44:47], v[32:35], v[40:43]
    v_bitop3_b32 v66, v66, v64, v32 bitop3:0xf6
    s_waitcnt vmcnt(0)
    v_mfma_f32_16x16x32_bf16 v[40:43], v[44:47], v[36:39], v[40:43]
    v_bitop3_b32 v66, v66, v64, v36 bitop3:0xf6
    v_and_b32 v66, 1, v66
    v_cmp_ne_u32 vcc, 0, v66
    s_nop 0
    s_cbranch_vccnz L_redslow2_s_w1
L_redgo_s_w1:
    s_waitcnt vmcnt(0)
    v_mov_b32 v71, 0
    s_nop 0
    v_add_f32_dpp v40, v40, v40 row_ror:8 row_mask:0xf bank_mask:0xf
    v_add_f32_dpp v41, v41, v41 row_ror:8 row_mask:0xf bank_mask:0xf
    v_cvt_pk_bf16_f32 v40, v40, v41
    buffer_store_dword v40, v65, s[12:15], s34 offen sc1
    buffer_store_dword v70, v65, s[12:15], s35 offen sc1
    buffer_store_byte v71, v0, s[40:43], 0 offen sc1
    s_branch L_redend_s_w1
.p2align 6
L_loop_s_w2:
    s_add_u32 s31, s31, 524288
    s_mov_b32 m0, 6144
    s_add_u32 s34, s29, 6144
    s_waitcnt lgkmcnt(0)
    s_barrier
L_pa_s_w2:
    ds_read_b128 v[24:27], v0 offset:0
    ds_read_b128 v[28:31], v0 offset:1024
    buffer_load_dwordx4 v0, s[12:15], s34 offen sc1 lds
    s_waitcnt lgkmcnt(1)
    v_smfmac_f32_16x16x64_bf16 v[48:51], v[24:27], v[8:15], v2
    ds_read_b128 v[8:11], v1 offset:4096
    v_smfmac_f32_16x16x64_bf16 v[52:55], v[24:27], v[16:23], v2
    ds_read_b128 v[12:15], v1 offset:5120
    v_smfmac_f32_16x16x64_bf16 v[56:59], v[24:27], a[0:7], v2
    ds_read_b128 v[16:19], v1 offset:6144
    v_smfmac_f32_16x16x64_bf16 v[60:63], v[24:27], a[8:15], v2
    ds_read_b128 v[20:23], v1 offset:7168
    buffer_load_dwordx4 v[64:67], v0, s[16:19], s31 offen offset:0 sc1
    s_barrier
    s_waitcnt lgkmcnt(4)
    v_smfmac_f32_16x16x64_bf16 v[48:51], v[28:31], a[16:23], v2
    ds_read_b128 v[32:35], v0 offset:2048
    v_smfmac_f32_16x16x64_bf16 v[52:55], v[28:31], a[24:31], v2
    v_smfmac_f32_16x16x64_bf16 v[56:59], v[28:31], a[32:39], v2
    ds_read_b128 v[36:39], v0 offset:3072
    v_smfmac_f32_16x16x64_bf16 v[60:63], v[28:31], a[40:47], v2
    ds_read_b128 v[24:27], v0 offset:8192
    buffer_load_dwordx4 v[68:71], v0, s[16:19], s31 offen offset:1024 sc1
    s_waitcnt lgkmcnt(2)
    v_smfmac_f32_16x16x64_bf16 v[48:51], v[32:35], v[8:15], v2
    ds_read_b128 v[8:11], v1 offset:8192
    v_smfmac_f32_16x16x64_bf16 v[52:55], v[32:35], v[16:23], v2
    ds_read_b128 v[12:15], v1 offset:9216
    v_smfmac_f32_16x16x64_bf16 v[56:59], v[32:35], a[48:55], v2
    ds_read_b128 v[16:19], v1 offset:10240
    v_smfmac_f32_16x16x64_bf16 v[60:63], v[32:35], a[56:63], v2
    ds_read_b128 v[20:23], v1 offset:11264
    buffer_load_dwordx4 v[40:43], v0, s[16:19], s31 offen offset:2048 sc1
    s_waitcnt lgkmcnt(5)
    v_smfmac_f32_16x16x64_bf16 v[48:51], v[36:39], a[64:71], v2
    v_add_u32 v72, s33, v0
    v_smfmac_f32_16x16x64_bf16 v[52:55], v[36:39], a[72:79], v2
    s_sub_u32 s35, s25, 1
    s_waitcnt lgkmcnt(2)
    v_smfmac_f32_16x16x64_bf16 v[56:59], v[36:39], v[8:15], v2
    ds_read_b128 v[8:11], v1 offset:12288
    v_mov_b32 v76, s35
    s_waitcnt lgkmcnt(1)
    v_smfmac_f32_16x16x64_bf16 v[60:63], v[36:39], v[16:23], v2
    ds_read_b128 v[12:15], v1 offset:13312
    buffer_load_dwordx4 v[44:47], v0, s[16:19], s31 offen offset:3072 sc1
    s_waitcnt vmcnt(4)
    s_barrier
    v_smfmac_f32_16x16x64_bf16 v[48:51], v[24:27], a[80:87], v2
    ds_read_b128 v[28:31], v0 offset:4096
    buffer_store_dword v76, v0, s[48:51], 0 offen sc1
    v_smfmac_f32_16x16x64_bf16 v[52:55], v[24:27], a[88:95], v2
    ds_read_b128 v[72:75], v72 offset:0
    v_smfmac_f32_16x16x64_bf16 v[56:59], v[24:27], a[96:103], v2
    ds_read_b128 v[32:35], v0 offset:5120
    v_smfmac_f32_16x16x64_bf16 v[60:63], v[24:27], a[104:111], v2
    ds_read_b128 v[16:19], v1 offset:14336
    s_waitcnt lgkmcnt(3)
    v_smfmac_f32_16x16x64_bf16 v[48:51], v[28:31], a[112:119], v2
    ds_read_b128 v[36:39], v0 offset:6144
    v_smfmac_f32_16x16x64_bf16 v[52:55], v[28:31], a[120:127], v2
    ds_read_b128 v[20:23], v1 offset:15360
    s_waitcnt lgkmcnt(4)
    buffer_store_dwordx4 v[72:75], v0, s[44:47], 0 offen sc1
    s_waitcnt lgkmcnt(3)
    v_smfmac_f32_16x16x64_bf16 v[48:51], v[32:35], a[128:135], v2
    ds_read_b128 v[24:27], v0 offset:7168
    v_smfmac_f32_16x16x64_bf16 v[52:55], v[32:35], a[136:143], v2
    s_waitcnt lgkmcnt(2)
    v_smfmac_f32_16x16x64_bf16 v[48:51], v[36:39], v[8:15], v2
    ds_read_b128 v[8:11], v1 offset:16384
    s_waitcnt lgkmcnt(2)
    v_smfmac_f32_16x16x64_bf16 v[52:55], v[36:39], v[16:23], v2
    ds_read_b128 v[12:15], v1 offset:17408
    s_waitcnt lgkmcnt(2)
    v_smfmac_f32_16x16x64_bf16 v[48:51], v[24:27], a[144:151], v2
    ds_read_b128 v[16:19], v1 offset:18432
    v_smfmac_f32_16x16x64_bf16 v[52:55], v[24:27], a[152:159], v2
    ds_read_b128 v[20:23], v1 offset:19456
    v_smfmac_f32_16x16x64_bf16 v[56:59], v[28:31], a[160:167], v2
    v_cvt_pk_bf16_f32 v72, v48, v49
    v_smfmac_f32_16x16x64_bf16 v[60:63], v[28:31], a[168:175], v2
    v_cvt_pk_bf16_f32 v73, v50, v51
    v_smfmac_f32_16x16x64_bf16 v[56:59], v[32:35], a[176:183], v2
    v_cvt_pk_bf16_f32 v74, v52, v53
    v_mfma_f32_16x16x16_bf16 v[48:51], v[72:73], v[4:5], 0
    s_waitcnt lgkmcnt(0)
    v_cvt_pk_bf16_f32 v75, v54, v55
    v_smfmac_f32_16x16x64_bf16 v[60:63], v[32:35], a[184:191], v2
    s_cmp_eq_u32 s22, s5
    s_cselect_b64 s[6:7], -1, 0
    v_mfma_f32_16x16x16_bf16 v[52:55], v[74:75], v[4:5], 0
    s_waitcnt vmcnt(4)
    v_cvt_pk_bf16_f32 v76, v48, v49
    v_cvt_pk_bf16_f32 v77, v50, v51
    v_smfmac_f32_16x16x64_bf16 v[56:59], v[36:39], v[8:15], v2
    ds_read_b128 v[8:11], v1 offset:20480
    v_cmp_u_f32 vcc, v48, v48
    v_smfmac_f32_16x16x64_bf16 v[60:63], v[36:39], v[16:23], v2
    ds_read_b128 v[12:15], v1 offset:21504
    v_cvt_pk_bf16_f32 v78, v52, v53
    v_smfmac_f32_16x16x64_bf16 v[56:59], v[24:27], a[192:199], v2
    ds_read_b128 v[16:19], v1 offset:22528
    s_or_b64 vcc, vcc, s[6:7]
    v_cvt_pk_bf16_f32 v79, v54, v55
    v_smfmac_f32_16x16x64_bf16 v[60:63], v[24:27], a[200:207], v2
    ds_read_b128 v[20:23], v1 offset:23552
    s_cbranch_scc1 L_redo_s_w2
L_xsb_s_w2:
    v_mov_b64 v[48:49], 0
    v_mfma_f32_16x16x32_bf16 v[64:67], v[64:67], v[76:79], 0
    v_cvt_pk_bf16_f32 v72, v56, v57
    v_cvt_pk_bf16_f32 v73, v58, v59
    v_mfma_f32_16x16x32_bf16 v[68:71], v[68:71], v[76:79], 0
    v_cvt_pk_bf16_f32 v74, v60, v61
    v_cvt_pk_bf16_f32 v75, v62, v63
    v_mfma_f32_16x16x16_bf16 v[56:59], v[72:73], v[4:5], 0
    s_mov_b32 s30, s29
    v_mov_b64 v[50:51], 0
    v_mov_b64 v[52:53], 0
    v_mfma_f32_16x16x16_bf16 v[60:63], v[74:75], v[4:5], 0
    s_add_u32 s29, s29, 9216
    v_mov_b64 v[54:55], 0
    v_cndmask_b32 v64, v64, v68, s[58:59]
    v_smfmac_f32_16x16x64_bf16 v[48:51], v[28:31], a[208:215], v2
    s_add_u32 s22, s22, 1
    s_add_u32 s23, s23, 1
    v_cvt_pk_bf16_f32 v72, v56, v57
    v_cvt_pk_bf16_f32 v73, v58, v59
    v_cvt_pk_bf16_f32 v74, v60, v61
    v_cvt_pk_bf16_f32 v75, v62, v63
    v_smfmac_f32_16x16x64_bf16 v[52:55], v[28:31], a[216:223], v2
    ds_read_b128 v[28:31], v0 offset:0
    s_add_u32 s25, s25, 1
    v_cndmask_b32 v65, v65, v69, s[58:59]
    v_mfma_f32_16x16x32_bf16 v[56:59], v[72:75], v[76:79], 0
    s_cmp_eq_u32 s29, 355328
    v_cndmask_b32 v66, v66, v70, s[58:59]
    v_cndmask_b32 v67, v67, v71, s[58:59]
    v_smfmac_f32_16x16x64_bf16 v[48:51], v[32:35], a[224:231], v2
    ds_write_b128 v0, v[64:67] offset:11264
    s_cselect_b32 s29, 327680, s29
    v_smfmac_f32_16x16x64_bf16 v[52:55], v[32:35], a[232:239], v2
    ds_read_b128 v[32:35], v0 offset:1024
    v_smfmac_f32_16x16x64_bf16 v[48:51], v[36:39], a[240:247], v2
    ds_write_b64 v6, v[56:57] offset:13344
    v_smfmac_f32_16x16x64_bf16 v[52:55], v[36:39], a[248:255], v2
    ds_read_b128 v[36:39], v0 offset:2048
    v_smfmac_f32_16x16x64_bf16 v[48:51], v[24:27], v[80:87], v2
    v_smfmac_f32_16x16x64_bf16 v[52:55], v[24:27], v[88:95], v2
    ds_read_b128 v[24:27], v0 offset:3072
    s_waitcnt lgkmcnt(5)
    v_smfmac_f32_16x16x64_bf16 v[48:51], v[28:31], v[96:103], v2
    s_waitcnt lgkmcnt(2)
    s_barrier
    ds_read_b128 v[60:63], v0 offset:9216
    v_smfmac_f32_16x16x64_bf16 v[52:55], v[28:31], v[104:111], v2
    ds_read_b128 v[72:75], v0 offset:10240
    s_add_u32 s44, s44, 9216
    v_smfmac_f32_16x16x64_bf16 v[48:51], v[32:35], v[112:119], v2
    ds_read_b128 v[76:79], v0 offset:12288
    s_addc_u32 s45, s45, 0
    v_smfmac_f32_16x16x64_bf16 v[52:55], v[32:35], v[120:127], v2
    ds_read_b128 v[28:31], v0 offset:8192
    s_waitcnt lgkmcnt(5)
    v_smfmac_f32_16x16x64_bf16 v[48:51], v[36:39], v[128:135], v2
    ds_read_b128 v[68:71], v6 offset:13312
    v_mov_b64 v[32:33], s[2:3]
    v_smfmac_f32_16x16x64_bf16 v[52:55], v[36:39], v[136:143], v2
    ds_read_b128 v[56:59], v6 offset:13344
    v_mov_b64 v[34:35], s[2:3]
    s_waitcnt lgkmcnt(6)
    v_smfmac_f32_16x16x64_bf16 v[48:51], v[24:27], v[144:151], v2
    v_mov_b64 v[36:37], s[0:1]
    v_smfmac_f32_16x16x64_bf16 v[52:55], v[24:27], v[152:159], v2
    s_waitcnt lgkmcnt(4)
    v_add_f32 v60, v60, v72
    s_waitcnt lgkmcnt(2)
    v_smfmac_f32_16x16x64_bf16 v[48:51], v[28:31], v[8:15], v2
    ds_read_b128 v[8:11], v1 offset:24576
    v_add_f32 v61, v61, v73
    v_smfmac_f32_16x16x64_bf16 v[52:55], v[28:31], v[16:23], v2
    ds_read_b128 v[12:15], v1 offset:25600
    v_add_f32 v62, v62, v74
    v_add_f32 v63, v63, v75
    v_pk_add_f32 v[64:65], v[64:65], v[76:77]
    v_pk_add_f32 v[66:67], v[66:67], v[78:79]
    v_pk_add_f32 v[60:61], v[60:61], v[64:65]
    v_pk_add_f32 v[62:63], v[62:63], v[66:67]
    s_waitcnt lgkmcnt(2)
    v_pk_add_f32 v[68:69], v[68:69], v[56:57]
    v_pk_add_f32 v[70:71], v[70:71], v[58:59]
    v_pk_add_f32 v[68:69], v[68:69], v[70:71]
    v_pk_mul_f32 v[68:69], v[68:69], s[32:33] op_sel_hi:[1,0]
    v_exp_f32 v60, v60
    v_exp_f32 v61, v61
    v_exp_f32 v62, v62
    v_exp_f32 v63, v63
    v_exp_f32 v68, v68
    v_exp_f32 v69, v69
L_maxback_s_w2:
    v_cvt_pk_bf16_f32 v72, v60, v61
    v_cvt_pk_bf16_f32 v73, v62, v63
    v_cvt_pk_bf16_f32 v76, v68, v68
    v_mov_b32_dpp v74, v72 quad_perm:[2,3,0,1] row_mask:0xf bank_mask:0xf
    v_mov_b32_dpp v75, v73 quad_perm:[2,3,0,1] row_mask:0xf bank_mask:0xf
    v_cvt_pk_bf16_f32 v77, v69, v69
    v_cvt_pk_bf16_f32 v24, v48, v49
    v_mfma_f32_16x16x32_bf16 v[28:31], v[32:35], v[72:75], 0
    s_waitcnt vmcnt(2)
    v_cvt_pk_bf16_f32 v25, v50, v51
    v_cvt_pk_bf16_f32 v26, v52, v53
    v_mfma_f32_16x16x32_bf16 v[56:59], v[40:43], v[72:75], 0
    ds_read_b128 v[16:19], v1 offset:26624
    v_cvt_pk_bf16_f32 v27, v54, v55
    v_mfma_f32_16x16x16_bf16 v[28:31], v[36:37], v[76:77], v[28:31]
    ds_read_b128 v[20:23], v1 offset:27648
    v_mfma_f32_16x16x32_bf16 v[68:71], v[44:47], v[72:75], 0
    v_mfma_f32_16x16x16_bf16 v[56:59], v[24:25], v[76:77], v[56:59]
    v_rcp_f32 v30, v28
    v_mfma_f32_16x16x16_bf16 v[68:71], v[26:27], v[76:77], v[68:71]
    v_max_f32 v28, v28, v30
    v_cmp_ngt_f32 vcc, s38, v28
    v_mov_b64 v[38:39], 0
    v_mov_b32 v78, s23
    v_pk_mul_f32 v[56:57], v[56:57], v[30:31] op_sel_hi:[1,0]
    v_pk_mul_f32 v[58:59], v[58:59], v[30:31] op_sel_hi:[1,0]
    v_cvt_pk_bf16_f32 v64, v56, v57
    v_cvt_pk_bf16_f32 v65, v58, v59
    v_pk_mul_f32 v[68:69], v[68:69], v[30:31] op_sel_hi:[1,0]
    v_pk_mul_f32 v[70:71], v[70:71], v[30:31] op_sel_hi:[1,0]
    s_cbranch_vccnz L_max_s_w2
L_maxskip_s_w2:
    v_cvt_pk_bf16_f32 v66, v68, v69
    v_cvt_pk_bf16_f32 v67, v70, v71
    v_mfma_f32_16x16x16_bf16 v[48:51], v[38:39], v[38:39], 0
    ds_write_b128 v7, v[64:67]
    v_mov_b64 v[34:35], 0
    v_mov_b64 v[36:37], 0
    v_mov_b64 v[40:41], 0
    v_mov_b64 v[42:43], 0
    v_mov_b64 v[44:45], 0
    v_mov_b64 v[46:47], 0
    v_mov_b64 v[56:57], 0
    v_mov_b64 v[58:59], 0
    v_mov_b64 v[24:25], 0
    v_mov_b64 v[26:27], 0
    v_mov_b64 v[28:29], 0
    v_mov_b64 v[30:31], 0
    v_mfma_f32_16x16x16_bf16 v[52:55], v[38:39], v[38:39], 0
    s_waitcnt lgkmcnt(0)
    s_barrier
    ds_read_b128 v[64:67], v0 offset:14336
    v_mov_b32 v32, 0
    ds_read_b128 v[68:71], v0 offset:15360
    v_mov_b32 v33, 0
    v_cndmask_b32 v62, 0, 1, s[56:57]
    v_lshrrev_b32 v63, 1, v0
    s_waitcnt lgkmcnt(1)
    v_smfmac_f32_16x16x64_bf16 v[24:27], v[64:67], v[8:15], v2
    ds_read_b128 v[8:11], v1 offset:28672
    s_waitcnt lgkmcnt(1)
    v_smfmac_f32_16x16x64_bf16 v[24:27], v[68:71], v[16:23], v2
    ds_read_b128 v[12:15], v1 offset:29696
    v_smfmac_f32_16x16x64_bf16 v[28:31], v[64:67], v[160:167], v2
    ds_read_b128 v[16:19], v1 offset:30720
    buffer_store_dword v78, v0, s[52:55], 0 offen sc1
    v_smfmac_f32_16x16x64_bf16 v[28:31], v[68:71], v[168:175], v2
    ds_read_b128 v[20:23], v1 offset:31744
    v_add_f32 v24, v24, v25
    v_add_f32 v26, v26, v27
    v_smfmac_f32_16x16x64_bf16 v[32:35], v[64:67], v[176:183], v2
    v_cvt_pk_bf16_f32 v24, v24, v26
    v_bfi_b32 v72, v62, s23, v24
    v_smfmac_f32_16x16x64_bf16 v[32:35], v[68:71], v[184:191], v2
    v_add_f32 v28, v28, v29
    v_add_f32 v30, v30, v31
    v_smfmac_f32_16x16x64_bf16 v[36:39], v[64:67], v[192:199], v2
    v_cvt_pk_bf16_f32 v73, v28, v30
    v_smfmac_f32_16x16x64_bf16 v[36:39], v[68:71], v[200:207], v2
    v_add_f32 v32, v32, v33
    v_add_f32 v34, v34, v35
    s_waitcnt lgkmcnt(2)
    v_smfmac_f32_16x16x64_bf16 v[40:43], v[64:67], v[8:15], v2
    ds_read_b128 v[8:11], v1 offset:32768
    buffer_store_dwordx2 v[72:73], v63, s[12:15], s24 offen sc1
    s_add_u32 s26, s24, 65536
    v_cvt_pk_bf16_f32 v32, v32, v34
    v_bfi_b32 v74, v62, s23, v32
    s_waitcnt lgkmcnt(1)
    v_smfmac_f32_16x16x64_bf16 v[40:43], v[68:71], v[16:23], v2
    ds_read_b128 v[12:15], v1 offset:33792
    v_add_f32 v36, v36, v37
    v_add_f32 v38, v38, v39
    v_smfmac_f32_16x16x64_bf16 v[44:47], v[64:67], v[208:215], v2
    ds_read_b128 v[16:19], v1 offset:34816
    v_cvt_pk_bf16_f32 v75, v36, v38
    v_smfmac_f32_16x16x64_bf16 v[44:47], v[68:71], v[216:223], v2
    ds_read_b128 v[20:23], v1 offset:35840
    v_add_f32 v40, v40, v41
    v_add_f32 v42, v42, v43
    v_smfmac_f32_16x16x64_bf16 v[48:51], v[64:67], v[224:231], v2
    buffer_store_dwordx2 v[74:75], v63, s[12:15], s26 offen sc1
    s_add_u32 s26, s24, 262144
    v_cvt_pk_bf16_f32 v40, v40, v42
    v_bfi_b32 v72, v62, s23, v40
    v_smfmac_f32_16x16x64_bf16 v[48:51], v[68:71], v[232:239], v2
    v_add_f32 v44, v44, v45
    v_add_f32 v46, v46, v47
    v_smfmac_f32_16x16x64_bf16 v[52:55], v[64:67], v[240:247], v2
    buffer_store_dwordx2 v[72:73], v63, s[12:15], s26 offen sc1
    s_add_u32 s26, s24, 131072
    v_cvt_pk_bf16_f32 v44, v44, v46
    v_bfi_b32 v76, v62, s23, v44
    v_smfmac_f32_16x16x64_bf16 v[52:55], v[68:71], v[248:255], v2
    v_add_f32 v48, v48, v49
    v_add_f32 v50, v50, v51
    s_waitcnt lgkmcnt(2)
    v_smfmac_f32_16x16x64_bf16 v[56:59], v[64:67], v[8:15], v2
    ds_read_b128 v[8:11], v1 offset:0
    v_cvt_pk_bf16_f32 v77, v48, v50
    s_waitcnt lgkmcnt(1)
    v_smfmac_f32_16x16x64_bf16 v[56:59], v[68:71], v[16:23], v2
    ds_read_b128 v[12:15], v1 offset:1024
    buffer_store_dwordx2 v[76:77], v63, s[12:15], s26 offen sc1
    s_add_u32 s26, s24, 196608
    v_add_f32 v52, v52, v53
    v_add_f32 v54, v54, v55
    v_cvt_pk_bf16_f32 v52, v52, v54
    v_bfi_b32 v78, v62, s23, v52
    s_nop 0
    v_add_f32 v56, v56, v57
    v_add_f32 v58, v58, v59
    v_cvt_pk_bf16_f32 v79, v56, v58
    buffer_store_dwordx2 v[78:79], v63, s[12:15], s26 offen sc1
    s_barrier
    ds_read_b128 v[16:19], v1 offset:2048
    ds_read_b128 v[20:23], v1 offset:3072
    s_cmp_ge_u32 s21, 16
    s_cbranch_scc1 L_nored_s_w2
    v_bfe_u32 v66, v0, 6, 1
    v_lshlrev_b32 v66, 4, v66
    v_mov_b32 v67, 0x3f80
    v_lshlrev_b32 v67, v66, v67
    v_and_b32 v66, 0xb0, v0
    v_cmp_eq_u32 vcc, 0, v66
    v_cmp_eq_u32 s[34:35], 16, v66
    v_lshrrev_b32 v68, 9, v0
    v_cndmask_b32 v44, 0, v67, vcc
    v_cndmask_b32 v46, 0, v67, s[34:35]
    v_cmp_eq_u32 vcc, 0x80, v66
    v_lshlrev_b32 v68, 10, v68
    buffer_load_dwordx4 v[24:27], v3, s[12:15], s27 offen offset:0 sc1
    buffer_load_dwordx4 v[28:31], v3, s[12:15], s27 offen offset:512 sc1
    buffer_load_dwordx4 v[32:35], v3, s[12:15], s27 offen offset:1024 sc1
    buffer_load_dwordx4 v[36:39], v3, s[12:15], s27 offen offset:1536 sc1
    v_bfe_u32 v69, v0, 8, 1
    v_cndmask_b32 v45, 0, v67, vcc
    v_cmp_eq_u32 vcc, 0x90, v66
    v_lshl_add_u32 v68, v69, 5, v68
    v_bfe_u32 v69, v0, 4, 3
    v_cndmask_b32 v47, 0, v67, vcc
    v_lshl_add_u32 v68, v69, 2, v68
    v_and_b32 v69, 640, v0
    v_cmp_eq_u32 vcc, 0, v69
    v_mov_b32 v69, 0x40000000
    s_nop 0
    v_cndmask_b32 v65, v69, v68, vcc
    v_mov_b32 v70, -1
    v_mov_b32 v64, s23
    s_add_u32 s34, s28, s29
    s_add_u32 s35, s28, s30
    v_mov_b64 v[48:49], 0
    v_mov_b64 v[50:51], 0
    v_mov_b64 v[52:53], 0
    v_mov_b64 v[54:55], 0
    v_mov_b64 v[56:57], 0
    v_mov_b64 v[58:59], 0
    v_mov_b64 v[60:61], 0
    v_mov_b64 v[62:63], 0
    s_waitcnt vmcnt(3)
    v_mfma_f32_16x16x32_bf16 v[40:43], v[44:47], v[24:27], 0
    v_xor_b32 v66, v64, v24
    s_waitcnt vmcnt(2)
    v_mfma_f32_16x16x32_bf16 v[40:43], v[44:47], v[28:31], v[40:43]
    v_bitop3_b32 v66, v66, v64, v28 bitop3:0xf6
    s_waitcnt vmcnt(1)
    v_mfma_f32_16x16x32_bf16 v[40:43], v[44:47], v[32:35], v[40:43]
    v_bitop3_b32 v66, v66, v64, v32 bitop3:0xf6
    s_waitcnt vmcnt(0)
    v_mfma_f32_16x16x32_bf16 v[40:43], v[44:47], v[36:39], v[40:43]
    v_bitop3_b32 v66, v66, v64, v36 bitop3:0xf6
    v_and_b32 v66, 1, v66
    v_cmp_ne_u32 vcc, 0, v66
    s_nop 0
    s_cbranch_vccnz L_redslow_s_w2
    s_nop 2
    v_add_f32_dpp v40, v40, v40 row_ror:8 row_mask:0xf bank_mask:0xf
    v_add_f32_dpp v41, v41, v41 row_ror:8 row_mask:0xf bank_mask:0xf
    v_cvt_pk_bf16_f32 v40, v40, v41
    buffer_store_dword v40, v65, s[12:15], s34 offen sc1
    buffer_store_dword v70, v65, s[12:15], s35 offen sc1
L_redend_s_w2:
    s_branch L_loop_s_w2
L_xs_s_w2:
    s_cmp_lg_u32 s5, 0
    s_cbranch_scc1 L_team_exit
    s_mov_b32 s5, 63
    s_lshl_b32 s35, s21, 7
    s_add_u32 s35, s35, 397312
L_xl_s_w2:
    buffer_load_dword v72, off, s[12:15], s35 sc1
    s_add_u32 s37, s37, 1
    s_cmp_gt_u32 s37, 400000
    s_waitcnt vmcnt(0)
    s_cbranch_scc1 L_xg_s_w2
    v_cmp_gt_u32 vcc, s25, v72
    s_nop 0
    s_cbranch_vccnz L_xl_s_w2
L_xg_s_w2:
    buffer_load_dwordx4 v[64:67], v0, s[16:19], s31 offen offset:0 sc1
    buffer_load_dwordx4 v[68:71], v0, s[16:19], s31 offen offset:1024 sc1
    buffer_load_dwordx4 v[40:43], v0, s[16:19], s31 offen offset:2048 sc1
    buffer_load_dwordx4 v[44:47], v0, s[16:19], s31 offen offset:3072 sc1
    s_waitcnt vmcnt(0)
    s_branch L_xsb_s_w2
L_redo_s_w2:
    v_cmp_u_f32 vcc, v48, v48
    s_nop 0
    s_cbranch_vccz L_xs_s_w2
    s_add_u32 s61, s61, 1
    s_add_u32 s37, s37, 64
    s_cmp_gt_u32 s37, 400000
    s_cbranch_scc0 L_redo2_s_w2
    s_cmp_eq_u32 s22, s5
    s_cbranch_scc1 L_xs_s_w2
    s_branch L_xsb_s_w2
L_redo2_s_w2:
    s_waitcnt vmcnt(0) lgkmcnt(0)
    s_barrier
    s_mov_b32 m0, 8192
    s_add_u32 s34, s29, 8192
    buffer_load_dwordx4 v0, s[12:15], s34 offen offset:0 sc1 lds
    s_mov_b32 m0, 6144
    s_add_u32 s34, s29, 6144
    s_nop 7
    v_mov_b64 v[48:49], 0
    v_mov_b64 v[50:51], 0
    v_mov_b64 v[52:53], 0
    v_mov_b64 v[54:55], 0
    v_mov_b64 v[56:57], 0
    v_mov_b64 v[58:59], 0
    v_mov_b64 v[60:61], 0
    v_mov_b64 v[62:63], 0
    ds_read_b128 v[8:11], v1 offset:0
    ds_read_b128 v[12:15], v1 offset:1024
    ds_read_b128 v[16:19], v1 offset:2048
    ds_read_b128 v[20:23], v1 offset:3072
    s_waitcnt vmcnt(0) lgkmcnt(0)
    s_barrier
    s_branch L_pa_s_w2
L_max_s_w2:
    s_cmp_eq_u32 s4, s23
    s_cbranch_scc1 L_maxskip_s_w2
    s_mov_b32 s4, s23
    s_nop 7
    ds_read_b128 v[60:63], v0 offset:9216
    ds_read_b128 v[72:75], v0 offset:10240
    ds_read_b128 v[76:79], v0 offset:12288
    ds_read_b128 v[64:67], v0 offset:11264
    ds_read_b128 v[68:71], v6 offset:13312
    ds_read_b128 v[56:59], v6 offset:13344
    s_waitcnt lgkmcnt(4)
    v_add_f32 v60, v60, v72
    v_add_f32 v61, v61, v73
    v_add_f32 v62, v62, v74
    v_add_f32 v63, v63, v75
    s_waitcnt lgkmcnt(2)
    v_add_f32 v64, v64, v76
    v_add_f32 v65, v65, v77
    v_add_f32 v66, v66, v78
    v_add_f32 v67, v67, v79
    v_add_f32 v60, v60, v64
    v_add_f32 v61, v61, v65
    v_add_f32 v62, v62, v66
    v_add_f32 v63, v63, v67
    s_waitcnt lgkmcnt(0)
    v_add_f32 v68, v68, v56
    v_add_f32 v69, v69, v57
    v_add_f32 v70, v70, v58
    v_add_f32 v71, v71, v59
    v_add_f32 v68, v68, v70
    v_add_f32 v69, v69, v71
    v_pk_mul_f32 v[68:69], v[68:69], s[32:33] op_sel_hi:[1,0]
    v_max3_f32 v72, v60, v61, v62
    v_max3_f32 v73, v63, v68, v69
    v_max_f32 v72, v72, v73
    s_nop 1
    v_max_f32_dpp v72, v72, v72 quad_perm:[2,3,0,1] row_mask:0xf bank_mask:0xf
    v_mov_b32 v73, v72
    s_nop 1
    v_permlane16_swap_b32 v72, v73
    v_max_f32 v72, v72, v73
    v_mov_b32 v73, v72
    s_nop 1
    v_permlane32_swap_b32 v72, v73
    v_max_f32 v72, v72, v73
    v_sub_f32 v60, v60, v72
    v_sub_f32 v61, v61, v72
    v_sub_f32 v62, v62, v72
    v_sub_f32 v63, v63, v72
    v_sub_f32 v68, v68, v72
    v_sub_f32 v69, v69, v72
    v_exp_f32 v60, v60
    v_exp_f32 v61, v61
    v_exp_f32 v62, v62
    v_exp_f32 v63, v63
    v_exp_f32 v68, v68
    v_exp_f32 v69, v69
    s_add_u32 s62, s62, 1
    s_waitcnt lgkmcnt(0)
    s_branch L_maxback_s_w2
L_nored_s_w2:
    v_mov_b64 v[48:49], 0
    v_mov_b64 v[50:51], 0
    v_mov_b64 v[52:53], 0
    v_mov_b64 v[54:55], 0
    v_mov_b64 v[56:57], 0
    v_mov_b64 v[58:59], 0
    v_mov_b64 v[60:61], 0
    v_mov_b64 v[62:63], 0
    s_branch L_redend_s_w2
L_redslow_s_w2:
    buffer_store_byte v70, v0, s[40:43], 0 offen sc1
L_redslow2_s_w2:
    buffer_load_dwordx4 v[24:27], v3, s[12:15], s27 offen offset:0 sc1
    buffer_load_dwordx4 v[28:31], v3, s[12:15], s27 offen offset:512 sc1
    buffer_load_dwordx4 v[32:35], v3, s[12:15], s27 offen offset:1024 sc1
    buffer_load_dwordx4 v[36:39], v3, s[12:15], s27 offen offset:1536 sc1
    s_add_u32 s60, s60, 1
    s_add_u32 s37, s37, 1
    s_cmp_gt_u32 s37, 400000
    s_cbranch_scc1 L_redgo_s_w2
    s_waitcnt vmcnt(3)
    v_mfma_f32_16x16x32_bf16 v[40:43], v[44:47], v[24:27], 0
    v_xor_b32 v66, v64, v24
    s_waitcnt vmcnt(2)
    v_mfma_f32_16x16x32_bf16 v[40:43], v[44:47], v[28:31], v[40:43]
    v_bitop3_b32 v66, v66, v64, v28 bitop3:0xf6
    s_waitcnt vmcnt(1)
    v_mfma_f32_16x16x32_bf16 v[40:43], v[44:47], v[32:35], v[40:43]
    v_bitop3_b32 v66, v66, v64, v32 bitop3:0xf6
    s_waitcnt vmcnt(0)
    v_mfma_f32_16x16x32_bf16 v[40:43], v[44:47], v[36:39], v[40:43]
    v_bitop3_b32 v66, v66, v64, v36 bitop3:0xf6
    v_and_b32 v66, 1, v66
    v_cmp_ne_u32 vcc, 0, v66
    s_nop 0
    s_cbranch_vccnz L_redslow2_s_w2
L_redgo_s_w2:
    s_waitcnt vmcnt(0)
    v_mov_b32 v71, 0
    s_nop 0
    v_add_f32_dpp v40, v40, v40 row_ror:8 row_mask:0xf bank_mask:0xf
    v_add_f32_dpp v41, v41, v41 row_ror:8 row_mask:0xf bank_mask:0xf
    v_cvt_pk_bf16_f32 v40, v40, v41
    buffer_store_dword v40, v65, s[12:15], s34 offen sc1
    buffer_store_dword v70, v65, s[12:15], s35 offen sc1
    buffer_store_byte v71, v0, s[40:43], 0 offen sc1
    s_branch L_redend_s_w2
.p2align 6
L_loop_s_w3:
    s_add_u32 s31, s31, 524288
    v_mov_b64 v[48:49], 0
    v_mov_b64 v[50:51], 0
    v_mov_b64 v[52:53], 0
    v_mov_b64 v[54:55], 0
    v_mov_b64 v[56:57], 0
    v_mov_b64 v[58:59], 0
    v_mov_b64 v[60:61], 0
    v_mov_b64 v[62:63], 0
    v_lshrrev_b32 v74, 2, v0
    v_and_b32 v39, 127, v74
    v_min_u32 v74, 92, v74
    v_mov_b64 v[28:29], -1
    v_mov_b64 v[30:31], -1
    v_mov_b64 v[32:33], -1
    s_waitcnt vmcnt(0)
L_pl_s_w3:
    s_waitcnt vmcnt(5)
    v_cmp_gt_i32 vcc, s23, v28
    buffer_load_dword v28, v39, s[12:15], s11 offen sc1
    s_cbranch_vccz L_pl_s_w3_o
    s_waitcnt vmcnt(5)
    v_cmp_gt_i32 vcc, s23, v29
    buffer_load_dword v29, v39, s[12:15], s11 offen sc1
    s_cbranch_vccz L_pl_s_w3_o
    s_waitcnt vmcnt(5)
    v_cmp_gt_i32 vcc, s23, v30
    buffer_load_dword v30, v39, s[12:15], s11 offen sc1
    s_cbranch_vccz L_pl_s_w3_o
    s_waitcnt vmcnt(5)
    v_cmp_gt_i32 vcc, s23, v31
    buffer_load_dword v31, v39, s[12:15], s11 offen sc1
    s_cbranch_vccz L_pl_s_w3_o
    s_waitcnt vmcnt(5)
    v_cmp_gt_i32 vcc, s23, v32
    buffer_load_dword v32, v39, s[12:15], s11 offen sc1
    s_cbranch_vccz L_pl_s_w3_o
    s_waitcnt vmcnt(5)
    v_cmp_gt_i32 vcc, s23, v33
    buffer_load_dword v33, v39, s[12:15], s11 offen sc1
    s_cbranch_vccz L_pl_s_w3_o
    s_add_u32 s60, s60, 1
    s_add_u32 s37, s37, 1
    s_cmp_lt_u32 s37, 400000
    s_cbranch_scc1 L_pl_s_w3
.p2align 3
L_pl_s_w3_o:
    buffer_load_dword v72, v74, s[12:15], s11 offen offset:256 sc1
    s_mov_b32 m0, 0
    s_add_u32 s34, s29, 0
    buffer_load_dwordx4 v0, s[12:15], s34 offen offset:0 sc1 lds
    buffer_load_dwordx4 v0, s[12:15], s34 offen offset:1024 sc1 lds
    buffer_load_dwordx4 v0, s[12:15], s34 offen offset:2048 sc1 lds
    buffer_load_dwordx4 v0, s[12:15], s34 offen offset:3072 sc1 lds
    s_mov_b32 m0, 8192
    s_add_u32 s34, s29, 8192
    buffer_load_dwordx4 v0, s[12:15], s34 offen offset:0 sc1 lds
    s_waitcnt vmcnt(5)
    v_cmp_ne_u32 vcc, 0, v72
    s_nop 0
    s_cbranch_vccnz L_pr0_s_w3_slow
L_pr0_s_w3_ok:
    s_mov_b32 m0, 7168
    s_add_u32 s34, s29, 7168
    s_waitcnt vmcnt(3)
    s_waitcnt lgkmcnt(0)
    s_barrier
L_pa_s_w3:
    ds_read_b128 v[24:27], v0 offset:0
    ds_read_b128 v[28:31], v0 offset:1024
    buffer_load_dwordx4 v0, s[12:15], s34 offen sc1 lds
    s_waitcnt lgkmcnt(1)
    v_smfmac_f32_16x16x64_bf16 v[48:51], v[24:27], v[8:15], v2
    ds_read_b128 v[8:11], v1 offset:4096
    v_smfmac_f32_16x16x64_bf16 v[52:55], v[24:27], v[16:23], v2
    ds_read_b128 v[12:15], v1 offset:5120
    v_smfmac_f32_16x16x64_bf16 v[56:59], v[24:27], a[0:7], v2
    ds_read_b128 v[16:19], v1 offset:6144
    v_smfmac_f32_16x16x64_bf16 v[60:63], v[24:27], a[8:15], v2
    ds_read_b128 v[20:23], v1 offset:7168
    s_waitcnt vmcnt(1)
    s_barrier
    s_waitcnt lgkmcnt(4)
    v_smfmac_f32_16x16x64_bf16 v[48:51], v[28:31], a[16:23], v2
    ds_read_b128 v[32:35], v0 offset:2048
    buffer_load_dwordx4 v[64:67], v0, s[16:19], s31 offen offset:0 sc1
    v_smfmac_f32_16x16x64_bf16 v[52:55], v[28:31], a[24:31], v2
    v_smfmac_f32_16x16x64_bf16 v[56:59], v[28:31], a[32:39], v2
    ds_read_b128 v[36:39], v0 offset:3072
    v_smfmac_f32_16x16x64_bf16 v[60:63], v[28:31], a[40:47], v2
    ds_read_b128 v[24:27], v0 offset:8192
    s_waitcnt lgkmcnt(2)
    v_smfmac_f32_16x16x64_bf16 v[48:51], v[32:35], v[8:15], v2
    ds_read_b128 v[8:11], v1 offset:8192
    buffer_load_dwordx4 v[68:71], v0, s[16:19], s31 offen offset:1024 sc1
    v_smfmac_f32_16x16x64_bf16 v[52:55], v[32:35], v[16:23], v2
    ds_read_b128 v[12:15], v1 offset:9216
    v_smfmac_f32_16x16x64_bf16 v[56:59], v[32:35], a[48:55], v2
    ds_read_b128 v[16:19], v1 offset:10240
    v_smfmac_f32_16x16x64_bf16 v[60:63], v[32:35], a[56:63], v2
    ds_read_b128 v[20:23], v1 offset:11264
    s_waitcnt lgkmcnt(5)
    v_smfmac_f32_16x16x64_bf16 v[48:51], v[36:39], a[64:71], v2
    buffer_load_dwordx4 v[40:43], v0, s[16:19], s31 offen offset:2048 sc1
    v_smfmac_f32_16x16x64_bf16 v[52:55], v[36:39], a[72:79], v2
    s_waitcnt lgkmcnt(2)
    v_smfmac_f32_16x16x64_bf16 v[56:59], v[36:39], v[8:15], v2
    ds_read_b128 v[8:11], v1 offset:12288
    s_waitcnt lgkmcnt(1)
    v_smfmac_f32_16x16x64_bf16 v[60:63], v[36:39], v[16:23], v2
    ds_read_b128 v[12:15], v1 offset:13312
    s_waitcnt vmcnt(3)
    s_barrier
    v_smfmac_f32_16x16x64_bf16 v[48:51], v[24:27], a[80:87], v2
    ds_read_b128 v[28:31], v0 offset:4096
    buffer_load_dwordx4 v[44:47], v0, s[16:19], s31 offen offset:3072 sc1
    v_smfmac_f32_16x16x64_bf16 v[52:55], v[24:27], a[88:95], v2
    ds_read_b128 v[16:19], v1 offset:14336
    v_smfmac_f32_16x16x64_bf16 v[56:59], v[24:27], a[96:103], v2
    ds_read_b128 v[32:35], v0 offset:5120
    v_smfmac_f32_16x16x64_bf16 v[60:63], v[24:27], a[104:111], v2
    ds_read_b128 v[20:23], v1 offset:15360
    s_waitcnt lgkmcnt(3)
    v_smfmac_f32_16x16x64_bf16 v[48:51], v[28:31], a[112:119], v2
    ds_read_b128 v[36:39], v0 offset:6144
    v_smfmac_f32_16x16x64_bf16 v[52:55], v[28:31], a[120:127], v2
    s_waitcnt lgkmcnt(2)
    v_smfmac_f32_16x16x64_bf16 v[48:51], v[32:35], a[128:135], v2
    ds_read_b128 v[24:27], v0 offset:7168
    v_smfmac_f32_16x16x64_bf16 v[52:55], v[32:35], a[136:143], v2
    s_waitcnt lgkmcnt(1)
    v_smfmac_f32_16x16x64_bf16 v[48:51], v[36:39], v[8:15], v2
    ds_read_b128 v[8:11], v1 offset:16384
    v_smfmac_f32_16x16x64_bf16 v[52:55], v[36:39], v[16:23], v2
    ds_read_b128 v[12:15], v1 offset:17408
    s_waitcnt lgkmcnt(2)
    v_smfmac_f32_16x16x64_bf16 v[48:51], v[24:27], a[144:151], v2
    ds_read_b128 v[16:19], v1 offset:18432
    v_smfmac_f32_16x16x64_bf16 v[52:55], v[24:27], a[152:159], v2
    ds_read_b128 v[20:23], v1 offset:19456
    v_smfmac_f32_16x16x64_bf16 v[56:59], v[28:31], a[160:167], v2
    v_cvt_pk_bf16_f32 v72, v48, v49
    v_smfmac_f32_16x16x64_bf16 v[60:63], v[28:31], a[168:175], v2
    v_cvt_pk_bf16_f32 v73, v50, v51
    v_smfmac_f32_16x16x64_bf16 v[56:59], v[32:35], a[176:183], v2
    v_cvt_pk_bf16_f32 v74, v52, v53
    v_mfma_f32_16x16x16_bf16 v[48:51], v[72:73], v[4:5], 0
    s_waitcnt lgkmcnt(0)
    v_cvt_pk_bf16_f32 v75, v54, v55
    v_smfmac_f32_16x16x64_bf16 v[60:63], v[32:35], a[184:191], v2
    s_cmp_eq_u32 s22, s5
    s_cselect_b64 s[6:7], -1, 0
    v_mfma_f32_16x16x16_bf16 v[52:55], v[74:75], v[4:5], 0
    s_waitcnt vmcnt(2)
    v_cvt_pk_bf16_f32 v76, v48, v49
    v_cvt_pk_bf16_f32 v77, v50, v51
    v_smfmac_f32_16x16x64_bf16 v[56:59], v[36:39], v[8:15], v2
    ds_read_b128 v[8:11], v1 offset:20480
    v_cmp_u_f32 vcc, v48, v48
    v_smfmac_f32_16x16x64_bf16 v[60:63], v[36:39], v[16:23], v2
    ds_read_b128 v[12:15], v1 offset:21504
    v_cvt_pk_bf16_f32 v78, v52, v53
    v_smfmac_f32_16x16x64_bf16 v[56:59], v[24:27], a[192:199], v2
    ds_read_b128 v[16:19], v1 offset:22528
    s_or_b64 vcc, vcc, s[6:7]
    v_cvt_pk_bf16_f32 v79, v54, v55
    v_smfmac_f32_16x16x64_bf16 v[60:63], v[24:27], a[200:207], v2
    ds_read_b128 v[20:23], v1 offset:23552
    s_cbranch_scc1 L_redo_s_w3
L_xsb_s_w3:
    v_mov_b64 v[48:49], 0
    v_mfma_f32_16x16x32_bf16 v[64:67], v[64:67], v[76:79], 0
    v_cvt_pk_bf16_f32 v72, v56, v57
    v_cvt_pk_bf16_f32 v73, v58, v59
    v_mfma_f32_16x16x32_bf16 v[68:71], v[68:71], v[76:79], 0
    v_cvt_pk_bf16_f32 v74, v60, v61
    v_cvt_pk_bf16_f32 v75, v62, v63
    v_mfma_f32_16x16x16_bf16 v[56:59], v[72:73], v[4:5], 0
    s_mov_b32 s30, s29
    v_mov_b64 v[50:51], 0
    v_mov_b64 v[52:53], 0
    v_mfma_f32_16x16x16_bf16 v[60:63], v[74:75], v[4:5], 0
    s_add_u32 s29, s29, 9216
    v_mov_b64 v[54:55], 0
    v_cndmask_b32 v64, v64, v68, s[58:59]
    v_smfmac_f32_16x16x64_bf16 v[48:51], v[28:31], a[208:215], v2
    s_add_u32 s22, s22, 1
    s_add_u32 s23, s23, 1
    v_cvt_pk_bf16_f32 v72, v56, v57
    v_cvt_pk_bf16_f32 v73, v58, v59
    v_cvt_pk_bf16_f32 v74, v60, v61
    v_cvt_pk_bf16_f32 v75, v62, v63
    v_smfmac_f32_16x16x64_bf16 v[52:55], v[28:31], a[216:223], v2
    ds_read_b128 v[28:31], v0 offset:0
    s_add_u32 s25, s25, 1
    v_cndmask_b32 v65, v65, v69, s[58:59]
    v_mfma_f32_16x16x32_bf16 v[56:59], v[72:75], v[76:79], 0
    s_cmp_eq_u32 s29, 355328
    v_cndmask_b32 v66, v66, v70, s[58:59]
    v_cndmask_b32 v67, v67, v71, s[58:59]
    v_smfmac_f32_16x16x64_bf16 v[48:51], v[32:35], a[224:231], v2
    s_cselect_b32 s29, 327680, s29
    v_smfmac_f32_16x16x64_bf16 v[52:55], v[32:35], a[232:239], v2
    ds_write_b128 v0, v[64:67] offset:12288
    v_smfmac_f32_16x16x64_bf16 v[48:51], v[36:39], a[240:247], v2
    ds_read_b128 v[32:35], v0 offset:1024
    v_smfmac_f32_16x16x64_bf16 v[52:55], v[36:39], a[248:255], v2
    ds_write_b64 v6, v[56:57] offset:13352
    v_smfmac_f32_16x16x64_bf16 v[48:51], v[24:27], v[80:87], v2
    ds_read_b128 v[36:39], v0 offset:2048
    v_smfmac_f32_16x16x64_bf16 v[52:55], v[24:27], v[88:95], v2
    ds_read_b128 v[24:27], v0 offset:3072
    s_waitcnt lgkmcnt(5)
    v_smfmac_f32_16x16x64_bf16 v[48:51], v[28:31], v[96:103], v2
    s_waitcnt lgkmcnt(2)
    s_barrier
    ds_read_b128 v[60:63], v0 offset:9216
    v_smfmac_f32_16x16x64_bf16 v[52:55], v[28:31], v[104:111], v2
    ds_read_b128 v[72:75], v0 offset:10240
    v_smfmac_f32_16x16x64_bf16 v[48:51], v[32:35], v[112:119], v2
    ds_read_b128 v[76:79], v0 offset:11264
    v_smfmac_f32_16x16x64_bf16 v[52:55], v[32:35], v[120:127], v2
    ds_read_b128 v[28:31], v0 offset:8192
    s_waitcnt lgkmcnt(5)
    v_smfmac_f32_16x16x64_bf16 v[48:51], v[36:39], v[128:135], v2
    ds_read_b128 v[68:71], v6 offset:13312
    v_mov_b64 v[32:33], s[2:3]
    v_smfmac_f32_16x16x64_bf16 v[52:55], v[36:39], v[136:143], v2
    ds_read_b128 v[56:59], v6 offset:13344
    v_mov_b64 v[34:35], s[2:3]
    s_waitcnt lgkmcnt(6)
    v_smfmac_f32_16x16x64_bf16 v[48:51], v[24:27], v[144:151], v2
    v_mov_b64 v[36:37], s[0:1]
    v_smfmac_f32_16x16x64_bf16 v[52:55], v[24:27], v[152:159], v2
    s_waitcnt lgkmcnt(4)
    v_add_f32 v60, v60, v72
    s_waitcnt lgkmcnt(2)
    v_smfmac_f32_16x16x64_bf16 v[48:51], v[28:31], v[8:15], v2
    ds_read_b128 v[8:11], v1 offset:24576
    v_add_f32 v61, v61, v73
    v_smfmac_f32_16x16x64_bf16 v[52:55], v[28:31], v[16:23], v2
    ds_read_b128 v[12:15], v1 offset:25600
    v_add_f32 v62, v62, v74
    v_add_f32 v63, v63, v75
    v_pk_add_f32 v[76:77], v[76:77], v[64:65]
    v_pk_add_f32 v[78:79], v[78:79], v[66:67]
    v_pk_add_f32 v[60:61], v[60:61], v[76:77]
    v_pk_add_f32 v[62:63], v[62:63], v[78:79]
    s_waitcnt lgkmcnt(2)
    v_pk_add_f32 v[68:69], v[68:69], v[56:57]
    v_pk_add_f32 v[70:71], v[70:71], v[58:59]
    v_pk_add_f32 v[68:69], v[68:69], v[70:71]
    v_pk_mul_f32 v[68:69], v[68:69], s[32:33] op_sel_hi:[1,0]
    v_exp_f32 v60, v60
    v_exp_f32 v61, v61
    v_exp_f32 v62, v62
    v_exp_f32 v63, v63
    v_exp_f32 v68, v68
    v_exp_f32 v69, v69
L_maxback_s_w3:
    v_cvt_pk_bf16_f32 v72, v60, v61
    v_cvt_pk_bf16_f32 v73, v62, v63
    v_cvt_pk_bf16_f32 v76, v68, v68
    v_mov_b32_dpp v74, v72 quad_perm:[2,3,0,1] row_mask:0xf bank_mask:0xf
    v_mov_b32_dpp v75, v73 quad_perm:[2,3,0,1] row_mask:0xf bank_mask:0xf
    v_cvt_pk_bf16_f32 v77, v69, v69
    v_cvt_pk_bf16_f32 v24, v48, v49
    v_mfma_f32_16x16x32_bf16 v[28:31], v[32:35], v[72:75], 0
    s_waitcnt vmcnt(0)
    v_cvt_pk_bf16_f32 v25, v50, v51
    v_cvt_pk_bf16_f32 v26, v52, v53
    v_mfma_f32_16x16x32_bf16 v[56:59], v[40:43], v[72:75], 0
    ds_read_b128 v[16:19], v1 offset:26624
    v_cvt_pk_bf16_f32 v27, v54, v55
    v_mfma_f32_16x16x16_bf16 v[28:31], v[36:37], v[76:77], v[28:31]
    ds_read_b128 v[20:23], v1 offset:27648
    v_mfma_f32_16x16x32_bf16 v[68:71], v[44:47], v[72:75], 0
    v_mfma_f32_16x16x16_bf16 v[56:59], v[24:25], v[76:77], v[56:59]
    v_rcp_f32 v30, v28
    v_mfma_f32_16x16x16_bf16 v[68:71], v[26:27], v[76:77], v[68:71]
    v_max_f32 v28, v28, v30
    v_cmp_ngt_f32 vcc, s38, v28
    v_mov_b64 v[38:39], 0
    v_mov_b32 v78, s23
    v_pk_mul_f32 v[56:57], v[56:57], v[30:31] op_sel_hi:[1,0]
    v_pk_mul_f32 v[58:59], v[58:59], v[30:31] op_sel_hi:[1,0]
    v_cvt_pk_bf16_f32 v64, v56, v57
    v_cvt_pk_bf16_f32 v65, v58, v59
    v_pk_mul_f32 v[68:69], v[68:69], v[30:31] op_sel_hi:[1,0]
    v_pk_mul_f32 v[70:71], v[70:71], v[30:31] op_sel_hi:[1,0]
    s_cbranch_vccnz L_max_s_w3
L_maxskip_s_w3:
    v_cvt_pk_bf16_f32 v66, v68, v69
    v_cvt_pk_bf16_f32 v67, v70, v71
    v_mfma_f32_16x16x16_bf16 v[48:51], v[38:39], v[38:39], 0
    ds_write_b128 v7, v[64:67]
    v_mov_b64 v[34:35], 0
    v_mov_b64 v[36:37], 0
    v_mov_b64 v[40:41], 0
    v_mov_b64 v[42:43], 0
    v_mov_b64 v[44:45], 0
    v_mov_b64 v[46:47], 0
    v_mov_b64 v[56:57], 0
    v_mov_b64 v[58:59], 0
    v_mov_b64 v[24:25], 0
    v_mov_b64 v[26:27], 0
    v_mov_b64 v[28:29], 0
    v_mov_b64 v[30:31], 0
    v_mfma_f32_16x16x16_bf16 v[52:55], v[38:39], v[38:39], 0
    s_waitcnt lgkmcnt(0)
    s_barrier
    ds_read_b128 v[64:67], v0 offset:14336
    v_mov_b32 v32, 0
    ds_read_b128 v[68:71], v0 offset:15360
    v_mov_b32 v33, 0
    v_lshrrev_b32 v79, 2, v0
    v_and_b32 v79, 127, v79
    v_cndmask_b32 v62, 0, 1, s[56:57]
    v_lshrrev_b32 v63, 1, v0
    s_waitcnt lgkmcnt(1)
    v_smfmac_f32_16x16x64_bf16 v[24:27], v[64:67], v[8:15], v2
    ds_read_b128 v[8:11], v1 offset:28672
    s_waitcnt lgkmcnt(1)
    v_smfmac_f32_16x16x64_bf16 v[24:27], v[68:71], v[16:23], v2
    ds_read_b128 v[12:15], v1 offset:29696
    v_smfmac_f32_16x16x64_bf16 v[28:31], v[64:67], v[160:167], v2
    ds_read_b128 v[16:19], v1 offset:30720
    v_smfmac_f32_16x16x64_bf16 v[28:31], v[68:71], v[168:175], v2
    ds_read_b128 v[20:23], v1 offset:31744
    v_add_f32 v24, v24, v25
    v_add_f32 v26, v26, v27
    v_smfmac_f32_16x16x64_bf16 v[32:35], v[64:67], v[176:183], v2
    v_cvt_pk_bf16_f32 v24, v24, v26
    v_bfi_b32 v72, v62, s23, v24
    v_smfmac_f32_16x16x64_bf16 v[32:35], v[68:71], v[184:191], v2
    v_add_f32 v28, v28, v29
    v_add_f32 v30, v30, v31
    v_smfmac_f32_16x16x64_bf16 v[36:39], v[64:67], v[192:199], v2
    v_cvt_pk_bf16_f32 v73, v28, v30
    v_smfmac_f32_16x16x64_bf16 v[36:39], v[68:71], v[200:207], v2
    buffer_load_dword v24, v79, s[12:15], s11 offen offset:128 sc1
    v_add_f32 v32, v32, v33
    v_add_f32 v34, v34, v35
    s_waitcnt lgkmcnt(2)
    v_smfmac_f32_16x16x64_bf16 v[40:43], v[64:67], v[8:15], v2
    ds_read_b128 v[8:11], v1 offset:32768
    buffer_store_dwordx2 v[72:73], v63, s[12:15], s24 offen sc1
    s_add_u32 s26, s24, 65536
    v_cvt_pk_bf16_f32 v32, v32, v34
    v_bfi_b32 v74, v62, s23, v32
    s_waitcnt lgkmcnt(1)
    v_smfmac_f32_16x16x64_bf16 v[40:43], v[68:71], v[16:23], v2
    ds_read_b128 v[12:15], v1 offset:33792
    v_add_f32 v36, v36, v37
    v_add_f32 v38, v38, v39
    v_smfmac_f32_16x16x64_bf16 v[44:47], v[64:67], v[208:215], v2
    ds_read_b128 v[16:19], v1 offset:34816
    buffer_load_dword v25, v79, s[12:15], s11 offen offset:128 sc1
    v_cvt_pk_bf16_f32 v75, v36, v38
    v_smfmac_f32_16x16x64_bf16 v[44:47], v[68:71], v[216:223], v2
    ds_read_b128 v[20:23], v1 offset:35840
    v_add_f32 v40, v40, v41
    v_add_f32 v42, v42, v43
    v_smfmac_f32_16x16x64_bf16 v[48:51], v[64:67], v[224:231], v2
    buffer_store_dwordx2 v[74:75], v63, s[12:15], s26 offen sc1
    s_add_u32 s26, s24, 262144
    v_cvt_pk_bf16_f32 v40, v40, v42
    v_bfi_b32 v72, v62, s23, v40
    v_smfmac_f32_16x16x64_bf16 v[48:51], v[68:71], v[232:239], v2
    v_add_f32 v44, v44, v45
    v_add_f32 v46, v46, v47
    v_smfmac_f32_16x16x64_bf16 v[52:55], v[64:67], v[240:247], v2
    buffer_load_dword v26, v79, s[12:15], s11 offen offset:128 sc1
    buffer_store_dwordx2 v[72:73], v63, s[12:15], s26 offen sc1
    s_add_u32 s26, s24, 131072
    v_cvt_pk_bf16_f32 v44, v44, v46
    v_bfi_b32 v76, v62, s23, v44
    v_smfmac_f32_16x16x64_bf16 v[52:55], v[68:71], v[248:255], v2
    v_add_f32 v48, v48, v49
    v_add_f32 v50, v50, v51
    s_waitcnt lgkmcnt(2)
    v_smfmac_f32_16x16x64_bf16 v[56:59], v[64:67], v[8:15], v2
    ds_read_b128 v[8:11], v1 offset:0
    v_cvt_pk_bf16_f32 v77, v48, v50
    s_waitcnt lgkmcnt(1)
    v_smfmac_f32_16x16x64_bf16 v[56:59], v[68:71], v[16:23], v2
    ds_read_b128 v[12:15], v1 offset:1024
    buffer_store_dwordx2 v[76:77], v63, s[12:15], s26 offen sc1
    s_add_u32 s26, s24, 196608
    v_add_f32 v52, v52, v53
    v_add_f32 v54, v54, v55
    v_cvt_pk_bf16_f32 v52, v52, v54
    v_bfi_b32 v78, v62, s23, v52
    s_waitcnt vmcnt(6)
    v_cmp_gt_u32 vcc, s23, v24
    v_add_f32 v56, v56, v57
    v_add_f32 v58, v58, v59
    v_cvt_pk_bf16_f32 v79, v56, v58
    buffer_store_dwordx2 v[78:79], v63, s[12:15], s26 offen sc1
    s_cbranch_vccnz L_gb_s_w3
L_gbok_s_w3:
    s_barrier
    ds_read_b128 v[16:19], v1 offset:2048
    ds_read_b128 v[20:23], v1 offset:3072
    s_branch L_loop_s_w3
L_pr0_s_w3_slow:
    buffer_load_dword v72, v74, s[12:15], s11 offen offset:256 sc1
    s_mov_b32 m0, 0
    s_add_u32 s34, s29, 0
    buffer_load_dwordx4 v0, s[12:15], s34 offen offset:0 sc1 lds
    buffer_load_dwordx4 v0, s[12:15], s34 offen offset:1024 sc1 lds
    buffer_load_dwordx4 v0, s[12:15], s34 offen offset:2048 sc1 lds
    buffer_load_dwordx4 v0, s[12:15], s34 offen offset:3072 sc1 lds
    s_mov_b32 m0, 8192
    s_add_u32 s34, s29, 8192
    buffer_load_dwordx4 v0, s[12:15], s34 offen offset:0 sc1 lds
    s_add_u32 s63, s63, 1
    s_add_u32 s37, s37, 1
    s_cmp_gt_u32 s37, 400000
    s_cbranch_scc1 L_pr0_s_w3_ok
    s_waitcnt vmcnt(5)
    v_cmp_ne_u32 vcc, 0, v72
    s_nop 0
    s_cbranch_vccnz L_pr0_s_w3_slow
    s_branch L_pr0_s_w3_ok
L_xs_s_w3:
    s_cmp_lg_u32 s5, 0
    s_cbranch_scc1 L_team_exit
    s_mov_b32 s5, 63
    s_lshl_b32 s35, s21, 7
    s_add_u32 s35, s35, 397312
L_xl_s_w3:
    buffer_load_dword v72, off, s[12:15], s35 sc1
    s_add_u32 s37, s37, 1
    s_cmp_gt_u32 s37, 400000
    s_waitcnt vmcnt(0)
    s_cbranch_scc1 L_xg_s_w3
    v_cmp_gt_u32 vcc, s25, v72
    s_nop 0
    s_cbranch_vccnz L_xl_s_w3
L_xg_s_w3:
    buffer_load_dwordx4 v[64:67], v0, s[16:19], s31 offen offset:0 sc1
    buffer_load_dwordx4 v[68:71], v0, s[16:19], s31 offen offset:1024 sc1
    buffer_load_dwordx4 v[40:43], v0, s[16:19], s31 offen offset:2048 sc1
    buffer_load_dwordx4 v[44:47], v0, s[16:19], s31 offen offset:3072 sc1
    s_waitcnt vmcnt(0)
    s_branch L_xsb_s_w3
L_redo_s_w3:
    v_cmp_u_f32 vcc, v48, v48
    s_nop 0
    s_cbranch_vccz L_xs_s_w3
    s_add_u32 s61, s61, 1
    s_add_u32 s37, s37, 64
    s_cmp_gt_u32 s37, 400000
    s_cbranch_scc0 L_redo2_s_w3
    s_cmp_eq_u32 s22, s5
    s_cbranch_scc1 L_xs_s_w3
    s_branch L_xsb_s_w3
L_redo2_s_w3:
    s_waitcnt vmcnt(0) lgkmcnt(0)
    s_barrier
    v_mov_b32 v75, 4096
    s_mov_b32 m0, 7168
    s_add_u32 s34, s29, 7168
    s_nop 7
    v_mov_b64 v[48:49], 0
    v_mov_b64 v[50:51], 0
    v_mov_b64 v[52:53], 0
    v_mov_b64 v[54:55], 0
    v_mov_b64 v[56:57], 0
    v_mov_b64 v[58:59], 0
    v_mov_b64 v[60:61], 0
    v_mov_b64 v[62:63], 0
    ds_read_b128 v[8:11], v1 offset:0
    ds_read_b128 v[12:15], v1 offset:1024
    ds_read_b128 v[16:19], v1 offset:2048
    ds_read_b128 v[20:23], v1 offset:3072
    s_waitcnt vmcnt(0) lgkmcnt(0)
    s_barrier
    s_branch L_pa_s_w3
L_max_s_w3:
    s_cmp_eq_u32 s4, s23
    s_cbranch_scc1 L_maxskip_s_w3
    s_mov_b32 s4, s23
    s_nop 7
    ds_read_b128 v[60:63], v0 offset:9216
    ds_read_b128 v[72:75], v0 offset:10240
    ds_read_b128 v[76:79], v0 offset:11264
    ds_read_b128 v[64:67], v0 offset:12288
    ds_read_b128 v[68:71], v6 offset:13312
    ds_read_b128 v[56:59], v6 offset:13344
    s_waitcnt lgkmcnt(4)
    v_add_f32 v60, v60, v72
    v_add_f32 v61, v61, v73
    v_add_f32 v62, v62, v74
    v_add_f32 v63, v63, v75
    s_waitcnt lgkmcnt(2)
    v_add_f32 v76, v76, v64
    v_add_f32 v77, v77, v65
    v_add_f32 v78, v78, v66
    v_add_f32 v79, v79, v67
    v_add_f32 v60, v60, v76
    v_add_f32 v61, v61, v77
    v_add_f32 v62, v62, v78
    v_add_f32 v63, v63, v79
    s_waitcnt lgkmcnt(0)
    v_add_f32 v68, v68, v56
    v_add_f32 v69, v69, v57
    v_add_f32 v70, v70, v58
    v_add_f32 v71, v71, v59
    v_add_f32 v68, v68, v70
    v_add_f32 v69, v69, v71
    v_pk_mul_f32 v[68:69], v[68:69], s[32:33] op_sel_hi:[1,0]
    v_max3_f32 v72, v60, v61, v62
    v_max3_f32 v73, v63, v68, v69
    v_max_f32 v72, v72, v73
    s_nop 1
    v_max_f32_dpp v72, v72, v72 quad_perm:[2,3,0,1] row_mask:0xf bank_mask:0xf
    v_mov_b32 v73, v72
    s_nop 1
    v_permlane16_swap_b32 v72, v73
    v_max_f32 v72, v72, v73
    v_mov_b32 v73, v72
    s_nop 1
    v_permlane32_swap_b32 v72, v73
    v_max_f32 v72, v72, v73
    v_sub_f32 v60, v60, v72
    v_sub_f32 v61, v61, v72
    v_sub_f32 v62, v62, v72
    v_sub_f32 v63, v63, v72
    v_sub_f32 v68, v68, v72
    v_sub_f32 v69, v69, v72
    v_exp_f32 v60, v60
    v_exp_f32 v61, v61
    v_exp_f32 v62, v62
    v_exp_f32 v63, v63
    v_exp_f32 v68, v68
    v_exp_f32 v69, v69
    s_add_u32 s62, s62, 1
    s_waitcnt lgkmcnt(0)
    s_branch L_maxback_s_w3
L_gb_s_w3:
    v_lshrrev_b32 v64, 2, v0
    v_and_b32 v64, 127, v64
    buffer_load_dword v24, v64, s[12:15], s11 offen offset:128 sc1
    s_add_u32 s62, s62, 65536
    s_waitcnt vmcnt(6)
    v_cmp_gt_u32 vcc, s23, v25
    buffer_load_dword v25, v64, s[12:15], s11 offen offset:128 sc1
    s_nop 0
    s_cbranch_vccz L_gbok_s_w3
    s_add_u32 s62, s62, 65536
    s_waitcnt vmcnt(5)
    v_cmp_gt_u32 vcc, s23, v26
    buffer_load_dword v26, v64, s[12:15], s11 offen offset:128 sc1
    s_nop 0
    s_cbranch_vccz L_gbok_s_w3
L_gbl_s_w3:
    s_add_u32 s62, s62, 65536
    s_waitcnt vmcnt(2)
    v_cmp_gt_u32 vcc, s23, v24
    buffer_load_dword v24, v64, s[12:15], s11 offen offset:128 sc1
    s_nop 0
    s_cbranch_vccz L_gbok_s_w3
    s_add_u32 s62, s62, 65536
    s_waitcnt vmcnt(2)
    v_cmp_gt_u32 vcc, s23, v25
    buffer_load_dword v25, v64, s[12:15], s11 offen offset:128 sc1
    s_nop 0
    s_cbranch_vccz L_gbok_s_w3
    s_add_u32 s62, s62, 65536
    s_waitcnt vmcnt(2)
    v_cmp_gt_u32 vcc, s23, v26
    buffer_load_dword v26, v64, s[12:15], s11 offen offset:128 sc1
    s_nop 0
    s_cbranch_vccz L_gbok_s_w3
    s_add_u32 s37, s37, 1
    s_cmp_lt_u32 s37, 400000
    s_cbranch_scc1 L_gbl_s_w3
    s_branch L_gbok_s_w3
L_team_exit:
    s_waitcnt vmcnt(0) lgkmcnt(0)
    s_cmp_lg_u32 s20, 2
    s_cbranch_scc1 L_team_x2
    v_mov_b32 v26, s25
    buffer_store_dword v26, v0, s[48:51], 0 offen sc1
L_team_x2:
    s_add_u32 s9, s9, 1
    s_cmp_ge_u32 s9, 2
    s_cbranch_scc1 L_ww_team
    s_waitcnt vmcnt(0)
    s_barrier
    s_add_u32 s10, s10, 32
    s_cmp_lg_u32 s20, 0
    s_cbranch_scc1 L_ta6
    v_mov_b32 v58, 12
    v_mov_b32 v59, 1
    s_mov_b64 exec, 1
    global_atomic_add v58, v59, s[86:87]
    s_mov_b64 exec, -1
L_ta6:
    v_mov_b32 v26, 12
L_tw7:
    global_load_dword v27, v26, s[86:87] sc1
    s_add_u32 s37, s37, 1
    s_cmp_gt_u32 s37, 400000
    s_waitcnt vmcnt(0)
    s_cbranch_scc1 L_tw7_d
    v_cmp_gt_u32 vcc, s10, v27
    s_nop 0
    s_cbranch_vccnz L_tw7
L_tw7_d:
    v_lshrrev_b32 v24, 4, v0
    s_lshl_b32 s34, s20, 6
    v_add_u32 v24, s34, v24
    s_mul_i32 s34, s9, 33554432
    s_add_u32 s34, s34, 61702144
    s_add_u32 s16, s88, s34
    s_addc_u32 s17, s89, 0
    s_mov_b32 s18, 33554432
    s_mov_b32 s19, 0x20000
    s_mul_i32 s34, s9, 589824
    s_add_u32 s34, s34, s33
    s_add_u32 s34, s34, 491520
    s_add_u32 s44, s88, s34
    s_addc_u32 s45, s89, 0
    s_mov_b32 s46, 576
    s_mov_b32 s47, 0x20000
    s_cmp_ge_u32 s21, 16
    s_cselect_b32 s46, 576, 0
    s_mov_b32 s29, 327680
    s_mov_b32 s30, 327680
    s_lshl_b32 s31, s21, 14
    s_lshl_b32 s34, s20, 12
    s_add_u32 s31, s31, s34
    s_sub_u32 s31, s31, 524288
    s_mov_b32 s22, 0
    s_mov_b32 s5, 0
    s_mov_b32 s4, 0
    s_mov_b32 s23, 0
    s_lshl_b32 s25, s9, 6
    s_add_u32 s25, s25, 1
    s_lshl_b32 s8, s21, 7
    s_add_u32 s8, s8, 397312
    s_mul_i32 s34, s21, 18
    v_add_u32 v77, s34, v24
    v_bfe_u32 v59, v77, 1, 3
    v_mul_u32_u24 v59, 1152, v59
    v_lshrrev_b32 v64, 4, v77
    v_lshl_add_u32 v59, v64, 5, v59
    v_and_b32 v64, 1, v77
    v_lshl_add_u32 v59, v64, 4, v59
    v_lshlrev_b32 v77, 4, v77
    v_mov_b32 v64, 0x40000000
    v_cmp_gt_u32 vcc, 18, v24
    s_nop 1
    v_cndmask_b32 v77, v64, v77, vcc
    v_cndmask_b32 v59, v64, v59, vcc
    s_mov_b32 s52, s66
    s_mov_b32 s53, s67
    s_mov_b32 s54, 9216
    s_mov_b32 s55, 0x20000
    buffer_load_dwordx4 v[68:71], v59, s[52:55], 0 offen
    v_and_b32 v57, 63, v24
    v_lshlrev_b32 v57, 3, v57
    v_mov_b32 v60, 0
    v_mov_b32 v61, 0
    s_mov_b32 s26, s24
    buffer_store_dwordx2 v[60:61], v57, s[12:15], s26 offen sc1
    s_add_u32 s26, s26, 65536
    buffer_store_dwordx2 v[60:61], v57, s[12:15], s26 offen sc1
    s_add_u32 s26, s26, 65536
    buffer_store_dwordx2 v[60:61], v57, s[12:15], s26 offen sc1
    s_add_u32 s26, s26, 65536
    buffer_store_dwordx2 v[60:61], v57, s[12:15], s26 offen sc1
    s_add_u32 s26, s26, 65536
    buffer_store_dwordx2 v[60:61], v57, s[12:15], s26 offen sc1
    s_add_u32 s26, s26, 65536
    v_lshlrev_b32 v58, 7, v24
    s_lshl_b32 s34, s21, 2
    s_add_u32 s34, s34, 355328
    v_mov_b32 v64, 0x40000000
    v_cmp_gt_u32 vcc, 4, v24
    s_nop 1
    v_cndmask_b32 v58, v64, v58, vcc
    buffer_store_dword v60, v58, s[12:15], s34 offen sc1
    v_mov_b64 v[64:65], -1
    v_mov_b64 v[66:67], -1
    s_mov_b32 s34, 336896
    s_mov_b32 s35, 346112
    buffer_store_dwordx4 v[64:67], v77, s[12:15], s34 offen sc1
    buffer_store_dwordx4 v[64:67], v77, s[12:15], s35 offen sc1
    s_waitcnt vmcnt(8)
    buffer_store_dwordx4 v[68:71], v77, s[12:15], s29 offen sc1
    s_waitcnt vmcnt(0)
    s_barrier
    s_add_u32 s10, s10, 32
    s_cmp_lg_u32 s20, 0
    s_cbranch_scc1 L_ta8
    v_mov_b32 v58, 12
    v_mov_b32 v59, 1
    s_mov_b64 exec, 1
    global_atomic_add v58, v59, s[86:87]
    s_mov_b64 exec, -1
L_ta8:
    v_mov_b32 v73, 0
    s_branch L_team_go
L_hw:
    s_and_b32 s40, s21, 31
    s_lshr_b32 s41, s21, 5
    s_lshl_b32 s47, s21, 2
    s_lshl_b32 s47, s47, 5
    s_add_u32 s48, s47, 409600
    s_add_u32 s47, s47, 397312
    s_mov_b32 s46, 0x3e0293ee
    v_and_b32 v24, 63, v0
    v_lshrrev_b32 v25, 4, v24
    s_lshl_b32 s34, s20, 4
    v_add_u32 v26, s34, v25
    v_lshlrev_b32 v26, 13, v26
    s_lshl_b32 s34, s40, 8
    v_add_u32 v26, s34, v26
    v_lshlrev_b32 v27, 1, v25
    v_and_b32 v40, 15, v24
    v_xor_b32 v27, v27, v40
    v_xor_b32 v41, 0, v27
    v_lshl_add_u32 v41, v41, 4, v26
    v_add_u32 v28, 0, v41
    v_xor_b32 v41, 0, v27
    v_lshl_add_u32 v41, v41, 4, v26
    v_add_u32 v29, 32768, v41
    v_xor_b32 v41, 8, v27
    v_lshl_add_u32 v41, v41, 4, v26
    v_add_u32 v30, 65536, v41
    v_xor_b32 v41, 8, v27
    v_lshl_add_u32 v41, v41, 4, v26
    v_add_u32 v31, 98304, v41
    v_bfe_u32 v40, v24, 2, 1
    v_bfe_u32 v41, v24, 3, 1
    v_bfe_u32 v42, v24, 4, 1
    v_bfe_u32 v43, v24, 5, 1
    v_and_b32 v44, 3, v24
    v_lshlrev_b32 v44, 3, v44
    v_add_u32 v44, 16384, v44
    v_lshl_add_u32 v46, v41, 1, v40
    v_lshl_add_u32 v45, v42, 3, v46
    v_lshl_add_u32 v45, v45, 8, v44
    v_mul_u32_u24 v47, 36864, v43
    v_add_u32 v45, v45, v47
    v_lshl_add_u32 v46, v42, 2, v46
    s_lshl_b32 s34, s20, 1
    v_xor_b32 v46, s34, v46
    v_lshl_add_u32 v48, v46, 5, v45
    v_xor_b32 v46, 1, v46
    v_lshl_add_u32 v50, v46, 5, v45
    v_add_u32 v49, 73728, v48
    v_add_u32 v51, 73728, v50
    s_mul_i32 s36, s20, 36864
    s_add_u32 s36, s36, 16384
    s_mov_b32 s30, 4718592
    s_mov_b32 s31, 0x20000
    s_mov_b32 s28, s70
    s_mov_b32 s29, s71
    s_mov_b32 s34, 0
    s_add_u32 m0, s36, 0
    s_nop 0
    buffer_load_dwordx4 v28, s[28:31], s34 offen lds
    s_add_u32 m0, s36, 1024
    s_nop 0
    buffer_load_dwordx4 v29, s[28:31], s34 offen lds
    s_add_u32 m0, s36, 2048
    s_nop 0
    buffer_load_dwordx4 v30, s[28:31], s34 offen lds
    s_add_u32 m0, s36, 3072
    s_nop 0
    buffer_load_dwordx4 v31, s[28:31], s34 offen lds
    s_mov_b32 s34, 524288
    s_add_u32 m0, s36, 4096
    s_nop 0
    buffer_load_dwordx4 v28, s[28:31], s34 offen lds
    s_add_u32 m0, s36, 5120
    s_nop 0
    buffer_load_dwordx4 v29, s[28:31], s34 offen lds
    s_add_u32 m0, s36, 6144
    s_nop 0
    buffer_load_dwordx4 v30, s[28:31], s34 offen lds
    s_add_u32 m0, s36, 7168
    s_nop 0
    buffer_load_dwordx4 v31, s[28:31], s34 offen lds
    s_mov_b32 s34, 1048576
    s_add_u32 m0, s36, 8192
    s_nop 0
    buffer_load_dwordx4 v28, s[28:31], s34 offen lds
    s_add_u32 m0, s36, 9216
    s_nop 0
    buffer_load_dwordx4 v29, s[28:31], s34 offen lds
    s_add_u32 m0, s36, 10240
    s_nop 0
    buffer_load_dwordx4 v30, s[28:31], s34 offen lds
    s_add_u32 m0, s36, 11264
    s_nop 0
    buffer_load_dwordx4 v31, s[28:31], s34 offen lds
    s_mov_b32 s34, 1572864
    s_add_u32 m0, s36, 12288
    s_nop 0
    buffer_load_dwordx4 v28, s[28:31], s34 offen lds
    s_add_u32 m0, s36, 13312
    s_nop 0
    buffer_load_dwordx4 v29, s[28:31], s34 offen lds
    s_add_u32 m0, s36, 14336
    s_nop 0
    buffer_load_dwordx4 v30, s[28:31], s34 offen lds
    s_add_u32 m0, s36, 15360
    s_nop 0
    buffer_load_dwordx4 v31, s[28:31], s34 offen lds
    s_mov_b32 s34, 2097152
    s_add_u32 m0, s36, 16384
    s_nop 0
    buffer_load_dwordx4 v28, s[28:31], s34 offen lds
    s_add_u32 m0, s36, 17408
    s_nop 0
    buffer_load_dwordx4 v29, s[28:31], s34 offen lds
    s_add_u32 m0, s36, 18432
    s_nop 0
    buffer_load_dwordx4 v30, s[28:31], s34 offen lds
    s_add_u32 m0, s36, 19456
    s_nop 0
    buffer_load_dwordx4 v31, s[28:31], s34 offen lds
    s_mov_b32 s34, 2621440
    s_add_u32 m0, s36, 20480
    s_nop 0
    buffer_load_dwordx4 v28, s[28:31], s34 offen lds
    s_add_u32 m0, s36, 21504
    s_nop 0
    buffer_load_dwordx4 v29, s[28:31], s34 offen lds
    s_add_u32 m0, s36, 22528
    s_nop 0
    buffer_load_dwordx4 v30, s[28:31], s34 offen lds
    s_add_u32 m0, s36, 23552
    s_nop 0
    buffer_load_dwordx4 v31, s[28:31], s34 offen lds
    s_mov_b32 s34, 3145728
    s_add_u32 m0, s36, 24576
    s_nop 0
    buffer_load_dwordx4 v28, s[28:31], s34 offen lds
    s_add_u32 m0, s36, 25600
    s_nop 0
    buffer_load_dwordx4 v29, s[28:31], s34 offen lds
    s_add_u32 m0, s36, 26624
    s_nop 0
    buffer_load_dwordx4 v30, s[28:31], s34 offen lds
    s_add_u32 m0, s36, 27648
    s_nop 0
    buffer_load_dwordx4 v31, s[28:31], s34 offen lds
    s_mov_b32 s34, 3670016
    s_add_u32 m0, s36, 28672
    s_nop 0
    buffer_load_dwordx4 v28, s[28:31], s34 offen lds
    s_add_u32 m0, s36, 29696
    s_nop 0
    buffer_load_dwordx4 v29, s[28:31], s34 offen lds
    s_add_u32 m0, s36, 30720
    s_nop 0
    buffer_load_dwordx4 v30, s[28:31], s34 offen lds
    s_add_u32 m0, s36, 31744
    s_nop 0
    buffer_load_dwordx4 v31, s[28:31], s34 offen lds
    s_mov_b32 s34, 4194304
    s_add_u32 m0, s36, 32768
    s_nop 0
    buffer_load_dwordx4 v28, s[28:31], s34 offen lds
    s_add_u32 m0, s36, 33792
    s_nop 0
    buffer_load_dwordx4 v29, s[28:31], s34 offen lds
    s_add_u32 m0, s36, 34816
    s_nop 0
    buffer_load_dwordx4 v30, s[28:31], s34 offen lds
    s_add_u32 m0, s36, 35840
    s_nop 0
    buffer_load_dwordx4 v31, s[28:31], s34 offen lds
    s_waitcnt vmcnt(32) lgkmcnt(0)
    s_barrier
    ds_read_b64_tr_b16 a[144:145], v48 offset:0
    ds_read_b64_tr_b16 a[146:147], v48 offset:1024
    ds_read_b64_tr_b16 a[148:149], v49 offset:0
    ds_read_b64_tr_b16 a[150:151], v49 offset:1024
    ds_read_b64_tr_b16 a[152:153], v50 offset:0
    ds_read_b64_tr_b16 a[154:155], v50 offset:1024
    ds_read_b64_tr_b16 a[156:157], v51 offset:0
    ds_read_b64_tr_b16 a[158:159], v51 offset:1024
    s_waitcnt vmcnt(28) lgkmcnt(0)
    s_barrier
    s_mov_b32 s28, s72
    s_mov_b32 s29, s73
    s_mov_b32 s34, 0
    s_add_u32 m0, s36, 0
    s_nop 0
    buffer_load_dwordx4 v28, s[28:31], s34 offen lds
    s_add_u32 m0, s36, 1024
    s_nop 0
    buffer_load_dwordx4 v29, s[28:31], s34 offen lds
    s_add_u32 m0, s36, 2048
    s_nop 0
    buffer_load_dwordx4 v30, s[28:31], s34 offen lds
    s_add_u32 m0, s36, 3072
    s_nop 0
    buffer_load_dwordx4 v31, s[28:31], s34 offen lds
    ds_read_b64_tr_b16 a[160:161], v48 offset:4096
    ds_read_b64_tr_b16 a[162:163], v48 offset:5120
    ds_read_b64_tr_b16 a[164:165], v49 offset:4096
    ds_read_b64_tr_b16 a[166:167], v49 offset:5120
    ds_read_b64_tr_b16 a[168:169], v50 offset:4096
    ds_read_b64_tr_b16 a[170:171], v50 offset:5120
    ds_read_b64_tr_b16 a[172:173], v51 offset:4096
    ds_read_b64_tr_b16 a[174:175], v51 offset:5120
    s_waitcnt vmcnt(28) lgkmcnt(0)
    s_barrier
    s_mov_b32 s34, 524288
    s_add_u32 m0, s36, 4096
    s_nop 0
    buffer_load_dwordx4 v28, s[28:31], s34 offen lds
    s_add_u32 m0, s36, 5120
    s_nop 0
    buffer_load_dwordx4 v29, s[28:31], s34 offen lds
    s_add_u32 m0, s36, 6144
    s_nop 0
    buffer_load_dwordx4 v30, s[28:31], s34 offen lds
    s_add_u32 m0, s36, 7168
    s_nop 0
    buffer_load_dwordx4 v31, s[28:31], s34 offen lds
    ds_read_b64_tr_b16 a[176:177], v48 offset:8192
    ds_read_b64_tr_b16 a[178:179], v48 offset:9216
    ds_read_b64_tr_b16 a[180:181], v49 offset:8192
    ds_read_b64_tr_b16 a[182:183], v49 offset:9216
    ds_read_b64_tr_b16 a[184:185], v50 offset:8192
    ds_read_b64_tr_b16 a[186:187], v50 offset:9216
    ds_read_b64_tr_b16 a[188:189], v51 offset:8192
    ds_read_b64_tr_b16 a[190:191], v51 offset:9216
    s_waitcnt vmcnt(28) lgkmcnt(0)
    s_barrier
    s_mov_b32 s34, 1048576
    s_add_u32 m0, s36, 8192
    s_nop 0
    buffer_load_dwordx4 v28, s[28:31], s34 offen lds
    s_add_u32 m0, s36, 9216
    s_nop 0
    buffer_load_dwordx4 v29, s[28:31], s34 offen lds
    s_add_u32 m0, s36, 10240
    s_nop 0
    buffer_load_dwordx4 v30, s[28:31], s34 offen lds
    s_add_u32 m0, s36, 11264
    s_nop 0
    buffer_load_dwordx4 v31, s[28:31], s34 offen lds
    ds_read_b64_tr_b16 a[192:193], v48 offset:12288
    ds_read_b64_tr_b16 a[194:195], v48 offset:13312
    ds_read_b64_tr_b16 a[196:197], v49 offset:12288
    ds_read_b64_tr_b16 a[198:199], v49 offset:13312
    ds_read_b64_tr_b16 a[200:201], v50 offset:12288
    ds_read_b64_tr_b16 a[202:203], v50 offset:13312
    ds_read_b64_tr_b16 a[204:205], v51 offset:12288
    ds_read_b64_tr_b16 a[206:207], v51 offset:13312
    s_waitcnt vmcnt(28) lgkmcnt(0)
    s_barrier
    s_mov_b32 s34, 1572864
    s_add_u32 m0, s36, 12288
    s_nop 0
    buffer_load_dwordx4 v28, s[28:31], s34 offen lds
    s_add_u32 m0, s36, 13312
    s_nop 0
    buffer_load_dwordx4 v29, s[28:31], s34 offen lds
    s_add_u32 m0, s36, 14336
    s_nop 0
    buffer_load_dwordx4 v30, s[28:31], s34 offen lds
    s_add_u32 m0, s36, 15360
    s_nop 0
    buffer_load_dwordx4 v31, s[28:31], s34 offen lds
    ds_read_b64_tr_b16 a[208:209], v48 offset:16384
    ds_read_b64_tr_b16 a[210:211], v48 offset:17408
    ds_read_b64_tr_b16 a[212:213], v49 offset:16384
    ds_read_b64_tr_b16 a[214:215], v49 offset:17408
    ds_read_b64_tr_b16 a[216:217], v50 offset:16384
    ds_read_b64_tr_b16 a[218:219], v50 offset:17408
    ds_read_b64_tr_b16 a[220:221], v51 offset:16384
    ds_read_b64_tr_b16 a[222:223], v51 offset:17408
    s_waitcnt vmcnt(28) lgkmcnt(0)
    s_barrier
    s_mov_b32 s34, 2097152
    s_add_u32 m0, s36, 16384
    s_nop 0
    buffer_load_dwordx4 v28, s[28:31], s34 offen lds
    s_add_u32 m0, s36, 17408
    s_nop 0
    buffer_load_dwordx4 v29, s[28:31], s34 offen lds
    s_add_u32 m0, s36, 18432
    s_nop 0
    buffer_load_dwordx4 v30, s[28:31], s34 offen lds
    s_add_u32 m0, s36, 19456
    s_nop 0
    buffer_load_dwordx4 v31, s[28:31], s34 offen lds
    ds_read_b64_tr_b16 a[224:225], v48 offset:20480
    ds_read_b64_tr_b16 a[226:227], v48 offset:21504
    ds_read_b64_tr_b16 a[228:229], v49 offset:20480
    ds_read_b64_tr_b16 a[230:231], v49 offset:21504
    ds_read_b64_tr_b16 a[232:233], v50 offset:20480
    ds_read_b64_tr_b16 a[234:235], v50 offset:21504
    ds_read_b64_tr_b16 a[236:237], v51 offset:20480
    ds_read_b64_tr_b16 a[238:239], v51 offset:21504
    s_waitcnt vmcnt(28) lgkmcnt(0)
    s_barrier
    s_mov_b32 s34, 2621440
    s_add_u32 m0, s36, 20480
    s_nop 0
    buffer_load_dwordx4 v28, s[28:31], s34 offen lds
    s_add_u32 m0, s36, 21504
    s_nop 0
    buffer_load_dwordx4 v29, s[28:31], s34 offen lds
    s_add_u32 m0, s36, 22528
    s_nop 0
    buffer_load_dwordx4 v30, s[28:31], s34 offen lds
    s_add_u32 m0, s36, 23552
    s_nop 0
    buffer_load_dwordx4 v31, s[28:31], s34 offen lds
    ds_read_b64_tr_b16 a[240:241], v48 offset:24576
    ds_read_b64_tr_b16 a[242:243], v48 offset:25600
    ds_read_b64_tr_b16 a[244:245], v49 offset:24576
    ds_read_b64_tr_b16 a[246:247], v49 offset:25600
    ds_read_b64_tr_b16 a[248:249], v50 offset:24576
    ds_read_b64_tr_b16 a[250:251], v50 offset:25600
    ds_read_b64_tr_b16 a[252:253], v51 offset:24576
    ds_read_b64_tr_b16 a[254:255], v51 offset:25600
    s_waitcnt vmcnt(28) lgkmcnt(0)
    s_barrier
    s_mov_b32 s34, 3145728
    s_add_u32 m0, s36, 24576
    s_nop 0
    buffer_load_dwordx4 v28, s[28:31], s34 offen lds
    s_add_u32 m0, s36, 25600
    s_nop 0
    buffer_load_dwordx4 v29, s[28:31], s34 offen lds
    s_add_u32 m0, s36, 26624
    s_nop 0
    buffer_load_dwordx4 v30, s[28:31], s34 offen lds
    s_add_u32 m0, s36, 27648
    s_nop 0
    buffer_load_dwordx4 v31, s[28:31], s34 offen lds
    ds_read_b64_tr_b16 v[80:81], v48 offset:28672
    ds_read_b64_tr_b16 v[82:83], v48 offset:29696
    ds_read_b64_tr_b16 v[84:85], v49 offset:28672
    ds_read_b64_tr_b16 v[86:87], v49 offset:29696
    ds_read_b64_tr_b16 v[88:89], v50 offset:28672
    ds_read_b64_tr_b16 v[90:91], v50 offset:29696
    ds_read_b64_tr_b16 v[92:93], v51 offset:28672
    ds_read_b64_tr_b16 v[94:95], v51 offset:29696
    s_waitcnt vmcnt(28) lgkmcnt(0)
    s_barrier
    s_mov_b32 s34, 3670016
    s_add_u32 m0, s36, 28672
    s_nop 0
    buffer_load_dwordx4 v28, s[28:31], s34 offen lds
    s_add_u32 m0, s36, 29696
    s_nop 0
    buffer_load_dwordx4 v29, s[28:31], s34 offen lds
    s_add_u32 m0, s36, 30720
    s_nop 0
    buffer_load_dwordx4 v30, s[28:31], s34 offen lds
    s_add_u32 m0, s36, 31744
    s_nop 0
    buffer_load_dwordx4 v31, s[28:31], s34 offen lds
    ds_read_b64_tr_b16 v[96:97], v48 offset:32768
    ds_read_b64_tr_b16 v[98:99], v48 offset:33792
    ds_read_b64_tr_b16 v[100:101], v49 offset:32768
    ds_read_b64_tr_b16 v[102:103], v49 offset:33792
    ds_read_b64_tr_b16 v[104:105], v50 offset:32768
    ds_read_b64_tr_b16 v[106:107], v50 offset:33792
    ds_read_b64_tr_b16 v[108:109], v51 offset:32768
    ds_read_b64_tr_b16 v[110:111], v51 offset:33792
    s_waitcnt vmcnt(28) lgkmcnt(0)
    s_barrier
    s_mov_b32 s34, 4194304
    s_add_u32 m0, s36, 32768
    s_nop 0
    buffer_load_dwordx4 v28, s[28:31], s34 offen lds
    s_add_u32 m0, s36, 33792
    s_nop 0
    buffer_load_dwordx4 v29, s[28:31], s34 offen lds
    s_add_u32 m0, s36, 34816
    s_nop 0
    buffer_load_dwordx4 v30, s[28:31], s34 offen lds
    s_add_u32 m0, s36, 35840
    s_nop 0
    buffer_load_dwordx4 v31, s[28:31], s34 offen lds
    ds_read_b64_tr_b16 v[112:113], v48 offset:0
    ds_read_b64_tr_b16 v[114:115], v48 offset:1024
    ds_read_b64_tr_b16 v[116:117], v49 offset:0
    ds_read_b64_tr_b16 v[118:119], v49 offset:1024
    ds_read_b64_tr_b16 v[120:121], v50 offset:0
    ds_read_b64_tr_b16 v[122:123], v50 offset:1024
    ds_read_b64_tr_b16 v[124:125], v51 offset:0
    ds_read_b64_tr_b16 v[126:127], v51 offset:1024
    s_waitcnt vmcnt(28) lgkmcnt(0)
    s_barrier
    s_mov_b32 s28, s68
    s_mov_b32 s29, s69
    s_mov_b32 s34, 0
    s_add_u32 m0, s36, 0
    s_nop 0
    buffer_load_dwordx4 v28, s[28:31], s34 offen lds
    s_add_u32 m0, s36, 1024
    s_nop 0
    buffer_load_dwordx4 v29, s[28:31], s34 offen lds
    s_add_u32 m0, s36, 2048
    s_nop 0
    buffer_load_dwordx4 v30, s[28:31], s34 offen lds
    s_add_u32 m0, s36, 3072
    s_nop 0
    buffer_load_dwordx4 v31, s[28:31], s34 offen lds
    ds_read_b64_tr_b16 v[128:129], v48 offset:4096
    ds_read_b64_tr_b16 v[130:131], v48 offset:5120
    ds_read_b64_tr_b16 v[132:133], v49 offset:4096
    ds_read_b64_tr_b16 v[134:135], v49 offset:5120
    ds_read_b64_tr_b16 v[136:137], v50 offset:4096
    ds_read_b64_tr_b16 v[138:139], v50 offset:5120
    ds_read_b64_tr_b16 v[140:141], v51 offset:4096
    ds_read_b64_tr_b16 v[142:143], v51 offset:5120
    s_waitcnt vmcnt(28) lgkmcnt(0)
    s_barrier
    s_mov_b32 s34, 524288
    s_add_u32 m0, s36, 4096
    s_nop 0
    buffer_load_dwordx4 v28, s[28:31], s34 offen lds
    s_add_u32 m0, s36, 5120
    s_nop 0
    buffer_load_dwordx4 v29, s[28:31], s34 offen lds
    s_add_u32 m0, s36, 6144
    s_nop 0
    buffer_load_dwordx4 v30, s[28:31], s34 offen lds
    s_add_u32 m0, s36, 7168
    s_nop 0
    buffer_load_dwordx4 v31, s[28:31], s34 offen lds
    ds_read_b64_tr_b16 v[144:145], v48 offset:8192
    ds_read_b64_tr_b16 v[146:147], v48 offset:9216
    ds_read_b64_tr_b16 v[148:149], v49 offset:8192
    ds_read_b64_tr_b16 v[150:151], v49 offset:9216
    ds_read_b64_tr_b16 v[152:153], v50 offset:8192
    ds_read_b64_tr_b16 v[154:155], v50 offset:9216
    ds_read_b64_tr_b16 v[156:157], v51 offset:8192
    ds_read_b64_tr_b16 v[158:159], v51 offset:9216
    s_waitcnt vmcnt(28) lgkmcnt(0)
    s_barrier
    s_mov_b32 s34, 1048576
    s_add_u32 m0, s36, 8192
    s_nop 0
    buffer_load_dwordx4 v28, s[28:31], s34 offen lds
    s_add_u32 m0, s36, 9216
    s_nop 0
    buffer_load_dwordx4 v29, s[28:31], s34 offen lds
    s_add_u32 m0, s36, 10240
    s_nop 0
    buffer_load_dwordx4 v30, s[28:31], s34 offen lds
    s_add_u32 m0, s36, 11264
    s_nop 0
    buffer_load_dwordx4 v31, s[28:31], s34 offen lds
    ds_read_b64_tr_b16 v[160:161], v48 offset:12288
    ds_read_b64_tr_b16 v[162:163], v48 offset:13312
    ds_read_b64_tr_b16 v[164:165], v49 offset:12288
    ds_read_b64_tr_b16 v[166:167], v49 offset:13312
    ds_read_b64_tr_b16 v[168:169], v50 offset:12288
    ds_read_b64_tr_b16 v[170:171], v50 offset:13312
    ds_read_b64_tr_b16 v[172:173], v51 offset:12288
    ds_read_b64_tr_b16 v[174:175], v51 offset:13312
    s_waitcnt vmcnt(28) lgkmcnt(0)
    s_barrier
    s_mov_b32 s34, 1572864
    s_add_u32 m0, s36, 12288
    s_nop 0
    buffer_load_dwordx4 v28, s[28:31], s34 offen lds
    s_add_u32 m0, s36, 13312
    s_nop 0
    buffer_load_dwordx4 v29, s[28:31], s34 offen lds
    s_add_u32 m0, s36, 14336
    s_nop 0
    buffer_load_dwordx4 v30, s[28:31], s34 offen lds
    s_add_u32 m0, s36, 15360
    s_nop 0
    buffer_load_dwordx4 v31, s[28:31], s34 offen lds
    ds_read_b64_tr_b16 v[176:177], v48 offset:16384
    ds_read_b64_tr_b16 v[178:179], v48 offset:17408
    ds_read_b64_tr_b16 v[180:181], v49 offset:16384
    ds_read_b64_tr_b16 v[182:183], v49 offset:17408
    ds_read_b64_tr_b16 v[184:185], v50 offset:16384
    ds_read_b64_tr_b16 v[186:187], v50 offset:17408
    ds_read_b64_tr_b16 v[188:189], v51 offset:16384
    ds_read_b64_tr_b16 v[190:191], v51 offset:17408
    s_waitcnt vmcnt(28) lgkmcnt(0)
    s_barrier
    s_mov_b32 s34, 2097152
    s_add_u32 m0, s36, 16384
    s_nop 0
    buffer_load_dwordx4 v28, s[28:31], s34 offen lds
    s_add_u32 m0, s36, 17408
    s_nop 0
    buffer_load_dwordx4 v29, s[28:31], s34 offen lds
    s_add_u32 m0, s36, 18432
    s_nop 0
    buffer_load_dwordx4 v30, s[28:31], s34 offen lds
    s_add_u32 m0, s36, 19456
    s_nop 0
    buffer_load_dwordx4 v31, s[28:31], s34 offen lds
    ds_read_b64_tr_b16 v[192:193], v48 offset:20480
    ds_read_b64_tr_b16 v[194:195], v48 offset:21504
    ds_read_b64_tr_b16 v[196:197], v49 offset:20480
    ds_read_b64_tr_b16 v[198:199], v49 offset:21504
    ds_read_b64_tr_b16 v[200:201], v50 offset:20480
    ds_read_b64_tr_b16 v[202:203], v50 offset:21504
    ds_read_b64_tr_b16 v[204:205], v51 offset:20480
    ds_read_b64_tr_b16 v[206:207], v51 offset:21504
    s_waitcnt vmcnt(28) lgkmcnt(0)
    s_barrier
    s_mov_b32 s34, 2621440
    s_add_u32 m0, s36, 20480
    s_nop 0
    buffer_load_dwordx4 v28, s[28:31], s34 offen lds
    s_add_u32 m0, s36, 21504
    s_nop 0
    buffer_load_dwordx4 v29, s[28:31], s34 offen lds
    s_add_u32 m0, s36, 22528
    s_nop 0
    buffer_load_dwordx4 v30, s[28:31], s34 offen lds
    s_add_u32 m0, s36, 23552
    s_nop 0
    buffer_load_dwordx4 v31, s[28:31], s34 offen lds
    ds_read_b64_tr_b16 v[208:209], v48 offset:24576
    ds_read_b64_tr_b16 v[210:211], v48 offset:25600
    ds_read_b64_tr_b16 v[212:213], v49 offset:24576
    ds_read_b64_tr_b16 v[214:215], v49 offset:25600
    ds_read_b64_tr_b16 v[216:217], v50 offset:24576
    ds_read_b64_tr_b16 v[218:219], v50 offset:25600
    ds_read_b64_tr_b16 v[220:221], v51 offset:24576
    ds_read_b64_tr_b16 v[222:223], v51 offset:25600
    s_waitcnt vmcnt(28) lgkmcnt(0)
    s_barrier
    s_mov_b32 s34, 3145728
    s_add_u32 m0, s36, 24576
    s_nop 0
    buffer_load_dwordx4 v28, s[28:31], s34 offen lds
    s_add_u32 m0, s36, 25600
    s_nop 0
    buffer_load_dwordx4 v29, s[28:31], s34 offen lds
    s_add_u32 m0, s36, 26624
    s_nop 0
    buffer_load_dwordx4 v30, s[28:31], s34 offen lds
    s_add_u32 m0, s36, 27648
    s_nop 0
    buffer_load_dwordx4 v31, s[28:31], s34 offen lds
    ds_read_b64_tr_b16 v[224:225], v48 offset:28672
    ds_read_b64_tr_b16 v[226:227], v48 offset:29696
    ds_read_b64_tr_b16 v[228:229], v49 offset:28672
    ds_read_b64_tr_b16 v[230:231], v49 offset:29696
    ds_read_b64_tr_b16 v[232:233], v50 offset:28672
    ds_read_b64_tr_b16 v[234:235], v50 offset:29696
    ds_read_b64_tr_b16 v[236:237], v51 offset:28672
    ds_read_b64_tr_b16 v[238:239], v51 offset:29696
    s_waitcnt vmcnt(28) lgkmcnt(0)
    s_barrier
    s_mov_b32 s34, 3670016
    s_add_u32 m0, s36, 28672
    s_nop 0
    buffer_load_dwordx4 v28, s[28:31], s34 offen lds
    s_add_u32 m0, s36, 29696
    s_nop 0
    buffer_load_dwordx4 v29, s[28:31], s34 offen lds
    s_add_u32 m0, s36, 30720
    s_nop 0
    buffer_load_dwordx4 v30, s[28:31], s34 offen lds
    s_add_u32 m0, s36, 31744
    s_nop 0
    buffer_load_dwordx4 v31, s[28:31], s34 offen lds
    ds_read_b64_tr_b16 v[240:241], v48 offset:32768
    ds_read_b64_tr_b16 v[242:243], v48 offset:33792
    ds_read_b64_tr_b16 v[244:245], v49 offset:32768
    ds_read_b64_tr_b16 v[246:247], v49 offset:33792
    ds_read_b64_tr_b16 v[248:249], v50 offset:32768
    ds_read_b64_tr_b16 v[250:251], v50 offset:33792
    ds_read_b64_tr_b16 v[252:253], v51 offset:32768
    ds_read_b64_tr_b16 v[254:255], v51 offset:33792
    s_waitcnt vmcnt(28) lgkmcnt(0)
    s_barrier
    s_mov_b32 s34, 4194304
    s_add_u32 m0, s36, 32768
    s_nop 0
    buffer_load_dwordx4 v28, s[28:31], s34 offen lds
    s_add_u32 m0, s36, 33792
    s_nop 0
    buffer_load_dwordx4 v29, s[28:31], s34 offen lds
    s_add_u32 m0, s36, 34816
    s_nop 0
    buffer_load_dwordx4 v30, s[28:31], s34 offen lds
    s_add_u32 m0, s36, 35840
    s_nop 0
    buffer_load_dwordx4 v31, s[28:31], s34 offen lds
    ds_read_b64_tr_b16 a[0:1], v48 offset:0
    ds_read_b64_tr_b16 a[2:3], v48 offset:1024
    ds_read_b64_tr_b16 a[4:5], v49 offset:0
    ds_read_b64_tr_b16 a[6:7], v49 offset:1024
    ds_read_b64_tr_b16 a[8:9], v50 offset:0
    ds_read_b64_tr_b16 a[10:11], v50 offset:1024
    ds_read_b64_tr_b16 a[12:13], v51 offset:0
    ds_read_b64_tr_b16 a[14:15], v51 offset:1024
    s_waitcnt vmcnt(28) lgkmcnt(0)
    s_barrier
    ds_read_b64_tr_b16 a[16:17], v48 offset:4096
    ds_read_b64_tr_b16 a[18:19], v48 offset:5120
    ds_read_b64_tr_b16 a[20:21], v49 offset:4096
    ds_read_b64_tr_b16 a[22:23], v49 offset:5120
    ds_read_b64_tr_b16 a[24:25], v50 offset:4096
    ds_read_b64_tr_b16 a[26:27], v50 offset:5120
    ds_read_b64_tr_b16 a[28:29], v51 offset:4096
    ds_read_b64_tr_b16 a[30:31], v51 offset:5120
    s_waitcnt vmcnt(24) lgkmcnt(0)
    s_barrier
    ds_read_b64_tr_b16 a[32:33], v48 offset:8192
    ds_read_b64_tr_b16 a[34:35], v48 offset:9216
    ds_read_b64_tr_b16 a[36:37], v49 offset:8192
    ds_read_b64_tr_b16 a[38:39], v49 offset:9216
    ds_read_b64_tr_b16 a[40:41], v50 offset:8192
    ds_read_b64_tr_b16 a[42:43], v50 offset:9216
    ds_read_b64_tr_b16 a[44:45], v51 offset:8192
    ds_read_b64_tr_b16 a[46:47], v51 offset:9216
    s_waitcnt vmcnt(20) lgkmcnt(0)
    s_barrier
    ds_read_b64_tr_b16 a[48:49], v48 offset:12288
    ds_read_b64_tr_b16 a[50:51], v48 offset:13312
    ds_read_b64_tr_b16 a[52:53], v49 offset:12288
    ds_read_b64_tr_b16 a[54:55], v49 offset:13312
    ds_read_b64_tr_b16 a[56:57], v50 offset:12288
    ds_read_b64_tr_b16 a[58:59], v50 offset:13312
    ds_read_b64_tr_b16 a[60:61], v51 offset:12288
    ds_read_b64_tr_b16 a[62:63], v51 offset:13312
    s_waitcnt vmcnt(16) lgkmcnt(0)
    s_barrier
    ds_read_b64_tr_b16 a[64:65], v48 offset:16384
    ds_read_b64_tr_b16 a[66:67], v48 offset:17408
    ds_read_b64_tr_b16 a[68:69], v49 offset:16384
    ds_read_b64_tr_b16 a[70:71], v49 offset:17408
    ds_read_b64_tr_b16 a[72:73], v50 offset:16384
    ds_read_b64_tr_b16 a[74:75], v50 offset:17408
    ds_read_b64_tr_b16 a[76:77], v51 offset:16384
    ds_read_b64_tr_b16 a[78:79], v51 offset:17408
    s_waitcnt vmcnt(12) lgkmcnt(0)
    s_barrier
    ds_read_b64_tr_b16 a[80:81], v48 offset:20480
    ds_read_b64_tr_b16 a[82:83], v48 offset:21504
    ds_read_b64_tr_b16 a[84:85], v49 offset:20480
    ds_read_b64_tr_b16 a[86:87], v49 offset:21504
    ds_read_b64_tr_b16 a[88:89], v50 offset:20480
    ds_read_b64_tr_b16 a[90:91], v50 offset:21504
    ds_read_b64_tr_b16 a[92:93], v51 offset:20480
    ds_read_b64_tr_b16 a[94:95], v51 offset:21504
    s_waitcnt vmcnt(8) lgkmcnt(0)
    s_barrier
    ds_read_b64_tr_b16 a[96:97], v48 offset:24576
    ds_read_b64_tr_b16 a[98:99], v48 offset:25600
    ds_read_b64_tr_b16 a[100:101], v49 offset:24576
    ds_read_b64_tr_b16 a[102:103], v49 offset:25600
    ds_read_b64_tr_b16 a[104:105], v50 offset:24576
    ds_read_b64_tr_b16 a[106:107], v50 offset:25600
    ds_read_b64_tr_b16 a[108:109], v51 offset:24576
    ds_read_b64_tr_b16 a[110:111], v51 offset:25600
    s_waitcnt vmcnt(4) lgkmcnt(0)
    s_barrier
    ds_read_b64_tr_b16 a[112:113], v48 offset:28672
    ds_read_b64_tr_b16 a[114:115], v48 offset:29696
    ds_read_b64_tr_b16 a[116:117], v49 offset:28672
    ds_read_b64_tr_b16 a[118:119], v49 offset:29696
    ds_read_b64_tr_b16 a[120:121], v50 offset:28672
    ds_read_b64_tr_b16 a[122:123], v50 offset:29696
    ds_read_b64_tr_b16 a[124:125], v51 offset:28672
    ds_read_b64_tr_b16 a[126:127], v51 offset:29696
    s_waitcnt vmcnt(0) lgkmcnt(0)
    s_barrier
    ds_read_b64_tr_b16 a[128:129], v48 offset:32768
    ds_read_b64_tr_b16 a[130:131], v48 offset:33792
    ds_read_b64_tr_b16 a[132:133], v49 offset:32768
    ds_read_b64_tr_b16 a[134:135], v49 offset:33792
    ds_read_b64_tr_b16 a[136:137], v50 offset:32768
    ds_read_b64_tr_b16 a[138:139], v50 offset:33792
    ds_read_b64_tr_b16 a[140:141], v51 offset:32768
    ds_read_b64_tr_b16 a[142:143], v51 offset:33792
    s_waitcnt lgkmcnt(0)
    s_barrier
    v_mov_b32 v8, s39
    v_mov_b32 v9, s39
    v_mov_b32 v10, s39
    v_mov_b32 v11, s39
    s_nop 1
    v_mfma_f32_16x16x32_bf16 v[24:27], v[8:11], a[0:3], 0
    v_mfma_f32_16x16x32_bf16 v[28:31], v[8:11], a[8:11], 0
    v_mfma_f32_16x16x32_bf16 v[32:35], v[8:11], a[144:147], 0
    v_mfma_f32_16x16x32_bf16 v[36:39], v[8:11], a[152:155], 0
    v_mfma_f32_16x16x32_bf16 v[40:43], v[8:11], v[112:115], 0
    v_mfma_f32_16x16x32_bf16 v[44:47], v[8:11], v[120:123], 0
    v_mfma_f32_16x16x32_bf16 v[24:27], v[8:11], a[4:7], v[24:27]
    v_mfma_f32_16x16x32_bf16 v[28:31], v[8:11], a[12:15], v[28:31]
    v_mfma_f32_16x16x32_bf16 v[32:35], v[8:11], a[148:151], v[32:35]
    v_mfma_f32_16x16x32_bf16 v[36:39], v[8:11], a[156:159], v[36:39]
    v_mfma_f32_16x16x32_bf16 v[40:43], v[8:11], v[116:119], v[40:43]
    v_mfma_f32_16x16x32_bf16 v[44:47], v[8:11], v[124:127], v[44:47]
    v_mfma_f32_16x16x32_bf16 v[24:27], v[8:11], a[16:19], v[24:27]
    v_mfma_f32_16x16x32_bf16 v[28:31], v[8:11], a[24:27], v[28:31]
    v_mfma_f32_16x16x32_bf16 v[32:35], v[8:11], a[160:163], v[32:35]
    v_mfma_f32_16x16x32_bf16 v[36:39], v[8:11], a[168:171], v[36:39]
    v_mfma_f32_16x16x32_bf16 v[40:43], v[8:11], v[128:131], v[40:43]
    v_mfma_f32_16x16x32_bf16 v[44:47], v[8:11], v[136:139], v[44:47]
    v_mfma_f32_16x16x32_bf16 v[24:27], v[8:11], a[20:23], v[24:27]
    v_mfma_f32_16x16x32_bf16 v[28:31], v[8:11], a[28:31], v[28:31]
    v_mfma_f32_16x16x32_bf16 v[32:35], v[8:11], a[164:167], v[32:35]
    v_mfma_f32_16x16x32_bf16 v[36:39], v[8:11], a[172:175], v[36:39]
    v_mfma_f32_16x16x32_bf16 v[40:43], v[8:11], v[132:135], v[40:43]
    v_mfma_f32_16x16x32_bf16 v[44:47], v[8:11], v[140:143], v[44:47]
    v_mfma_f32_16x16x32_bf16 v[24:27], v[8:11], a[32:35], v[24:27]
    v_mfma_f32_16x16x32_bf16 v[28:31], v[8:11], a[40:43], v[28:31]
    v_mfma_f32_16x16x32_bf16 v[32:35], v[8:11], a[176:179], v[32:35]
    v_mfma_f32_16x16x32_bf16 v[36:39], v[8:11], a[184:187], v[36:39]
    v_mfma_f32_16x16x32_bf16 v[40:43], v[8:11], v[144:147], v[40:43]
    v_mfma_f32_16x16x32_bf16 v[44:47], v[8:11], v[152:155], v[44:47]
    v_mfma_f32_16x16x32_bf16 v[24:27], v[8:11], a[36:39], v[24:27]
    v_mfma_f32_16x16x32_bf16 v[28:31], v[8:11], a[44:47], v[28:31]
    v_mfma_f32_16x16x32_bf16 v[32:35], v[8:11], a[180:183], v[32:35]
    v_mfma_f32_16x16x32_bf16 v[36:39], v[8:11], a[188:191], v[36:39]
    v_mfma_f32_16x16x32_bf16 v[40:43], v[8:11], v[148:151], v[40:43]
    v_mfma_f32_16x16x32_bf16 v[44:47], v[8:11], v[156:159], v[44:47]
    v_mfma_f32_16x16x32_bf16 v[24:27], v[8:11], a[48:51], v[24:27]
    v_mfma_f32_16x16x32_bf16 v[28:31], v[8:11], a[56:59], v[28:31]
    v_mfma_f32_16x16x32_bf16 v[32:35], v[8:11], a[192:195], v[32:35]
    v_mfma_f32_16x16x32_bf16 v[36:39], v[8:11], a[200:203], v[36:39]
    v_mfma_f32_16x16x32_bf16 v[40:43], v[8:11], v[160:163], v[40:43]
    v_mfma_f32_16x16x32_bf16 v[44:47], v[8:11], v[168:171], v[44:47]
    v_mfma_f32_16x16x32_bf16 v[24:27], v[8:11], a[52:55], v[24:27]
    v_mfma_f32_16x16x32_bf16 v[28:31], v[8:11], a[60:63], v[28:31]
    v_mfma_f32_16x16x32_bf16 v[32:35], v[8:11], a[196:199], v[32:35]
    v_mfma_f32_16x16x32_bf16 v[36:39], v[8:11], a[204:207], v[36:39]
    v_mfma_f32_16x16x32_bf16 v[40:43], v[8:11], v[164:167], v[40:43]
    v_mfma_f32_16x16x32_bf16 v[44:47], v[8:11], v[172:175], v[44:47]
    v_mfma_f32_16x16x32_bf16 v[24:27], v[8:11], a[64:67], v[24:27]
    v_mfma_f32_16x16x32_bf16 v[28:31], v[8:11], a[72:75], v[28:31]
    v_mfma_f32_16x16x32_bf16 v[32:35], v[8:11], a[208:211], v[32:35]
    v_mfma_f32_16x16x32_bf16 v[36:39], v[8:11], a[216:219], v[36:39]
    v_mfma_f32_16x16x32_bf16 v[40:43], v[8:11], v[176:179], v[40:43]
    v_mfma_f32_16x16x32_bf16 v[44:47], v[8:11], v[184:187], v[44:47]
    v_mfma_f32_16x16x32_bf16 v[24:27], v[8:11], a[68:71], v[24:27]
    v_mfma_f32_16x16x32_bf16 v[28:31], v[8:11], a[76:79], v[28:31]
    v_mfma_f32_16x16x32_bf16 v[32:35], v[8:11], a[212:215], v[32:35]
    v_mfma_f32_16x16x32_bf16 v[36:39], v[8:11], a[220:223], v[36:39]
    v_mfma_f32_16x16x32_bf16 v[40:43], v[8:11], v[180:183], v[40:43]
    v_mfma_f32_16x16x32_bf16 v[44:47], v[8:11], v[188:191], v[44:47]
    v_mfma_f32_16x16x32_bf16 v[24:27], v[8:11], a[80:83], v[24:27]
    v_mfma_f32_16x16x32_bf16 v[28:31], v[8:11], a[88:91], v[28:31]
    v_mfma_f32_16x16x32_bf16 v[32:35], v[8:11], a[224:227], v[32:35]
    v_mfma_f32_16x16x32_bf16 v[36:39], v[8:11], a[232:235], v[36:39]
    v_mfma_f32_16x16x32_bf16 v[40:43], v[8:11], v[192:195], v[40:43]
    v_mfma_f32_16x16x32_bf16 v[44:47], v[8:11], v[200:203], v[44:47]
    v_mfma_f32_16x16x32_bf16 v[24:27], v[8:11], a[84:87], v[24:27]
    v_mfma_f32_16x16x32_bf16 v[28:31], v[8:11], a[92:95], v[28:31]
    v_mfma_f32_16x16x32_bf16 v[32:35], v[8:11], a[228:231], v[32:35]
    v_mfma_f32_16x16x32_bf16 v[36:39], v[8:11], a[236:239], v[36:39]
    v_mfma_f32_16x16x32_bf16 v[40:43], v[8:11], v[196:199], v[40:43]
    v_mfma_f32_16x16x32_bf16 v[44:47], v[8:11], v[204:207], v[44:47]
    v_mfma_f32_16x16x32_bf16 v[24:27], v[8:11], a[96:99], v[24:27]
    v_mfma_f32_16x16x32_bf16 v[28:31], v[8:11], a[104:107], v[28:31]
    v_mfma_f32_16x16x32_bf16 v[32:35], v[8:11], a[240:243], v[32:35]
    v_mfma_f32_16x16x32_bf16 v[36:39], v[8:11], a[248:251], v[36:39]
    v_mfma_f32_16x16x32_bf16 v[40:43], v[8:11], v[208:211], v[40:43]
    v_mfma_f32_16x16x32_bf16 v[44:47], v[8:11], v[216:219], v[44:47]
    v_mfma_f32_16x16x32_bf16 v[24:27], v[8:11], a[100:103], v[24:27]
    v_mfma_f32_16x16x32_bf16 v[28:31], v[8:11], a[108:111], v[28:31]
    v_mfma_f32_16x16x32_bf16 v[32:35], v[8:11], a[244:247], v[32:35]
    v_mfma_f32_16x16x32_bf16 v[36:39], v[8:11], a[252:255], v[36:39]
    v_mfma_f32_16x16x32_bf16 v[40:43], v[8:11], v[212:215], v[40:43]
    v_mfma_f32_16x16x32_bf16 v[44:47], v[8:11], v[220:223], v[44:47]
    v_mfma_f32_16x16x32_bf16 v[24:27], v[8:11], a[112:115], v[24:27]
    v_mfma_f32_16x16x32_bf16 v[28:31], v[8:11], a[120:123], v[28:31]
    v_mfma_f32_16x16x32_bf16 v[32:35], v[8:11], v[80:83], v[32:35]
    v_mfma_f32_16x16x32_bf16 v[36:39], v[8:11], v[88:91], v[36:39]
    v_mfma_f32_16x16x32_bf16 v[40:43], v[8:11], v[224:227], v[40:43]
    v_mfma_f32_16x16x32_bf16 v[44:47], v[8:11], v[232:235], v[44:47]
    v_mfma_f32_16x16x32_bf16 v[24:27], v[8:11], a[116:119], v[24:27]
    v_mfma_f32_16x16x32_bf16 v[28:31], v[8:11], a[124:127], v[28:31]
    v_mfma_f32_16x16x32_bf16 v[32:35], v[8:11], v[84:87], v[32:35]
    v_mfma_f32_16x16x32_bf16 v[36:39], v[8:11], v[92:95], v[36:39]
    v_mfma_f32_16x16x32_bf16 v[40:43], v[8:11], v[228:231], v[40:43]
    v_mfma_f32_16x16x32_bf16 v[44:47], v[8:11], v[236:239], v[44:47]
    v_mfma_f32_16x16x32_bf16 v[24:27], v[8:11], a[128:131], v[24:27]
    v_mfma_f32_16x16x32_bf16 v[28:31], v[8:11], a[136:139], v[28:31]
    v_mfma_f32_16x16x32_bf16 v[32:35], v[8:11], v[96:99], v[32:35]
    v_mfma_f32_16x16x32_bf16 v[36:39], v[8:11], v[104:107], v[36:39]
    v_mfma_f32_16x16x32_bf16 v[40:43], v[8:11], v[240:243], v[40:43]
    v_mfma_f32_16x16x32_bf16 v[44:47], v[8:11], v[248:251], v[44:47]
    v_mfma_f32_16x16x32_bf16 v[24:27], v[8:11], a[132:135], v[24:27]
    v_mfma_f32_16x16x32_bf16 v[28:31], v[8:11], a[140:143], v[28:31]
    v_mfma_f32_16x16x32_bf16 v[32:35], v[8:11], v[100:103], v[32:35]
    v_mfma_f32_16x16x32_bf16 v[36:39], v[8:11], v[108:111], v[36:39]
    v_mfma_f32_16x16x32_bf16 v[40:43], v[8:11], v[244:247], v[40:43]
    v_mfma_f32_16x16x32_bf16 v[44:47], v[8:11], v[252:255], v[44:47]
    v_and_b32 v4, 15, v0
    v_lshlrev_b32 v4, 2, v4
    s_lshl_b32 s34, s20, 7
    v_add_u32 v4, s34, v4
    ds_write_b32 v4, v24 offset:54528
    ds_write_b32 v4, v28 offset:54592
    ds_write_b32 v4, v32 offset:55040
    ds_write_b32 v4, v36 offset:55104
    ds_write_b32 v4, v40 offset:55552
    ds_write_b32 v4, v44 offset:55616
    s_waitcnt lgkmcnt(0)
    v_and_b32 v24, 63, v0
    v_lshlrev_b32 v0, 4, v24
    v_and_b32 v25, 15, v24
    v_lshrrev_b32 v26, 4, v24
    s_and_b32 s34, s20, 1
    s_lshl_b32 s34, s34, 4
    v_add_u32 v27, s34, v25
    v_lshlrev_b32 v28, 2, v26
    v_sub_u32 v3, v27, v28
    v_and_b32 v27, 7, v25
    v_lshlrev_b32 v27, 5, v27
    v_lshrrev_b32 v28, 1, v26
    v_lshl_add_u32 v27, v28, 8, v27
    v_and_b32 v28, 1, v26
    v_lshl_add_u32 v27, v28, 4, v27
    v_add_u32 v2, 36864, v27
    s_mov_b32 s32, 0
    v_lshrrev_b32 v27, 3, v24
    v_and_b32 v1, 7, v24
    v_xor_b32 v1, v1, v27
    s_lshr_b32 s34, s20, 2
    v_xor_b32 v1, s34, v1
    s_lshl_b32 s34, s20, 3
    v_add_u32 v27, s34, v27
    v_mul_u32_u24 v27, 1152, v27
    v_lshl_add_u32 v1, v1, 4, v27
    v_cmp_le_i32 s[66:67], 0, v3
    v_cmp_le_i32 s[68:69], 1, v3
    v_cmp_le_i32 s[70:71], 2, v3
    v_cmp_le_i32 s[72:73], 3, v3
    v_cmp_le_i32 s[74:75], 16, v3
    v_cmp_le_i32 s[76:77], 17, v3
    v_cmp_le_i32 s[78:79], 18, v3
    v_cmp_le_i32 s[80:81], 19, v3
    v_bfe_u32 v6, v0, 4, 3
    v_lshrrev_b32 v7, 8, v0
    v_xor_b32 v7, v7, v6
    v_lshlrev_b32 v7, 4, v7
    v_lshl_add_u32 v6, v6, 7, v7
    v_bfe_u32 v7, v0, 7, 1
    v_mul_u32_u24 v7, 9216, v7
    v_add_u32 v3, v6, v7
    s_mov_b32 s49, 0
    s_mov_b32 s52, 0
    s_mov_b32 s16, s64
    s_mov_b32 s17, s65
    s_mov_b32 s18, 2359296
    s_mov_b32 s19, 0x20000
L_i9:
    v_mov_b32 v4, 0
    global_load_dword v5, v4, s[86:87] offset:12 sc1
    global_load_dword v4, v4, s[86:87] offset:128 sc1
    s_add_u32 s37, s37, 1
    s_waitcnt vmcnt(0)
    v_min_u32 v5, 32, v5
    v_min_u32 v4, 224, v4
    v_add_u32 v5, v5, v4
    v_cmp_gt_u32 vcc, 256, v5
    s_nop 0
    s_cbranch_vccz L_i9_d
    s_sleep 4
    s_cmp_lt_u32 s37, 400000
    s_cbranch_scc1 L_i9
L_i9_d:
L_hw_layer:
    s_mov_b32 s42, s41
    s_mov_b32 s43, s41
    s_mov_b32 s44, 57344
    s_mov_b32 s45, 57344
L_hw_first:
    s_call_b64 s[50:51], L_hw_pre
L_hw_loop:
    s_cmp_ge_u32 s42, 64
    s_cbranch_scc1 L_hw_f
    s_mul_i32 s35, s20, 9216
    v_add_u32 v4, s35, v0
    v_lshrrev_b32 v36, 7, v0
    s_lshl_b32 s35, s20, 5
    s_add_u32 s35, s35, 54272
    v_lshl_add_u32 v36, v36, 2, s35
    v_xor_b32 v7, 64, v3
    s_lshl_b32 s38, s32, 6
    s_add_u32 s38, s38, s43
    s_add_u32 s38, s38, 1
    s_mov_b32 s34, 395264
    v_lshlrev_b32 v5, 3, v0
    v_and_b32 v5, 2047, v5
    s_cmp_eq_u32 s49, 0
    s_cbranch_scc0 L_hq10a
    s_waitcnt vmcnt(0)
L_hq10a:
    s_waitcnt vmcnt(2)
    s_barrier
    buffer_load_dword v5, v5, s[12:15], s34 offen sc1
    ds_read_b128 v[8:11], v3 offset:0
    ds_read_b128 v[12:15], v3 offset:18432
    s_waitcnt lgkmcnt(1)
    v_mfma_f32_16x16x32_bf16 v[40:43], a[144:147], v[8:11], 0
    ds_read_b128 v[16:19], v7 offset:0
    ds_read_b128 v[24:27], v4 offset:0
    ds_read_b128 v[28:31], v4 offset:1024
    v_mov_b32 v32, 0
    v_mov_b32 v33, 0
    v_mfma_f32_16x16x32_bf16 v[44:47], a[152:155], v[8:11], 0
    ds_read_b128 v[20:23], v7 offset:18432
    s_waitcnt lgkmcnt(4)
    v_mfma_f32_16x16x32_bf16 v[48:51], a[144:147], v[12:15], 0
    v_mfma_f32_16x16x32_bf16 v[52:55], a[152:155], v[12:15], 0
    v_mfma_f32_16x16x32_bf16 v[56:59], v[8:11], v[112:115], 0
    s_waitcnt lgkmcnt(2)
    v_lshlrev_b32 v34, 16, v24
    v_and_b32 v35, 0xffff0000, v24
    v_mfma_f32_16x16x32_bf16 v[64:67], v[8:11], v[120:123], 0
    v_add_f32 v32, v32, v34
    v_fmac_f32 v33, v34, v34
    v_mfma_f32_16x16x32_bf16 v[60:63], v[12:15], v[112:115], 0
    v_add_f32 v32, v32, v35
    v_fmac_f32 v33, v35, v35
    v_mfma_f32_16x16x32_bf16 v[68:71], v[12:15], v[120:123], 0
    s_waitcnt lgkmcnt(0)
    v_lshlrev_b32 v34, 16, v25
    v_and_b32 v35, 0xffff0000, v25
    v_mfma_f32_16x16x32_bf16 v[40:43], a[148:151], v[16:19], v[40:43]
    ds_read_b128 v[8:11], v3 offset:1024
    v_add_f32 v32, v32, v34
    v_fmac_f32 v33, v34, v34
    v_mfma_f32_16x16x32_bf16 v[44:47], a[156:159], v[16:19], v[44:47]
    ds_read_b128 v[12:15], v3 offset:19456
    v_add_f32 v32, v32, v35
    v_fmac_f32 v33, v35, v35
    v_mfma_f32_16x16x32_bf16 v[48:51], a[148:151], v[20:23], v[48:51]
    v_lshlrev_b32 v34, 16, v26
    v_and_b32 v35, 0xffff0000, v26
    v_mfma_f32_16x16x32_bf16 v[52:55], a[156:159], v[20:23], v[52:55]
    v_add_f32 v32, v32, v34
    v_fmac_f32 v33, v34, v34
    v_mfma_f32_16x16x32_bf16 v[56:59], v[16:19], v[116:119], v[56:59]
    v_add_f32 v32, v32, v35
    v_fmac_f32 v33, v35, v35
    v_mfma_f32_16x16x32_bf16 v[64:67], v[16:19], v[124:127], v[64:67]
    v_lshlrev_b32 v34, 16, v27
    v_and_b32 v35, 0xffff0000, v27
    v_mfma_f32_16x16x32_bf16 v[60:63], v[20:23], v[116:119], v[60:63]
    ds_read_b128 v[24:27], v4 offset:2048
    v_add_f32 v32, v32, v34
    v_fmac_f32 v33, v34, v34
    v_mfma_f32_16x16x32_bf16 v[68:71], v[20:23], v[124:127], v[68:71]
    s_waitcnt lgkmcnt(1)
    v_add_f32 v32, v32, v35
    v_fmac_f32 v33, v35, v35
    v_mfma_f32_16x16x32_bf16 v[40:43], a[160:163], v[8:11], v[40:43]
    ds_read_b128 v[16:19], v7 offset:1024
    v_lshlrev_b32 v34, 16, v28
    v_and_b32 v35, 0xffff0000, v28
    v_mfma_f32_16x16x32_bf16 v[44:47], a[168:171], v[8:11], v[44:47]
    ds_read_b128 v[20:23], v7 offset:19456
    v_add_f32 v32, v32, v34
    v_fmac_f32 v33, v34, v34
    v_mfma_f32_16x16x32_bf16 v[48:51], a[160:163], v[12:15], v[48:51]
    v_add_f32 v32, v32, v35
    v_fmac_f32 v33, v35, v35
    v_mfma_f32_16x16x32_bf16 v[52:55], a[168:171], v[12:15], v[52:55]
    v_lshlrev_b32 v34, 16, v29
    v_and_b32 v35, 0xffff0000, v29
    v_mfma_f32_16x16x32_bf16 v[56:59], v[8:11], v[128:131], v[56:59]
    v_add_f32 v32, v32, v34
    v_fmac_f32 v33, v34, v34
    v_mfma_f32_16x16x32_bf16 v[64:67], v[8:11], v[136:139], v[64:67]
    v_add_f32 v32, v32, v35
    v_fmac_f32 v33, v35, v35
    v_mfma_f32_16x16x32_bf16 v[60:63], v[12:15], v[128:131], v[60:63]
    v_lshlrev_b32 v34, 16, v30
    v_and_b32 v35, 0xffff0000, v30
    v_mfma_f32_16x16x32_bf16 v[68:71], v[12:15], v[136:139], v[68:71]
    s_waitcnt lgkmcnt(0)
    v_add_f32 v32, v32, v34
    v_fmac_f32 v33, v34, v34
    v_mfma_f32_16x16x32_bf16 v[40:43], a[164:167], v[16:19], v[40:43]
    ds_read_b128 v[8:11], v3 offset:2048
    v_add_f32 v32, v32, v35
    v_fmac_f32 v33, v35, v35
    v_mfma_f32_16x16x32_bf16 v[44:47], a[172:175], v[16:19], v[44:47]
    ds_read_b128 v[12:15], v3 offset:20480
    v_lshlrev_b32 v34, 16, v31
    v_and_b32 v35, 0xffff0000, v31
    v_mfma_f32_16x16x32_bf16 v[48:51], a[164:167], v[20:23], v[48:51]
    ds_read_b128 v[28:31], v4 offset:3072
    v_add_f32 v32, v32, v34
    v_fmac_f32 v33, v34, v34
    v_mfma_f32_16x16x32_bf16 v[52:55], a[172:175], v[20:23], v[52:55]
    v_add_f32 v32, v32, v35
    v_fmac_f32 v33, v35, v35
    v_mfma_f32_16x16x32_bf16 v[56:59], v[16:19], v[132:135], v[56:59]
    v_lshlrev_b32 v34, 16, v24
    v_and_b32 v35, 0xffff0000, v24
    v_mfma_f32_16x16x32_bf16 v[64:67], v[16:19], v[140:143], v[64:67]
    v_add_f32 v32, v32, v34
    v_fmac_f32 v33, v34, v34
    v_mfma_f32_16x16x32_bf16 v[60:63], v[20:23], v[132:135], v[60:63]
    v_add_f32 v32, v32, v35
    v_fmac_f32 v33, v35, v35
    v_mfma_f32_16x16x32_bf16 v[68:71], v[20:23], v[140:143], v[68:71]
    s_waitcnt lgkmcnt(1)
    v_lshlrev_b32 v34, 16, v25
    v_and_b32 v35, 0xffff0000, v25
    v_mfma_f32_16x16x32_bf16 v[40:43], a[176:179], v[8:11], v[40:43]
    ds_read_b128 v[16:19], v7 offset:2048
    v_add_f32 v32, v32, v34
    v_fmac_f32 v33, v34, v34
    v_mfma_f32_16x16x32_bf16 v[44:47], a[184:187], v[8:11], v[44:47]
    ds_read_b128 v[20:23], v7 offset:20480
    v_add_f32 v32, v32, v35
    v_fmac_f32 v33, v35, v35
    v_mfma_f32_16x16x32_bf16 v[48:51], a[176:179], v[12:15], v[48:51]
    v_lshlrev_b32 v34, 16, v26
    v_and_b32 v35, 0xffff0000, v26
    v_mfma_f32_16x16x32_bf16 v[52:55], a[184:187], v[12:15], v[52:55]
    v_add_f32 v32, v32, v34
    v_fmac_f32 v33, v34, v34
    v_mfma_f32_16x16x32_bf16 v[56:59], v[8:11], v[144:147], v[56:59]
    v_add_f32 v32, v32, v35
    v_fmac_f32 v33, v35, v35
    v_mfma_f32_16x16x32_bf16 v[64:67], v[8:11], v[152:155], v[64:67]
    v_lshlrev_b32 v34, 16, v27
    v_and_b32 v35, 0xffff0000, v27
    v_mfma_f32_16x16x32_bf16 v[60:63], v[12:15], v[144:147], v[60:63]
    ds_read_b128 v[24:27], v4 offset:4096
    v_add_f32 v32, v32, v34
    v_fmac_f32 v33, v34, v34
    v_mfma_f32_16x16x32_bf16 v[68:71], v[12:15], v[152:155], v[68:71]
    s_waitcnt lgkmcnt(1)
    v_add_f32 v32, v32, v35
    v_fmac_f32 v33, v35, v35
    v_mfma_f32_16x16x32_bf16 v[40:43], a[180:183], v[16:19], v[40:43]
    ds_read_b128 v[8:11], v3 offset:3072
    v_lshlrev_b32 v34, 16, v28
    s_waitcnt vmcnt(0)
    v_cmp_gt_u32 vcc, s38, v5
    s_barrier
    s_cmp_eq_u32 s49, 0
    s_cbranch_scc1 L_hq10b
    s_cmp_lg_u32 s20, 0
    s_cbranch_scc1 L_s11
    v_mov_b32 v72, s49
    v_mov_b32 v73, 0
    s_mov_b64 exec, 1
    buffer_store_dword v72, v73, s[12:15], s48 offen sc1
    s_mov_b64 exec, -1
L_s11:
    s_mov_b32 s49, 0
L_hq10b:
    s_cbranch_vccnz L_hq10c
    s_call_b64 s[50:51], L_hw_mreq
L_hq10c:
    v_and_b32 v35, 0xffff0000, v28
    v_mfma_f32_16x16x32_bf16 v[44:47], a[188:191], v[16:19], v[44:47]
    ds_read_b128 v[12:15], v3 offset:21504
    v_add_f32 v32, v32, v34
    v_fmac_f32 v33, v34, v34
    v_mfma_f32_16x16x32_bf16 v[48:51], a[180:183], v[20:23], v[48:51]
    v_add_f32 v32, v32, v35
    v_fmac_f32 v33, v35, v35
    v_mfma_f32_16x16x32_bf16 v[52:55], a[188:191], v[20:23], v[52:55]
    v_lshlrev_b32 v34, 16, v29
    v_and_b32 v35, 0xffff0000, v29
    v_mfma_f32_16x16x32_bf16 v[56:59], v[16:19], v[148:151], v[56:59]
    v_add_f32 v32, v32, v34
    v_fmac_f32 v33, v34, v34
    v_mfma_f32_16x16x32_bf16 v[64:67], v[16:19], v[156:159], v[64:67]
    v_add_f32 v32, v32, v35
    v_fmac_f32 v33, v35, v35
    v_mfma_f32_16x16x32_bf16 v[60:63], v[20:23], v[148:151], v[60:63]
    v_lshlrev_b32 v34, 16, v30
    v_and_b32 v35, 0xffff0000, v30
    v_mfma_f32_16x16x32_bf16 v[68:71], v[20:23], v[156:159], v[68:71]
    s_waitcnt lgkmcnt(0)
    v_add_f32 v32, v32, v34
    v_fmac_f32 v33, v34, v34
    v_mfma_f32_16x16x32_bf16 v[40:43], a[192:195], v[8:11], v[40:43]
    ds_read_b128 v[16:19], v7 offset:3072
    v_add_f32 v32, v32, v35
    v_fmac_f32 v33, v35, v35
    v_mfma_f32_16x16x32_bf16 v[44:47], a[200:203], v[8:11], v[44:47]
    ds_read_b128 v[20:23], v7 offset:21504
    v_lshlrev_b32 v34, 16, v31
    v_and_b32 v35, 0xffff0000, v31
    v_mfma_f32_16x16x32_bf16 v[48:51], a[192:195], v[12:15], v[48:51]
    ds_read_b128 v[28:31], v4 offset:5120
    v_add_f32 v32, v32, v34
    v_fmac_f32 v33, v34, v34
    v_mfma_f32_16x16x32_bf16 v[52:55], a[200:203], v[12:15], v[52:55]
    v_add_f32 v32, v32, v35
    v_fmac_f32 v33, v35, v35
    v_mfma_f32_16x16x32_bf16 v[56:59], v[8:11], v[160:163], v[56:59]
    v_lshlrev_b32 v34, 16, v24
    v_and_b32 v35, 0xffff0000, v24
    v_mfma_f32_16x16x32_bf16 v[64:67], v[8:11], v[168:171], v[64:67]
    v_add_f32 v32, v32, v34
    v_fmac_f32 v33, v34, v34
    v_mfma_f32_16x16x32_bf16 v[60:63], v[12:15], v[160:163], v[60:63]
    v_add_f32 v32, v32, v35
    v_fmac_f32 v33, v35, v35
    v_mfma_f32_16x16x32_bf16 v[68:71], v[12:15], v[168:171], v[68:71]
    s_waitcnt lgkmcnt(1)
    v_lshlrev_b32 v34, 16, v25
    v_and_b32 v35, 0xffff0000, v25
    v_mfma_f32_16x16x32_bf16 v[40:43], a[196:199], v[16:19], v[40:43]
    ds_read_b128 v[8:11], v3 offset:4096
    v_add_f32 v32, v32, v34
    v_fmac_f32 v33, v34, v34
    v_mfma_f32_16x16x32_bf16 v[44:47], a[204:207], v[16:19], v[44:47]
    ds_read_b128 v[12:15], v3 offset:22528
    v_add_f32 v32, v32, v35
    v_fmac_f32 v33, v35, v35
    v_mfma_f32_16x16x32_bf16 v[48:51], a[196:199], v[20:23], v[48:51]
    v_lshlrev_b32 v34, 16, v26
    v_and_b32 v35, 0xffff0000, v26
    v_mfma_f32_16x16x32_bf16 v[52:55], a[204:207], v[20:23], v[52:55]
    v_add_f32 v32, v32, v34
    v_fmac_f32 v33, v34, v34
    v_mfma_f32_16x16x32_bf16 v[56:59], v[16:19], v[164:167], v[56:59]
    v_add_f32 v32, v32, v35
    v_fmac_f32 v33, v35, v35
    v_mfma_f32_16x16x32_bf16 v[64:67], v[16:19], v[172:175], v[64:67]
    v_lshlrev_b32 v34, 16, v27
    v_and_b32 v35, 0xffff0000, v27
    v_mfma_f32_16x16x32_bf16 v[60:63], v[20:23], v[164:167], v[60:63]
    ds_read_b128 v[24:27], v4 offset:6144
    v_add_f32 v32, v32, v34
    v_fmac_f32 v33, v34, v34
    v_mfma_f32_16x16x32_bf16 v[68:71], v[20:23], v[172:175], v[68:71]
    s_waitcnt lgkmcnt(1)
    v_add_f32 v32, v32, v35
    v_fmac_f32 v33, v35, v35
    v_mfma_f32_16x16x32_bf16 v[40:43], a[208:211], v[8:11], v[40:43]
    ds_read_b128 v[16:19], v7 offset:4096
    v_lshlrev_b32 v34, 16, v28
    v_and_b32 v35, 0xffff0000, v28
    v_mfma_f32_16x16x32_bf16 v[44:47], a[216:219], v[8:11], v[44:47]
    ds_read_b128 v[20:23], v7 offset:22528
    v_add_f32 v32, v32, v34
    v_fmac_f32 v33, v34, v34
    v_mfma_f32_16x16x32_bf16 v[48:51], a[208:211], v[12:15], v[48:51]
    v_add_f32 v32, v32, v35
    v_fmac_f32 v33, v35, v35
    v_mfma_f32_16x16x32_bf16 v[52:55], a[216:219], v[12:15], v[52:55]
    v_lshlrev_b32 v34, 16, v29
    v_and_b32 v35, 0xffff0000, v29
    v_mfma_f32_16x16x32_bf16 v[56:59], v[8:11], v[176:179], v[56:59]
    v_add_f32 v32, v32, v34
    v_fmac_f32 v33, v34, v34
    v_mfma_f32_16x16x32_bf16 v[64:67], v[8:11], v[184:187], v[64:67]
    v_add_f32 v32, v32, v35
    v_fmac_f32 v33, v35, v35
    v_mfma_f32_16x16x32_bf16 v[60:63], v[12:15], v[176:179], v[60:63]
    v_lshlrev_b32 v34, 16, v30
    v_and_b32 v35, 0xffff0000, v30
    v_mfma_f32_16x16x32_bf16 v[68:71], v[12:15], v[184:187], v[68:71]
    s_waitcnt lgkmcnt(0)
    v_add_f32 v32, v32, v34
    v_fmac_f32 v33, v34, v34
    v_mfma_f32_16x16x32_bf16 v[40:43], a[212:215], v[16:19], v[40:43]
    ds_read_b128 v[8:11], v3 offset:5120
    v_add_f32 v32, v32, v35
    v_fmac_f32 v33, v35, v35
    v_mfma_f32_16x16x32_bf16 v[44:47], a[220:223], v[16:19], v[44:47]
    ds_read_b128 v[12:15], v3 offset:23552
    v_lshlrev_b32 v34, 16, v31
    v_and_b32 v35, 0xffff0000, v31
    v_mfma_f32_16x16x32_bf16 v[48:51], a[212:215], v[20:23], v[48:51]
    ds_read_b128 v[28:31], v4 offset:7168
    v_add_f32 v32, v32, v34
    v_fmac_f32 v33, v34, v34
    v_mfma_f32_16x16x32_bf16 v[52:55], a[220:223], v[20:23], v[52:55]
    v_add_f32 v32, v32, v35
    v_fmac_f32 v33, v35, v35
    v_mfma_f32_16x16x32_bf16 v[56:59], v[16:19], v[180:183], v[56:59]
    v_lshlrev_b32 v34, 16, v24
    v_and_b32 v35, 0xffff0000, v24
    v_mfma_f32_16x16x32_bf16 v[64:67], v[16:19], v[188:191], v[64:67]
    v_add_f32 v32, v32, v34
    v_fmac_f32 v33, v34, v34
    v_mfma_f32_16x16x32_bf16 v[60:63], v[20:23], v[180:183], v[60:63]
    v_add_f32 v32, v32, v35
    v_fmac_f32 v33, v35, v35
    v_mfma_f32_16x16x32_bf16 v[68:71], v[20:23], v[188:191], v[68:71]
    s_waitcnt lgkmcnt(1)
    v_lshlrev_b32 v34, 16, v25
    v_and_b32 v35, 0xffff0000, v25
    v_mfma_f32_16x16x32_bf16 v[40:43], a[224:227], v[8:11], v[40:43]
    ds_read_b128 v[16:19], v7 offset:5120
    v_add_f32 v32, v32, v34
    v_fmac_f32 v33, v34, v34
    v_mfma_f32_16x16x32_bf16 v[44:47], a[232:235], v[8:11], v[44:47]
    ds_read_b128 v[20:23], v7 offset:23552
    v_add_f32 v32, v32, v35
    v_fmac_f32 v33, v35, v35
    v_mfma_f32_16x16x32_bf16 v[48:51], a[224:227], v[12:15], v[48:51]
    v_lshlrev_b32 v34, 16, v26
    v_and_b32 v35, 0xffff0000, v26
    v_mfma_f32_16x16x32_bf16 v[52:55], a[232:235], v[12:15], v[52:55]
    v_add_f32 v32, v32, v34
    v_fmac_f32 v33, v34, v34
    v_mfma_f32_16x16x32_bf16 v[56:59], v[8:11], v[192:195], v[56:59]
    v_add_f32 v32, v32, v35
    v_fmac_f32 v33, v35, v35
    v_mfma_f32_16x16x32_bf16 v[64:67], v[8:11], v[200:203], v[64:67]
    v_lshlrev_b32 v34, 16, v27
    v_and_b32 v35, 0xffff0000, v27
    v_mfma_f32_16x16x32_bf16 v[60:63], v[12:15], v[192:195], v[60:63]
    ds_read_b128 v[24:27], v4 offset:8192
    v_add_f32 v32, v32, v34
    v_fmac_f32 v33, v34, v34
    v_mfma_f32_16x16x32_bf16 v[68:71], v[12:15], v[200:203], v[68:71]
    s_waitcnt lgkmcnt(1)
    v_add_f32 v32, v32, v35
    v_fmac_f32 v33, v35, v35
    v_mfma_f32_16x16x32_bf16 v[40:43], a[228:231], v[16:19], v[40:43]
    ds_read_b128 v[8:11], v3 offset:6144
    v_lshlrev_b32 v34, 16, v28
    v_and_b32 v35, 0xffff0000, v28
    v_mfma_f32_16x16x32_bf16 v[44:47], a[236:239], v[16:19], v[44:47]
    ds_read_b128 v[12:15], v3 offset:24576
    v_add_f32 v32, v32, v34
    v_fmac_f32 v33, v34, v34
    v_mfma_f32_16x16x32_bf16 v[48:51], a[228:231], v[20:23], v[48:51]
    v_add_f32 v32, v32, v35
    v_fmac_f32 v33, v35, v35
    v_mfma_f32_16x16x32_bf16 v[52:55], a[236:239], v[20:23], v[52:55]
    v_lshlrev_b32 v34, 16, v29
    v_and_b32 v35, 0xffff0000, v29
    v_mfma_f32_16x16x32_bf16 v[56:59], v[16:19], v[196:199], v[56:59]
    v_add_f32 v32, v32, v34
    v_fmac_f32 v33, v34, v34
    v_mfma_f32_16x16x32_bf16 v[64:67], v[16:19], v[204:207], v[64:67]
    v_add_f32 v32, v32, v35
    v_fmac_f32 v33, v35, v35
    v_mfma_f32_16x16x32_bf16 v[60:63], v[20:23], v[196:199], v[60:63]
    v_lshlrev_b32 v34, 16, v30
    v_and_b32 v35, 0xffff0000, v30
    v_mfma_f32_16x16x32_bf16 v[68:71], v[20:23], v[204:207], v[68:71]
    s_waitcnt lgkmcnt(0)
    v_add_f32 v32, v32, v34
    v_fmac_f32 v33, v34, v34
    v_mfma_f32_16x16x32_bf16 v[40:43], a[240:243], v[8:11], v[40:43]
    ds_read_b128 v[16:19], v7 offset:6144
    v_add_f32 v32, v32, v35
    v_fmac_f32 v33, v35, v35
    v_mfma_f32_16x16x32_bf16 v[44:47], a[248:251], v[8:11], v[44:47]
    ds_read_b128 v[20:23], v7 offset:24576
    v_lshlrev_b32 v34, 16, v31
    v_and_b32 v35, 0xffff0000, v31
    v_mfma_f32_16x16x32_bf16 v[48:51], a[240:243], v[12:15], v[48:51]
    v_add_f32 v32, v32, v34
    v_fmac_f32 v33, v34, v34
    v_mfma_f32_16x16x32_bf16 v[52:55], a[248:251], v[12:15], v[52:55]
    v_add_f32 v32, v32, v35
    v_fmac_f32 v33, v35, v35
    v_mfma_f32_16x16x32_bf16 v[56:59], v[8:11], v[208:211], v[56:59]
    v_lshlrev_b32 v34, 16, v24
    v_and_b32 v35, 0xffff0000, v24
    v_mfma_f32_16x16x32_bf16 v[64:67], v[8:11], v[216:219], v[64:67]
    v_add_f32 v32, v32, v34
    v_fmac_f32 v33, v34, v34
    v_mfma_f32_16x16x32_bf16 v[60:63], v[12:15], v[208:211], v[60:63]
    v_add_f32 v32, v32, v35
    v_fmac_f32 v33, v35, v35
    v_mfma_f32_16x16x32_bf16 v[68:71], v[12:15], v[216:219], v[68:71]
    s_waitcnt lgkmcnt(0)
    v_lshlrev_b32 v34, 16, v25
    v_and_b32 v35, 0xffff0000, v25
    v_mfma_f32_16x16x32_bf16 v[40:43], a[244:247], v[16:19], v[40:43]
    ds_read_b128 v[8:11], v3 offset:7168
    v_add_f32 v32, v32, v34
    v_fmac_f32 v33, v34, v34
    v_mfma_f32_16x16x32_bf16 v[44:47], a[252:255], v[16:19], v[44:47]
    ds_read_b128 v[12:15], v3 offset:25600
    v_add_f32 v32, v32, v35
    v_fmac_f32 v33, v35, v35
    v_mfma_f32_16x16x32_bf16 v[48:51], a[244:247], v[20:23], v[48:51]
    v_lshlrev_b32 v34, 16, v26
    v_and_b32 v35, 0xffff0000, v26
    v_mfma_f32_16x16x32_bf16 v[52:55], a[252:255], v[20:23], v[52:55]
    v_add_f32 v32, v32, v34
    v_fmac_f32 v33, v34, v34
    v_mfma_f32_16x16x32_bf16 v[56:59], v[16:19], v[212:215], v[56:59]
    v_add_f32 v32, v32, v35
    v_fmac_f32 v33, v35, v35
    v_mfma_f32_16x16x32_bf16 v[64:67], v[16:19], v[220:223], v[64:67]
    v_lshlrev_b32 v34, 16, v27
    v_and_b32 v35, 0xffff0000, v27
    v_mfma_f32_16x16x32_bf16 v[60:63], v[20:23], v[212:215], v[60:63]
    v_add_f32 v32, v32, v34
    v_fmac_f32 v33, v34, v34
    v_mfma_f32_16x16x32_bf16 v[68:71], v[20:23], v[220:223], v[68:71]
    s_waitcnt lgkmcnt(0)
    v_add_f32 v32, v32, v35
    v_fmac_f32 v33, v35, v35
    v_mfma_f32_16x16x32_bf16 v[40:43], v[80:83], v[8:11], v[40:43]
    ds_read_b128 v[16:19], v7 offset:7168
    v_add_f32_dpp v32, v32, v32 quad_perm:[1,0,3,2] row_mask:0xf bank_mask:0xf
    v_add_f32_dpp v33, v33, v33 quad_perm:[1,0,3,2] row_mask:0xf bank_mask:0xf
    v_mfma_f32_16x16x32_bf16 v[44:47], v[88:91], v[8:11], v[44:47]
    ds_read_b128 v[20:23], v7 offset:25600
    v_add_f32_dpp v32, v32, v32 quad_perm:[2,3,0,1] row_mask:0xf bank_mask:0xf
    v_add_f32_dpp v33, v33, v33 quad_perm:[2,3,0,1] row_mask:0xf bank_mask:0xf
    v_mfma_f32_16x16x32_bf16 v[48:51], v[80:83], v[12:15], v[48:51]
    v_add_f32_dpp v32, v32, v32 row_half_mirror row_mask:0xf bank_mask:0xf
    v_add_f32_dpp v33, v33, v33 row_half_mirror row_mask:0xf bank_mask:0xf
    v_mfma_f32_16x16x32_bf16 v[52:55], v[88:91], v[12:15], v[52:55]
    v_mul_f32 v32, 0x3ae38e39, v32
    v_mul_f32 v33, 0x3ae38e39, v33
    v_mfma_f32_16x16x32_bf16 v[56:59], v[8:11], v[224:227], v[56:59]
    v_fma_f32 v33, -v32, v32, v33
    v_max_f32 v33, 0, v33
    v_mfma_f32_16x16x32_bf16 v[64:67], v[8:11], v[232:235], v[64:67]
    v_add_f32 v33, 0x3727c5ac, v33
    v_rsq_f32 v33, v33
    v_mfma_f32_16x16x32_bf16 v[60:63], v[12:15], v[224:227], v[60:63]
    ds_write2_b32 v36, v32, v33 offset0:0 offset1:32
    v_mfma_f32_16x16x32_bf16 v[68:71], v[12:15], v[232:235], v[68:71]
    s_waitcnt lgkmcnt(1)
    v_mfma_f32_16x16x32_bf16 v[40:43], v[84:87], v[16:19], v[40:43]
    ds_read_b128 v[8:11], v3 offset:8192
    v_mfma_f32_16x16x32_bf16 v[44:47], v[92:95], v[16:19], v[44:47]
    ds_read_b128 v[12:15], v3 offset:26624
    s_waitcnt lgkmcnt(2)
    s_barrier
    v_bfe_u32 v4, v0, 4, 4
    v_mfma_f32_16x16x32_bf16 v[48:51], v[84:87], v[20:23], v[48:51]
    v_lshlrev_b32 v4, 2, v4
    v_lshrrev_b32 v5, 4, v0
    v_mfma_f32_16x16x32_bf16 v[52:55], v[92:95], v[20:23], v[52:55]
    v_and_b32 v5, 48, v5
    s_lshl_b32 s34, s20, 7
    v_add_u32 v78, s34, v4
    v_mfma_f32_16x16x32_bf16 v[56:59], v[16:19], v[228:231], v[56:59]
    v_add_u32 v79, s34, v5
    v_add_u32 v4, 54272, v4
    v_mfma_f32_16x16x32_bf16 v[64:67], v[16:19], v[236:239], v[64:67]
    ds_read2_b32 v[72:73], v4 offset0:0 offset1:32
    ds_read2_b32 v[74:75], v4 offset0:16 offset1:48
    v_mfma_f32_16x16x32_bf16 v[60:63], v[20:23], v[228:231], v[60:63]
    ds_read_b128 v[24:27], v79 offset:55040
    ds_read_b128 v[28:31], v79 offset:55104
    v_mfma_f32_16x16x32_bf16 v[68:71], v[20:23], v[236:239], v[68:71]
    s_waitcnt lgkmcnt(4)
    ds_read_b32 v76, v78 offset:55552
    ds_read_b32 v77, v78 offset:55616
    v_mfma_f32_16x16x32_bf16 v[40:43], v[96:99], v[8:11], v[40:43]
    ds_read_b128 v[16:19], v7 offset:8192
    ds_read_b128 v[32:35], v5 offset:54272
    ds_read_b128 v[36:39], v5 offset:54400
    v_mfma_f32_16x16x32_bf16 v[44:47], v[104:107], v[8:11], v[44:47]
    ds_read_b128 v[20:23], v7 offset:26624
    v_mfma_f32_16x16x32_bf16 v[48:51], v[96:99], v[12:15], v[48:51]
    v_mfma_f32_16x16x32_bf16 v[52:55], v[104:107], v[12:15], v[52:55]
    v_mfma_f32_16x16x32_bf16 v[56:59], v[8:11], v[240:243], v[56:59]
    v_mfma_f32_16x16x32_bf16 v[64:67], v[8:11], v[248:251], v[64:67]
    v_mfma_f32_16x16x32_bf16 v[60:63], v[12:15], v[240:243], v[60:63]
    v_mfma_f32_16x16x32_bf16 v[68:71], v[12:15], v[248:251], v[68:71]
    s_waitcnt lgkmcnt(0)
    v_mfma_f32_16x16x32_bf16 v[40:43], v[100:103], v[16:19], v[40:43]
    ds_read_b128 v[8:11], v3 offset:0
    v_mfma_f32_16x16x32_bf16 v[44:47], v[108:111], v[16:19], v[44:47]
    ds_read_b128 v[12:15], v3 offset:18432
    v_mfma_f32_16x16x32_bf16 v[48:51], v[100:103], v[20:23], v[48:51]
    v_mfma_f32_16x16x32_bf16 v[52:55], v[108:111], v[20:23], v[52:55]
    v_mfma_f32_16x16x32_bf16 v[56:59], v[16:19], v[244:247], v[56:59]
    v_mfma_f32_16x16x32_bf16 v[64:67], v[16:19], v[252:255], v[64:67]
    v_mfma_f32_16x16x32_bf16 v[60:63], v[20:23], v[244:247], v[60:63]
    v_mfma_f32_16x16x32_bf16 v[68:71], v[20:23], v[252:255], v[68:71]
    s_waitcnt lgkmcnt(0)
    s_lshl_b32 s34, s42, 19
    s_lshl_b32 s35, s40, 14
    s_add_u32 s34, s34, s35
    s_lshl_b32 s35, s20, 12
    s_add_u32 s34, s34, s35
    s_mul_i32 s35, s32, 33554432
    s_add_u32 s34, s34, s35
    s_add_u32 s34, s34, 61702144
    s_lshl_b32 s35, s20, 11
    s_add_u32 s35, s35, s44
    v_add_u32 v4, s35, v0
    v_mul_f32 v78, s46, v73
    v_fma_f32 v40, -v72, v24, v40
    v_fma_f32 v41, -v72, v25, v41
    v_fma_f32 v42, -v72, v26, v42
    v_fma_f32 v43, -v72, v27, v43
    v_fma_f32 v44, -v72, v28, v44
    v_fma_f32 v45, -v72, v29, v45
    v_fma_f32 v46, -v72, v30, v46
    v_fma_f32 v47, -v72, v31, v47
    v_mul_f32 v40, v40, v78
    v_mul_f32 v41, v41, v78
    v_mul_f32 v42, v42, v78
    v_mul_f32 v43, v43, v78
    v_mul_f32 v44, v44, v78
    v_mul_f32 v45, v45, v78
    v_mul_f32 v46, v46, v78
    v_mul_f32 v47, v47, v78
    v_cvt_pk_bf16_f32 v40, v40, v41
    v_cvt_pk_bf16_f32 v41, v42, v43
    v_cvt_pk_bf16_f32 v42, v44, v45
    v_cvt_pk_bf16_f32 v43, v46, v47
    buffer_store_dwordx4 v[40:43], v0, s[12:15], s34 offen offset:0 sc1
    v_mul_f32 v78, s46, v75
    v_fma_f32 v48, -v74, v24, v48
    v_fma_f32 v49, -v74, v25, v49
    v_fma_f32 v50, -v74, v26, v50
    v_fma_f32 v51, -v74, v27, v51
    v_fma_f32 v52, -v74, v28, v52
    v_fma_f32 v53, -v74, v29, v53
    v_fma_f32 v54, -v74, v30, v54
    v_fma_f32 v55, -v74, v31, v55
    ds_read_b128 v[24:27], v5 offset:54336
    ds_read_b128 v[28:31], v5 offset:54464
    v_mul_f32 v48, v48, v78
    v_mul_f32 v49, v49, v78
    v_mul_f32 v50, v50, v78
    v_mul_f32 v51, v51, v78
    v_mul_f32 v52, v52, v78
    v_mul_f32 v53, v53, v78
    v_mul_f32 v54, v54, v78
    v_mul_f32 v55, v55, v78
    v_cvt_pk_bf16_f32 v48, v48, v49
    v_cvt_pk_bf16_f32 v49, v50, v51
    v_cvt_pk_bf16_f32 v50, v52, v53
    v_cvt_pk_bf16_f32 v51, v54, v55
    buffer_store_dwordx4 v[48:51], v0, s[12:15], s34 offen offset:1024 sc1
    v_fma_f32 v56, -v32, v76, v56
    v_fma_f32 v57, -v33, v76, v57
    v_fma_f32 v58, -v34, v76, v58
    v_fma_f32 v59, -v35, v76, v59
    v_mul_f32 v56, v56, v36
    v_mul_f32 v57, v57, v37
    v_mul_f32 v58, v58, v38
    v_mul_f32 v59, v59, v39
    s_waitcnt lgkmcnt(1)
    v_fma_f32 v60, -v24, v76, v60
    v_fma_f32 v61, -v25, v76, v61
    v_fma_f32 v62, -v26, v76, v62
    v_fma_f32 v63, -v27, v76, v63
    s_waitcnt lgkmcnt(0)
    v_mul_f32 v60, v60, v28
    v_mul_f32 v61, v61, v29
    v_mul_f32 v62, v62, v30
    v_mul_f32 v63, v63, v31
    v_cvt_pk_bf16_f32 v56, v56, v57
    v_cvt_pk_bf16_f32 v57, v58, v59
    v_cvt_pk_bf16_f32 v58, v60, v61
    v_cvt_pk_bf16_f32 v59, v62, v63
    buffer_store_dwordx4 v[56:59], v0, s[12:15], s34 offen offset:2048 sc1
    v_fma_f32 v64, -v32, v77, v64
    v_fma_f32 v65, -v33, v77, v65
    v_fma_f32 v66, -v34, v77, v66
    v_fma_f32 v67, -v35, v77, v67
    v_mul_f32 v64, v64, v36
    v_mul_f32 v65, v65, v37
    v_mul_f32 v66, v66, v38
    v_mul_f32 v67, v67, v39
    v_fma_f32 v68, -v24, v77, v68
    v_fma_f32 v69, -v25, v77, v69
    v_fma_f32 v70, -v26, v77, v70
    v_fma_f32 v71, -v27, v77, v71
    v_mul_f32 v68, v68, v28
    v_mul_f32 v69, v69, v29
    v_mul_f32 v70, v70, v30
    v_mul_f32 v71, v71, v31
    v_cvt_pk_bf16_f32 v64, v64, v65
    v_cvt_pk_bf16_f32 v65, v66, v67
    v_cvt_pk_bf16_f32 v66, v68, v69
    v_cvt_pk_bf16_f32 v67, v70, v71
    buffer_store_dwordx4 v[64:67], v0, s[12:15], s34 offen offset:3072 sc1
    v_mfma_f32_16x16x32_bf16 v[24:27], a[0:3], v[8:11], 0
    ds_read_b128 v[16:19], v7 offset:0
    v_lshlrev_b32 v6, 3, v0
    v_and_b32 v6, 2047, v6
    v_mfma_f32_16x16x32_bf16 v[28:31], a[8:11], v[8:11], 0
    ds_read_b128 v[20:23], v7 offset:18432
    s_mov_b32 s34, 395264
    v_mfma_f32_16x16x32_bf16 v[32:35], a[0:3], v[12:15], 0
    buffer_load_dword v6, v6, s[12:15], s34 offen sc1
    v_mfma_f32_16x16x32_bf16 v[36:39], a[8:11], v[12:15], 0
    s_waitcnt lgkmcnt(1)
    v_mfma_f32_16x16x32_bf16 v[24:27], a[4:7], v[16:19], v[24:27]
    ds_read_b128 v[8:11], v3 offset:1024
    ds_write_b128 v4, v[40:43] offset:8192
    v_mfma_f32_16x16x32_bf16 v[28:31], a[12:15], v[16:19], v[28:31]
    ds_read_b128 v[12:15], v3 offset:19456
    s_waitcnt lgkmcnt(3)
    v_mfma_f32_16x16x32_bf16 v[32:35], a[4:7], v[20:23], v[32:35]
    v_mfma_f32_16x16x32_bf16 v[36:39], a[12:15], v[20:23], v[36:39]
    s_waitcnt lgkmcnt(2)
    v_mfma_f32_16x16x32_bf16 v[24:27], a[16:19], v[8:11], v[24:27]
    ds_read_b128 v[16:19], v7 offset:1024
    ds_write_b128 v4, v[48:51] offset:9216
    v_mfma_f32_16x16x32_bf16 v[28:31], a[24:27], v[8:11], v[28:31]
    ds_read_b128 v[20:23], v7 offset:19456
    s_waitcnt lgkmcnt(3)
    v_mfma_f32_16x16x32_bf16 v[32:35], a[16:19], v[12:15], v[32:35]
    v_mfma_f32_16x16x32_bf16 v[36:39], a[24:27], v[12:15], v[36:39]
    s_waitcnt lgkmcnt(2)
    v_mfma_f32_16x16x32_bf16 v[24:27], a[20:23], v[16:19], v[24:27]
    ds_read_b128 v[8:11], v3 offset:2048
    ds_write_b128 v4, v[56:59] offset:16384
    v_mfma_f32_16x16x32_bf16 v[28:31], a[28:31], v[16:19], v[28:31]
    ds_read_b128 v[12:15], v3 offset:20480
    s_waitcnt lgkmcnt(3)
    v_mfma_f32_16x16x32_bf16 v[32:35], a[20:23], v[20:23], v[32:35]
    v_mfma_f32_16x16x32_bf16 v[36:39], a[28:31], v[20:23], v[36:39]
    s_waitcnt lgkmcnt(2)
    v_mfma_f32_16x16x32_bf16 v[24:27], a[32:35], v[8:11], v[24:27]
    ds_read_b128 v[16:19], v7 offset:2048
    ds_write_b128 v4, v[64:67] offset:17408
    v_mfma_f32_16x16x32_bf16 v[28:31], a[40:43], v[8:11], v[28:31]
    ds_read_b128 v[20:23], v7 offset:20480
    s_waitcnt lgkmcnt(3)
    v_mfma_f32_16x16x32_bf16 v[32:35], a[32:35], v[12:15], v[32:35]
    v_mfma_f32_16x16x32_bf16 v[36:39], a[40:43], v[12:15], v[36:39]
    s_waitcnt lgkmcnt(2)
    v_mfma_f32_16x16x32_bf16 v[24:27], a[36:39], v[16:19], v[24:27]
    ds_read_b128 v[8:11], v3 offset:3072
    ds_read_b128 v[44:47], v79 offset:54528
    v_mfma_f32_16x16x32_bf16 v[28:31], a[44:47], v[16:19], v[28:31]
    ds_read_b128 v[12:15], v3 offset:21504
    s_waitcnt lgkmcnt(3)
    v_mfma_f32_16x16x32_bf16 v[32:35], a[36:39], v[20:23], v[32:35]
    v_mfma_f32_16x16x32_bf16 v[36:39], a[44:47], v[20:23], v[36:39]
    s_waitcnt lgkmcnt(2)
    v_mfma_f32_16x16x32_bf16 v[24:27], a[48:51], v[8:11], v[24:27]
    ds_read_b128 v[16:19], v7 offset:3072
    ds_read_b128 v[52:55], v79 offset:54592
    v_mfma_f32_16x16x32_bf16 v[28:31], a[56:59], v[8:11], v[28:31]
    ds_read_b128 v[20:23], v7 offset:21504
    s_waitcnt lgkmcnt(3)
    v_mfma_f32_16x16x32_bf16 v[32:35], a[48:51], v[12:15], v[32:35]
    v_mfma_f32_16x16x32_bf16 v[36:39], a[56:59], v[12:15], v[36:39]
    s_waitcnt lgkmcnt(2)
    v_mfma_f32_16x16x32_bf16 v[24:27], a[52:55], v[16:19], v[24:27]
    ds_read_b128 v[8:11], v3 offset:4096
    v_mfma_f32_16x16x32_bf16 v[28:31], a[60:63], v[16:19], v[28:31]
    ds_read_b128 v[12:15], v3 offset:22528
    s_waitcnt lgkmcnt(2)
    v_mfma_f32_16x16x32_bf16 v[32:35], a[52:55], v[20:23], v[32:35]
    v_mfma_f32_16x16x32_bf16 v[36:39], a[60:63], v[20:23], v[36:39]
    s_waitcnt lgkmcnt(1)
    v_mfma_f32_16x16x32_bf16 v[24:27], a[64:67], v[8:11], v[24:27]
    ds_read_b128 v[16:19], v7 offset:4096
    v_mfma_f32_16x16x32_bf16 v[28:31], a[72:75], v[8:11], v[28:31]
    ds_read_b128 v[20:23], v7 offset:22528
    s_waitcnt lgkmcnt(2)
    v_mfma_f32_16x16x32_bf16 v[32:35], a[64:67], v[12:15], v[32:35]
    v_mfma_f32_16x16x32_bf16 v[36:39], a[72:75], v[12:15], v[36:39]
    s_waitcnt lgkmcnt(1)
    v_mfma_f32_16x16x32_bf16 v[24:27], a[68:71], v[16:19], v[24:27]
    ds_read_b128 v[8:11], v3 offset:5120
    v_mfma_f32_16x16x32_bf16 v[28:31], a[76:79], v[16:19], v[28:31]
    ds_read_b128 v[12:15], v3 offset:23552
    s_waitcnt lgkmcnt(2)
    v_mfma_f32_16x16x32_bf16 v[32:35], a[68:71], v[20:23], v[32:35]
    v_mfma_f32_16x16x32_bf16 v[36:39], a[76:79], v[20:23], v[36:39]
    s_waitcnt lgkmcnt(1)
    v_mfma_f32_16x16x32_bf16 v[24:27], a[80:83], v[8:11], v[24:27]
    ds_read_b128 v[16:19], v7 offset:5120
    v_mfma_f32_16x16x32_bf16 v[28:31], a[88:91], v[8:11], v[28:31]
    ds_read_b128 v[20:23], v7 offset:23552
    s_waitcnt lgkmcnt(2)
    v_mfma_f32_16x16x32_bf16 v[32:35], a[80:83], v[12:15], v[32:35]
    v_mfma_f32_16x16x32_bf16 v[36:39], a[88:91], v[12:15], v[36:39]
    s_waitcnt lgkmcnt(1)
    v_mfma_f32_16x16x32_bf16 v[24:27], a[84:87], v[16:19], v[24:27]
    ds_read_b128 v[8:11], v3 offset:6144
    v_mfma_f32_16x16x32_bf16 v[28:31], a[92:95], v[16:19], v[28:31]
    ds_read_b128 v[12:15], v3 offset:24576
    s_waitcnt lgkmcnt(2)
    v_mfma_f32_16x16x32_bf16 v[32:35], a[84:87], v[20:23], v[32:35]
    v_mfma_f32_16x16x32_bf16 v[36:39], a[92:95], v[20:23], v[36:39]
    s_waitcnt lgkmcnt(1)
    v_mfma_f32_16x16x32_bf16 v[24:27], a[96:99], v[8:11], v[24:27]
    ds_read_b128 v[16:19], v7 offset:6144
    v_mfma_f32_16x16x32_bf16 v[28:31], a[104:107], v[8:11], v[28:31]
    ds_read_b128 v[20:23], v7 offset:24576
    s_waitcnt lgkmcnt(2)
    v_mfma_f32_16x16x32_bf16 v[32:35], a[96:99], v[12:15], v[32:35]
    s_lshl_b32 s35, s32, 6
    s_add_u32 s35, s35, s42
    s_add_u32 s35, s35, 1
    s_waitcnt vmcnt(0)
    v_cmp_gt_u32 vcc, s38, v6
    s_barrier
    s_cmp_lg_u32 s20, 0
    s_cbranch_scc1 L_s12
    v_mov_b32 v76, s35
    v_mov_b32 v77, 0
    s_mov_b64 exec, 1
    buffer_store_dword v76, v77, s[12:15], s47 offen sc1
    s_mov_b64 exec, -1
L_s12:
    s_cmp_lg_u32 s52, 0
    s_cbranch_scc1 L_hq10d
    s_cbranch_vccnz L_hq10d
    s_call_b64 s[50:51], L_hw_mreq
L_hq10d:
    v_mfma_f32_16x16x32_bf16 v[36:39], a[104:107], v[12:15], v[36:39]
    s_waitcnt lgkmcnt(1)
    v_mfma_f32_16x16x32_bf16 v[24:27], a[100:103], v[16:19], v[24:27]
    ds_read_b128 v[8:11], v3 offset:7168
    v_mfma_f32_16x16x32_bf16 v[28:31], a[108:111], v[16:19], v[28:31]
    ds_read_b128 v[12:15], v3 offset:25600
    s_waitcnt lgkmcnt(2)
    v_mfma_f32_16x16x32_bf16 v[32:35], a[100:103], v[20:23], v[32:35]
    v_mfma_f32_16x16x32_bf16 v[36:39], a[108:111], v[20:23], v[36:39]
    s_waitcnt lgkmcnt(1)
    v_mfma_f32_16x16x32_bf16 v[24:27], a[112:115], v[8:11], v[24:27]
    ds_read_b128 v[16:19], v7 offset:7168
    v_mfma_f32_16x16x32_bf16 v[28:31], a[120:123], v[8:11], v[28:31]
    ds_read_b128 v[20:23], v7 offset:25600
    s_waitcnt lgkmcnt(2)
    v_mfma_f32_16x16x32_bf16 v[32:35], a[112:115], v[12:15], v[32:35]
    v_mfma_f32_16x16x32_bf16 v[36:39], a[120:123], v[12:15], v[36:39]
    s_waitcnt lgkmcnt(1)
    v_mfma_f32_16x16x32_bf16 v[24:27], a[116:119], v[16:19], v[24:27]
    ds_read_b128 v[8:11], v3 offset:8192
    v_mfma_f32_16x16x32_bf16 v[28:31], a[124:127], v[16:19], v[28:31]
    ds_read_b128 v[12:15], v3 offset:26624
    s_waitcnt lgkmcnt(2)
    v_mfma_f32_16x16x32_bf16 v[32:35], a[116:119], v[20:23], v[32:35]
    v_mfma_f32_16x16x32_bf16 v[36:39], a[124:127], v[20:23], v[36:39]
    s_waitcnt lgkmcnt(1)
    v_mfma_f32_16x16x32_bf16 v[24:27], a[128:131], v[8:11], v[24:27]
    ds_read_b128 v[16:19], v7 offset:8192
    v_mfma_f32_16x16x32_bf16 v[28:31], a[136:139], v[8:11], v[28:31]
    ds_read_b128 v[20:23], v7 offset:26624
    s_waitcnt lgkmcnt(2)
    v_mfma_f32_16x16x32_bf16 v[32:35], a[128:131], v[12:15], v[32:35]
    v_mfma_f32_16x16x32_bf16 v[36:39], a[136:139], v[12:15], v[36:39]
    s_waitcnt lgkmcnt(1)
    v_mfma_f32_16x16x32_bf16 v[24:27], a[132:135], v[16:19], v[24:27]
    v_mfma_f32_16x16x32_bf16 v[28:31], a[140:143], v[16:19], v[28:31]
    s_waitcnt lgkmcnt(0)
    v_mfma_f32_16x16x32_bf16 v[32:35], a[132:135], v[20:23], v[32:35]
    v_mfma_f32_16x16x32_bf16 v[36:39], a[140:143], v[20:23], v[36:39]
    v_fma_f32 v24, -v72, v44, v24
    v_fma_f32 v25, -v72, v45, v25
    v_fma_f32 v26, -v72, v46, v26
    v_fma_f32 v27, -v72, v47, v27
    v_fma_f32 v28, -v72, v52, v28
    v_fma_f32 v29, -v72, v53, v29
    v_fma_f32 v30, -v72, v54, v30
    v_fma_f32 v31, -v72, v55, v31
    v_mul_f32 v24, v24, v73
    v_mul_f32 v25, v25, v73
    v_mul_f32 v26, v26, v73
    v_mul_f32 v27, v27, v73
    v_mul_f32 v28, v28, v73
    v_mul_f32 v29, v29, v73
    v_mul_f32 v30, v30, v73
    v_mul_f32 v31, v31, v73
    v_cvt_pk_bf16_f32 v24, v24, v25
    v_cvt_pk_bf16_f32 v25, v26, v27
    v_cvt_pk_bf16_f32 v26, v28, v29
    v_cvt_pk_bf16_f32 v27, v30, v31
    ds_write_b128 v4, v[24:27] offset:0
    v_fma_f32 v32, -v74, v44, v32
    v_fma_f32 v33, -v74, v45, v33
    v_fma_f32 v34, -v74, v46, v34
    v_fma_f32 v35, -v74, v47, v35
    v_fma_f32 v36, -v74, v52, v36
    v_fma_f32 v37, -v74, v53, v37
    v_fma_f32 v38, -v74, v54, v38
    v_fma_f32 v39, -v74, v55, v39
    v_mul_f32 v32, v32, v75
    v_mul_f32 v33, v33, v75
    v_mul_f32 v34, v34, v75
    v_mul_f32 v35, v35, v75
    v_mul_f32 v36, v36, v75
    v_mul_f32 v37, v37, v75
    v_mul_f32 v38, v38, v75
    v_mul_f32 v39, v39, v75
    v_cvt_pk_bf16_f32 v32, v32, v33
    v_cvt_pk_bf16_f32 v33, v34, v35
    v_cvt_pk_bf16_f32 v34, v36, v37
    v_cvt_pk_bf16_f32 v35, v38, v39
    ds_write_b128 v4, v[32:35] offset:1024
    s_waitcnt lgkmcnt(0)
    s_barrier
    s_add_u32 s42, s42, 3
    s_add_u32 s44, s44, 24576
    s_cmp_eq_u32 s44, 131072
    s_cselect_b32 s44, 57344, s44
    s_sub_u32 s34, s42, s43
    s_cmp_lt_u32 s34, 9
    s_cbranch_scc1 L_hw_first
L_hw_f:
    s_and_b32 s34, s20, 1
    s_lshl_b32 s34, s34, 10
    s_add_u32 s34, s34, s45
    v_add_u32 v6, s34, v0
    v_add_u32 v7, s45, v0
    ds_read_b128 v[48:51], v6 offset:0
    ds_read_b128 v[8:11], v7 offset:8192
    ds_read_b128 v[24:27], v7 offset:9216
    ds_read_b128 v[52:55], v6 offset:2048
    ds_read_b128 v[12:15], v7 offset:10240
    ds_read_b128 v[28:31], v7 offset:11264
    ds_read_b128 v[56:59], v6 offset:4096
    ds_read_b128 v[16:19], v7 offset:12288
    ds_read_b128 v[32:35], v7 offset:13312
    ds_read_b128 v[60:63], v6 offset:6144
    ds_read_b128 v[20:23], v7 offset:14336
    ds_read_b128 v[36:39], v7 offset:15360
    s_lshl_b32 s38, s32, 6
    s_add_u32 s38, s38, s43
    s_add_u32 s38, s38, 1
    s_mov_b32 s34, 395264
    v_lshlrev_b32 v5, 3, v0
    v_and_b32 v5, 2047, v5
    s_cmp_lg_u32 s52, 0
    s_cbranch_scc1 L_hf13
    v_mov_b32 v4, v5
L_w14:
    buffer_load_dword v5, v4, s[12:15], s34 offen sc1
    s_add_u32 s37, s37, 1
    s_waitcnt vmcnt(0)
    v_cmp_gt_u32 vcc, s38, v5
    s_nop 0
    s_cbranch_vccz L_w14_d
    s_sleep 1
    s_cmp_lt_u32 s37, 400000
    s_cbranch_scc1 L_w14
L_w14_d:
    s_call_b64 s[50:51], L_hw_mreq
L_hf13:
    s_mov_b32 s52, 0
    s_mov_b32 s49, s38
    s_waitcnt lgkmcnt(10)
    v_mfma_f32_16x16x32_bf16 v[64:67], v[8:11], v[48:51], 0
    s_lshl_b32 s53, s43, 1
    s_and_b32 s35, s20, 1
    s_add_u32 s53, s53, s35
    s_waitcnt lgkmcnt(9)
    v_mfma_f32_16x16x32_bf16 v[68:71], v[24:27], v[48:51], 0
    s_lshl_b32 s53, s53, 5
    s_add_u32 s53, s53, s40
    s_lshl_b32 s53, s53, 12
    s_waitcnt lgkmcnt(7)
    v_mfma_f32_16x16x32_bf16 v[64:67], v[12:15], v[52:55], v[64:67]
    s_lshr_b32 s34, s20, 1
    s_lshl_b32 s34, s34, 11
    s_add_u32 s53, s53, s34
    s_waitcnt lgkmcnt(6)
    v_mfma_f32_16x16x32_bf16 v[68:71], v[28:31], v[52:55], v[68:71]
    s_mul_i32 s35, s32, 16777216
    s_add_u32 s53, s53, s35
    s_add_u32 s53, s53, 28147712
    s_waitcnt lgkmcnt(4)
    v_mfma_f32_16x16x32_bf16 v[64:67], v[16:19], v[56:59], v[64:67]
    v_add_u32 v78, s34, v0
    s_lshl_b32 s34, s34, 1
    v_add_u32 v7, s34, v7
    s_waitcnt lgkmcnt(3)
    v_mfma_f32_16x16x32_bf16 v[68:71], v[32:35], v[56:59], v[68:71]
    s_lshl_b32 s34, s20, 10
    v_add_u32 v6, s34, v0
    v_mov_b32 v79, 0xff800000
    s_waitcnt lgkmcnt(1)
    v_mfma_f32_16x16x32_bf16 v[64:67], v[20:23], v[60:63], v[64:67]
    s_waitcnt lgkmcnt(0)
    v_mfma_f32_16x16x32_bf16 v[68:71], v[36:39], v[60:63], v[68:71]
    s_cmp_lt_u32 s42, 64
    s_cbranch_scc1 L_hf13p
    s_waitcnt vmcnt(0)
    s_branch L_hf13q
L_hf13p:
    s_call_b64 s[50:51], L_hw_pre
    s_waitcnt vmcnt(9)
L_hf13q:
    s_barrier
    ds_read_b128 v[8:11], v2 offset:0
    ds_read_b128 v[12:15], v2 offset:512
    ds_read_b128 v[16:19], v2 offset:1024
    s_waitcnt lgkmcnt(2)
    v_mfma_f32_16x16x32_bf16 v[24:27], a[144:147], v[8:11], 0
    ds_read_b128 v[20:23], v2 offset:1536
    v_cndmask_b32 v64, v79, v64, s[66:67]
    v_cndmask_b32 v65, v79, v65, s[68:69]
    v_mfma_f32_16x16x32_bf16 v[28:31], a[152:155], v[8:11], 0
    s_waitcnt lgkmcnt(2)
    v_cndmask_b32 v66, v79, v66, s[70:71]
    v_cndmask_b32 v67, v79, v67, s[72:73]
    v_mfma_f32_16x16x32_bf16 v[24:27], a[148:151], v[12:15], v[24:27]
    ds_read_b128 v[8:11], v2 offset:2048
    v_cndmask_b32 v68, v79, v68, s[74:75]
    v_cndmask_b32 v69, v79, v69, s[76:77]
    v_mfma_f32_16x16x32_bf16 v[28:31], a[156:159], v[12:15], v[28:31]
    s_waitcnt lgkmcnt(2)
    v_cndmask_b32 v70, v79, v70, s[78:79]
    v_cndmask_b32 v71, v79, v71, s[80:81]
    v_mfma_f32_16x16x32_bf16 v[24:27], a[160:163], v[16:19], v[24:27]
    ds_read_b128 v[12:15], v2 offset:2560
    v_max3_f32 v76, v64, v65, v66
    v_max3_f32 v76, v76, v67, v68
    v_mfma_f32_16x16x32_bf16 v[28:31], a[168:171], v[16:19], v[28:31]
    s_waitcnt lgkmcnt(2)
    v_max3_f32 v76, v76, v69, v70
    v_max_f32 v76, v76, v71
    v_mfma_f32_16x16x32_bf16 v[24:27], a[164:167], v[20:23], v[24:27]
    ds_read_b128 v[16:19], v2 offset:3072
    v_cmp_gt_u32 vcc, 512, v0
    v_mfma_f32_16x16x32_bf16 v[28:31], a[172:175], v[20:23], v[28:31]
    s_waitcnt lgkmcnt(2)
    v_mfma_f32_16x16x32_bf16 v[24:27], a[176:179], v[8:11], v[24:27]
    ds_read_b128 v[20:23], v2 offset:3584
    v_mfma_f32_16x16x32_bf16 v[28:31], a[184:187], v[8:11], v[28:31]
    s_waitcnt lgkmcnt(2)
    v_mfma_f32_16x16x32_bf16 v[24:27], a[180:183], v[12:15], v[24:27]
    ds_read_b128 v[8:11], v2 offset:4096
    v_mfma_f32_16x16x32_bf16 v[28:31], a[188:191], v[12:15], v[28:31]
    s_waitcnt lgkmcnt(2)
    v_mfma_f32_16x16x32_bf16 v[24:27], a[192:195], v[16:19], v[24:27]
    ds_read_b128 v[12:15], v2 offset:4608
    v_mfma_f32_16x16x32_bf16 v[28:31], a[200:203], v[16:19], v[28:31]
    s_waitcnt lgkmcnt(2)
    v_mfma_f32_16x16x32_bf16 v[24:27], a[196:199], v[20:23], v[24:27]
    ds_read_b128 v[16:19], v2 offset:5120
    v_mfma_f32_16x16x32_bf16 v[28:31], a[204:207], v[20:23], v[28:31]
    s_waitcnt lgkmcnt(2)
    v_mfma_f32_16x16x32_bf16 v[24:27], a[208:211], v[8:11], v[24:27]
    ds_read_b128 v[20:23], v2 offset:5632
    v_mfma_f32_16x16x32_bf16 v[28:31], a[216:219], v[8:11], v[28:31]
    s_waitcnt lgkmcnt(2)
    v_mfma_f32_16x16x32_bf16 v[24:27], a[212:215], v[12:15], v[24:27]
    ds_read_b128 v[8:11], v2 offset:6144
    v_mfma_f32_16x16x32_bf16 v[28:31], a[220:223], v[12:15], v[28:31]
    s_waitcnt lgkmcnt(2)
    v_mfma_f32_16x16x32_bf16 v[24:27], a[224:227], v[16:19], v[24:27]
    ds_read_b128 v[12:15], v2 offset:6656
    v_mfma_f32_16x16x32_bf16 v[28:31], a[232:235], v[16:19], v[28:31]
    s_waitcnt lgkmcnt(2)
    v_mfma_f32_16x16x32_bf16 v[24:27], a[228:231], v[20:23], v[24:27]
    ds_read_b128 v[16:19], v2 offset:7168
    v_mfma_f32_16x16x32_bf16 v[28:31], a[236:239], v[20:23], v[28:31]
    s_waitcnt lgkmcnt(2)
    v_mfma_f32_16x16x32_bf16 v[24:27], a[240:243], v[8:11], v[24:27]
    ds_read_b128 v[20:23], v2 offset:7680
    v_mfma_f32_16x16x32_bf16 v[28:31], a[248:251], v[8:11], v[28:31]
    s_waitcnt lgkmcnt(2)
    v_mfma_f32_16x16x32_bf16 v[24:27], a[244:247], v[12:15], v[24:27]
    ds_read_b128 v[8:11], v2 offset:8192
    v_mfma_f32_16x16x32_bf16 v[28:31], a[252:255], v[12:15], v[28:31]
    s_waitcnt lgkmcnt(2)
    v_mfma_f32_16x16x32_bf16 v[24:27], v[80:83], v[16:19], v[24:27]
    ds_read_b128 v[12:15], v2 offset:8704
    v_mfma_f32_16x16x32_bf16 v[28:31], v[88:91], v[16:19], v[28:31]
    s_waitcnt lgkmcnt(2)
    v_mfma_f32_16x16x32_bf16 v[24:27], v[84:87], v[20:23], v[24:27]
    ds_read_b128 v[16:19], v2 offset:0
    v_mfma_f32_16x16x32_bf16 v[28:31], v[92:95], v[20:23], v[28:31]
    s_waitcnt lgkmcnt(2)
    v_mfma_f32_16x16x32_bf16 v[24:27], v[96:99], v[8:11], v[24:27]
    ds_read_b128 v[20:23], v2 offset:512
    v_mfma_f32_16x16x32_bf16 v[28:31], v[104:107], v[8:11], v[28:31]
    s_waitcnt lgkmcnt(2)
    v_mfma_f32_16x16x32_bf16 v[24:27], v[100:103], v[12:15], v[24:27]
    ds_read_b128 v[8:11], v2 offset:1024
    v_mfma_f32_16x16x32_bf16 v[28:31], v[108:111], v[12:15], v[28:31]
    s_waitcnt lgkmcnt(2)
    v_mfma_f32_16x16x32_bf16 v[32:35], v[16:19], v[112:115], 0
    ds_read_b128 v[12:15], v2 offset:1536
    v_mfma_f32_16x16x32_bf16 v[36:39], v[16:19], v[120:123], 0
    s_waitcnt lgkmcnt(2)
    v_mul_f32 v24, s46, v24
    v_mul_f32 v25, s46, v25
    v_mfma_f32_16x16x32_bf16 v[32:35], v[20:23], v[116:119], v[32:35]
    ds_read_b128 v[16:19], v2 offset:2048
    v_mul_f32 v26, s46, v26
    v_mul_f32 v27, s46, v27
    v_mfma_f32_16x16x32_bf16 v[36:39], v[20:23], v[124:127], v[36:39]
    s_waitcnt lgkmcnt(2)
    v_mul_f32 v28, s46, v28
    v_mul_f32 v29, s46, v29
    v_mfma_f32_16x16x32_bf16 v[32:35], v[8:11], v[128:131], v[32:35]
    ds_read_b128 v[20:23], v2 offset:2560
    v_mul_f32 v30, s46, v30
    v_mul_f32 v31, s46, v31
    v_mfma_f32_16x16x32_bf16 v[36:39], v[8:11], v[136:139], v[36:39]
    s_waitcnt lgkmcnt(2)
    v_cvt_pk_bf16_f32 v24, v24, v25
    v_cvt_pk_bf16_f32 v25, v26, v27
    v_mfma_f32_16x16x32_bf16 v[32:35], v[12:15], v[132:135], v[32:35]
    ds_read_b128 v[8:11], v2 offset:3072
    v_cvt_pk_bf16_f32 v26, v28, v29
    v_cvt_pk_bf16_f32 v27, v30, v31
    v_mfma_f32_16x16x32_bf16 v[36:39], v[12:15], v[140:143], v[36:39]
    s_waitcnt lgkmcnt(2)
    ds_write_b128 v6, v[24:27] offset:46080
    v_mfma_f32_16x16x32_bf16 v[32:35], v[16:19], v[144:147], v[32:35]
    ds_read_b128 v[12:15], v2 offset:3584
    v_mfma_f32_16x16x32_bf16 v[36:39], v[16:19], v[152:155], v[36:39]
    s_waitcnt lgkmcnt(3)
    v_mfma_f32_16x16x32_bf16 v[32:35], v[20:23], v[148:151], v[32:35]
    ds_read_b128 v[16:19], v2 offset:4096
    v_mfma_f32_16x16x32_bf16 v[36:39], v[20:23], v[156:159], v[36:39]
    s_waitcnt lgkmcnt(3)
    v_mfma_f32_16x16x32_bf16 v[32:35], v[8:11], v[160:163], v[32:35]
    ds_read_b128 v[20:23], v2 offset:4608
    s_waitcnt lgkmcnt(3)
    s_barrier
    ds_read_b128 v[24:27], v0 offset:46080
    v_mfma_f32_16x16x32_bf16 v[36:39], v[8:11], v[168:171], v[36:39]
    s_waitcnt lgkmcnt(3)
    ds_read_b128 v[28:31], v0 offset:47104
    v_mfma_f32_16x16x32_bf16 v[32:35], v[12:15], v[164:167], v[32:35]
    ds_read_b128 v[8:11], v2 offset:5120
    ds_read_b128 v[40:43], v0 offset:48128
    v_mfma_f32_16x16x32_bf16 v[36:39], v[12:15], v[172:175], v[36:39]
    s_waitcnt lgkmcnt(5)
    ds_read_b128 v[44:47], v0 offset:49152
    v_mfma_f32_16x16x32_bf16 v[32:35], v[16:19], v[176:179], v[32:35]
    ds_read_b128 v[12:15], v2 offset:5632
    v_mfma_f32_16x16x32_bf16 v[36:39], v[16:19], v[184:187], v[36:39]
    s_waitcnt lgkmcnt(6)
    v_mfma_f32_16x16x32_bf16 v[32:35], v[20:23], v[180:183], v[32:35]
    ds_read_b128 v[16:19], v2 offset:6144
    v_mfma_f32_16x16x32_bf16 v[36:39], v[20:23], v[188:191], v[36:39]
    s_waitcnt lgkmcnt(4)
    v_mfma_f32_16x16x32_bf16 v[72:75], v[24:27], v[48:51], 0
    v_mfma_f32_16x16x32_bf16 v[72:75], v[28:31], v[52:55], v[72:75]
    s_waitcnt lgkmcnt(3)
    v_mfma_f32_16x16x32_bf16 v[72:75], v[40:43], v[56:59], v[72:75]
    s_waitcnt lgkmcnt(2)
    v_mfma_f32_16x16x32_bf16 v[72:75], v[44:47], v[60:63], v[72:75]
    ds_read_b128 v[24:27], v7 offset:16384
    ds_read_b128 v[28:31], v7 offset:17408
    v_mfma_f32_16x16x32_bf16 v[32:35], v[8:11], v[192:195], v[32:35]
    ds_read_b128 v[20:23], v2 offset:6656
    ds_read_b128 v[40:43], v7 offset:18432
    ds_read_b128 v[44:47], v7 offset:19456
    v_mfma_f32_16x16x32_bf16 v[36:39], v[8:11], v[200:203], v[36:39]
    s_waitcnt lgkmcnt(6)
    v_cndmask_b32 v72, v79, v72, vcc
    v_cndmask_b32 v73, v79, v73, vcc
    v_mfma_f32_16x16x32_bf16 v[32:35], v[12:15], v[196:199], v[32:35]
    ds_read_b128 v[8:11], v2 offset:7168
    v_cndmask_b32 v74, v79, v74, vcc
    v_cndmask_b32 v75, v79, v75, vcc
    v_mfma_f32_16x16x32_bf16 v[36:39], v[12:15], v[204:207], v[36:39]
    s_waitcnt lgkmcnt(6)
    v_max3_f32 v76, v76, v72, v73
    v_max3_f32 v76, v76, v74, v75
    v_mfma_f32_16x16x32_bf16 v[32:35], v[16:19], v[208:211], v[32:35]
    ds_read_b128 v[12:15], v2 offset:7680
    v_mov_b32 v77, v76
    v_mfma_f32_16x16x32_bf16 v[36:39], v[16:19], v[216:219], v[36:39]
    s_waitcnt lgkmcnt(4)
    v_permlane16_swap_b32 v76, v77
    v_max_f32 v76, v76, v77
    v_mfma_f32_16x16x32_bf16 v[32:35], v[20:23], v[212:215], v[32:35]
    ds_read_b128 v[16:19], v2 offset:8192
    v_mov_b32 v77, v76
    v_mfma_f32_16x16x32_bf16 v[36:39], v[20:23], v[220:223], v[36:39]
    s_waitcnt lgkmcnt(2)
    v_permlane32_swap_b32 v76, v77
    v_max_f32 v76, v76, v77
    v_mfma_f32_16x16x32_bf16 v[32:35], v[8:11], v[224:227], v[32:35]
    ds_read_b128 v[20:23], v2 offset:8704
    v_sub_f32 v64, v64, v76
    v_sub_f32 v65, v65, v76
    v_mfma_f32_16x16x32_bf16 v[36:39], v[8:11], v[232:235], v[36:39]
    s_waitcnt lgkmcnt(2)
    v_sub_f32 v66, v66, v76
    v_sub_f32 v67, v67, v76
    v_mfma_f32_16x16x32_bf16 v[32:35], v[12:15], v[228:231], v[32:35]
    v_sub_f32 v68, v68, v76
    v_sub_f32 v69, v69, v76
    v_mfma_f32_16x16x32_bf16 v[36:39], v[12:15], v[236:239], v[36:39]
    s_waitcnt lgkmcnt(1)
    v_sub_f32 v70, v70, v76
    v_sub_f32 v71, v71, v76
    v_mfma_f32_16x16x32_bf16 v[32:35], v[16:19], v[240:243], v[32:35]
    v_sub_f32 v72, v72, v76
    v_sub_f32 v73, v73, v76
    v_mfma_f32_16x16x32_bf16 v[36:39], v[16:19], v[248:251], v[36:39]
    s_waitcnt lgkmcnt(0)
    v_sub_f32 v74, v74, v76
    v_sub_f32 v75, v75, v76
    v_mfma_f32_16x16x32_bf16 v[32:35], v[20:23], v[244:247], v[32:35]
    v_mfma_f32_16x16x32_bf16 v[36:39], v[20:23], v[252:255], v[36:39]
    v_exp_f32 v64, v64
    v_exp_f32 v65, v65
    v_exp_f32 v66, v66
    v_exp_f32 v67, v67
    v_cvt_pk_bf16_f32 v32, v32, v33
    v_cvt_pk_bf16_f32 v33, v34, v35
    v_cvt_pk_bf16_f32 v34, v36, v37
    v_cvt_pk_bf16_f32 v35, v38, v39
    ds_write_b128 v6, v[32:35] offset:50176
    v_exp_f32 v68, v68
    v_exp_f32 v69, v69
    v_exp_f32 v70, v70
    v_exp_f32 v71, v71
    v_exp_f32 v72, v72
    v_exp_f32 v73, v73
    v_exp_f32 v74, v74
    v_exp_f32 v75, v75
    v_pk_add_f32 v[76:77], v[64:65], v[66:67]
    v_pk_add_f32 v[76:77], v[76:77], v[68:69]
    v_pk_add_f32 v[76:77], v[76:77], v[70:71]
    v_pk_add_f32 v[76:77], v[76:77], v[72:73]
    v_pk_add_f32 v[76:77], v[76:77], v[74:75]
    s_waitcnt lgkmcnt(0)
    s_barrier
    ds_read_b128 v[8:11], v78 offset:50176
    ds_read_b128 v[12:15], v78 offset:51200
    v_add_f32 v76, v76, v77
    v_cvt_pk_bf16_f32 v64, v64, v65
    v_cvt_pk_bf16_f32 v65, v66, v67
    v_cvt_pk_bf16_f32 v66, v68, v69
    v_cvt_pk_bf16_f32 v67, v70, v71
    v_cvt_pk_bf16_f32 v68, v72, v73
    v_cvt_pk_bf16_f32 v69, v74, v75
    v_mfma_f32_16x16x32_bf16 v[48:51], v[24:27], v[64:67], 0
    v_mov_b32 v77, v76
    v_mfma_f32_16x16x32_bf16 v[52:55], v[28:31], v[64:67], 0
    s_nop 0
    v_permlane16_swap_b32 v76, v77
    v_add_f32 v76, v76, v77
    v_mfma_f32_16x16x32_bf16 v[56:59], v[40:43], v[64:67], 0
    v_mov_b32 v77, v76
    v_mfma_f32_16x16x32_bf16 v[60:63], v[44:47], v[64:67], 0
    s_nop 0
    v_permlane32_swap_b32 v76, v77
    v_add_f32 v76, v76, v77
    s_waitcnt lgkmcnt(1)
    v_mfma_f32_16x16x16_bf16 v[48:51], v[8:9], v[68:69], v[48:51]
    v_rcp_f32 v76, v76
    v_mfma_f32_16x16x16_bf16 v[52:55], v[10:11], v[68:69], v[52:55]
    s_waitcnt lgkmcnt(0)
    v_mfma_f32_16x16x16_bf16 v[56:59], v[12:13], v[68:69], v[56:59]
    v_mfma_f32_16x16x16_bf16 v[60:63], v[14:15], v[68:69], v[60:63]
    v_mul_f32 v48, v48, v76
    v_mul_f32 v49, v49, v76
    v_mul_f32 v50, v50, v76
    v_mul_f32 v51, v51, v76
    v_mul_f32 v52, v52, v76
    v_mul_f32 v53, v53, v76
    v_mul_f32 v54, v54, v76
    v_mul_f32 v55, v55, v76
    v_cvt_pk_bf16_f32 v48, v48, v49
    v_cvt_pk_bf16_f32 v49, v50, v51
    v_cvt_pk_bf16_f32 v50, v52, v53
    v_cvt_pk_bf16_f32 v51, v54, v55
    buffer_store_dwordx4 v[48:51], v0, s[12:15], s53 offen offset:0 sc1
    v_mul_f32 v56, v56, v76
    v_mul_f32 v57, v57, v76
    v_mul_f32 v58, v58, v76
    v_mul_f32 v59, v59, v76
    v_mul_f32 v60, v60, v76
    v_mul_f32 v61, v61, v76
    v_mul_f32 v62, v62, v76
    v_mul_f32 v63, v63, v76
    v_cvt_pk_bf16_f32 v56, v56, v57
    v_cvt_pk_bf16_f32 v57, v58, v59
    v_cvt_pk_bf16_f32 v58, v60, v61
    v_cvt_pk_bf16_f32 v59, v62, v63
    buffer_store_dwordx4 v[56:59], v0, s[12:15], s53 offen offset:1024 sc1
    s_cmp_lt_u32 s42, 64
    s_cbranch_scc1 L_hf13z
    s_waitcnt vmcnt(0) lgkmcnt(0)
    s_barrier
    s_cmp_lg_u32 s20, 0
    s_cbranch_scc1 L_s15
    v_mov_b32 v4, s49
    v_mov_b32 v5, 0
    s_mov_b64 exec, 1
    buffer_store_dword v4, v5, s[12:15], s48 offen sc1
    s_mov_b64 exec, -1
L_s15:
    s_mov_b32 s49, 0
L_hf13z:
    s_add_u32 s43, s43, 3
    s_add_u32 s45, s45, 24576
    s_cmp_eq_u32 s45, 131072
    s_cselect_b32 s45, 57344, s45
    s_cmp_lt_u32 s43, 64
    s_cbranch_scc1 L_hw_loop
    s_add_u32 s32, s32, 1
    s_cmp_ge_u32 s32, 2
    s_cbranch_scc1 L_help
    s_add_u32 s16, s88, 4030464
    s_addc_u32 s17, s89, 0
    s_mov_b32 s18, 2359296
    s_mov_b32 s19, 0x20000
    s_branch L_hw_layer
L_hw_pre:
    s_cmp_eq_u32 s32, 0
    s_cbranch_scc1 L_hp16
    s_lshl_b32 s38, s42, 1
    s_lshr_b32 s34, s20, 1
    s_add_u32 s38, s38, s34
    s_mul_i32 s34, s38, 3121
    s_lshr_b32 s34, s34, 16
    s_mul_i32 s34, s34, 21
    s_sub_u32 s34, s38, s34
    s_mul_i32 s34, s34, 12
    s_lshl_b32 s34, s34, 5
    s_add_u32 s34, s34, 446464
    s_add_u32 s38, s38, 1
    v_lshrrev_b32 v4, 2, v0
    v_min_u32 v4, 8, v4
    v_lshlrev_b32 v4, 5, v4
L_w17:
    buffer_load_dword v5, v4, s[12:15], s34 offen sc1
    s_add_u32 s37, s37, 1
    s_waitcnt vmcnt(0)
    v_cmp_gt_u32 vcc, s38, v5
    s_nop 0
    s_cbranch_vccz L_w17_d
    s_sleep 1
    s_cmp_lt_u32 s37, 400000
    s_cbranch_scc1 L_w17
L_w17_d:
L_hp16:
    s_mul_i32 s34, s42, 36864
    s_mul_i32 s35, s20, 9216
    s_add_u32 m0, s35, 0
    s_nop 0
    buffer_load_dwordx4 v1, s[16:19], s34 offen offset:0 sc1 lds
    s_add_u32 m0, s35, 896
    s_nop 0
    buffer_load_dwordx4 v1, s[16:19], s34 offen offset:128 sc1 lds
    s_add_u32 m0, s35, 1792
    s_nop 0
    buffer_load_dwordx4 v1, s[16:19], s34 offen offset:256 sc1 lds
    s_add_u32 m0, s35, 2688
    s_nop 0
    buffer_load_dwordx4 v1, s[16:19], s34 offen offset:384 sc1 lds
    s_add_u32 m0, s35, 3584
    s_nop 0
    buffer_load_dwordx4 v1, s[16:19], s34 offen offset:512 sc1 lds
    s_add_u32 m0, s35, 4480
    s_nop 0
    buffer_load_dwordx4 v1, s[16:19], s34 offen offset:640 sc1 lds
    s_add_u32 m0, s35, 5376
    s_nop 0
    buffer_load_dwordx4 v1, s[16:19], s34 offen offset:768 sc1 lds
    s_add_u32 m0, s35, 6272
    s_nop 0
    buffer_load_dwordx4 v1, s[16:19], s34 offen offset:896 sc1 lds
    s_add_u32 m0, s35, 7168
    s_nop 0
    buffer_load_dwordx4 v1, s[16:19], s34 offen offset:1024 sc1 lds
    s_setpc_b64 s[50:51]
L_hw_mreq:
    s_sub_u32 s35, s38, 1
    s_mul_i32 s35, s35, 9216
    s_lshl_b32 s36, s20, 10
    s_add_u32 s35, s35, s36
    s_add_u32 s35, s35, 491520
    s_add_u32 m0, s36, 36864
    s_nop 0
    buffer_load_dwordx4 v0, s[12:15], s35 offen sc1 lds
    s_add_u32 s35, s35, 4096
    s_add_u32 m0, s36, 40960
    s_nop 0
    buffer_load_dwordx4 v0, s[12:15], s35 offen sc1 lds
    s_mov_b32 s52, 1
    s_cmp_lg_u32 s20, 0
    s_cbranch_scc1 L_hw_mreq1
    s_add_u32 s35, s35, 4096
    s_mov_b32 m0, 45056
    s_nop 0
    buffer_load_dwordx4 v0, s[12:15], s35 offen sc1 lds
L_hw_mreq1:
    s_setpc_b64 s[50:51]
L_ow:
L_i18:
    v_mov_b32 v4, 0
    global_load_dword v5, v4, s[86:87] offset:12 sc1
    global_load_dword v4, v4, s[86:87] offset:128 sc1
    s_add_u32 s37, s37, 1
    s_waitcnt vmcnt(0)
    v_min_u32 v5, 32, v5
    v_min_u32 v4, 224, v4
    v_add_u32 v5, v5, v4
    v_cmp_gt_u32 vcc, 256, v5
    s_nop 0
    s_cbranch_vccz L_i18_d
    s_sleep 4
    s_cmp_lt_u32 s37, 400000
    s_cbranch_scc1 L_i18
L_i18_d:
    s_mov_b32 s34, 397312
    s_mov_b32 s38, 1
    v_mov_b32 v4, 0
L_w19:
    buffer_load_dword v5, v4, s[12:15], s34 offen sc1
    s_add_u32 s37, s37, 1
    s_waitcnt vmcnt(0)
    v_cmp_gt_u32 vcc, s38, v5
    s_nop 0
    s_cbranch_vccz L_w19_d
    s_sleep 8
    s_cmp_lt_u32 s37, 400000
    s_cbranch_scc1 L_w19
L_w19_d:
    s_cmp_ge_u32 s21, 24
    s_cselect_b32 s40, 1, 0
    s_mul_i32 s34, s40, 24
    s_sub_u32 s34, s21, s34
    s_lshl_b32 s43, s40, 5
    s_add_u32 s43, s43, s34
    s_lshl_b32 s43, s43, 2
    s_lshl_b32 s43, s43, 5
    s_add_u32 s43, s43, 421888
    s_cmp_ge_u32 s34, 12
    s_cselect_b32 s41, 1, 0
    s_mul_i32 s35, s41, 12
    s_sub_u32 s42, s34, s35
    s_mul_i32 s35, s42, 96
    s_mul_i32 s34, s20, 1179648
    s_add_u32 s35, s35, s34
    s_mov_b32 s28, s74
    s_mov_b32 s29, s75
    s_mov_b32 s30, 4718592
    s_mov_b32 s31, 0x20000
    v_and_b32 v4, 63, v0
    v_add_u32 v4, 0, v4
    v_mul_u32_u24 v5, 10923, v4
    v_lshrrev_b32 v5, 16, v5
    v_mul_u32_u24 v6, 6, v5
    v_sub_u32 v4, v4, v6
    v_mul_u32_u24 v5, 1152, v5
    v_lshl_add_u32 v5, v4, 4, v5
    v_add_u32 v8, s35, v5
    v_and_b32 v4, 63, v0
    v_add_u32 v4, 64, v4
    v_mul_u32_u24 v5, 10923, v4
    v_lshrrev_b32 v5, 16, v5
    v_mul_u32_u24 v6, 6, v5
    v_sub_u32 v4, v4, v6
    v_mul_u32_u24 v5, 1152, v5
    v_lshl_add_u32 v5, v4, 4, v5
    v_add_u32 v9, s35, v5
    v_and_b32 v4, 63, v0
    v_add_u32 v4, 128, v4
    v_mul_u32_u24 v5, 10923, v4
    v_lshrrev_b32 v5, 16, v5
    v_mul_u32_u24 v6, 6, v5
    v_sub_u32 v4, v4, v6
    v_mul_u32_u24 v5, 1152, v5
    v_lshl_add_u32 v5, v4, 4, v5
    v_add_u32 v10, s35, v5
    s_mul_i32 s36, s20, 36864
    v_and_b32 v4, 63, v0
    v_lshrrev_b32 v5, 2, v4
    v_mul_u32_u24 v5, 96, v5
    v_and_b32 v4, 3, v4
    v_lshl_add_u32 v5, v4, 3, v5
    v_add_u32 v12, s36, v5
    s_mov_b32 s34, 0
    s_add_u32 m0, s36, 0
    s_nop 0
    buffer_load_dwordx4 v8, s[28:31], s34 offen lds
    s_add_u32 m0, s36, 1024
    s_nop 0
    buffer_load_dwordx4 v9, s[28:31], s34 offen lds
    s_add_u32 m0, s36, 2048
    s_nop 0
    buffer_load_dwordx4 v10, s[28:31], s34 offen lds
    s_mov_b32 s34, 36864
    s_add_u32 m0, s36, 3072
    s_nop 0
    buffer_load_dwordx4 v8, s[28:31], s34 offen lds
    s_add_u32 m0, s36, 4096
    s_nop 0
    buffer_load_dwordx4 v9, s[28:31], s34 offen lds
    s_add_u32 m0, s36, 5120
    s_nop 0
    buffer_load_dwordx4 v10, s[28:31], s34 offen lds
    s_mov_b32 s34, 73728
    s_add_u32 m0, s36, 6144
    s_nop 0
    buffer_load_dwordx4 v8, s[28:31], s34 offen lds
    s_add_u32 m0, s36, 7168
    s_nop 0
    buffer_load_dwordx4 v9, s[28:31], s34 offen lds
    s_add_u32 m0, s36, 8192
    s_nop 0
    buffer_load_dwordx4 v10, s[28:31], s34 offen lds
    s_mov_b32 s34, 110592
    s_add_u32 m0, s36, 9216
    s_nop 0
    buffer_load_dwordx4 v8, s[28:31], s34 offen lds
    s_add_u32 m0, s36, 10240
    s_nop 0
    buffer_load_dwordx4 v9, s[28:31], s34 offen lds
    s_add_u32 m0, s36, 11264
    s_nop 0
    buffer_load_dwordx4 v10, s[28:31], s34 offen lds
    s_mov_b32 s34, 147456
    s_add_u32 m0, s36, 12288
    s_nop 0
    buffer_load_dwordx4 v8, s[28:31], s34 offen lds
    s_add_u32 m0, s36, 13312
    s_nop 0
    buffer_load_dwordx4 v9, s[28:31], s34 offen lds
    s_add_u32 m0, s36, 14336
    s_nop 0
    buffer_load_dwordx4 v10, s[28:31], s34 offen lds
    s_mov_b32 s34, 184320
    s_add_u32 m0, s36, 15360
    s_nop 0
    buffer_load_dwordx4 v8, s[28:31], s34 offen lds
    s_add_u32 m0, s36, 16384
    s_nop 0
    buffer_load_dwordx4 v9, s[28:31], s34 offen lds
    s_add_u32 m0, s36, 17408
    s_nop 0
    buffer_load_dwordx4 v10, s[28:31], s34 offen lds
    s_mov_b32 s34, 221184
    s_add_u32 m0, s36, 18432
    s_nop 0
    buffer_load_dwordx4 v8, s[28:31], s34 offen lds
    s_add_u32 m0, s36, 19456
    s_nop 0
    buffer_load_dwordx4 v9, s[28:31], s34 offen lds
    s_add_u32 m0, s36, 20480
    s_nop 0
    buffer_load_dwordx4 v10, s[28:31], s34 offen lds
    s_mov_b32 s34, 258048
    s_add_u32 m0, s36, 21504
    s_nop 0
    buffer_load_dwordx4 v8, s[28:31], s34 offen lds
    s_add_u32 m0, s36, 22528
    s_nop 0
    buffer_load_dwordx4 v9, s[28:31], s34 offen lds
    s_add_u32 m0, s36, 23552
    s_nop 0
    buffer_load_dwordx4 v10, s[28:31], s34 offen lds
    s_mov_b32 s34, 294912
    s_add_u32 m0, s36, 24576
    s_nop 0
    buffer_load_dwordx4 v8, s[28:31], s34 offen lds
    s_add_u32 m0, s36, 25600
    s_nop 0
    buffer_load_dwordx4 v9, s[28:31], s34 offen lds
    s_add_u32 m0, s36, 26624
    s_nop 0
    buffer_load_dwordx4 v10, s[28:31], s34 offen lds
    s_mov_b32 s34, 331776
    s_add_u32 m0, s36, 27648
    s_nop 0
    buffer_load_dwordx4 v8, s[28:31], s34 offen lds
    s_add_u32 m0, s36, 28672
    s_nop 0
    buffer_load_dwordx4 v9, s[28:31], s34 offen lds
    s_add_u32 m0, s36, 29696
    s_nop 0
    buffer_load_dwordx4 v10, s[28:31], s34 offen lds
    s_mov_b32 s34, 368640
    s_add_u32 m0, s36, 30720
    s_nop 0
    buffer_load_dwordx4 v8, s[28:31], s34 offen lds
    s_add_u32 m0, s36, 31744
    s_nop 0
    buffer_load_dwordx4 v9, s[28:31], s34 offen lds
    s_add_u32 m0, s36, 32768
    s_nop 0
    buffer_load_dwordx4 v10, s[28:31], s34 offen lds
    s_mov_b32 s34, 405504
    s_add_u32 m0, s36, 33792
    s_nop 0
    buffer_load_dwordx4 v8, s[28:31], s34 offen lds
    s_add_u32 m0, s36, 34816
    s_nop 0
    buffer_load_dwordx4 v9, s[28:31], s34 offen lds
    s_add_u32 m0, s36, 35840
    s_nop 0
    buffer_load_dwordx4 v10, s[28:31], s34 offen lds
    s_waitcnt vmcnt(33) lgkmcnt(0)
    ds_read_b64_tr_b16 a[0:1], v12 offset:0
    ds_read_b64_tr_b16 a[2:3], v12 offset:1536
    ds_read_b64_tr_b16 a[4:5], v12 offset:32
    ds_read_b64_tr_b16 a[6:7], v12 offset:1568
    ds_read_b64_tr_b16 a[8:9], v12 offset:64
    ds_read_b64_tr_b16 a[10:11], v12 offset:1600
    s_waitcnt vmcnt(30) lgkmcnt(0)
    s_mov_b32 s34, 442368
    s_add_u32 m0, s36, 0
    s_nop 0
    buffer_load_dwordx4 v8, s[28:31], s34 offen lds
    s_add_u32 m0, s36, 1024
    s_nop 0
    buffer_load_dwordx4 v9, s[28:31], s34 offen lds
    s_add_u32 m0, s36, 2048
    s_nop 0
    buffer_load_dwordx4 v10, s[28:31], s34 offen lds
    ds_read_b64_tr_b16 a[12:13], v12 offset:3072
    ds_read_b64_tr_b16 a[14:15], v12 offset:4608
    ds_read_b64_tr_b16 a[16:17], v12 offset:3104
    ds_read_b64_tr_b16 a[18:19], v12 offset:4640
    ds_read_b64_tr_b16 a[20:21], v12 offset:3136
    ds_read_b64_tr_b16 a[22:23], v12 offset:4672
    s_waitcnt vmcnt(30) lgkmcnt(0)
    s_mov_b32 s34, 479232
    s_add_u32 m0, s36, 3072
    s_nop 0
    buffer_load_dwordx4 v8, s[28:31], s34 offen lds
    s_add_u32 m0, s36, 4096
    s_nop 0
    buffer_load_dwordx4 v9, s[28:31], s34 offen lds
    s_add_u32 m0, s36, 5120
    s_nop 0
    buffer_load_dwordx4 v10, s[28:31], s34 offen lds
    ds_read_b64_tr_b16 a[24:25], v12 offset:6144
    ds_read_b64_tr_b16 a[26:27], v12 offset:7680
    ds_read_b64_tr_b16 a[28:29], v12 offset:6176
    ds_read_b64_tr_b16 a[30:31], v12 offset:7712
    ds_read_b64_tr_b16 a[32:33], v12 offset:6208
    ds_read_b64_tr_b16 a[34:35], v12 offset:7744
    s_waitcnt vmcnt(30) lgkmcnt(0)
    s_mov_b32 s34, 516096
    s_add_u32 m0, s36, 6144
    s_nop 0
    buffer_load_dwordx4 v8, s[28:31], s34 offen lds
    s_add_u32 m0, s36, 7168
    s_nop 0
    buffer_load_dwordx4 v9, s[28:31], s34 offen lds
    s_add_u32 m0, s36, 8192
    s_nop 0
    buffer_load_dwordx4 v10, s[28:31], s34 offen lds
    ds_read_b64_tr_b16 a[36:37], v12 offset:9216
    ds_read_b64_tr_b16 a[38:39], v12 offset:10752
    ds_read_b64_tr_b16 a[40:41], v12 offset:9248
    ds_read_b64_tr_b16 a[42:43], v12 offset:10784
    ds_read_b64_tr_b16 a[44:45], v12 offset:9280
    ds_read_b64_tr_b16 a[46:47], v12 offset:10816
    s_waitcnt vmcnt(30) lgkmcnt(0)
    s_mov_b32 s34, 552960
    s_add_u32 m0, s36, 9216
    s_nop 0
    buffer_load_dwordx4 v8, s[28:31], s34 offen lds
    s_add_u32 m0, s36, 10240
    s_nop 0
    buffer_load_dwordx4 v9, s[28:31], s34 offen lds
    s_add_u32 m0, s36, 11264
    s_nop 0
    buffer_load_dwordx4 v10, s[28:31], s34 offen lds
    ds_read_b64_tr_b16 a[48:49], v12 offset:12288
    ds_read_b64_tr_b16 a[50:51], v12 offset:13824
    ds_read_b64_tr_b16 a[52:53], v12 offset:12320
    ds_read_b64_tr_b16 a[54:55], v12 offset:13856
    ds_read_b64_tr_b16 a[56:57], v12 offset:12352
    ds_read_b64_tr_b16 a[58:59], v12 offset:13888
    s_waitcnt vmcnt(30) lgkmcnt(0)
    s_mov_b32 s34, 589824
    s_add_u32 m0, s36, 12288
    s_nop 0
    buffer_load_dwordx4 v8, s[28:31], s34 offen lds
    s_add_u32 m0, s36, 13312
    s_nop 0
    buffer_load_dwordx4 v9, s[28:31], s34 offen lds
    s_add_u32 m0, s36, 14336
    s_nop 0
    buffer_load_dwordx4 v10, s[28:31], s34 offen lds
    ds_read_b64_tr_b16 a[60:61], v12 offset:15360
    ds_read_b64_tr_b16 a[62:63], v12 offset:16896
    ds_read_b64_tr_b16 a[64:65], v12 offset:15392
    ds_read_b64_tr_b16 a[66:67], v12 offset:16928
    ds_read_b64_tr_b16 a[68:69], v12 offset:15424
    ds_read_b64_tr_b16 a[70:71], v12 offset:16960
    s_waitcnt vmcnt(30) lgkmcnt(0)
    s_mov_b32 s34, 626688
    s_add_u32 m0, s36, 15360
    s_nop 0
    buffer_load_dwordx4 v8, s[28:31], s34 offen lds
    s_add_u32 m0, s36, 16384
    s_nop 0
    buffer_load_dwordx4 v9, s[28:31], s34 offen lds
    s_add_u32 m0, s36, 17408
    s_nop 0
    buffer_load_dwordx4 v10, s[28:31], s34 offen lds
    ds_read_b64_tr_b16 a[72:73], v12 offset:18432
    ds_read_b64_tr_b16 a[74:75], v12 offset:19968
    ds_read_b64_tr_b16 a[76:77], v12 offset:18464
    ds_read_b64_tr_b16 a[78:79], v12 offset:20000
    ds_read_b64_tr_b16 a[80:81], v12 offset:18496
    ds_read_b64_tr_b16 a[82:83], v12 offset:20032
    s_waitcnt vmcnt(30) lgkmcnt(0)
    s_mov_b32 s34, 663552
    s_add_u32 m0, s36, 18432
    s_nop 0
    buffer_load_dwordx4 v8, s[28:31], s34 offen lds
    s_add_u32 m0, s36, 19456
    s_nop 0
    buffer_load_dwordx4 v9, s[28:31], s34 offen lds
    s_add_u32 m0, s36, 20480
    s_nop 0
    buffer_load_dwordx4 v10, s[28:31], s34 offen lds
    ds_read_b64_tr_b16 a[84:85], v12 offset:21504
    ds_read_b64_tr_b16 a[86:87], v12 offset:23040
    ds_read_b64_tr_b16 a[88:89], v12 offset:21536
    ds_read_b64_tr_b16 a[90:91], v12 offset:23072
    ds_read_b64_tr_b16 a[92:93], v12 offset:21568
    ds_read_b64_tr_b16 a[94:95], v12 offset:23104
    s_waitcnt vmcnt(30) lgkmcnt(0)
    s_mov_b32 s34, 700416
    s_add_u32 m0, s36, 21504
    s_nop 0
    buffer_load_dwordx4 v8, s[28:31], s34 offen lds
    s_add_u32 m0, s36, 22528
    s_nop 0
    buffer_load_dwordx4 v9, s[28:31], s34 offen lds
    s_add_u32 m0, s36, 23552
    s_nop 0
    buffer_load_dwordx4 v10, s[28:31], s34 offen lds
    ds_read_b64_tr_b16 a[96:97], v12 offset:24576
    ds_read_b64_tr_b16 a[98:99], v12 offset:26112
    ds_read_b64_tr_b16 a[100:101], v12 offset:24608
    ds_read_b64_tr_b16 a[102:103], v12 offset:26144
    ds_read_b64_tr_b16 a[104:105], v12 offset:24640
    ds_read_b64_tr_b16 a[106:107], v12 offset:26176
    s_waitcnt vmcnt(30) lgkmcnt(0)
    s_mov_b32 s34, 737280
    s_add_u32 m0, s36, 24576
    s_nop 0
    buffer_load_dwordx4 v8, s[28:31], s34 offen lds
    s_add_u32 m0, s36, 25600
    s_nop 0
    buffer_load_dwordx4 v9, s[28:31], s34 offen lds
    s_add_u32 m0, s36, 26624
    s_nop 0
    buffer_load_dwordx4 v10, s[28:31], s34 offen lds
    ds_read_b64_tr_b16 a[108:109], v12 offset:27648
    ds_read_b64_tr_b16 a[110:111], v12 offset:29184
    ds_read_b64_tr_b16 a[112:113], v12 offset:27680
    ds_read_b64_tr_b16 a[114:115], v12 offset:29216
    ds_read_b64_tr_b16 a[116:117], v12 offset:27712
    ds_read_b64_tr_b16 a[118:119], v12 offset:29248
    s_waitcnt vmcnt(30) lgkmcnt(0)
    s_mov_b32 s34, 774144
    s_add_u32 m0, s36, 27648
    s_nop 0
    buffer_load_dwordx4 v8, s[28:31], s34 offen lds
    s_add_u32 m0, s36, 28672
    s_nop 0
    buffer_load_dwordx4 v9, s[28:31], s34 offen lds
    s_add_u32 m0, s36, 29696
    s_nop 0
    buffer_load_dwordx4 v10, s[28:31], s34 offen lds
    ds_read_b64_tr_b16 a[120:121], v12 offset:30720
    ds_read_b64_tr_b16 a[122:123], v12 offset:32256
    ds_read_b64_tr_b16 a[124:125], v12 offset:30752
    ds_read_b64_tr_b16 a[126:127], v12 offset:32288
    ds_read_b64_tr_b16 a[128:129], v12 offset:30784
    ds_read_b64_tr_b16 a[130:131], v12 offset:32320
    s_waitcnt vmcnt(30) lgkmcnt(0)
    s_mov_b32 s34, 811008
    s_add_u32 m0, s36, 30720
    s_nop 0
    buffer_load_dwordx4 v8, s[28:31], s34 offen lds
    s_add_u32 m0, s36, 31744
    s_nop 0
    buffer_load_dwordx4 v9, s[28:31], s34 offen lds
    s_add_u32 m0, s36, 32768
    s_nop 0
    buffer_load_dwordx4 v10, s[28:31], s34 offen lds
    ds_read_b64_tr_b16 a[132:133], v12 offset:33792
    ds_read_b64_tr_b16 a[134:135], v12 offset:35328
    ds_read_b64_tr_b16 a[136:137], v12 offset:33824
    ds_read_b64_tr_b16 a[138:139], v12 offset:35360
    ds_read_b64_tr_b16 a[140:141], v12 offset:33856
    ds_read_b64_tr_b16 a[142:143], v12 offset:35392
    s_waitcnt vmcnt(30) lgkmcnt(0)
    s_mov_b32 s34, 847872
    s_add_u32 m0, s36, 33792
    s_nop 0
    buffer_load_dwordx4 v8, s[28:31], s34 offen lds
    s_add_u32 m0, s36, 34816
    s_nop 0
    buffer_load_dwordx4 v9, s[28:31], s34 offen lds
    s_add_u32 m0, s36, 35840
    s_nop 0
    buffer_load_dwordx4 v10, s[28:31], s34 offen lds
    ds_read_b64_tr_b16 a[144:145], v12 offset:0
    ds_read_b64_tr_b16 a[146:147], v12 offset:1536
    ds_read_b64_tr_b16 a[148:149], v12 offset:32
    ds_read_b64_tr_b16 a[150:151], v12 offset:1568
    ds_read_b64_tr_b16 a[152:153], v12 offset:64
    ds_read_b64_tr_b16 a[154:155], v12 offset:1600
    s_waitcnt vmcnt(30) lgkmcnt(0)
    s_mov_b32 s34, 884736
    s_add_u32 m0, s36, 0
    s_nop 0
    buffer_load_dwordx4 v8, s[28:31], s34 offen lds
    s_add_u32 m0, s36, 1024
    s_nop 0
    buffer_load_dwordx4 v9, s[28:31], s34 offen lds
    s_add_u32 m0, s36, 2048
    s_nop 0
    buffer_load_dwordx4 v10, s[28:31], s34 offen lds
    ds_read_b64_tr_b16 a[156:157], v12 offset:3072
    ds_read_b64_tr_b16 a[158:159], v12 offset:4608
    ds_read_b64_tr_b16 a[160:161], v12 offset:3104
    ds_read_b64_tr_b16 a[162:163], v12 offset:4640
    ds_read_b64_tr_b16 a[164:165], v12 offset:3136
    ds_read_b64_tr_b16 a[166:167], v12 offset:4672
    s_waitcnt vmcnt(30) lgkmcnt(0)
    s_mov_b32 s34, 921600
    s_add_u32 m0, s36, 3072
    s_nop 0
    buffer_load_dwordx4 v8, s[28:31], s34 offen lds
    s_add_u32 m0, s36, 4096
    s_nop 0
    buffer_load_dwordx4 v9, s[28:31], s34 offen lds
    s_add_u32 m0, s36, 5120
    s_nop 0
    buffer_load_dwordx4 v10, s[28:31], s34 offen lds
    ds_read_b64_tr_b16 a[168:169], v12 offset:6144
    ds_read_b64_tr_b16 a[170:171], v12 offset:7680
    ds_read_b64_tr_b16 a[172:173], v12 offset:6176
    ds_read_b64_tr_b16 a[174:175], v12 offset:7712
    ds_read_b64_tr_b16 a[176:177], v12 offset:6208
    ds_read_b64_tr_b16 a[178:179], v12 offset:7744
    s_waitcnt vmcnt(30) lgkmcnt(0)
    s_mov_b32 s34, 958464
    s_add_u32 m0, s36, 6144
    s_nop 0
    buffer_load_dwordx4 v8, s[28:31], s34 offen lds
    s_add_u32 m0, s36, 7168
    s_nop 0
    buffer_load_dwordx4 v9, s[28:31], s34 offen lds
    s_add_u32 m0, s36, 8192
    s_nop 0
    buffer_load_dwordx4 v10, s[28:31], s34 offen lds
    ds_read_b64_tr_b16 a[180:181], v12 offset:9216
    ds_read_b64_tr_b16 a[182:183], v12 offset:10752
    ds_read_b64_tr_b16 a[184:185], v12 offset:9248
    ds_read_b64_tr_b16 a[186:187], v12 offset:10784
    ds_read_b64_tr_b16 a[188:189], v12 offset:9280
    ds_read_b64_tr_b16 a[190:191], v12 offset:10816
    s_waitcnt vmcnt(30) lgkmcnt(0)
    s_mov_b32 s34, 995328
    s_add_u32 m0, s36, 9216
    s_nop 0
    buffer_load_dwordx4 v8, s[28:31], s34 offen lds
    s_add_u32 m0, s36, 10240
    s_nop 0
    buffer_load_dwordx4 v9, s[28:31], s34 offen lds
    s_add_u32 m0, s36, 11264
    s_nop 0
    buffer_load_dwordx4 v10, s[28:31], s34 offen lds
    ds_read_b64_tr_b16 a[192:193], v12 offset:12288
    ds_read_b64_tr_b16 a[194:195], v12 offset:13824
    ds_read_b64_tr_b16 a[196:197], v12 offset:12320
    ds_read_b64_tr_b16 a[198:199], v12 offset:13856
    ds_read_b64_tr_b16 a[200:201], v12 offset:12352
    ds_read_b64_tr_b16 a[202:203], v12 offset:13888
    s_waitcnt vmcnt(30) lgkmcnt(0)
    s_mov_b32 s34, 1032192
    s_add_u32 m0, s36, 12288
    s_nop 0
    buffer_load_dwordx4 v8, s[28:31], s34 offen lds
    s_add_u32 m0, s36, 13312
    s_nop 0
    buffer_load_dwordx4 v9, s[28:31], s34 offen lds
    s_add_u32 m0, s36, 14336
    s_nop 0
    buffer_load_dwordx4 v10, s[28:31], s34 offen lds
    ds_read_b64_tr_b16 a[204:205], v12 offset:15360
    ds_read_b64_tr_b16 a[206:207], v12 offset:16896
    ds_read_b64_tr_b16 a[208:209], v12 offset:15392
    ds_read_b64_tr_b16 a[210:211], v12 offset:16928
    ds_read_b64_tr_b16 a[212:213], v12 offset:15424
    ds_read_b64_tr_b16 a[214:215], v12 offset:16960
    s_waitcnt vmcnt(30) lgkmcnt(0)
    s_mov_b32 s34, 1069056
    s_add_u32 m0, s36, 15360
    s_nop 0
    buffer_load_dwordx4 v8, s[28:31], s34 offen lds
    s_add_u32 m0, s36, 16384
    s_nop 0
    buffer_load_dwordx4 v9, s[28:31], s34 offen lds
    s_add_u32 m0, s36, 17408
    s_nop 0
    buffer_load_dwordx4 v10, s[28:31], s34 offen lds
    ds_read_b64_tr_b16 a[216:217], v12 offset:18432
    ds_read_b64_tr_b16 a[218:219], v12 offset:19968
    ds_read_b64_tr_b16 a[220:221], v12 offset:18464
    ds_read_b64_tr_b16 a[222:223], v12 offset:20000
    ds_read_b64_tr_b16 a[224:225], v12 offset:18496
    ds_read_b64_tr_b16 a[226:227], v12 offset:20032
    s_waitcnt vmcnt(30) lgkmcnt(0)
    s_mov_b32 s34, 1105920
    s_add_u32 m0, s36, 18432
    s_nop 0
    buffer_load_dwordx4 v8, s[28:31], s34 offen lds
    s_add_u32 m0, s36, 19456
    s_nop 0
    buffer_load_dwordx4 v9, s[28:31], s34 offen lds
    s_add_u32 m0, s36, 20480
    s_nop 0
    buffer_load_dwordx4 v10, s[28:31], s34 offen lds
    ds_read_b64_tr_b16 a[228:229], v12 offset:21504
    ds_read_b64_tr_b16 a[230:231], v12 offset:23040
    ds_read_b64_tr_b16 a[232:233], v12 offset:21536
    ds_read_b64_tr_b16 a[234:235], v12 offset:23072
    ds_read_b64_tr_b16 a[236:237], v12 offset:21568
    ds_read_b64_tr_b16 a[238:239], v12 offset:23104
    s_waitcnt vmcnt(30) lgkmcnt(0)
    s_mov_b32 s34, 1142784
    s_add_u32 m0, s36, 21504
    s_nop 0
    buffer_load_dwordx4 v8, s[28:31], s34 offen lds
    s_add_u32 m0, s36, 22528
    s_nop 0
    buffer_load_dwordx4 v9, s[28:31], s34 offen lds
    s_add_u32 m0, s36, 23552
    s_nop 0
    buffer_load_dwordx4 v10, s[28:31], s34 offen lds
    ds_read_b64_tr_b16 a[240:241], v12 offset:24576
    ds_read_b64_tr_b16 a[242:243], v12 offset:26112
    ds_read_b64_tr_b16 a[244:245], v12 offset:24608
    ds_read_b64_tr_b16 a[246:247], v12 offset:26144
    ds_read_b64_tr_b16 a[248:249], v12 offset:24640
    ds_read_b64_tr_b16 a[250:251], v12 offset:26176
    s_waitcnt vmcnt(30) lgkmcnt(0)
    ds_read_b64_tr_b16 a[252:253], v12 offset:27648
    ds_read_b64_tr_b16 a[254:255], v12 offset:29184
    ds_read_b64_tr_b16 v[128:129], v12 offset:27680
    ds_read_b64_tr_b16 v[130:131], v12 offset:29216
    ds_read_b64_tr_b16 v[132:133], v12 offset:27712
    ds_read_b64_tr_b16 v[134:135], v12 offset:29248
    s_waitcnt vmcnt(27) lgkmcnt(0)
    ds_read_b64_tr_b16 v[136:137], v12 offset:30720
    ds_read_b64_tr_b16 v[138:139], v12 offset:32256
    ds_read_b64_tr_b16 v[140:141], v12 offset:30752
    ds_read_b64_tr_b16 v[142:143], v12 offset:32288
    ds_read_b64_tr_b16 v[144:145], v12 offset:30784
    ds_read_b64_tr_b16 v[146:147], v12 offset:32320
    s_waitcnt vmcnt(24) lgkmcnt(0)
    ds_read_b64_tr_b16 v[148:149], v12 offset:33792
    ds_read_b64_tr_b16 v[150:151], v12 offset:35328
    ds_read_b64_tr_b16 v[152:153], v12 offset:33824
    ds_read_b64_tr_b16 v[154:155], v12 offset:35360
    ds_read_b64_tr_b16 v[156:157], v12 offset:33856
    ds_read_b64_tr_b16 v[158:159], v12 offset:35392
    s_waitcnt vmcnt(21) lgkmcnt(0)
    ds_read_b64_tr_b16 v[160:161], v12 offset:0
    ds_read_b64_tr_b16 v[162:163], v12 offset:1536
    ds_read_b64_tr_b16 v[164:165], v12 offset:32
    ds_read_b64_tr_b16 v[166:167], v12 offset:1568
    ds_read_b64_tr_b16 v[168:169], v12 offset:64
    ds_read_b64_tr_b16 v[170:171], v12 offset:1600
    s_waitcnt vmcnt(18) lgkmcnt(0)
    ds_read_b64_tr_b16 v[172:173], v12 offset:3072
    ds_read_b64_tr_b16 v[174:175], v12 offset:4608
    ds_read_b64_tr_b16 v[176:177], v12 offset:3104
    ds_read_b64_tr_b16 v[178:179], v12 offset:4640
    ds_read_b64_tr_b16 v[180:181], v12 offset:3136
    ds_read_b64_tr_b16 v[182:183], v12 offset:4672
    s_waitcnt vmcnt(15) lgkmcnt(0)
    ds_read_b64_tr_b16 v[184:185], v12 offset:6144
    ds_read_b64_tr_b16 v[186:187], v12 offset:7680
    ds_read_b64_tr_b16 v[188:189], v12 offset:6176
    ds_read_b64_tr_b16 v[190:191], v12 offset:7712
    ds_read_b64_tr_b16 v[192:193], v12 offset:6208
    ds_read_b64_tr_b16 v[194:195], v12 offset:7744
    s_waitcnt vmcnt(12) lgkmcnt(0)
    ds_read_b64_tr_b16 v[196:197], v12 offset:9216
    ds_read_b64_tr_b16 v[198:199], v12 offset:10752
    ds_read_b64_tr_b16 v[200:201], v12 offset:9248
    ds_read_b64_tr_b16 v[202:203], v12 offset:10784
    ds_read_b64_tr_b16 v[204:205], v12 offset:9280
    ds_read_b64_tr_b16 v[206:207], v12 offset:10816
    s_waitcnt vmcnt(9) lgkmcnt(0)
    ds_read_b64_tr_b16 v[208:209], v12 offset:12288
    ds_read_b64_tr_b16 v[210:211], v12 offset:13824
    ds_read_b64_tr_b16 v[212:213], v12 offset:12320
    ds_read_b64_tr_b16 v[214:215], v12 offset:13856
    ds_read_b64_tr_b16 v[216:217], v12 offset:12352
    ds_read_b64_tr_b16 v[218:219], v12 offset:13888
    s_waitcnt vmcnt(6) lgkmcnt(0)
    ds_read_b64_tr_b16 v[220:221], v12 offset:15360
    ds_read_b64_tr_b16 v[222:223], v12 offset:16896
    ds_read_b64_tr_b16 v[224:225], v12 offset:15392
    ds_read_b64_tr_b16 v[226:227], v12 offset:16928
    ds_read_b64_tr_b16 v[228:229], v12 offset:15424
    ds_read_b64_tr_b16 v[230:231], v12 offset:16960
    s_waitcnt vmcnt(3) lgkmcnt(0)
    ds_read_b64_tr_b16 v[232:233], v12 offset:18432
    ds_read_b64_tr_b16 v[234:235], v12 offset:19968
    ds_read_b64_tr_b16 v[236:237], v12 offset:18464
    ds_read_b64_tr_b16 v[238:239], v12 offset:20000
    ds_read_b64_tr_b16 v[240:241], v12 offset:18496
    ds_read_b64_tr_b16 v[242:243], v12 offset:20032
    s_waitcnt vmcnt(0) lgkmcnt(0)
    ds_read_b64_tr_b16 v[244:245], v12 offset:21504
    ds_read_b64_tr_b16 v[246:247], v12 offset:23040
    ds_read_b64_tr_b16 v[248:249], v12 offset:21536
    ds_read_b64_tr_b16 v[250:251], v12 offset:23072
    ds_read_b64_tr_b16 v[252:253], v12 offset:21568
    ds_read_b64_tr_b16 v[254:255], v12 offset:23104
    s_waitcnt lgkmcnt(0)
    s_barrier
    v_mul_u32_u24 v5, 10923, v0
    v_lshrrev_b32 v5, 16, v5
    v_mul_u32_u24 v6, 6, v5
    v_sub_u32 v4, v0, v6
    v_lshrrev_b32 v6, 1, v4
    v_lshlrev_b32 v6, 10, v6
    v_and_b32 v7, 1, v4
    v_lshl_add_u32 v6, v7, 9, v6
    v_lshl_add_u32 v2, v5, 4, v6
    s_lshl_b32 s34, s41, 4
    v_add_u32 v5, s34, v5
    v_mul_u32_u24 v5, 1152, v5
    v_lshl_add_u32 v5, v4, 4, v5
    s_mul_i32 s34, s42, 96
    v_add_u32 v5, s34, v5
    v_mov_b32 v6, 1073741824
    v_cmp_gt_u32 vcc, 96, v0
    s_nop 1
    v_cndmask_b32 v1, v6, v5, vcc
    v_and_b32 v4, 63, v0
    v_lshlrev_b32 v0, 4, v4
    s_mov_b32 s32, 0
    s_mov_b32 s16, s64
    s_mov_b32 s17, s65
    s_mov_b32 s18, 2359296
    s_mov_b32 s19, 0x20000
    s_add_u32 s24, s88, 1671168
    s_addc_u32 s25, s89, 0
    s_mov_b32 s26, 2359296
    s_mov_b32 s27, 0x20000
L_i20:
    v_mov_b32 v4, 0
    global_load_dword v5, v4, s[86:87] offset:12 sc1
    global_load_dword v4, v4, s[86:87] offset:128 sc1
    s_add_u32 s37, s37, 1
    s_waitcnt vmcnt(0)
    v_min_u32 v5, 32, v5
    v_min_u32 v4, 224, v4
    v_add_u32 v5, v5, v4
    v_cmp_gt_u32 vcc, 256, v5
    s_nop 0
    s_cbranch_vccz L_i20_d
    s_sleep 4
    s_cmp_lt_u32 s37, 400000
    s_cbranch_scc1 L_i20
L_i20_d:
    v_lshlrev_b32 v3, 3, v0
    v_and_b32 v3, 1023, v3
L_ow_layer:
    s_mov_b32 s33, s40
    v_mov_b32 v6, 0
    s_mul_i32 s34, s33, 21846
    s_lshr_b32 s34, s34, 16
    s_mul_i32 s34, s34, 3
    s_sub_u32 s34, s33, s34
    s_lshl_b32 s34, s34, 7
    s_lshl_b32 s45, s20, 5
    s_add_u32 s45, s45, s34
    s_lshl_b32 s45, s45, 5
    s_add_u32 s45, s45, 409600
L_ow_loop:
    s_lshl_b32 s38, s32, 6
    s_add_u32 s38, s38, s33
    s_lshl_b32 s44, s38, 1
    s_add_u32 s38, s38, 1
    v_cmp_gt_u32 vcc, s38, v6
    s_add_u32 s44, s44, s41
    s_lshl_b32 s44, s44, 2
    s_add_u32 s44, s44, s20
    s_lshl_b32 s44, s44, 15
    s_add_u32 s44, s44, 28147712
    s_cbranch_vccz L_ow_go
    v_mov_b32 v4, v3
L_w21:
    buffer_load_dword v5, v4, s[12:15], s45 offen sc1
    s_add_u32 s37, s37, 1
    s_waitcnt vmcnt(0)
    v_cmp_gt_u32 vcc, s38, v5
    s_nop 0
    s_cbranch_vccz L_w21_d
    s_sleep 1
    s_cmp_lt_u32 s37, 400000
    s_cbranch_scc1 L_w21
L_w21_d:
L_ow_go:
    buffer_load_dwordx4 v[24:27], v0, s[12:15], s44 offen offset:0 sc1
    buffer_load_dwordx4 v[28:31], v0, s[12:15], s44 offen offset:1024 sc1
    buffer_load_dwordx4 v[32:35], v0, s[12:15], s44 offen offset:2048 sc1
    buffer_load_dwordx4 v[36:39], v0, s[12:15], s44 offen offset:3072 sc1
    s_add_u32 s44, s44, 4096
    buffer_load_dwordx4 v[40:43], v0, s[12:15], s44 offen offset:0 sc1
    buffer_load_dwordx4 v[44:47], v0, s[12:15], s44 offen offset:1024 sc1
    buffer_load_dwordx4 v[48:51], v0, s[12:15], s44 offen offset:2048 sc1
    buffer_load_dwordx4 v[52:55], v0, s[12:15], s44 offen offset:3072 sc1
    s_add_u32 s44, s44, 4096
    buffer_load_dwordx4 v[56:59], v0, s[12:15], s44 offen offset:0 sc1
    buffer_load_dwordx4 v[60:63], v0, s[12:15], s44 offen offset:1024 sc1
    buffer_load_dwordx4 v[64:67], v0, s[12:15], s44 offen offset:2048 sc1
    buffer_load_dwordx4 v[68:71], v0, s[12:15], s44 offen offset:3072 sc1
    s_add_u32 s44, s44, 4096
    buffer_load_dwordx4 v[72:75], v0, s[12:15], s44 offen offset:0 sc1
    buffer_load_dwordx4 v[76:79], v0, s[12:15], s44 offen offset:1024 sc1
    buffer_load_dwordx4 v[80:83], v0, s[12:15], s44 offen offset:2048 sc1
    buffer_load_dwordx4 v[84:87], v0, s[12:15], s44 offen offset:3072 sc1
    s_add_u32 s44, s44, 4096
    buffer_load_dwordx4 v[88:91], v0, s[12:15], s44 offen offset:0 sc1
    buffer_load_dwordx4 v[92:95], v0, s[12:15], s44 offen offset:1024 sc1
    buffer_load_dwordx4 v[96:99], v0, s[12:15], s44 offen offset:2048 sc1
    buffer_load_dwordx4 v[100:103], v0, s[12:15], s44 offen offset:3072 sc1
    s_add_u32 s44, s44, 4096
    buffer_load_dwordx4 v[104:107], v0, s[12:15], s44 offen offset:0 sc1
    buffer_load_dwordx4 v[108:111], v0, s[12:15], s44 offen offset:1024 sc1
    buffer_load_dwordx4 v[112:115], v0, s[12:15], s44 offen offset:2048 sc1
    buffer_load_dwordx4 v[116:119], v0, s[12:15], s44 offen offset:3072 sc1
    s_waitcnt vmcnt(23)
    v_mfma_f32_16x16x32_bf16 v[8:11], a[0:3], v[24:27], 0
    v_mfma_f32_16x16x32_bf16 v[12:15], a[4:7], v[24:27], 0
    v_mfma_f32_16x16x32_bf16 v[16:19], a[8:11], v[24:27], 0
    s_add_u32 s44, s44, 4096
    buffer_load_dwordx4 v[24:27], v0, s[12:15], s44 offen offset:0 sc1
    s_waitcnt vmcnt(23)
    v_mfma_f32_16x16x32_bf16 v[8:11], a[12:15], v[28:31], v[8:11]
    v_mfma_f32_16x16x32_bf16 v[12:15], a[16:19], v[28:31], v[12:15]
    v_mfma_f32_16x16x32_bf16 v[16:19], a[20:23], v[28:31], v[16:19]
    buffer_load_dwordx4 v[28:31], v0, s[12:15], s44 offen offset:1024 sc1
    s_waitcnt vmcnt(23)
    v_mfma_f32_16x16x32_bf16 v[8:11], a[24:27], v[32:35], v[8:11]
    v_mfma_f32_16x16x32_bf16 v[12:15], a[28:31], v[32:35], v[12:15]
    v_mfma_f32_16x16x32_bf16 v[16:19], a[32:35], v[32:35], v[16:19]
    buffer_load_dwordx4 v[32:35], v0, s[12:15], s44 offen offset:2048 sc1
    s_waitcnt vmcnt(23)
    v_mfma_f32_16x16x32_bf16 v[8:11], a[36:39], v[36:39], v[8:11]
    v_mfma_f32_16x16x32_bf16 v[12:15], a[40:43], v[36:39], v[12:15]
    v_mfma_f32_16x16x32_bf16 v[16:19], a[44:47], v[36:39], v[16:19]
    buffer_load_dwordx4 v[36:39], v0, s[12:15], s44 offen offset:3072 sc1
    s_waitcnt vmcnt(23)
    v_mfma_f32_16x16x32_bf16 v[8:11], a[48:51], v[40:43], v[8:11]
    v_mfma_f32_16x16x32_bf16 v[12:15], a[52:55], v[40:43], v[12:15]
    v_mfma_f32_16x16x32_bf16 v[16:19], a[56:59], v[40:43], v[16:19]
    s_add_u32 s44, s44, 4096
    buffer_load_dwordx4 v[40:43], v0, s[12:15], s44 offen offset:0 sc1
    s_waitcnt vmcnt(23)
    v_mfma_f32_16x16x32_bf16 v[8:11], a[60:63], v[44:47], v[8:11]
    v_mfma_f32_16x16x32_bf16 v[12:15], a[64:67], v[44:47], v[12:15]
    v_mfma_f32_16x16x32_bf16 v[16:19], a[68:71], v[44:47], v[16:19]
    buffer_load_dwordx4 v[44:47], v0, s[12:15], s44 offen offset:1024 sc1
    s_waitcnt vmcnt(23)
    v_mfma_f32_16x16x32_bf16 v[8:11], a[72:75], v[48:51], v[8:11]
    v_mfma_f32_16x16x32_bf16 v[12:15], a[76:79], v[48:51], v[12:15]
    v_mfma_f32_16x16x32_bf16 v[16:19], a[80:83], v[48:51], v[16:19]
    buffer_load_dwordx4 v[48:51], v0, s[12:15], s44 offen offset:2048 sc1
    s_waitcnt vmcnt(23)
    v_mfma_f32_16x16x32_bf16 v[8:11], a[84:87], v[52:55], v[8:11]
    v_mfma_f32_16x16x32_bf16 v[12:15], a[88:91], v[52:55], v[12:15]
    v_mfma_f32_16x16x32_bf16 v[16:19], a[92:95], v[52:55], v[16:19]
    buffer_load_dwordx4 v[52:55], v0, s[12:15], s44 offen offset:3072 sc1
    s_waitcnt vmcnt(23)
    v_mfma_f32_16x16x32_bf16 v[8:11], a[96:99], v[56:59], v[8:11]
    v_mfma_f32_16x16x32_bf16 v[12:15], a[100:103], v[56:59], v[12:15]
    v_mfma_f32_16x16x32_bf16 v[16:19], a[104:107], v[56:59], v[16:19]
    s_mul_i32 s35, s33, 36864
    buffer_load_dwordx4 v[20:23], v1, s[16:19], s35 offen sc1
    s_waitcnt vmcnt(23)
    v_mfma_f32_16x16x32_bf16 v[8:11], a[108:111], v[60:63], v[8:11]
    v_mfma_f32_16x16x32_bf16 v[12:15], a[112:115], v[60:63], v[12:15]
    v_mfma_f32_16x16x32_bf16 v[16:19], a[116:119], v[60:63], v[16:19]
    s_waitcnt vmcnt(22)
    v_mfma_f32_16x16x32_bf16 v[8:11], a[120:123], v[64:67], v[8:11]
    v_mfma_f32_16x16x32_bf16 v[12:15], a[124:127], v[64:67], v[12:15]
    v_mfma_f32_16x16x32_bf16 v[16:19], a[128:131], v[64:67], v[16:19]
    s_add_u32 s36, s33, 2
    s_mul_i32 s34, s36, 21846
    s_lshr_b32 s34, s34, 16
    s_mul_i32 s34, s34, 3
    s_sub_u32 s34, s36, s34
    s_lshl_b32 s34, s34, 7
    s_lshl_b32 s45, s20, 5
    s_add_u32 s45, s45, s34
    s_lshl_b32 s45, s45, 5
    s_add_u32 s45, s45, 409600
    s_waitcnt vmcnt(21)
    v_mfma_f32_16x16x32_bf16 v[8:11], a[132:135], v[68:71], v[8:11]
    v_mfma_f32_16x16x32_bf16 v[12:15], a[136:139], v[68:71], v[12:15]
    v_mfma_f32_16x16x32_bf16 v[16:19], a[140:143], v[68:71], v[16:19]
    s_waitcnt vmcnt(20)
    v_mfma_f32_16x16x32_bf16 v[8:11], a[144:147], v[72:75], v[8:11]
    v_mfma_f32_16x16x32_bf16 v[12:15], a[148:151], v[72:75], v[12:15]
    v_mfma_f32_16x16x32_bf16 v[16:19], a[152:155], v[72:75], v[16:19]
    s_waitcnt vmcnt(19)
    v_mfma_f32_16x16x32_bf16 v[8:11], a[156:159], v[76:79], v[8:11]
    v_mfma_f32_16x16x32_bf16 v[12:15], a[160:163], v[76:79], v[12:15]
    v_mfma_f32_16x16x32_bf16 v[16:19], a[164:167], v[76:79], v[16:19]
    s_waitcnt vmcnt(18)
    v_mfma_f32_16x16x32_bf16 v[8:11], a[168:171], v[80:83], v[8:11]
    v_mfma_f32_16x16x32_bf16 v[12:15], a[172:175], v[80:83], v[12:15]
    v_mfma_f32_16x16x32_bf16 v[16:19], a[176:179], v[80:83], v[16:19]
    s_waitcnt vmcnt(17)
    v_mfma_f32_16x16x32_bf16 v[8:11], a[180:183], v[84:87], v[8:11]
    v_mfma_f32_16x16x32_bf16 v[12:15], a[184:187], v[84:87], v[12:15]
    v_mfma_f32_16x16x32_bf16 v[16:19], a[188:191], v[84:87], v[16:19]
    s_waitcnt vmcnt(16)
    v_mfma_f32_16x16x32_bf16 v[8:11], a[192:195], v[88:91], v[8:11]
    v_mfma_f32_16x16x32_bf16 v[12:15], a[196:199], v[88:91], v[12:15]
    v_mfma_f32_16x16x32_bf16 v[16:19], a[200:203], v[88:91], v[16:19]
    s_waitcnt vmcnt(15)
    v_mfma_f32_16x16x32_bf16 v[8:11], a[204:207], v[92:95], v[8:11]
    v_mfma_f32_16x16x32_bf16 v[12:15], a[208:211], v[92:95], v[12:15]
    v_mfma_f32_16x16x32_bf16 v[16:19], a[212:215], v[92:95], v[16:19]
    s_waitcnt vmcnt(14)
    v_mfma_f32_16x16x32_bf16 v[8:11], a[216:219], v[96:99], v[8:11]
    v_mfma_f32_16x16x32_bf16 v[12:15], a[220:223], v[96:99], v[12:15]
    v_mfma_f32_16x16x32_bf16 v[16:19], a[224:227], v[96:99], v[16:19]
    s_waitcnt vmcnt(13)
    v_mfma_f32_16x16x32_bf16 v[8:11], a[228:231], v[100:103], v[8:11]
    v_mfma_f32_16x16x32_bf16 v[12:15], a[232:235], v[100:103], v[12:15]
    v_mfma_f32_16x16x32_bf16 v[16:19], a[236:239], v[100:103], v[16:19]
    s_waitcnt vmcnt(12)
    v_mfma_f32_16x16x32_bf16 v[8:11], a[240:243], v[104:107], v[8:11]
    v_mfma_f32_16x16x32_bf16 v[12:15], a[244:247], v[104:107], v[12:15]
    v_mfma_f32_16x16x32_bf16 v[16:19], a[248:251], v[104:107], v[16:19]
    s_waitcnt vmcnt(11)
    v_mfma_f32_16x16x32_bf16 v[8:11], a[252:255], v[108:111], v[8:11]
    v_mfma_f32_16x16x32_bf16 v[12:15], v[128:131], v[108:111], v[12:15]
    v_mfma_f32_16x16x32_bf16 v[16:19], v[132:135], v[108:111], v[16:19]
    s_waitcnt vmcnt(10)
    v_mfma_f32_16x16x32_bf16 v[8:11], v[136:139], v[112:115], v[8:11]
    v_mfma_f32_16x16x32_bf16 v[12:15], v[140:143], v[112:115], v[12:15]
    v_mfma_f32_16x16x32_bf16 v[16:19], v[144:147], v[112:115], v[16:19]
    s_waitcnt vmcnt(9)
    v_mfma_f32_16x16x32_bf16 v[8:11], v[148:151], v[116:119], v[8:11]
    v_mfma_f32_16x16x32_bf16 v[12:15], v[152:155], v[116:119], v[12:15]
    v_mfma_f32_16x16x32_bf16 v[16:19], v[156:159], v[116:119], v[16:19]
    s_waitcnt vmcnt(8)
    v_mfma_f32_16x16x32_bf16 v[8:11], v[160:163], v[24:27], v[8:11]
    v_mfma_f32_16x16x32_bf16 v[12:15], v[164:167], v[24:27], v[12:15]
    v_mfma_f32_16x16x32_bf16 v[16:19], v[168:171], v[24:27], v[16:19]
    s_waitcnt vmcnt(7)
    v_mfma_f32_16x16x32_bf16 v[8:11], v[172:175], v[28:31], v[8:11]
    v_mfma_f32_16x16x32_bf16 v[12:15], v[176:179], v[28:31], v[12:15]
    v_mfma_f32_16x16x32_bf16 v[16:19], v[180:183], v[28:31], v[16:19]
    s_waitcnt vmcnt(6)
    v_mfma_f32_16x16x32_bf16 v[8:11], v[184:187], v[32:35], v[8:11]
    v_mfma_f32_16x16x32_bf16 v[12:15], v[188:191], v[32:35], v[12:15]
    v_mfma_f32_16x16x32_bf16 v[16:19], v[192:195], v[32:35], v[16:19]
    s_waitcnt vmcnt(5)
    v_mfma_f32_16x16x32_bf16 v[8:11], v[196:199], v[36:39], v[8:11]
    v_mfma_f32_16x16x32_bf16 v[12:15], v[200:203], v[36:39], v[12:15]
    v_mfma_f32_16x16x32_bf16 v[16:19], v[204:207], v[36:39], v[16:19]
    s_waitcnt vmcnt(4)
    v_mfma_f32_16x16x32_bf16 v[8:11], v[208:211], v[40:43], v[8:11]
    v_mfma_f32_16x16x32_bf16 v[12:15], v[212:215], v[40:43], v[12:15]
    v_mfma_f32_16x16x32_bf16 v[16:19], v[216:219], v[40:43], v[16:19]
    s_waitcnt vmcnt(3)
    v_mfma_f32_16x16x32_bf16 v[8:11], v[220:223], v[44:47], v[8:11]
    v_mfma_f32_16x16x32_bf16 v[12:15], v[224:227], v[44:47], v[12:15]
    v_mfma_f32_16x16x32_bf16 v[16:19], v[228:231], v[44:47], v[16:19]
    s_waitcnt vmcnt(2)
    v_mfma_f32_16x16x32_bf16 v[8:11], v[232:235], v[48:51], v[8:11]
    v_mfma_f32_16x16x32_bf16 v[12:15], v[236:239], v[48:51], v[12:15]
    v_mfma_f32_16x16x32_bf16 v[16:19], v[240:243], v[48:51], v[16:19]
    s_waitcnt vmcnt(1)
    v_mfma_f32_16x16x32_bf16 v[8:11], v[244:247], v[52:55], v[8:11]
    v_mfma_f32_16x16x32_bf16 v[12:15], v[248:251], v[52:55], v[12:15]
    v_mfma_f32_16x16x32_bf16 v[16:19], v[252:255], v[52:55], v[16:19]
    s_mul_i32 s34, s20, 3072
    v_add_u32 v4, s34, v0
    ds_write_b128 v4, v[8:11] offset:0
    s_nop 0
    ds_write_b128 v4, v[12:15] offset:1024
    s_nop 2
    ds_write_b128 v4, v[16:19] offset:2048
    s_waitcnt lgkmcnt(0)
    s_barrier
    s_cmp_ge_u32 s20, 2
    s_cbranch_scc1 L_ow_sig
    ds_read_b128 v[24:27], v2 offset:0
    ds_read_b128 v[28:31], v2 offset:256
    ds_read_b128 v[32:35], v2 offset:3072
    ds_read_b128 v[36:39], v2 offset:3328
    ds_read_b128 v[40:43], v2 offset:6144
    ds_read_b128 v[44:47], v2 offset:6400
    ds_read_b128 v[48:51], v2 offset:9216
    ds_read_b128 v[52:55], v2 offset:9472
    s_waitcnt vmcnt(0)
    v_lshlrev_b32 v8, 16, v20
    v_and_b32 v9, 0xffff0000, v20
    v_lshlrev_b32 v10, 16, v21
    v_and_b32 v11, 0xffff0000, v21
    v_lshlrev_b32 v12, 16, v22
    v_and_b32 v13, 0xffff0000, v22
    v_lshlrev_b32 v14, 16, v23
    v_and_b32 v15, 0xffff0000, v23
    s_waitcnt lgkmcnt(5)
    v_add_f32 v24, v24, v32
    v_add_f32 v25, v25, v33
    v_add_f32 v26, v26, v34
    v_add_f32 v27, v27, v35
    s_waitcnt lgkmcnt(4)
    v_add_f32 v28, v28, v36
    v_add_f32 v29, v29, v37
    v_add_f32 v30, v30, v38
    v_add_f32 v31, v31, v39
    s_waitcnt lgkmcnt(3)
    v_add_f32 v24, v24, v40
    v_add_f32 v25, v25, v41
    v_add_f32 v26, v26, v42
    v_add_f32 v27, v27, v43
    s_waitcnt lgkmcnt(2)
    v_add_f32 v28, v28, v44
    v_add_f32 v29, v29, v45
    v_add_f32 v30, v30, v46
    v_add_f32 v31, v31, v47
    s_waitcnt lgkmcnt(1)
    v_add_f32 v24, v24, v48
    v_add_f32 v25, v25, v49
    v_add_f32 v26, v26, v50
    v_add_f32 v27, v27, v51
    s_waitcnt lgkmcnt(0)
    v_add_f32 v28, v28, v52
    v_add_f32 v29, v29, v53
    v_add_f32 v30, v30, v54
    v_add_f32 v31, v31, v55
    v_add_f32 v24, v24, v8
    v_add_f32 v25, v25, v9
    v_add_f32 v26, v26, v10
    v_add_f32 v27, v27, v11
    v_add_f32 v28, v28, v12
    v_add_f32 v29, v29, v13
    v_add_f32 v30, v30, v14
    v_add_f32 v31, v31, v15
    v_cvt_pk_bf16_f32 v24, v24, v25
    v_cvt_pk_bf16_f32 v25, v26, v27
    v_cvt_pk_bf16_f32 v26, v28, v29
    v_cvt_pk_bf16_f32 v27, v30, v31
    buffer_store_dwordx4 v[24:27], v1, s[24:27], s35 offen sc1
L_ow_sig:
    buffer_load_dword v6, v3, s[12:15], s45 offen sc1
    s_waitcnt vmcnt(0) lgkmcnt(0)
    s_barrier
    s_cmp_lg_u32 s20, 0
    s_cbranch_scc1 L_s22
    v_mov_b32 v4, s38
    v_mov_b32 v5, 0
    s_mov_b64 exec, 1
    buffer_store_dword v4, v5, s[12:15], s43 offen sc1
    s_mov_b64 exec, -1
L_s22:
    s_add_u32 s33, s33, 2
    s_cmp_lt_u32 s33, 64
    s_cbranch_scc1 L_ow_loop
    s_add_u32 s32, s32, 1
    s_cmp_ge_u32 s32, 2
    s_cbranch_scc1 L_ww_ow
    s_add_u32 s16, s88, 4030464
    s_addc_u32 s17, s89, 0
    s_mov_b32 s18, 2359296
    s_mov_b32 s19, 0x20000
    s_add_u32 s24, s88, 6389760
    s_addc_u32 s25, s89, 0
    s_mov_b32 s26, 2359296
    s_mov_b32 s27, 0x20000
    s_branch L_ow_layer
L_qw:
L_i23:
    v_mov_b32 v4, 0
    global_load_dword v5, v4, s[86:87] offset:12 sc1
    global_load_dword v4, v4, s[86:87] offset:128 sc1
    s_add_u32 s37, s37, 1
    s_waitcnt vmcnt(0)
    v_min_u32 v5, 32, v5
    v_min_u32 v4, 224, v4
    v_add_u32 v5, v5, v4
    v_cmp_gt_u32 vcc, 256, v5
    s_nop 0
    s_cbranch_vccz L_i23_d
    s_sleep 4
    s_cmp_lt_u32 s37, 400000
    s_cbranch_scc1 L_i23
L_i23_d:
    s_mov_b32 s34, 397312
    s_mov_b32 s38, 1
    v_mov_b32 v4, 0
L_w24:
    buffer_load_dword v5, v4, s[12:15], s34 offen sc1
    s_add_u32 s37, s37, 1
    s_waitcnt vmcnt(0)
    v_cmp_gt_u32 vcc, s38, v5
    s_nop 0
    s_cbranch_vccz L_w24_d
    s_sleep 8
    s_cmp_lt_u32 s37, 400000
    s_cbranch_scc1 L_w24
L_w24_d:
    s_lshr_b32 s40, s21, 3
    s_and_b32 s34, s21, 7
    s_lshl_b32 s42, s40, 5
    s_add_u32 s42, s42, s34
    s_lshl_b32 s42, s42, 2
    s_lshl_b32 s42, s42, 5
    s_add_u32 s42, s42, 430080
    s_lshl_b32 s41, s34, 2
    s_add_u32 s41, s41, s20
    s_mov_b32 s43, 0x3eae1a93
    v_and_b32 v24, 63, v0
    v_lshrrev_b32 v25, 4, v24
    v_mul_u32_u24 v25, 3456, v25
    s_mul_i32 s34, s41, 36
    v_add_u32 v25, s34, v25
    v_and_b32 v26, 7, v24
    v_lshl_add_u32 v27, v26, 2, v25
    v_bfe_u32 v26, v24, 3, 1
    v_mul_u32_u24 v26, 1152, v26
    v_add_u32 v20, v27, v26
    v_and_b32 v26, 15, v24
    v_lshlrev_b32 v27, 2, v26
    v_add_u32 v27, 2304, v27
    v_cmp_eq_u32 vcc, 9, v26
    s_nop 1
    v_cndmask_b32 v27, v27, 32, vcc
    v_mov_b32 v28, 1184
    v_cmp_eq_u32 vcc, 10, v26
    s_nop 1
    v_cndmask_b32 v27, v27, v28, vcc
    v_add_u32 v27, v27, v25
    v_mov_b32 v28, 1073741824
    v_cmp_gt_u32 vcc, 11, v26
    s_nop 1
    v_cndmask_b32 v21, v28, v27, vcc
    v_bfe_u32 v25, v24, 2, 2
    v_lshrrev_b32 v26, 5, v24
    v_lshl_add_u32 v25, v26, 3, v25
    v_lshlrev_b32 v25, 6, v25
    v_bfe_u32 v26, v24, 4, 1
    v_lshl_add_u32 v25, v26, 5, v25
    v_and_b32 v26, 3, v24
    v_lshl_add_u32 v25, v26, 3, v25
    s_lshl_b32 s36, s20, 14
    v_add_u32 v22, s36, v25
    s_mov_b32 s28, s80
    s_mov_b32 s29, s81
    s_mov_b32 s30, 1990656
    s_mov_b32 s31, 0x20000
    s_mov_b32 s34, 0
    s_add_u32 m0, s36, 0
    s_nop 0
    buffer_load_dword v20, s[28:31], s34 offen lds
    s_mov_b32 s34, 13824
    s_add_u32 m0, s36, 256
    s_nop 0
    buffer_load_dword v20, s[28:31], s34 offen lds
    s_mov_b32 s34, 27648
    s_add_u32 m0, s36, 512
    s_nop 0
    buffer_load_dword v20, s[28:31], s34 offen lds
    s_mov_b32 s34, 41472
    s_add_u32 m0, s36, 768
    s_nop 0
    buffer_load_dword v20, s[28:31], s34 offen lds
    s_mov_b32 s34, 0
    s_add_u32 m0, s36, 1024
    s_nop 0
    buffer_load_dword v21, s[28:31], s34 offen lds
    s_mov_b32 s34, 13824
    s_add_u32 m0, s36, 1280
    s_nop 0
    buffer_load_dword v21, s[28:31], s34 offen lds
    s_mov_b32 s34, 27648
    s_add_u32 m0, s36, 1536
    s_nop 0
    buffer_load_dword v21, s[28:31], s34 offen lds
    s_mov_b32 s34, 41472
    s_add_u32 m0, s36, 1792
    s_nop 0
    buffer_load_dword v21, s[28:31], s34 offen lds
    s_mov_b32 s34, 55296
    s_add_u32 m0, s36, 2048
    s_nop 0
    buffer_load_dword v20, s[28:31], s34 offen lds
    s_mov_b32 s34, 69120
    s_add_u32 m0, s36, 2304
    s_nop 0
    buffer_load_dword v20, s[28:31], s34 offen lds
    s_mov_b32 s34, 82944
    s_add_u32 m0, s36, 2560
    s_nop 0
    buffer_load_dword v20, s[28:31], s34 offen lds
    s_mov_b32 s34, 96768
    s_add_u32 m0, s36, 2816
    s_nop 0
    buffer_load_dword v20, s[28:31], s34 offen lds
    s_mov_b32 s34, 55296
    s_add_u32 m0, s36, 3072
    s_nop 0
    buffer_load_dword v21, s[28:31], s34 offen lds
    s_mov_b32 s34, 69120
    s_add_u32 m0, s36, 3328
    s_nop 0
    buffer_load_dword v21, s[28:31], s34 offen lds
    s_mov_b32 s34, 82944
    s_add_u32 m0, s36, 3584
    s_nop 0
    buffer_load_dword v21, s[28:31], s34 offen lds
    s_mov_b32 s34, 96768
    s_add_u32 m0, s36, 3840
    s_nop 0
    buffer_load_dword v21, s[28:31], s34 offen lds
    s_mov_b32 s34, 110592
    s_add_u32 m0, s36, 4096
    s_nop 0
    buffer_load_dword v20, s[28:31], s34 offen lds
    s_mov_b32 s34, 124416
    s_add_u32 m0, s36, 4352
    s_nop 0
    buffer_load_dword v20, s[28:31], s34 offen lds
    s_mov_b32 s34, 138240
    s_add_u32 m0, s36, 4608
    s_nop 0
    buffer_load_dword v20, s[28:31], s34 offen lds
    s_mov_b32 s34, 152064
    s_add_u32 m0, s36, 4864
    s_nop 0
    buffer_load_dword v20, s[28:31], s34 offen lds
    s_mov_b32 s34, 110592
    s_add_u32 m0, s36, 5120
    s_nop 0
    buffer_load_dword v21, s[28:31], s34 offen lds
    s_mov_b32 s34, 124416
    s_add_u32 m0, s36, 5376
    s_nop 0
    buffer_load_dword v21, s[28:31], s34 offen lds
    s_mov_b32 s34, 138240
    s_add_u32 m0, s36, 5632
    s_nop 0
    buffer_load_dword v21, s[28:31], s34 offen lds
    s_mov_b32 s34, 152064
    s_add_u32 m0, s36, 5888
    s_nop 0
    buffer_load_dword v21, s[28:31], s34 offen lds
    s_mov_b32 s34, 165888
    s_add_u32 m0, s36, 6144
    s_nop 0
    buffer_load_dword v20, s[28:31], s34 offen lds
    s_mov_b32 s34, 179712
    s_add_u32 m0, s36, 6400
    s_nop 0
    buffer_load_dword v20, s[28:31], s34 offen lds
    s_mov_b32 s34, 193536
    s_add_u32 m0, s36, 6656
    s_nop 0
    buffer_load_dword v20, s[28:31], s34 offen lds
    s_mov_b32 s34, 207360
    s_add_u32 m0, s36, 6912
    s_nop 0
    buffer_load_dword v20, s[28:31], s34 offen lds
    s_mov_b32 s34, 165888
    s_add_u32 m0, s36, 7168
    s_nop 0
    buffer_load_dword v21, s[28:31], s34 offen lds
    s_mov_b32 s34, 179712
    s_add_u32 m0, s36, 7424
    s_nop 0
    buffer_load_dword v21, s[28:31], s34 offen lds
    s_mov_b32 s34, 193536
    s_add_u32 m0, s36, 7680
    s_nop 0
    buffer_load_dword v21, s[28:31], s34 offen lds
    s_mov_b32 s34, 207360
    s_add_u32 m0, s36, 7936
    s_nop 0
    buffer_load_dword v21, s[28:31], s34 offen lds
    s_mov_b32 s34, 221184
    s_add_u32 m0, s36, 8192
    s_nop 0
    buffer_load_dword v20, s[28:31], s34 offen lds
    s_mov_b32 s34, 235008
    s_add_u32 m0, s36, 8448
    s_nop 0
    buffer_load_dword v20, s[28:31], s34 offen lds
    s_mov_b32 s34, 248832
    s_add_u32 m0, s36, 8704
    s_nop 0
    buffer_load_dword v20, s[28:31], s34 offen lds
    s_mov_b32 s34, 262656
    s_add_u32 m0, s36, 8960
    s_nop 0
    buffer_load_dword v20, s[28:31], s34 offen lds
    s_mov_b32 s34, 221184
    s_add_u32 m0, s36, 9216
    s_nop 0
    buffer_load_dword v21, s[28:31], s34 offen lds
    s_mov_b32 s34, 235008
    s_add_u32 m0, s36, 9472
    s_nop 0
    buffer_load_dword v21, s[28:31], s34 offen lds
    s_mov_b32 s34, 248832
    s_add_u32 m0, s36, 9728
    s_nop 0
    buffer_load_dword v21, s[28:31], s34 offen lds
    s_mov_b32 s34, 262656
    s_add_u32 m0, s36, 9984
    s_nop 0
    buffer_load_dword v21, s[28:31], s34 offen lds
    s_mov_b32 s34, 276480
    s_add_u32 m0, s36, 10240
    s_nop 0
    buffer_load_dword v20, s[28:31], s34 offen lds
    s_mov_b32 s34, 290304
    s_add_u32 m0, s36, 10496
    s_nop 0
    buffer_load_dword v20, s[28:31], s34 offen lds
    s_mov_b32 s34, 304128
    s_add_u32 m0, s36, 10752
    s_nop 0
    buffer_load_dword v20, s[28:31], s34 offen lds
    s_mov_b32 s34, 317952
    s_add_u32 m0, s36, 11008
    s_nop 0
    buffer_load_dword v20, s[28:31], s34 offen lds
    s_mov_b32 s34, 276480
    s_add_u32 m0, s36, 11264
    s_nop 0
    buffer_load_dword v21, s[28:31], s34 offen lds
    s_mov_b32 s34, 290304
    s_add_u32 m0, s36, 11520
    s_nop 0
    buffer_load_dword v21, s[28:31], s34 offen lds
    s_mov_b32 s34, 304128
    s_add_u32 m0, s36, 11776
    s_nop 0
    buffer_load_dword v21, s[28:31], s34 offen lds
    s_mov_b32 s34, 317952
    s_add_u32 m0, s36, 12032
    s_nop 0
    buffer_load_dword v21, s[28:31], s34 offen lds
    s_mov_b32 s34, 331776
    s_add_u32 m0, s36, 12288
    s_nop 0
    buffer_load_dword v20, s[28:31], s34 offen lds
    s_mov_b32 s34, 345600
    s_add_u32 m0, s36, 12544
    s_nop 0
    buffer_load_dword v20, s[28:31], s34 offen lds
    s_mov_b32 s34, 359424
    s_add_u32 m0, s36, 12800
    s_nop 0
    buffer_load_dword v20, s[28:31], s34 offen lds
    s_mov_b32 s34, 373248
    s_add_u32 m0, s36, 13056
    s_nop 0
    buffer_load_dword v20, s[28:31], s34 offen lds
    s_mov_b32 s34, 331776
    s_add_u32 m0, s36, 13312
    s_nop 0
    buffer_load_dword v21, s[28:31], s34 offen lds
    s_mov_b32 s34, 345600
    s_add_u32 m0, s36, 13568
    s_nop 0
    buffer_load_dword v21, s[28:31], s34 offen lds
    s_mov_b32 s34, 359424
    s_add_u32 m0, s36, 13824
    s_nop 0
    buffer_load_dword v21, s[28:31], s34 offen lds
    s_mov_b32 s34, 373248
    s_add_u32 m0, s36, 14080
    s_nop 0
    buffer_load_dword v21, s[28:31], s34 offen lds
    s_mov_b32 s34, 387072
    s_add_u32 m0, s36, 14336
    s_nop 0
    buffer_load_dword v20, s[28:31], s34 offen lds
    s_mov_b32 s34, 400896
    s_add_u32 m0, s36, 14592
    s_nop 0
    buffer_load_dword v20, s[28:31], s34 offen lds
    s_mov_b32 s34, 414720
    s_add_u32 m0, s36, 14848
    s_nop 0
    buffer_load_dword v20, s[28:31], s34 offen lds
    s_mov_b32 s34, 428544
    s_add_u32 m0, s36, 15104
    s_nop 0
    buffer_load_dword v20, s[28:31], s34 offen lds
    s_waitcnt vmcnt(56) lgkmcnt(0)
    s_mov_b32 s34, 387072
    s_add_u32 m0, s36, 15360
    s_nop 0
    buffer_load_dword v21, s[28:31], s34 offen lds
    s_mov_b32 s34, 400896
    s_add_u32 m0, s36, 15616
    s_nop 0
    buffer_load_dword v21, s[28:31], s34 offen lds
    s_mov_b32 s34, 414720
    s_add_u32 m0, s36, 15872
    s_nop 0
    buffer_load_dword v21, s[28:31], s34 offen lds
    s_mov_b32 s34, 428544
    s_add_u32 m0, s36, 16128
    s_nop 0
    buffer_load_dword v21, s[28:31], s34 offen lds
    ds_read_b64_tr_b16 a[0:1], v22 offset:0
    ds_read_b64_tr_b16 a[2:3], v22 offset:256
    s_waitcnt vmcnt(56) lgkmcnt(0)
    s_mov_b32 s34, 442368
    s_add_u32 m0, s36, 0
    s_nop 0
    buffer_load_dword v20, s[28:31], s34 offen lds
    s_mov_b32 s34, 456192
    s_add_u32 m0, s36, 256
    s_nop 0
    buffer_load_dword v20, s[28:31], s34 offen lds
    s_mov_b32 s34, 470016
    s_add_u32 m0, s36, 512
    s_nop 0
    buffer_load_dword v20, s[28:31], s34 offen lds
    s_mov_b32 s34, 483840
    s_add_u32 m0, s36, 768
    s_nop 0
    buffer_load_dword v20, s[28:31], s34 offen lds
    ds_read_b64_tr_b16 a[144:145], v22 offset:1024
    ds_read_b64_tr_b16 a[146:147], v22 offset:1280
    s_waitcnt vmcnt(56) lgkmcnt(0)
    s_mov_b32 s34, 442368
    s_add_u32 m0, s36, 1024
    s_nop 0
    buffer_load_dword v21, s[28:31], s34 offen lds
    s_mov_b32 s34, 456192
    s_add_u32 m0, s36, 1280
    s_nop 0
    buffer_load_dword v21, s[28:31], s34 offen lds
    s_mov_b32 s34, 470016
    s_add_u32 m0, s36, 1536
    s_nop 0
    buffer_load_dword v21, s[28:31], s34 offen lds
    s_mov_b32 s34, 483840
    s_add_u32 m0, s36, 1792
    s_nop 0
    buffer_load_dword v21, s[28:31], s34 offen lds
    ds_read_b64_tr_b16 a[4:5], v22 offset:2048
    ds_read_b64_tr_b16 a[6:7], v22 offset:2304
    s_waitcnt vmcnt(56) lgkmcnt(0)
    s_mov_b32 s34, 497664
    s_add_u32 m0, s36, 2048
    s_nop 0
    buffer_load_dword v20, s[28:31], s34 offen lds
    s_mov_b32 s34, 511488
    s_add_u32 m0, s36, 2304
    s_nop 0
    buffer_load_dword v20, s[28:31], s34 offen lds
    s_mov_b32 s34, 525312
    s_add_u32 m0, s36, 2560
    s_nop 0
    buffer_load_dword v20, s[28:31], s34 offen lds
    s_mov_b32 s34, 539136
    s_add_u32 m0, s36, 2816
    s_nop 0
    buffer_load_dword v20, s[28:31], s34 offen lds
    ds_read_b64_tr_b16 a[148:149], v22 offset:3072
    ds_read_b64_tr_b16 a[150:151], v22 offset:3328
    s_waitcnt vmcnt(56) lgkmcnt(0)
    s_mov_b32 s34, 497664
    s_add_u32 m0, s36, 3072
    s_nop 0
    buffer_load_dword v21, s[28:31], s34 offen lds
    s_mov_b32 s34, 511488
    s_add_u32 m0, s36, 3328
    s_nop 0
    buffer_load_dword v21, s[28:31], s34 offen lds
    s_mov_b32 s34, 525312
    s_add_u32 m0, s36, 3584
    s_nop 0
    buffer_load_dword v21, s[28:31], s34 offen lds
    s_mov_b32 s34, 539136
    s_add_u32 m0, s36, 3840
    s_nop 0
    buffer_load_dword v21, s[28:31], s34 offen lds
    ds_read_b64_tr_b16 a[8:9], v22 offset:4096
    ds_read_b64_tr_b16 a[10:11], v22 offset:4352
    s_waitcnt vmcnt(56) lgkmcnt(0)
    s_mov_b32 s34, 552960
    s_add_u32 m0, s36, 4096
    s_nop 0
    buffer_load_dword v20, s[28:31], s34 offen lds
    s_mov_b32 s34, 566784
    s_add_u32 m0, s36, 4352
    s_nop 0
    buffer_load_dword v20, s[28:31], s34 offen lds
    s_mov_b32 s34, 580608
    s_add_u32 m0, s36, 4608
    s_nop 0
    buffer_load_dword v20, s[28:31], s34 offen lds
    s_mov_b32 s34, 594432
    s_add_u32 m0, s36, 4864
    s_nop 0
    buffer_load_dword v20, s[28:31], s34 offen lds
    ds_read_b64_tr_b16 a[152:153], v22 offset:5120
    ds_read_b64_tr_b16 a[154:155], v22 offset:5376
    s_waitcnt vmcnt(56) lgkmcnt(0)
    s_mov_b32 s34, 552960
    s_add_u32 m0, s36, 5120
    s_nop 0
    buffer_load_dword v21, s[28:31], s34 offen lds
    s_mov_b32 s34, 566784
    s_add_u32 m0, s36, 5376
    s_nop 0
    buffer_load_dword v21, s[28:31], s34 offen lds
    s_mov_b32 s34, 580608
    s_add_u32 m0, s36, 5632
    s_nop 0
    buffer_load_dword v21, s[28:31], s34 offen lds
    s_mov_b32 s34, 594432
    s_add_u32 m0, s36, 5888
    s_nop 0
    buffer_load_dword v21, s[28:31], s34 offen lds
    ds_read_b64_tr_b16 a[12:13], v22 offset:6144
    ds_read_b64_tr_b16 a[14:15], v22 offset:6400
    s_waitcnt vmcnt(56) lgkmcnt(0)
    s_mov_b32 s34, 608256
    s_add_u32 m0, s36, 6144
    s_nop 0
    buffer_load_dword v20, s[28:31], s34 offen lds
    s_mov_b32 s34, 622080
    s_add_u32 m0, s36, 6400
    s_nop 0
    buffer_load_dword v20, s[28:31], s34 offen lds
    s_mov_b32 s34, 635904
    s_add_u32 m0, s36, 6656
    s_nop 0
    buffer_load_dword v20, s[28:31], s34 offen lds
    s_mov_b32 s34, 649728
    s_add_u32 m0, s36, 6912
    s_nop 0
    buffer_load_dword v20, s[28:31], s34 offen lds
    ds_read_b64_tr_b16 a[156:157], v22 offset:7168
    ds_read_b64_tr_b16 a[158:159], v22 offset:7424
    s_waitcnt vmcnt(56) lgkmcnt(0)
    s_mov_b32 s34, 608256
    s_add_u32 m0, s36, 7168
    s_nop 0
    buffer_load_dword v21, s[28:31], s34 offen lds
    s_mov_b32 s34, 622080
    s_add_u32 m0, s36, 7424
    s_nop 0
    buffer_load_dword v21, s[28:31], s34 offen lds
    s_mov_b32 s34, 635904
    s_add_u32 m0, s36, 7680
    s_nop 0
    buffer_load_dword v21, s[28:31], s34 offen lds
    s_mov_b32 s34, 649728
    s_add_u32 m0, s36, 7936
    s_nop 0
    buffer_load_dword v21, s[28:31], s34 offen lds
    ds_read_b64_tr_b16 a[16:17], v22 offset:8192
    ds_read_b64_tr_b16 a[18:19], v22 offset:8448
    s_waitcnt vmcnt(56) lgkmcnt(0)
    s_mov_b32 s34, 663552
    s_add_u32 m0, s36, 8192
    s_nop 0
    buffer_load_dword v20, s[28:31], s34 offen lds
    s_mov_b32 s34, 677376
    s_add_u32 m0, s36, 8448
    s_nop 0
    buffer_load_dword v20, s[28:31], s34 offen lds
    s_mov_b32 s34, 691200
    s_add_u32 m0, s36, 8704
    s_nop 0
    buffer_load_dword v20, s[28:31], s34 offen lds
    s_mov_b32 s34, 705024
    s_add_u32 m0, s36, 8960
    s_nop 0
    buffer_load_dword v20, s[28:31], s34 offen lds
    ds_read_b64_tr_b16 a[160:161], v22 offset:9216
    ds_read_b64_tr_b16 a[162:163], v22 offset:9472
    s_waitcnt vmcnt(56) lgkmcnt(0)
    s_mov_b32 s34, 663552
    s_add_u32 m0, s36, 9216
    s_nop 0
    buffer_load_dword v21, s[28:31], s34 offen lds
    s_mov_b32 s34, 677376
    s_add_u32 m0, s36, 9472
    s_nop 0
    buffer_load_dword v21, s[28:31], s34 offen lds
    s_mov_b32 s34, 691200
    s_add_u32 m0, s36, 9728
    s_nop 0
    buffer_load_dword v21, s[28:31], s34 offen lds
    s_mov_b32 s34, 705024
    s_add_u32 m0, s36, 9984
    s_nop 0
    buffer_load_dword v21, s[28:31], s34 offen lds
    ds_read_b64_tr_b16 a[20:21], v22 offset:10240
    ds_read_b64_tr_b16 a[22:23], v22 offset:10496
    s_waitcnt vmcnt(56) lgkmcnt(0)
    s_mov_b32 s34, 718848
    s_add_u32 m0, s36, 10240
    s_nop 0
    buffer_load_dword v20, s[28:31], s34 offen lds
    s_mov_b32 s34, 732672
    s_add_u32 m0, s36, 10496
    s_nop 0
    buffer_load_dword v20, s[28:31], s34 offen lds
    s_mov_b32 s34, 746496
    s_add_u32 m0, s36, 10752
    s_nop 0
    buffer_load_dword v20, s[28:31], s34 offen lds
    s_mov_b32 s34, 760320
    s_add_u32 m0, s36, 11008
    s_nop 0
    buffer_load_dword v20, s[28:31], s34 offen lds
    ds_read_b64_tr_b16 a[164:165], v22 offset:11264
    ds_read_b64_tr_b16 a[166:167], v22 offset:11520
    s_waitcnt vmcnt(56) lgkmcnt(0)
    s_mov_b32 s34, 718848
    s_add_u32 m0, s36, 11264
    s_nop 0
    buffer_load_dword v21, s[28:31], s34 offen lds
    s_mov_b32 s34, 732672
    s_add_u32 m0, s36, 11520
    s_nop 0
    buffer_load_dword v21, s[28:31], s34 offen lds
    s_mov_b32 s34, 746496
    s_add_u32 m0, s36, 11776
    s_nop 0
    buffer_load_dword v21, s[28:31], s34 offen lds
    s_mov_b32 s34, 760320
    s_add_u32 m0, s36, 12032
    s_nop 0
    buffer_load_dword v21, s[28:31], s34 offen lds
    ds_read_b64_tr_b16 a[24:25], v22 offset:12288
    ds_read_b64_tr_b16 a[26:27], v22 offset:12544
    s_waitcnt vmcnt(56) lgkmcnt(0)
    s_mov_b32 s34, 774144
    s_add_u32 m0, s36, 12288
    s_nop 0
    buffer_load_dword v20, s[28:31], s34 offen lds
    s_mov_b32 s34, 787968
    s_add_u32 m0, s36, 12544
    s_nop 0
    buffer_load_dword v20, s[28:31], s34 offen lds
    s_mov_b32 s34, 801792
    s_add_u32 m0, s36, 12800
    s_nop 0
    buffer_load_dword v20, s[28:31], s34 offen lds
    s_mov_b32 s34, 815616
    s_add_u32 m0, s36, 13056
    s_nop 0
    buffer_load_dword v20, s[28:31], s34 offen lds
    ds_read_b64_tr_b16 a[168:169], v22 offset:13312
    ds_read_b64_tr_b16 a[170:171], v22 offset:13568
    s_waitcnt vmcnt(56) lgkmcnt(0)
    s_mov_b32 s34, 774144
    s_add_u32 m0, s36, 13312
    s_nop 0
    buffer_load_dword v21, s[28:31], s34 offen lds
    s_mov_b32 s34, 787968
    s_add_u32 m0, s36, 13568
    s_nop 0
    buffer_load_dword v21, s[28:31], s34 offen lds
    s_mov_b32 s34, 801792
    s_add_u32 m0, s36, 13824
    s_nop 0
    buffer_load_dword v21, s[28:31], s34 offen lds
    s_mov_b32 s34, 815616
    s_add_u32 m0, s36, 14080
    s_nop 0
    buffer_load_dword v21, s[28:31], s34 offen lds
    ds_read_b64_tr_b16 a[28:29], v22 offset:14336
    ds_read_b64_tr_b16 a[30:31], v22 offset:14592
    s_waitcnt vmcnt(56) lgkmcnt(0)
    s_mov_b32 s34, 829440
    s_add_u32 m0, s36, 14336
    s_nop 0
    buffer_load_dword v20, s[28:31], s34 offen lds
    s_mov_b32 s34, 843264
    s_add_u32 m0, s36, 14592
    s_nop 0
    buffer_load_dword v20, s[28:31], s34 offen lds
    s_mov_b32 s34, 857088
    s_add_u32 m0, s36, 14848
    s_nop 0
    buffer_load_dword v20, s[28:31], s34 offen lds
    s_mov_b32 s34, 870912
    s_add_u32 m0, s36, 15104
    s_nop 0
    buffer_load_dword v20, s[28:31], s34 offen lds
    ds_read_b64_tr_b16 a[172:173], v22 offset:15360
    ds_read_b64_tr_b16 a[174:175], v22 offset:15616
    s_waitcnt vmcnt(56) lgkmcnt(0)
    s_mov_b32 s34, 829440
    s_add_u32 m0, s36, 15360
    s_nop 0
    buffer_load_dword v21, s[28:31], s34 offen lds
    s_mov_b32 s34, 843264
    s_add_u32 m0, s36, 15616
    s_nop 0
    buffer_load_dword v21, s[28:31], s34 offen lds
    s_mov_b32 s34, 857088
    s_add_u32 m0, s36, 15872
    s_nop 0
    buffer_load_dword v21, s[28:31], s34 offen lds
    s_mov_b32 s34, 870912
    s_add_u32 m0, s36, 16128
    s_nop 0
    buffer_load_dword v21, s[28:31], s34 offen lds
    ds_read_b64_tr_b16 a[32:33], v22 offset:0
    ds_read_b64_tr_b16 a[34:35], v22 offset:256
    s_waitcnt vmcnt(56) lgkmcnt(0)
    s_mov_b32 s34, 884736
    s_add_u32 m0, s36, 0
    s_nop 0
    buffer_load_dword v20, s[28:31], s34 offen lds
    s_mov_b32 s34, 898560
    s_add_u32 m0, s36, 256
    s_nop 0
    buffer_load_dword v20, s[28:31], s34 offen lds
    s_mov_b32 s34, 912384
    s_add_u32 m0, s36, 512
    s_nop 0
    buffer_load_dword v20, s[28:31], s34 offen lds
    s_mov_b32 s34, 926208
    s_add_u32 m0, s36, 768
    s_nop 0
    buffer_load_dword v20, s[28:31], s34 offen lds
    ds_read_b64_tr_b16 a[176:177], v22 offset:1024
    ds_read_b64_tr_b16 a[178:179], v22 offset:1280
    s_waitcnt vmcnt(56) lgkmcnt(0)
    s_mov_b32 s34, 884736
    s_add_u32 m0, s36, 1024
    s_nop 0
    buffer_load_dword v21, s[28:31], s34 offen lds
    s_mov_b32 s34, 898560
    s_add_u32 m0, s36, 1280
    s_nop 0
    buffer_load_dword v21, s[28:31], s34 offen lds
    s_mov_b32 s34, 912384
    s_add_u32 m0, s36, 1536
    s_nop 0
    buffer_load_dword v21, s[28:31], s34 offen lds
    s_mov_b32 s34, 926208
    s_add_u32 m0, s36, 1792
    s_nop 0
    buffer_load_dword v21, s[28:31], s34 offen lds
    ds_read_b64_tr_b16 a[36:37], v22 offset:2048
    ds_read_b64_tr_b16 a[38:39], v22 offset:2304
    s_waitcnt vmcnt(56) lgkmcnt(0)
    s_mov_b32 s34, 940032
    s_add_u32 m0, s36, 2048
    s_nop 0
    buffer_load_dword v20, s[28:31], s34 offen lds
    s_mov_b32 s34, 953856
    s_add_u32 m0, s36, 2304
    s_nop 0
    buffer_load_dword v20, s[28:31], s34 offen lds
    s_mov_b32 s34, 967680
    s_add_u32 m0, s36, 2560
    s_nop 0
    buffer_load_dword v20, s[28:31], s34 offen lds
    s_mov_b32 s34, 981504
    s_add_u32 m0, s36, 2816
    s_nop 0
    buffer_load_dword v20, s[28:31], s34 offen lds
    ds_read_b64_tr_b16 a[180:181], v22 offset:3072
    ds_read_b64_tr_b16 a[182:183], v22 offset:3328
    s_waitcnt vmcnt(56) lgkmcnt(0)
    s_mov_b32 s34, 940032
    s_add_u32 m0, s36, 3072
    s_nop 0
    buffer_load_dword v21, s[28:31], s34 offen lds
    s_mov_b32 s34, 953856
    s_add_u32 m0, s36, 3328
    s_nop 0
    buffer_load_dword v21, s[28:31], s34 offen lds
    s_mov_b32 s34, 967680
    s_add_u32 m0, s36, 3584
    s_nop 0
    buffer_load_dword v21, s[28:31], s34 offen lds
    s_mov_b32 s34, 981504
    s_add_u32 m0, s36, 3840
    s_nop 0
    buffer_load_dword v21, s[28:31], s34 offen lds
    ds_read_b64_tr_b16 a[40:41], v22 offset:4096
    ds_read_b64_tr_b16 a[42:43], v22 offset:4352
    s_waitcnt vmcnt(56) lgkmcnt(0)
    s_mov_b32 s34, 995328
    s_add_u32 m0, s36, 4096
    s_nop 0
    buffer_load_dword v20, s[28:31], s34 offen lds
    s_mov_b32 s34, 1009152
    s_add_u32 m0, s36, 4352
    s_nop 0
    buffer_load_dword v20, s[28:31], s34 offen lds
    s_mov_b32 s34, 1022976
    s_add_u32 m0, s36, 4608
    s_nop 0
    buffer_load_dword v20, s[28:31], s34 offen lds
    s_mov_b32 s34, 1036800
    s_add_u32 m0, s36, 4864
    s_nop 0
    buffer_load_dword v20, s[28:31], s34 offen lds
    ds_read_b64_tr_b16 a[184:185], v22 offset:5120
    ds_read_b64_tr_b16 a[186:187], v22 offset:5376
    s_waitcnt vmcnt(56) lgkmcnt(0)
    s_mov_b32 s34, 995328
    s_add_u32 m0, s36, 5120
    s_nop 0
    buffer_load_dword v21, s[28:31], s34 offen lds
    s_mov_b32 s34, 1009152
    s_add_u32 m0, s36, 5376
    s_nop 0
    buffer_load_dword v21, s[28:31], s34 offen lds
    s_mov_b32 s34, 1022976
    s_add_u32 m0, s36, 5632
    s_nop 0
    buffer_load_dword v21, s[28:31], s34 offen lds
    s_mov_b32 s34, 1036800
    s_add_u32 m0, s36, 5888
    s_nop 0
    buffer_load_dword v21, s[28:31], s34 offen lds
    ds_read_b64_tr_b16 a[44:45], v22 offset:6144
    ds_read_b64_tr_b16 a[46:47], v22 offset:6400
    s_waitcnt vmcnt(56) lgkmcnt(0)
    s_mov_b32 s34, 1050624
    s_add_u32 m0, s36, 6144
    s_nop 0
    buffer_load_dword v20, s[28:31], s34 offen lds
    s_mov_b32 s34, 1064448
    s_add_u32 m0, s36, 6400
    s_nop 0
    buffer_load_dword v20, s[28:31], s34 offen lds
    s_mov_b32 s34, 1078272
    s_add_u32 m0, s36, 6656
    s_nop 0
    buffer_load_dword v20, s[28:31], s34 offen lds
    s_mov_b32 s34, 1092096
    s_add_u32 m0, s36, 6912
    s_nop 0
    buffer_load_dword v20, s[28:31], s34 offen lds
    ds_read_b64_tr_b16 a[188:189], v22 offset:7168
    ds_read_b64_tr_b16 a[190:191], v22 offset:7424
    s_waitcnt vmcnt(56) lgkmcnt(0)
    s_mov_b32 s34, 1050624
    s_add_u32 m0, s36, 7168
    s_nop 0
    buffer_load_dword v21, s[28:31], s34 offen lds
    s_mov_b32 s34, 1064448
    s_add_u32 m0, s36, 7424
    s_nop 0
    buffer_load_dword v21, s[28:31], s34 offen lds
    s_mov_b32 s34, 1078272
    s_add_u32 m0, s36, 7680
    s_nop 0
    buffer_load_dword v21, s[28:31], s34 offen lds
    s_mov_b32 s34, 1092096
    s_add_u32 m0, s36, 7936
    s_nop 0
    buffer_load_dword v21, s[28:31], s34 offen lds
    ds_read_b64_tr_b16 a[48:49], v22 offset:8192
    ds_read_b64_tr_b16 a[50:51], v22 offset:8448
    s_waitcnt vmcnt(56) lgkmcnt(0)
    s_mov_b32 s34, 1105920
    s_add_u32 m0, s36, 8192
    s_nop 0
    buffer_load_dword v20, s[28:31], s34 offen lds
    s_mov_b32 s34, 1119744
    s_add_u32 m0, s36, 8448
    s_nop 0
    buffer_load_dword v20, s[28:31], s34 offen lds
    s_mov_b32 s34, 1133568
    s_add_u32 m0, s36, 8704
    s_nop 0
    buffer_load_dword v20, s[28:31], s34 offen lds
    s_mov_b32 s34, 1147392
    s_add_u32 m0, s36, 8960
    s_nop 0
    buffer_load_dword v20, s[28:31], s34 offen lds
    ds_read_b64_tr_b16 a[192:193], v22 offset:9216
    ds_read_b64_tr_b16 a[194:195], v22 offset:9472
    s_waitcnt vmcnt(56) lgkmcnt(0)
    s_mov_b32 s34, 1105920
    s_add_u32 m0, s36, 9216
    s_nop 0
    buffer_load_dword v21, s[28:31], s34 offen lds
    s_mov_b32 s34, 1119744
    s_add_u32 m0, s36, 9472
    s_nop 0
    buffer_load_dword v21, s[28:31], s34 offen lds
    s_mov_b32 s34, 1133568
    s_add_u32 m0, s36, 9728
    s_nop 0
    buffer_load_dword v21, s[28:31], s34 offen lds
    s_mov_b32 s34, 1147392
    s_add_u32 m0, s36, 9984
    s_nop 0
    buffer_load_dword v21, s[28:31], s34 offen lds
    ds_read_b64_tr_b16 a[52:53], v22 offset:10240
    ds_read_b64_tr_b16 a[54:55], v22 offset:10496
    s_waitcnt vmcnt(56) lgkmcnt(0)
    s_mov_b32 s34, 1161216
    s_add_u32 m0, s36, 10240
    s_nop 0
    buffer_load_dword v20, s[28:31], s34 offen lds
    s_mov_b32 s34, 1175040
    s_add_u32 m0, s36, 10496
    s_nop 0
    buffer_load_dword v20, s[28:31], s34 offen lds
    s_mov_b32 s34, 1188864
    s_add_u32 m0, s36, 10752
    s_nop 0
    buffer_load_dword v20, s[28:31], s34 offen lds
    s_mov_b32 s34, 1202688
    s_add_u32 m0, s36, 11008
    s_nop 0
    buffer_load_dword v20, s[28:31], s34 offen lds
    ds_read_b64_tr_b16 a[196:197], v22 offset:11264
    ds_read_b64_tr_b16 a[198:199], v22 offset:11520
    s_waitcnt vmcnt(56) lgkmcnt(0)
    s_mov_b32 s34, 1161216
    s_add_u32 m0, s36, 11264
    s_nop 0
    buffer_load_dword v21, s[28:31], s34 offen lds
    s_mov_b32 s34, 1175040
    s_add_u32 m0, s36, 11520
    s_nop 0
    buffer_load_dword v21, s[28:31], s34 offen lds
    s_mov_b32 s34, 1188864
    s_add_u32 m0, s36, 11776
    s_nop 0
    buffer_load_dword v21, s[28:31], s34 offen lds
    s_mov_b32 s34, 1202688
    s_add_u32 m0, s36, 12032
    s_nop 0
    buffer_load_dword v21, s[28:31], s34 offen lds
    ds_read_b64_tr_b16 a[56:57], v22 offset:12288
    ds_read_b64_tr_b16 a[58:59], v22 offset:12544
    s_waitcnt vmcnt(56) lgkmcnt(0)
    s_mov_b32 s34, 1216512
    s_add_u32 m0, s36, 12288
    s_nop 0
    buffer_load_dword v20, s[28:31], s34 offen lds
    s_mov_b32 s34, 1230336
    s_add_u32 m0, s36, 12544
    s_nop 0
    buffer_load_dword v20, s[28:31], s34 offen lds
    s_mov_b32 s34, 1244160
    s_add_u32 m0, s36, 12800
    s_nop 0
    buffer_load_dword v20, s[28:31], s34 offen lds
    s_mov_b32 s34, 1257984
    s_add_u32 m0, s36, 13056
    s_nop 0
    buffer_load_dword v20, s[28:31], s34 offen lds
    ds_read_b64_tr_b16 a[200:201], v22 offset:13312
    ds_read_b64_tr_b16 a[202:203], v22 offset:13568
    s_waitcnt vmcnt(56) lgkmcnt(0)
    s_mov_b32 s34, 1216512
    s_add_u32 m0, s36, 13312
    s_nop 0
    buffer_load_dword v21, s[28:31], s34 offen lds
    s_mov_b32 s34, 1230336
    s_add_u32 m0, s36, 13568
    s_nop 0
    buffer_load_dword v21, s[28:31], s34 offen lds
    s_mov_b32 s34, 1244160
    s_add_u32 m0, s36, 13824
    s_nop 0
    buffer_load_dword v21, s[28:31], s34 offen lds
    s_mov_b32 s34, 1257984
    s_add_u32 m0, s36, 14080
    s_nop 0
    buffer_load_dword v21, s[28:31], s34 offen lds
    ds_read_b64_tr_b16 a[60:61], v22 offset:14336
    ds_read_b64_tr_b16 a[62:63], v22 offset:14592
    s_waitcnt vmcnt(56) lgkmcnt(0)
    s_mov_b32 s34, 1271808
    s_add_u32 m0, s36, 14336
    s_nop 0
    buffer_load_dword v20, s[28:31], s34 offen lds
    s_mov_b32 s34, 1285632
    s_add_u32 m0, s36, 14592
    s_nop 0
    buffer_load_dword v20, s[28:31], s34 offen lds
    s_mov_b32 s34, 1299456
    s_add_u32 m0, s36, 14848
    s_nop 0
    buffer_load_dword v20, s[28:31], s34 offen lds
    s_mov_b32 s34, 1313280
    s_add_u32 m0, s36, 15104
    s_nop 0
    buffer_load_dword v20, s[28:31], s34 offen lds
    ds_read_b64_tr_b16 a[204:205], v22 offset:15360
    ds_read_b64_tr_b16 a[206:207], v22 offset:15616
    s_waitcnt vmcnt(56) lgkmcnt(0)
    s_mov_b32 s34, 1271808
    s_add_u32 m0, s36, 15360
    s_nop 0
    buffer_load_dword v21, s[28:31], s34 offen lds
    s_mov_b32 s34, 1285632
    s_add_u32 m0, s36, 15616
    s_nop 0
    buffer_load_dword v21, s[28:31], s34 offen lds
    s_mov_b32 s34, 1299456
    s_add_u32 m0, s36, 15872
    s_nop 0
    buffer_load_dword v21, s[28:31], s34 offen lds
    s_mov_b32 s34, 1313280
    s_add_u32 m0, s36, 16128
    s_nop 0
    buffer_load_dword v21, s[28:31], s34 offen lds
    ds_read_b64_tr_b16 a[64:65], v22 offset:0
    ds_read_b64_tr_b16 a[66:67], v22 offset:256
    s_waitcnt vmcnt(56) lgkmcnt(0)
    s_mov_b32 s34, 1327104
    s_add_u32 m0, s36, 0
    s_nop 0
    buffer_load_dword v20, s[28:31], s34 offen lds
    s_mov_b32 s34, 1340928
    s_add_u32 m0, s36, 256
    s_nop 0
    buffer_load_dword v20, s[28:31], s34 offen lds
    s_mov_b32 s34, 1354752
    s_add_u32 m0, s36, 512
    s_nop 0
    buffer_load_dword v20, s[28:31], s34 offen lds
    s_mov_b32 s34, 1368576
    s_add_u32 m0, s36, 768
    s_nop 0
    buffer_load_dword v20, s[28:31], s34 offen lds
    ds_read_b64_tr_b16 a[208:209], v22 offset:1024
    ds_read_b64_tr_b16 a[210:211], v22 offset:1280
    s_waitcnt vmcnt(56) lgkmcnt(0)
    s_mov_b32 s34, 1327104
    s_add_u32 m0, s36, 1024
    s_nop 0
    buffer_load_dword v21, s[28:31], s34 offen lds
    s_mov_b32 s34, 1340928
    s_add_u32 m0, s36, 1280
    s_nop 0
    buffer_load_dword v21, s[28:31], s34 offen lds
    s_mov_b32 s34, 1354752
    s_add_u32 m0, s36, 1536
    s_nop 0
    buffer_load_dword v21, s[28:31], s34 offen lds
    s_mov_b32 s34, 1368576
    s_add_u32 m0, s36, 1792
    s_nop 0
    buffer_load_dword v21, s[28:31], s34 offen lds
    ds_read_b64_tr_b16 a[68:69], v22 offset:2048
    ds_read_b64_tr_b16 a[70:71], v22 offset:2304
    s_waitcnt vmcnt(56) lgkmcnt(0)
    s_mov_b32 s34, 1382400
    s_add_u32 m0, s36, 2048
    s_nop 0
    buffer_load_dword v20, s[28:31], s34 offen lds
    s_mov_b32 s34, 1396224
    s_add_u32 m0, s36, 2304
    s_nop 0
    buffer_load_dword v20, s[28:31], s34 offen lds
    s_mov_b32 s34, 1410048
    s_add_u32 m0, s36, 2560
    s_nop 0
    buffer_load_dword v20, s[28:31], s34 offen lds
    s_mov_b32 s34, 1423872
    s_add_u32 m0, s36, 2816
    s_nop 0
    buffer_load_dword v20, s[28:31], s34 offen lds
    ds_read_b64_tr_b16 a[212:213], v22 offset:3072
    ds_read_b64_tr_b16 a[214:215], v22 offset:3328
    s_waitcnt vmcnt(56) lgkmcnt(0)
    s_mov_b32 s34, 1382400
    s_add_u32 m0, s36, 3072
    s_nop 0
    buffer_load_dword v21, s[28:31], s34 offen lds
    s_mov_b32 s34, 1396224
    s_add_u32 m0, s36, 3328
    s_nop 0
    buffer_load_dword v21, s[28:31], s34 offen lds
    s_mov_b32 s34, 1410048
    s_add_u32 m0, s36, 3584
    s_nop 0
    buffer_load_dword v21, s[28:31], s34 offen lds
    s_mov_b32 s34, 1423872
    s_add_u32 m0, s36, 3840
    s_nop 0
    buffer_load_dword v21, s[28:31], s34 offen lds
    ds_read_b64_tr_b16 a[72:73], v22 offset:4096
    ds_read_b64_tr_b16 a[74:75], v22 offset:4352
    s_waitcnt vmcnt(56) lgkmcnt(0)
    s_mov_b32 s34, 1437696
    s_add_u32 m0, s36, 4096
    s_nop 0
    buffer_load_dword v20, s[28:31], s34 offen lds
    s_mov_b32 s34, 1451520
    s_add_u32 m0, s36, 4352
    s_nop 0
    buffer_load_dword v20, s[28:31], s34 offen lds
    s_mov_b32 s34, 1465344
    s_add_u32 m0, s36, 4608
    s_nop 0
    buffer_load_dword v20, s[28:31], s34 offen lds
    s_mov_b32 s34, 1479168
    s_add_u32 m0, s36, 4864
    s_nop 0
    buffer_load_dword v20, s[28:31], s34 offen lds
    ds_read_b64_tr_b16 a[216:217], v22 offset:5120
    ds_read_b64_tr_b16 a[218:219], v22 offset:5376
    s_waitcnt vmcnt(56) lgkmcnt(0)
    s_mov_b32 s34, 1437696
    s_add_u32 m0, s36, 5120
    s_nop 0
    buffer_load_dword v21, s[28:31], s34 offen lds
    s_mov_b32 s34, 1451520
    s_add_u32 m0, s36, 5376
    s_nop 0
    buffer_load_dword v21, s[28:31], s34 offen lds
    s_mov_b32 s34, 1465344
    s_add_u32 m0, s36, 5632
    s_nop 0
    buffer_load_dword v21, s[28:31], s34 offen lds
    s_mov_b32 s34, 1479168
    s_add_u32 m0, s36, 5888
    s_nop 0
    buffer_load_dword v21, s[28:31], s34 offen lds
    ds_read_b64_tr_b16 a[76:77], v22 offset:6144
    ds_read_b64_tr_b16 a[78:79], v22 offset:6400
    s_waitcnt vmcnt(56) lgkmcnt(0)
    s_mov_b32 s34, 1492992
    s_add_u32 m0, s36, 6144
    s_nop 0
    buffer_load_dword v20, s[28:31], s34 offen lds
    s_mov_b32 s34, 1506816
    s_add_u32 m0, s36, 6400
    s_nop 0
    buffer_load_dword v20, s[28:31], s34 offen lds
    s_mov_b32 s34, 1520640
    s_add_u32 m0, s36, 6656
    s_nop 0
    buffer_load_dword v20, s[28:31], s34 offen lds
    s_mov_b32 s34, 1534464
    s_add_u32 m0, s36, 6912
    s_nop 0
    buffer_load_dword v20, s[28:31], s34 offen lds
    ds_read_b64_tr_b16 a[220:221], v22 offset:7168
    ds_read_b64_tr_b16 a[222:223], v22 offset:7424
    s_waitcnt vmcnt(56) lgkmcnt(0)
    s_mov_b32 s34, 1492992
    s_add_u32 m0, s36, 7168
    s_nop 0
    buffer_load_dword v21, s[28:31], s34 offen lds
    s_mov_b32 s34, 1506816
    s_add_u32 m0, s36, 7424
    s_nop 0
    buffer_load_dword v21, s[28:31], s34 offen lds
    s_mov_b32 s34, 1520640
    s_add_u32 m0, s36, 7680
    s_nop 0
    buffer_load_dword v21, s[28:31], s34 offen lds
    s_mov_b32 s34, 1534464
    s_add_u32 m0, s36, 7936
    s_nop 0
    buffer_load_dword v21, s[28:31], s34 offen lds
    ds_read_b64_tr_b16 a[80:81], v22 offset:8192
    ds_read_b64_tr_b16 a[82:83], v22 offset:8448
    s_waitcnt vmcnt(56) lgkmcnt(0)
    s_mov_b32 s34, 1548288
    s_add_u32 m0, s36, 8192
    s_nop 0
    buffer_load_dword v20, s[28:31], s34 offen lds
    s_mov_b32 s34, 1562112
    s_add_u32 m0, s36, 8448
    s_nop 0
    buffer_load_dword v20, s[28:31], s34 offen lds
    s_mov_b32 s34, 1575936
    s_add_u32 m0, s36, 8704
    s_nop 0
    buffer_load_dword v20, s[28:31], s34 offen lds
    s_mov_b32 s34, 1589760
    s_add_u32 m0, s36, 8960
    s_nop 0
    buffer_load_dword v20, s[28:31], s34 offen lds
    ds_read_b64_tr_b16 a[224:225], v22 offset:9216
    ds_read_b64_tr_b16 a[226:227], v22 offset:9472
    s_waitcnt vmcnt(56) lgkmcnt(0)
    s_mov_b32 s34, 1548288
    s_add_u32 m0, s36, 9216
    s_nop 0
    buffer_load_dword v21, s[28:31], s34 offen lds
    s_mov_b32 s34, 1562112
    s_add_u32 m0, s36, 9472
    s_nop 0
    buffer_load_dword v21, s[28:31], s34 offen lds
    s_mov_b32 s34, 1575936
    s_add_u32 m0, s36, 9728
    s_nop 0
    buffer_load_dword v21, s[28:31], s34 offen lds
    s_mov_b32 s34, 1589760
    s_add_u32 m0, s36, 9984
    s_nop 0
    buffer_load_dword v21, s[28:31], s34 offen lds
    ds_read_b64_tr_b16 a[84:85], v22 offset:10240
    ds_read_b64_tr_b16 a[86:87], v22 offset:10496
    s_waitcnt vmcnt(56) lgkmcnt(0)
    s_mov_b32 s34, 1603584
    s_add_u32 m0, s36, 10240
    s_nop 0
    buffer_load_dword v20, s[28:31], s34 offen lds
    s_mov_b32 s34, 1617408
    s_add_u32 m0, s36, 10496
    s_nop 0
    buffer_load_dword v20, s[28:31], s34 offen lds
    s_mov_b32 s34, 1631232
    s_add_u32 m0, s36, 10752
    s_nop 0
    buffer_load_dword v20, s[28:31], s34 offen lds
    s_mov_b32 s34, 1645056
    s_add_u32 m0, s36, 11008
    s_nop 0
    buffer_load_dword v20, s[28:31], s34 offen lds
    ds_read_b64_tr_b16 a[228:229], v22 offset:11264
    ds_read_b64_tr_b16 a[230:231], v22 offset:11520
    s_waitcnt vmcnt(56) lgkmcnt(0)
    s_mov_b32 s34, 1603584
    s_add_u32 m0, s36, 11264
    s_nop 0
    buffer_load_dword v21, s[28:31], s34 offen lds
    s_mov_b32 s34, 1617408
    s_add_u32 m0, s36, 11520
    s_nop 0
    buffer_load_dword v21, s[28:31], s34 offen lds
    s_mov_b32 s34, 1631232
    s_add_u32 m0, s36, 11776
    s_nop 0
    buffer_load_dword v21, s[28:31], s34 offen lds
    s_mov_b32 s34, 1645056
    s_add_u32 m0, s36, 12032
    s_nop 0
    buffer_load_dword v21, s[28:31], s34 offen lds
    ds_read_b64_tr_b16 a[88:89], v22 offset:12288
    ds_read_b64_tr_b16 a[90:91], v22 offset:12544
    s_waitcnt vmcnt(56) lgkmcnt(0)
    s_mov_b32 s34, 1658880
    s_add_u32 m0, s36, 12288
    s_nop 0
    buffer_load_dword v20, s[28:31], s34 offen lds
    s_mov_b32 s34, 1672704
    s_add_u32 m0, s36, 12544
    s_nop 0
    buffer_load_dword v20, s[28:31], s34 offen lds
    s_mov_b32 s34, 1686528
    s_add_u32 m0, s36, 12800
    s_nop 0
    buffer_load_dword v20, s[28:31], s34 offen lds
    s_mov_b32 s34, 1700352
    s_add_u32 m0, s36, 13056
    s_nop 0
    buffer_load_dword v20, s[28:31], s34 offen lds
    ds_read_b64_tr_b16 a[232:233], v22 offset:13312
    ds_read_b64_tr_b16 a[234:235], v22 offset:13568
    s_waitcnt vmcnt(56) lgkmcnt(0)
    s_mov_b32 s34, 1658880
    s_add_u32 m0, s36, 13312
    s_nop 0
    buffer_load_dword v21, s[28:31], s34 offen lds
    s_mov_b32 s34, 1672704
    s_add_u32 m0, s36, 13568
    s_nop 0
    buffer_load_dword v21, s[28:31], s34 offen lds
    s_mov_b32 s34, 1686528
    s_add_u32 m0, s36, 13824
    s_nop 0
    buffer_load_dword v21, s[28:31], s34 offen lds
    s_mov_b32 s34, 1700352
    s_add_u32 m0, s36, 14080
    s_nop 0
    buffer_load_dword v21, s[28:31], s34 offen lds
    ds_read_b64_tr_b16 a[92:93], v22 offset:14336
    ds_read_b64_tr_b16 a[94:95], v22 offset:14592
    s_waitcnt vmcnt(56) lgkmcnt(0)
    s_mov_b32 s34, 1714176
    s_add_u32 m0, s36, 14336
    s_nop 0
    buffer_load_dword v20, s[28:31], s34 offen lds
    s_mov_b32 s34, 1728000
    s_add_u32 m0, s36, 14592
    s_nop 0
    buffer_load_dword v20, s[28:31], s34 offen lds
    s_mov_b32 s34, 1741824
    s_add_u32 m0, s36, 14848
    s_nop 0
    buffer_load_dword v20, s[28:31], s34 offen lds
    s_mov_b32 s34, 1755648
    s_add_u32 m0, s36, 15104
    s_nop 0
    buffer_load_dword v20, s[28:31], s34 offen lds
    ds_read_b64_tr_b16 a[236:237], v22 offset:15360
    ds_read_b64_tr_b16 a[238:239], v22 offset:15616
    s_waitcnt vmcnt(56) lgkmcnt(0)
    s_mov_b32 s34, 1714176
    s_add_u32 m0, s36, 15360
    s_nop 0
    buffer_load_dword v21, s[28:31], s34 offen lds
    s_mov_b32 s34, 1728000
    s_add_u32 m0, s36, 15616
    s_nop 0
    buffer_load_dword v21, s[28:31], s34 offen lds
    s_mov_b32 s34, 1741824
    s_add_u32 m0, s36, 15872
    s_nop 0
    buffer_load_dword v21, s[28:31], s34 offen lds
    s_mov_b32 s34, 1755648
    s_add_u32 m0, s36, 16128
    s_nop 0
    buffer_load_dword v21, s[28:31], s34 offen lds
    ds_read_b64_tr_b16 a[96:97], v22 offset:0
    ds_read_b64_tr_b16 a[98:99], v22 offset:256
    s_waitcnt vmcnt(56) lgkmcnt(0)
    s_mov_b32 s34, 1769472
    s_add_u32 m0, s36, 0
    s_nop 0
    buffer_load_dword v20, s[28:31], s34 offen lds
    s_mov_b32 s34, 1783296
    s_add_u32 m0, s36, 256
    s_nop 0
    buffer_load_dword v20, s[28:31], s34 offen lds
    s_mov_b32 s34, 1797120
    s_add_u32 m0, s36, 512
    s_nop 0
    buffer_load_dword v20, s[28:31], s34 offen lds
    s_mov_b32 s34, 1810944
    s_add_u32 m0, s36, 768
    s_nop 0
    buffer_load_dword v20, s[28:31], s34 offen lds
    ds_read_b64_tr_b16 a[240:241], v22 offset:1024
    ds_read_b64_tr_b16 a[242:243], v22 offset:1280
    s_waitcnt vmcnt(56) lgkmcnt(0)
    s_mov_b32 s34, 1769472
    s_add_u32 m0, s36, 1024
    s_nop 0
    buffer_load_dword v21, s[28:31], s34 offen lds
    s_mov_b32 s34, 1783296
    s_add_u32 m0, s36, 1280
    s_nop 0
    buffer_load_dword v21, s[28:31], s34 offen lds
    s_mov_b32 s34, 1797120
    s_add_u32 m0, s36, 1536
    s_nop 0
    buffer_load_dword v21, s[28:31], s34 offen lds
    s_mov_b32 s34, 1810944
    s_add_u32 m0, s36, 1792
    s_nop 0
    buffer_load_dword v21, s[28:31], s34 offen lds
    ds_read_b64_tr_b16 a[100:101], v22 offset:2048
    ds_read_b64_tr_b16 a[102:103], v22 offset:2304
    s_waitcnt vmcnt(56) lgkmcnt(0)
    s_mov_b32 s34, 1824768
    s_add_u32 m0, s36, 2048
    s_nop 0
    buffer_load_dword v20, s[28:31], s34 offen lds
    s_mov_b32 s34, 1838592
    s_add_u32 m0, s36, 2304
    s_nop 0
    buffer_load_dword v20, s[28:31], s34 offen lds
    s_mov_b32 s34, 1852416
    s_add_u32 m0, s36, 2560
    s_nop 0
    buffer_load_dword v20, s[28:31], s34 offen lds
    s_mov_b32 s34, 1866240
    s_add_u32 m0, s36, 2816
    s_nop 0
    buffer_load_dword v20, s[28:31], s34 offen lds
    ds_read_b64_tr_b16 a[244:245], v22 offset:3072
    ds_read_b64_tr_b16 a[246:247], v22 offset:3328
    s_waitcnt vmcnt(56) lgkmcnt(0)
    s_mov_b32 s34, 1824768
    s_add_u32 m0, s36, 3072
    s_nop 0
    buffer_load_dword v21, s[28:31], s34 offen lds
    s_mov_b32 s34, 1838592
    s_add_u32 m0, s36, 3328
    s_nop 0
    buffer_load_dword v21, s[28:31], s34 offen lds
    s_mov_b32 s34, 1852416
    s_add_u32 m0, s36, 3584
    s_nop 0
    buffer_load_dword v21, s[28:31], s34 offen lds
    s_mov_b32 s34, 1866240
    s_add_u32 m0, s36, 3840
    s_nop 0
    buffer_load_dword v21, s[28:31], s34 offen lds
    ds_read_b64_tr_b16 a[104:105], v22 offset:4096
    ds_read_b64_tr_b16 a[106:107], v22 offset:4352
    s_waitcnt vmcnt(56) lgkmcnt(0)
    s_mov_b32 s34, 1880064
    s_add_u32 m0, s36, 4096
    s_nop 0
    buffer_load_dword v20, s[28:31], s34 offen lds
    s_mov_b32 s34, 1893888
    s_add_u32 m0, s36, 4352
    s_nop 0
    buffer_load_dword v20, s[28:31], s34 offen lds
    s_mov_b32 s34, 1907712
    s_add_u32 m0, s36, 4608
    s_nop 0
    buffer_load_dword v20, s[28:31], s34 offen lds
    s_mov_b32 s34, 1921536
    s_add_u32 m0, s36, 4864
    s_nop 0
    buffer_load_dword v20, s[28:31], s34 offen lds
    ds_read_b64_tr_b16 a[248:249], v22 offset:5120
    ds_read_b64_tr_b16 a[250:251], v22 offset:5376
    s_waitcnt vmcnt(56) lgkmcnt(0)
    s_mov_b32 s34, 1880064
    s_add_u32 m0, s36, 5120
    s_nop 0
    buffer_load_dword v21, s[28:31], s34 offen lds
    s_mov_b32 s34, 1893888
    s_add_u32 m0, s36, 5376
    s_nop 0
    buffer_load_dword v21, s[28:31], s34 offen lds
    s_mov_b32 s34, 1907712
    s_add_u32 m0, s36, 5632
    s_nop 0
    buffer_load_dword v21, s[28:31], s34 offen lds
    s_mov_b32 s34, 1921536
    s_add_u32 m0, s36, 5888
    s_nop 0
    buffer_load_dword v21, s[28:31], s34 offen lds
    ds_read_b64_tr_b16 a[108:109], v22 offset:6144
    ds_read_b64_tr_b16 a[110:111], v22 offset:6400
    s_waitcnt vmcnt(56) lgkmcnt(0)
    s_mov_b32 s34, 1935360
    s_add_u32 m0, s36, 6144
    s_nop 0
    buffer_load_dword v20, s[28:31], s34 offen lds
    s_mov_b32 s34, 1949184
    s_add_u32 m0, s36, 6400
    s_nop 0
    buffer_load_dword v20, s[28:31], s34 offen lds
    s_mov_b32 s34, 1963008
    s_add_u32 m0, s36, 6656
    s_nop 0
    buffer_load_dword v20, s[28:31], s34 offen lds
    s_mov_b32 s34, 1976832
    s_add_u32 m0, s36, 6912
    s_nop 0
    buffer_load_dword v20, s[28:31], s34 offen lds
    ds_read_b64_tr_b16 a[252:253], v22 offset:7168
    ds_read_b64_tr_b16 a[254:255], v22 offset:7424
    s_waitcnt vmcnt(56) lgkmcnt(0)
    s_mov_b32 s34, 1935360
    s_add_u32 m0, s36, 7168
    s_nop 0
    buffer_load_dword v21, s[28:31], s34 offen lds
    s_mov_b32 s34, 1949184
    s_add_u32 m0, s36, 7424
    s_nop 0
    buffer_load_dword v21, s[28:31], s34 offen lds
    s_mov_b32 s34, 1963008
    s_add_u32 m0, s36, 7680
    s_nop 0
    buffer_load_dword v21, s[28:31], s34 offen lds
    s_mov_b32 s34, 1976832
    s_add_u32 m0, s36, 7936
    s_nop 0
    buffer_load_dword v21, s[28:31], s34 offen lds
    ds_read_b64_tr_b16 a[112:113], v22 offset:8192
    ds_read_b64_tr_b16 a[114:115], v22 offset:8448
    s_waitcnt vmcnt(56) lgkmcnt(0)
    ds_read_b64_tr_b16 v[128:129], v22 offset:9216
    ds_read_b64_tr_b16 v[130:131], v22 offset:9472
    s_waitcnt vmcnt(52) lgkmcnt(0)
    ds_read_b64_tr_b16 a[116:117], v22 offset:10240
    ds_read_b64_tr_b16 a[118:119], v22 offset:10496
    s_waitcnt vmcnt(48) lgkmcnt(0)
    ds_read_b64_tr_b16 v[132:133], v22 offset:11264
    ds_read_b64_tr_b16 v[134:135], v22 offset:11520
    s_waitcnt vmcnt(44) lgkmcnt(0)
    ds_read_b64_tr_b16 a[120:121], v22 offset:12288
    ds_read_b64_tr_b16 a[122:123], v22 offset:12544
    s_waitcnt vmcnt(40) lgkmcnt(0)
    ds_read_b64_tr_b16 v[136:137], v22 offset:13312
    ds_read_b64_tr_b16 v[138:139], v22 offset:13568
    s_waitcnt vmcnt(36) lgkmcnt(0)
    ds_read_b64_tr_b16 a[124:125], v22 offset:14336
    ds_read_b64_tr_b16 a[126:127], v22 offset:14592
    s_waitcnt vmcnt(32) lgkmcnt(0)
    ds_read_b64_tr_b16 v[140:141], v22 offset:15360
    ds_read_b64_tr_b16 v[142:143], v22 offset:15616
    s_waitcnt vmcnt(28) lgkmcnt(0)
    ds_read_b64_tr_b16 a[128:129], v22 offset:0
    ds_read_b64_tr_b16 a[130:131], v22 offset:256
    s_waitcnt vmcnt(24) lgkmcnt(0)
    ds_read_b64_tr_b16 v[144:145], v22 offset:1024
    ds_read_b64_tr_b16 v[146:147], v22 offset:1280
    s_waitcnt vmcnt(20) lgkmcnt(0)
    ds_read_b64_tr_b16 a[132:133], v22 offset:2048
    ds_read_b64_tr_b16 a[134:135], v22 offset:2304
    s_waitcnt vmcnt(16) lgkmcnt(0)
    ds_read_b64_tr_b16 v[148:149], v22 offset:3072
    ds_read_b64_tr_b16 v[150:151], v22 offset:3328
    s_waitcnt vmcnt(12) lgkmcnt(0)
    ds_read_b64_tr_b16 a[136:137], v22 offset:4096
    ds_read_b64_tr_b16 a[138:139], v22 offset:4352
    s_waitcnt vmcnt(8) lgkmcnt(0)
    ds_read_b64_tr_b16 v[152:153], v22 offset:5120
    ds_read_b64_tr_b16 v[154:155], v22 offset:5376
    s_waitcnt vmcnt(4) lgkmcnt(0)
    ds_read_b64_tr_b16 a[140:141], v22 offset:6144
    ds_read_b64_tr_b16 a[142:143], v22 offset:6400
    s_waitcnt vmcnt(0) lgkmcnt(0)
    ds_read_b64_tr_b16 v[156:157], v22 offset:7168
    ds_read_b64_tr_b16 v[158:159], v22 offset:7424
    s_waitcnt lgkmcnt(0)
    s_barrier
    v_lshrrev_b32 v27, 3, v24
    v_and_b32 v1, 7, v24
    v_xor_b32 v1, v1, v27
    s_lshr_b32 s34, s20, 1
    v_xor_b32 v1, s34, v1
    s_lshl_b32 s34, s20, 3
    v_add_u32 v27, s34, v27
    v_mul_u32_u24 v27, 1152, v27
    v_lshl_add_u32 v1, v1, 4, v27
    v_mov_b32 v12, s39
    v_mov_b32 v13, s39
    v_mov_b32 v14, s39
    v_mov_b32 v15, s39
    s_nop 1
    v_mfma_f32_32x32x16_bf16 v[160:175], a[0:3], v[12:15], 0
    v_mfma_f32_32x32x16_bf16 v[176:191], v[12:15], a[144:147], 0
    v_mfma_f32_32x32x16_bf16 v[160:175], a[4:7], v[12:15], v[160:175]
    v_mfma_f32_32x32x16_bf16 v[176:191], v[12:15], a[148:151], v[176:191]
    v_mfma_f32_32x32x16_bf16 v[160:175], a[8:11], v[12:15], v[160:175]
    v_mfma_f32_32x32x16_bf16 v[176:191], v[12:15], a[152:155], v[176:191]
    v_mfma_f32_32x32x16_bf16 v[160:175], a[12:15], v[12:15], v[160:175]
    v_mfma_f32_32x32x16_bf16 v[176:191], v[12:15], a[156:159], v[176:191]
    v_mfma_f32_32x32x16_bf16 v[160:175], a[16:19], v[12:15], v[160:175]
    v_mfma_f32_32x32x16_bf16 v[176:191], v[12:15], a[160:163], v[176:191]
    v_mfma_f32_32x32x16_bf16 v[160:175], a[20:23], v[12:15], v[160:175]
    v_mfma_f32_32x32x16_bf16 v[176:191], v[12:15], a[164:167], v[176:191]
    v_mfma_f32_32x32x16_bf16 v[160:175], a[24:27], v[12:15], v[160:175]
    v_mfma_f32_32x32x16_bf16 v[176:191], v[12:15], a[168:171], v[176:191]
    v_mfma_f32_32x32x16_bf16 v[160:175], a[28:31], v[12:15], v[160:175]
    v_mfma_f32_32x32x16_bf16 v[176:191], v[12:15], a[172:175], v[176:191]
    v_mfma_f32_32x32x16_bf16 v[160:175], a[32:35], v[12:15], v[160:175]
    v_mfma_f32_32x32x16_bf16 v[176:191], v[12:15], a[176:179], v[176:191]
    v_mfma_f32_32x32x16_bf16 v[160:175], a[36:39], v[12:15], v[160:175]
    v_mfma_f32_32x32x16_bf16 v[176:191], v[12:15], a[180:183], v[176:191]
    v_mfma_f32_32x32x16_bf16 v[160:175], a[40:43], v[12:15], v[160:175]
    v_mfma_f32_32x32x16_bf16 v[176:191], v[12:15], a[184:187], v[176:191]
    v_mfma_f32_32x32x16_bf16 v[160:175], a[44:47], v[12:15], v[160:175]
    v_mfma_f32_32x32x16_bf16 v[176:191], v[12:15], a[188:191], v[176:191]
    v_mfma_f32_32x32x16_bf16 v[160:175], a[48:51], v[12:15], v[160:175]
    v_mfma_f32_32x32x16_bf16 v[176:191], v[12:15], a[192:195], v[176:191]
    v_mfma_f32_32x32x16_bf16 v[160:175], a[52:55], v[12:15], v[160:175]
    v_mfma_f32_32x32x16_bf16 v[176:191], v[12:15], a[196:199], v[176:191]
    v_mfma_f32_32x32x16_bf16 v[160:175], a[56:59], v[12:15], v[160:175]
    v_mfma_f32_32x32x16_bf16 v[176:191], v[12:15], a[200:203], v[176:191]
    v_mfma_f32_32x32x16_bf16 v[160:175], a[60:63], v[12:15], v[160:175]
    v_mfma_f32_32x32x16_bf16 v[176:191], v[12:15], a[204:207], v[176:191]
    v_mfma_f32_32x32x16_bf16 v[160:175], a[64:67], v[12:15], v[160:175]
    v_mfma_f32_32x32x16_bf16 v[176:191], v[12:15], a[208:211], v[176:191]
    v_mfma_f32_32x32x16_bf16 v[160:175], a[68:71], v[12:15], v[160:175]
    v_mfma_f32_32x32x16_bf16 v[176:191], v[12:15], a[212:215], v[176:191]
    v_mfma_f32_32x32x16_bf16 v[160:175], a[72:75], v[12:15], v[160:175]
    v_mfma_f32_32x32x16_bf16 v[176:191], v[12:15], a[216:219], v[176:191]
    v_mfma_f32_32x32x16_bf16 v[160:175], a[76:79], v[12:15], v[160:175]
    v_mfma_f32_32x32x16_bf16 v[176:191], v[12:15], a[220:223], v[176:191]
    v_mfma_f32_32x32x16_bf16 v[160:175], a[80:83], v[12:15], v[160:175]
    v_mfma_f32_32x32x16_bf16 v[176:191], v[12:15], a[224:227], v[176:191]
    v_mfma_f32_32x32x16_bf16 v[160:175], a[84:87], v[12:15], v[160:175]
    v_mfma_f32_32x32x16_bf16 v[176:191], v[12:15], a[228:231], v[176:191]
    v_mfma_f32_32x32x16_bf16 v[160:175], a[88:91], v[12:15], v[160:175]
    v_mfma_f32_32x32x16_bf16 v[176:191], v[12:15], a[232:235], v[176:191]
    v_mfma_f32_32x32x16_bf16 v[160:175], a[92:95], v[12:15], v[160:175]
    v_mfma_f32_32x32x16_bf16 v[176:191], v[12:15], a[236:239], v[176:191]
    v_mfma_f32_32x32x16_bf16 v[160:175], a[96:99], v[12:15], v[160:175]
    v_mfma_f32_32x32x16_bf16 v[176:191], v[12:15], a[240:243], v[176:191]
    v_mfma_f32_32x32x16_bf16 v[160:175], a[100:103], v[12:15], v[160:175]
    v_mfma_f32_32x32x16_bf16 v[176:191], v[12:15], a[244:247], v[176:191]
    v_mfma_f32_32x32x16_bf16 v[160:175], a[104:107], v[12:15], v[160:175]
    v_mfma_f32_32x32x16_bf16 v[176:191], v[12:15], a[248:251], v[176:191]
    v_mfma_f32_32x32x16_bf16 v[160:175], a[108:111], v[12:15], v[160:175]
    v_mfma_f32_32x32x16_bf16 v[176:191], v[12:15], a[252:255], v[176:191]
    v_mfma_f32_32x32x16_bf16 v[160:175], a[112:115], v[12:15], v[160:175]
    v_mfma_f32_32x32x16_bf16 v[176:191], v[12:15], v[128:131], v[176:191]
    v_mfma_f32_32x32x16_bf16 v[160:175], a[116:119], v[12:15], v[160:175]
    v_mfma_f32_32x32x16_bf16 v[176:191], v[12:15], v[132:135], v[176:191]
    v_mfma_f32_32x32x16_bf16 v[160:175], a[120:123], v[12:15], v[160:175]
    v_mfma_f32_32x32x16_bf16 v[176:191], v[12:15], v[136:139], v[176:191]
    v_mfma_f32_32x32x16_bf16 v[160:175], a[124:127], v[12:15], v[160:175]
    v_mfma_f32_32x32x16_bf16 v[176:191], v[12:15], v[140:143], v[176:191]
    v_mfma_f32_32x32x16_bf16 v[160:175], a[128:131], v[12:15], v[160:175]
    v_mfma_f32_32x32x16_bf16 v[176:191], v[12:15], v[144:147], v[176:191]
    v_mfma_f32_32x32x16_bf16 v[160:175], a[132:135], v[12:15], v[160:175]
    v_mfma_f32_32x32x16_bf16 v[176:191], v[12:15], v[148:151], v[176:191]
    v_mfma_f32_32x32x16_bf16 v[160:175], a[136:139], v[12:15], v[160:175]
    v_mfma_f32_32x32x16_bf16 v[176:191], v[12:15], v[152:155], v[176:191]
    v_mfma_f32_32x32x16_bf16 v[160:175], a[140:143], v[12:15], v[160:175]
    v_mfma_f32_32x32x16_bf16 v[176:191], v[12:15], v[156:159], v[176:191]
    v_lshlrev_b32 v0, 4, v24
    v_and_b32 v25, 31, v24
    v_lshrrev_b32 v26, 5, v24
    v_mul_u32_u24 v27, 18, v26
    v_add_u32 v27, v27, v25
    v_lshlrev_b32 v27, 4, v27
    v_mov_b32 v28, 1073741824
    v_cmp_gt_u32 vcc, 18, v25
    s_nop 1
    v_cndmask_b32 v2, v28, v27, vcc
    v_lshlrev_b32 v27, 4, v26
    v_add_u32 v29, 3328, v27
    v_add_u32 v27, 1024, v27
    v_cmp_eq_u32 vcc, 20, v25
    s_nop 1
    v_cndmask_b32 v28, v28, v27, vcc
    v_cmp_eq_u32 vcc, 18, v25
    s_nop 1
    v_cndmask_b32 v3, v28, v29, vcc
    v_mov_b32 v27, s43
    v_cndmask_b32 v6, 1.0, v27, vcc
    v_and_b32 v27, 7, v24
    v_xor_b32 v28, v27, v26
    v_bfe_u32 v29, v24, 4, 1
    v_xor_b32 v28, v28, v29
    v_lshlrev_b32 v28, 4, v28
    v_lshl_add_u32 v28, v27, 7, v28
    v_lshrrev_b32 v27, 3, v25
    v_mul_u32_u24 v27, 9216, v27
    v_add_u32 v8, v28, v27
    s_mul_i32 s34, s20, 9216
    v_add_u32 v7, s34, v0
    v_lshrrev_b32 v27, 3, v24
    s_lshl_b32 s34, s20, 5
    s_add_u32 s34, s34, 36864
    v_lshl_add_u32 v60, v27, 2, s34
    v_lshlrev_b32 v27, 2, v25
    v_add_u32 v61, 36864, v27
    v_lshlrev_b32 v62, 4, v26
    v_min_u32 v27, 11, v24
    v_lshlrev_b32 v63, 7, v27
    v_xor_b32 v9, 32, v8
    v_xor_b32 v10, 64, v8
    v_xor_b32 v11, 96, v8
    s_mov_b32 s32, 0
    s_add_u32 s16, s88, 1671168
    s_addc_u32 s17, s89, 0
    s_mov_b32 s18, 2359296
    s_mov_b32 s19, 0x20000
L_i25:
    v_mov_b32 v4, 0
    global_load_dword v5, v4, s[86:87] offset:12 sc1
    global_load_dword v4, v4, s[86:87] offset:128 sc1
    s_add_u32 s37, s37, 1
    s_waitcnt vmcnt(0)
    v_min_u32 v5, 32, v5
    v_min_u32 v4, 224, v4
    v_add_u32 v5, v5, v4
    v_cmp_gt_u32 vcc, 256, v5
    s_nop 0
    s_cbranch_vccz L_i25_d
    s_sleep 4
    s_cmp_lt_u32 s37, 400000
    s_cbranch_scc1 L_i25
L_i25_d:
    s_lshl_b32 s44, s40, 7
    s_lshr_b32 s35, s20, 1
    s_mul_i32 s35, s35, 48
    s_add_u32 s44, s44, s35
    s_lshl_b32 s44, s44, 5
    s_add_u32 s44, s44, 421888
L_qw_layer:
    s_mov_b32 s33, s40
    v_mov_b32 v64, 0
L_qw_loop:
    s_lshl_b32 s38, s32, 6
    s_add_u32 s38, s38, s33
    s_add_u32 s38, s38, 1
    v_cmp_gt_u32 vcc, s38, v64
    s_nop 0
    s_cbranch_vccz L_qw_go
    v_mov_b32 v4, v63
L_w26:
    buffer_load_dword v5, v4, s[12:15], s44 offen sc1
    s_add_u32 s37, s37, 1
    s_waitcnt vmcnt(0)
    v_cmp_gt_u32 vcc, s38, v5
    s_nop 0
    s_cbranch_vccz L_w26_d
    s_sleep 1
    s_cmp_lt_u32 s37, 400000
    s_cbranch_scc1 L_w26
L_w26_d:
L_qw_go:
    s_mul_i32 s34, s33, 36864
    s_mul_i32 s35, s20, 9216
    s_add_u32 m0, s35, 0
    s_nop 0
    buffer_load_dwordx4 v1, s[16:19], s34 offen offset:0 sc1 lds
    s_add_u32 m0, s35, 896
    s_nop 0
    buffer_load_dwordx4 v1, s[16:19], s34 offen offset:128 sc1 lds
    s_add_u32 m0, s35, 1792
    s_nop 0
    buffer_load_dwordx4 v1, s[16:19], s34 offen offset:256 sc1 lds
    s_add_u32 m0, s35, 2688
    s_nop 0
    buffer_load_dwordx4 v1, s[16:19], s34 offen offset:384 sc1 lds
    s_add_u32 m0, s35, 3584
    s_nop 0
    buffer_load_dwordx4 v1, s[16:19], s34 offen offset:512 sc1 lds
    s_add_u32 m0, s35, 4480
    s_nop 0
    buffer_load_dwordx4 v1, s[16:19], s34 offen offset:640 sc1 lds
    s_add_u32 m0, s35, 5376
    s_nop 0
    buffer_load_dwordx4 v1, s[16:19], s34 offen offset:768 sc1 lds
    s_add_u32 m0, s35, 6272
    s_nop 0
    buffer_load_dwordx4 v1, s[16:19], s34 offen offset:896 sc1 lds
    s_add_u32 m0, s35, 7168
    s_nop 0
    buffer_load_dwordx4 v1, s[16:19], s34 offen offset:1024 sc1 lds
    s_sub_u32 s34, s38, 1
    s_lshl_b32 s34, s34, 5
    s_add_u32 s34, s34, s41
    s_mul_i32 s34, s34, 3584
    s_add_u32 s34, s34, 13467648
    s_waitcnt vmcnt(0)
    s_barrier
    ds_read_b128 v[12:15], v8 offset:0
    ds_read_b128 v[16:19], v9 offset:0
    ds_read_b128 v[20:23], v10 offset:0
    s_waitcnt lgkmcnt(2)
    v_mfma_f32_32x32x16_bf16 v[28:43], a[0:3], v[12:15], 0
    ds_read_b128 v[24:27], v11 offset:0
    ds_read_b128 v[80:83], v7 offset:0
    ds_read_b128 v[84:87], v7 offset:1024
    v_mov_b32 v72, 0
    v_mov_b32 v73, 0
    v_mfma_f32_32x32x16_bf16 v[44:59], v[12:15], a[144:147], 0
    s_waitcnt lgkmcnt(1)
    v_lshlrev_b32 v74, 16, v80
    v_and_b32 v75, 0xffff0000, v80
    v_mfma_f32_32x32x16_bf16 v[28:43], a[4:7], v[16:19], v[28:43]
    ds_read_b128 v[12:15], v8 offset:1024
    v_add_f32 v72, v72, v74
    v_fmac_f32 v73, v74, v74
    v_add_f32 v72, v72, v75
    v_fmac_f32 v73, v75, v75
    v_lshlrev_b32 v74, 16, v81
    v_mfma_f32_32x32x16_bf16 v[44:59], v[16:19], a[148:151], v[44:59]
    v_and_b32 v75, 0xffff0000, v81
    v_add_f32 v72, v72, v74
    v_fmac_f32 v73, v74, v74
    v_add_f32 v72, v72, v75
    v_fmac_f32 v73, v75, v75
    v_mfma_f32_32x32x16_bf16 v[28:43], a[8:11], v[20:23], v[28:43]
    ds_read_b128 v[16:19], v9 offset:1024
    v_lshlrev_b32 v74, 16, v82
    v_and_b32 v75, 0xffff0000, v82
    v_add_f32 v72, v72, v74
    v_fmac_f32 v73, v74, v74
    v_add_f32 v72, v72, v75
    v_mfma_f32_32x32x16_bf16 v[44:59], v[20:23], a[152:155], v[44:59]
    v_fmac_f32 v73, v75, v75
    v_lshlrev_b32 v74, 16, v83
    v_and_b32 v75, 0xffff0000, v83
    ds_read_b128 v[80:83], v7 offset:2048
    v_add_f32 v72, v72, v74
    v_fmac_f32 v73, v74, v74
    v_mfma_f32_32x32x16_bf16 v[28:43], a[12:15], v[24:27], v[28:43]
    ds_read_b128 v[20:23], v10 offset:1024
    v_add_f32 v72, v72, v75
    v_fmac_f32 v73, v75, v75
    s_waitcnt lgkmcnt(4)
    v_lshlrev_b32 v74, 16, v84
    v_and_b32 v75, 0xffff0000, v84
    v_add_f32 v72, v72, v74
    v_mfma_f32_32x32x16_bf16 v[44:59], v[24:27], a[156:159], v[44:59]
    v_fmac_f32 v73, v74, v74
    v_add_f32 v72, v72, v75
    v_fmac_f32 v73, v75, v75
    v_lshlrev_b32 v74, 16, v85
    v_and_b32 v75, 0xffff0000, v85
    s_waitcnt lgkmcnt(3)
    v_mfma_f32_32x32x16_bf16 v[28:43], a[16:19], v[12:15], v[28:43]
    ds_read_b128 v[24:27], v11 offset:1024
    v_add_f32 v72, v72, v74
    v_fmac_f32 v73, v74, v74
    v_add_f32 v72, v72, v75
    v_fmac_f32 v73, v75, v75
    v_lshlrev_b32 v74, 16, v86
    v_mfma_f32_32x32x16_bf16 v[44:59], v[12:15], a[160:163], v[44:59]
    v_and_b32 v75, 0xffff0000, v86
    v_add_f32 v72, v72, v74
    v_fmac_f32 v73, v74, v74
    v_add_f32 v72, v72, v75
    v_fmac_f32 v73, v75, v75
    s_waitcnt lgkmcnt(3)
    v_mfma_f32_32x32x16_bf16 v[28:43], a[20:23], v[16:19], v[28:43]
    ds_read_b128 v[12:15], v8 offset:2048
    v_lshlrev_b32 v74, 16, v87
    v_and_b32 v75, 0xffff0000, v87
    ds_read_b128 v[84:87], v7 offset:3072
    v_add_f32 v72, v72, v74
    v_fmac_f32 v73, v74, v74
    v_add_f32 v72, v72, v75
    v_mfma_f32_32x32x16_bf16 v[44:59], v[16:19], a[164:167], v[44:59]
    v_fmac_f32 v73, v75, v75
    s_waitcnt lgkmcnt(4)
    v_lshlrev_b32 v74, 16, v80
    v_and_b32 v75, 0xffff0000, v80
    v_add_f32 v72, v72, v74
    v_fmac_f32 v73, v74, v74
    s_waitcnt lgkmcnt(3)
    v_mfma_f32_32x32x16_bf16 v[28:43], a[24:27], v[20:23], v[28:43]
    ds_read_b128 v[16:19], v9 offset:2048
    v_add_f32 v72, v72, v75
    v_fmac_f32 v73, v75, v75
    v_lshlrev_b32 v74, 16, v81
    v_and_b32 v75, 0xffff0000, v81
    v_add_f32 v72, v72, v74
    v_mfma_f32_32x32x16_bf16 v[44:59], v[20:23], a[168:171], v[44:59]
    v_fmac_f32 v73, v74, v74
    v_add_f32 v72, v72, v75
    v_fmac_f32 v73, v75, v75
    v_lshlrev_b32 v74, 16, v82
    v_and_b32 v75, 0xffff0000, v82
    s_waitcnt lgkmcnt(3)
    v_mfma_f32_32x32x16_bf16 v[28:43], a[28:31], v[24:27], v[28:43]
    ds_read_b128 v[20:23], v10 offset:2048
    v_add_f32 v72, v72, v74
    v_fmac_f32 v73, v74, v74
    v_add_f32 v72, v72, v75
    v_fmac_f32 v73, v75, v75
    v_lshlrev_b32 v74, 16, v83
    v_mfma_f32_32x32x16_bf16 v[44:59], v[24:27], a[172:175], v[44:59]
    v_and_b32 v75, 0xffff0000, v83
    ds_read_b128 v[80:83], v7 offset:4096
    v_add_f32 v72, v72, v74
    v_fmac_f32 v73, v74, v74
    v_add_f32 v72, v72, v75
    v_fmac_f32 v73, v75, v75
    s_waitcnt lgkmcnt(4)
    v_mfma_f32_32x32x16_bf16 v[28:43], a[32:35], v[12:15], v[28:43]
    ds_read_b128 v[24:27], v11 offset:2048
    s_waitcnt lgkmcnt(4)
    v_lshlrev_b32 v74, 16, v84
    v_and_b32 v75, 0xffff0000, v84
    v_add_f32 v72, v72, v74
    v_fmac_f32 v73, v74, v74
    v_add_f32 v72, v72, v75
    v_mfma_f32_32x32x16_bf16 v[44:59], v[12:15], a[176:179], v[44:59]
    v_fmac_f32 v73, v75, v75
    v_lshlrev_b32 v74, 16, v85
    v_and_b32 v75, 0xffff0000, v85
    v_add_f32 v72, v72, v74
    v_fmac_f32 v73, v74, v74
    s_waitcnt lgkmcnt(3)
    v_mfma_f32_32x32x16_bf16 v[28:43], a[36:39], v[16:19], v[28:43]
    ds_read_b128 v[12:15], v8 offset:3072
    v_add_f32 v72, v72, v75
    v_fmac_f32 v73, v75, v75
    v_lshlrev_b32 v74, 16, v86
    v_and_b32 v75, 0xffff0000, v86
    v_add_f32 v72, v72, v74
    v_mfma_f32_32x32x16_bf16 v[44:59], v[16:19], a[180:183], v[44:59]
    v_fmac_f32 v73, v74, v74
    v_add_f32 v72, v72, v75
    v_fmac_f32 v73, v75, v75
    v_lshlrev_b32 v74, 16, v87
    v_and_b32 v75, 0xffff0000, v87
    s_waitcnt lgkmcnt(3)
    v_mfma_f32_32x32x16_bf16 v[28:43], a[40:43], v[20:23], v[28:43]
    ds_read_b128 v[16:19], v9 offset:3072
    ds_read_b128 v[84:87], v7 offset:5120
    v_add_f32 v72, v72, v74
    v_fmac_f32 v73, v74, v74
    v_add_f32 v72, v72, v75
    v_fmac_f32 v73, v75, v75
    s_waitcnt lgkmcnt(4)
    v_lshlrev_b32 v74, 16, v80
    v_mfma_f32_32x32x16_bf16 v[44:59], v[20:23], a[184:187], v[44:59]
    v_and_b32 v75, 0xffff0000, v80
    v_add_f32 v72, v72, v74
    v_fmac_f32 v73, v74, v74
    v_add_f32 v72, v72, v75
    v_fmac_f32 v73, v75, v75
    s_waitcnt lgkmcnt(3)
    v_mfma_f32_32x32x16_bf16 v[28:43], a[44:47], v[24:27], v[28:43]
    ds_read_b128 v[20:23], v10 offset:3072
    v_lshlrev_b32 v74, 16, v81
    v_and_b32 v75, 0xffff0000, v81
    v_add_f32 v72, v72, v74
    v_fmac_f32 v73, v74, v74
    v_add_f32 v72, v72, v75
    v_mfma_f32_32x32x16_bf16 v[44:59], v[24:27], a[188:191], v[44:59]
    v_fmac_f32 v73, v75, v75
    v_lshlrev_b32 v74, 16, v82
    v_and_b32 v75, 0xffff0000, v82
    v_add_f32 v72, v72, v74
    v_fmac_f32 v73, v74, v74
    s_waitcnt lgkmcnt(3)
    v_mfma_f32_32x32x16_bf16 v[28:43], a[48:51], v[12:15], v[28:43]
    ds_read_b128 v[24:27], v11 offset:3072
    v_add_f32 v72, v72, v75
    v_fmac_f32 v73, v75, v75
    v_lshlrev_b32 v74, 16, v83
    v_and_b32 v75, 0xffff0000, v83
    ds_read_b128 v[80:83], v7 offset:6144
    v_add_f32 v72, v72, v74
    v_mfma_f32_32x32x16_bf16 v[44:59], v[12:15], a[192:195], v[44:59]
    v_fmac_f32 v73, v74, v74
    v_add_f32 v72, v72, v75
    v_fmac_f32 v73, v75, v75
    s_waitcnt lgkmcnt(3)
    v_lshlrev_b32 v74, 16, v84
    v_and_b32 v75, 0xffff0000, v84
    v_mfma_f32_32x32x16_bf16 v[28:43], a[52:55], v[16:19], v[28:43]
    ds_read_b128 v[12:15], v8 offset:4096
    v_add_f32 v72, v72, v74
    v_fmac_f32 v73, v74, v74
    v_add_f32 v72, v72, v75
    v_fmac_f32 v73, v75, v75
    v_lshlrev_b32 v74, 16, v85
    v_mfma_f32_32x32x16_bf16 v[44:59], v[16:19], a[196:199], v[44:59]
    v_and_b32 v75, 0xffff0000, v85
    v_add_f32 v72, v72, v74
    v_fmac_f32 v73, v74, v74
    v_add_f32 v72, v72, v75
    v_fmac_f32 v73, v75, v75
    s_waitcnt lgkmcnt(3)
    v_mfma_f32_32x32x16_bf16 v[28:43], a[56:59], v[20:23], v[28:43]
    ds_read_b128 v[16:19], v9 offset:4096
    v_lshlrev_b32 v74, 16, v86
    v_and_b32 v75, 0xffff0000, v86
    v_add_f32 v72, v72, v74
    v_fmac_f32 v73, v74, v74
    v_add_f32 v72, v72, v75
    v_mfma_f32_32x32x16_bf16 v[44:59], v[20:23], a[200:203], v[44:59]
    v_fmac_f32 v73, v75, v75
    v_lshlrev_b32 v74, 16, v87
    v_and_b32 v75, 0xffff0000, v87
    ds_read_b128 v[84:87], v7 offset:7168
    v_add_f32 v72, v72, v74
    v_fmac_f32 v73, v74, v74
    s_waitcnt lgkmcnt(4)
    v_mfma_f32_32x32x16_bf16 v[28:43], a[60:63], v[24:27], v[28:43]
    ds_read_b128 v[20:23], v10 offset:4096
    v_add_f32 v72, v72, v75
    v_fmac_f32 v73, v75, v75
    s_waitcnt lgkmcnt(4)
    v_lshlrev_b32 v74, 16, v80
    v_and_b32 v75, 0xffff0000, v80
    v_add_f32 v72, v72, v74
    v_mfma_f32_32x32x16_bf16 v[44:59], v[24:27], a[204:207], v[44:59]
    v_fmac_f32 v73, v74, v74
    v_add_f32 v72, v72, v75
    v_fmac_f32 v73, v75, v75
    v_lshlrev_b32 v74, 16, v81
    v_and_b32 v75, 0xffff0000, v81
    s_waitcnt lgkmcnt(3)
    v_mfma_f32_32x32x16_bf16 v[28:43], a[64:67], v[12:15], v[28:43]
    ds_read_b128 v[24:27], v11 offset:4096
    v_add_f32 v72, v72, v74
    v_fmac_f32 v73, v74, v74
    v_add_f32 v72, v72, v75
    v_fmac_f32 v73, v75, v75
    v_lshlrev_b32 v74, 16, v82
    v_mfma_f32_32x32x16_bf16 v[44:59], v[12:15], a[208:211], v[44:59]
    v_and_b32 v75, 0xffff0000, v82
    v_add_f32 v72, v72, v74
    v_fmac_f32 v73, v74, v74
    v_add_f32 v72, v72, v75
    v_fmac_f32 v73, v75, v75
    s_waitcnt lgkmcnt(3)
    v_mfma_f32_32x32x16_bf16 v[28:43], a[68:71], v[16:19], v[28:43]
    ds_read_b128 v[12:15], v8 offset:5120
    v_lshlrev_b32 v74, 16, v83
    v_and_b32 v75, 0xffff0000, v83
    ds_read_b128 v[80:83], v7 offset:8192
    v_add_f32 v72, v72, v74
    v_fmac_f32 v73, v74, v74
    v_add_f32 v72, v72, v75
    v_mfma_f32_32x32x16_bf16 v[44:59], v[16:19], a[212:215], v[44:59]
    v_fmac_f32 v73, v75, v75
    s_waitcnt lgkmcnt(4)
    v_lshlrev_b32 v74, 16, v84
    v_and_b32 v75, 0xffff0000, v84
    v_add_f32 v72, v72, v74
    v_fmac_f32 v73, v74, v74
    s_waitcnt lgkmcnt(3)
    v_mfma_f32_32x32x16_bf16 v[28:43], a[72:75], v[20:23], v[28:43]
    ds_read_b128 v[16:19], v9 offset:5120
    v_add_f32 v72, v72, v75
    v_fmac_f32 v73, v75, v75
    v_lshlrev_b32 v74, 16, v85
    v_and_b32 v75, 0xffff0000, v85
    v_add_f32 v72, v72, v74
    v_mfma_f32_32x32x16_bf16 v[44:59], v[20:23], a[216:219], v[44:59]
    v_fmac_f32 v73, v74, v74
    v_add_f32 v72, v72, v75
    v_fmac_f32 v73, v75, v75
    v_lshlrev_b32 v74, 16, v86
    v_and_b32 v75, 0xffff0000, v86
    s_waitcnt lgkmcnt(3)
    v_mfma_f32_32x32x16_bf16 v[28:43], a[76:79], v[24:27], v[28:43]
    ds_read_b128 v[20:23], v10 offset:5120
    v_add_f32 v72, v72, v74
    v_fmac_f32 v73, v74, v74
    v_add_f32 v72, v72, v75
    v_fmac_f32 v73, v75, v75
    v_lshlrev_b32 v74, 16, v87
    v_mfma_f32_32x32x16_bf16 v[44:59], v[24:27], a[220:223], v[44:59]
    v_and_b32 v75, 0xffff0000, v87
    v_add_f32 v72, v72, v74
    v_fmac_f32 v73, v74, v74
    v_add_f32 v72, v72, v75
    v_fmac_f32 v73, v75, v75
    s_waitcnt lgkmcnt(3)
    v_mfma_f32_32x32x16_bf16 v[28:43], a[80:83], v[12:15], v[28:43]
    ds_read_b128 v[24:27], v11 offset:5120
    s_waitcnt lgkmcnt(3)
    v_lshlrev_b32 v74, 16, v80
    v_and_b32 v75, 0xffff0000, v80
    v_add_f32 v72, v72, v74
    v_fmac_f32 v73, v74, v74
    v_add_f32 v72, v72, v75
    v_mfma_f32_32x32x16_bf16 v[44:59], v[12:15], a[224:227], v[44:59]
    v_fmac_f32 v73, v75, v75
    v_lshlrev_b32 v74, 16, v81
    v_and_b32 v75, 0xffff0000, v81
    v_add_f32 v72, v72, v74
    v_fmac_f32 v73, v74, v74
    s_waitcnt lgkmcnt(2)
    v_mfma_f32_32x32x16_bf16 v[28:43], a[84:87], v[16:19], v[28:43]
    ds_read_b128 v[12:15], v8 offset:6144
    v_add_f32 v72, v72, v75
    v_fmac_f32 v73, v75, v75
    v_lshlrev_b32 v74, 16, v82
    v_and_b32 v75, 0xffff0000, v82
    v_add_f32 v72, v72, v74
    v_mfma_f32_32x32x16_bf16 v[44:59], v[16:19], a[228:231], v[44:59]
    v_fmac_f32 v73, v74, v74
    v_add_f32 v72, v72, v75
    v_fmac_f32 v73, v75, v75
    v_lshlrev_b32 v74, 16, v83
    v_and_b32 v75, 0xffff0000, v83
    s_waitcnt lgkmcnt(2)
    v_mfma_f32_32x32x16_bf16 v[28:43], a[88:91], v[20:23], v[28:43]
    ds_read_b128 v[16:19], v9 offset:6144
    v_add_f32 v72, v72, v74
    v_fmac_f32 v73, v74, v74
    v_add_f32 v72, v72, v75
    v_fmac_f32 v73, v75, v75
    s_nop 0
    v_add_f32_dpp v72, v72, v72 quad_perm:[1,0,3,2] row_mask:0xf bank_mask:0xf
    v_mfma_f32_32x32x16_bf16 v[44:59], v[20:23], a[232:235], v[44:59]
    v_add_f32_dpp v73, v73, v73 quad_perm:[1,0,3,2] row_mask:0xf bank_mask:0xf
    v_add_f32_dpp v72, v72, v72 quad_perm:[2,3,0,1] row_mask:0xf bank_mask:0xf
    s_nop 0
    v_add_f32_dpp v73, v73, v73 quad_perm:[2,3,0,1] row_mask:0xf bank_mask:0xf
    v_add_f32_dpp v72, v72, v72 row_half_mirror row_mask:0xf bank_mask:0xf
    s_nop 0
    v_add_f32_dpp v73, v73, v73 row_half_mirror row_mask:0xf bank_mask:0xf
    s_waitcnt lgkmcnt(2)
    v_mfma_f32_32x32x16_bf16 v[28:43], a[92:95], v[24:27], v[28:43]
    ds_read_b128 v[20:23], v10 offset:6144
    v_mul_f32 v72, 0x3ae38e39, v72
    v_mul_f32 v73, 0x3ae38e39, v73
    v_fma_f32 v73, -v72, v72, v73
    v_max_f32 v73, 0, v73
    v_add_f32 v73, 0x3727c5ac, v73
    v_mfma_f32_32x32x16_bf16 v[44:59], v[24:27], a[236:239], v[44:59]
    v_rsq_f32 v73, v73
    ds_write2_b32 v60, v72, v73 offset0:0 offset1:32
    s_waitcnt lgkmcnt(3)
    v_mfma_f32_32x32x16_bf16 v[28:43], a[96:99], v[12:15], v[28:43]
    ds_read_b128 v[24:27], v11 offset:6144
    v_mfma_f32_32x32x16_bf16 v[44:59], v[12:15], a[240:243], v[44:59]
    s_waitcnt lgkmcnt(0)
    s_barrier
    ds_read2_b32 v[64:65], v61 offset0:0 offset1:32
    v_mfma_f32_32x32x16_bf16 v[28:43], a[100:103], v[16:19], v[28:43]
    ds_read_b128 v[12:15], v8 offset:7168
    ds_read_b128 v[192:195], v62 offset:36864
    v_mfma_f32_32x32x16_bf16 v[44:59], v[16:19], a[244:247], v[44:59]
    ds_read_b128 v[208:211], v62 offset:36992
    ds_read_b128 v[196:199], v62 offset:36896
    v_mfma_f32_32x32x16_bf16 v[28:43], a[104:107], v[20:23], v[28:43]
    ds_read_b128 v[16:19], v9 offset:7168
    ds_read_b128 v[212:215], v62 offset:37024
    v_mfma_f32_32x32x16_bf16 v[44:59], v[20:23], a[248:251], v[44:59]
    ds_read_b128 v[200:203], v62 offset:36928
    v_mfma_f32_32x32x16_bf16 v[28:43], a[108:111], v[24:27], v[28:43]
    ds_read_b128 v[20:23], v10 offset:7168
    ds_read_b128 v[216:219], v62 offset:37056
    v_mfma_f32_32x32x16_bf16 v[44:59], v[24:27], a[252:255], v[44:59]
    ds_read_b128 v[204:207], v62 offset:36960
    ds_read_b128 v[220:223], v62 offset:37088
    s_waitcnt lgkmcnt(10)
    v_mfma_f32_32x32x16_bf16 v[28:43], a[112:115], v[12:15], v[28:43]
    ds_read_b128 v[24:27], v11 offset:7168
    v_mfma_f32_32x32x16_bf16 v[44:59], v[12:15], v[128:131], v[44:59]
    s_waitcnt lgkmcnt(7)
    v_mfma_f32_32x32x16_bf16 v[28:43], a[116:119], v[16:19], v[28:43]
    ds_read_b128 v[12:15], v8 offset:8192
    v_mfma_f32_32x32x16_bf16 v[44:59], v[16:19], v[132:135], v[44:59]
    s_waitcnt lgkmcnt(5)
    v_mfma_f32_32x32x16_bf16 v[28:43], a[120:123], v[20:23], v[28:43]
    ds_read_b128 v[16:19], v9 offset:8192
    v_mfma_f32_32x32x16_bf16 v[44:59], v[20:23], v[136:139], v[44:59]
    s_waitcnt lgkmcnt(2)
    v_mfma_f32_32x32x16_bf16 v[28:43], a[124:127], v[24:27], v[28:43]
    ds_read_b128 v[20:23], v10 offset:8192
    v_mfma_f32_32x32x16_bf16 v[44:59], v[24:27], v[140:143], v[44:59]
    s_waitcnt lgkmcnt(2)
    v_mfma_f32_32x32x16_bf16 v[28:43], a[128:131], v[12:15], v[28:43]
    ds_read_b128 v[24:27], v11 offset:8192
    v_mfma_f32_32x32x16_bf16 v[44:59], v[12:15], v[144:147], v[44:59]
    s_waitcnt lgkmcnt(2)
    v_mfma_f32_32x32x16_bf16 v[28:43], a[132:135], v[16:19], v[28:43]
    v_mfma_f32_32x32x16_bf16 v[44:59], v[16:19], v[148:151], v[44:59]
    s_waitcnt lgkmcnt(1)
    v_mfma_f32_32x32x16_bf16 v[28:43], a[136:139], v[20:23], v[28:43]
    v_mfma_f32_32x32x16_bf16 v[44:59], v[20:23], v[152:155], v[44:59]
    s_waitcnt lgkmcnt(0)
    v_mfma_f32_32x32x16_bf16 v[28:43], a[140:143], v[24:27], v[28:43]
    v_mfma_f32_32x32x16_bf16 v[44:59], v[24:27], v[156:159], v[44:59]
    v_mul_f32 v72, s43, v65
    s_nop 2
    v_fma_f32 v36, -v64, v168, v36
    v_fma_f32 v37, -v64, v169, v37
    v_fma_f32 v38, -v64, v170, v38
    v_fma_f32 v39, -v64, v171, v39
    v_fma_f32 v40, -v64, v172, v40
    v_fma_f32 v41, -v64, v173, v41
    v_fma_f32 v42, -v64, v174, v42
    v_fma_f32 v43, -v64, v175, v43
    v_mul_f32 v36, v36, v65
    v_mul_f32 v37, v37, v65
    v_mul_f32 v38, v38, v65
    v_mul_f32 v39, v39, v65
    v_mul_f32 v40, v40, v65
    v_mul_f32 v41, v41, v65
    v_mul_f32 v42, v42, v65
    v_mul_f32 v43, v43, v65
    v_cvt_pk_bf16_f32 v36, v36, v37
    v_cvt_pk_bf16_f32 v37, v38, v39
    v_cvt_pk_bf16_f32 v38, v40, v41
    v_cvt_pk_bf16_f32 v39, v42, v43
    buffer_store_dwordx4 v[36:39], v0, s[12:15], s34 offen offset:0 sc1
    v_fma_f32 v28, -v64, v160, v28
    v_fma_f32 v29, -v64, v161, v29
    v_fma_f32 v30, -v64, v162, v30
    v_fma_f32 v31, -v64, v163, v31
    v_fma_f32 v32, -v64, v164, v32
    v_fma_f32 v33, -v64, v165, v33
    v_fma_f32 v34, -v64, v166, v34
    v_fma_f32 v35, -v64, v167, v35
    v_mul_f32 v28, v28, v72
    v_mul_f32 v29, v29, v72
    v_mul_f32 v30, v30, v72
    v_mul_f32 v31, v31, v72
    v_mul_f32 v32, v32, v72
    v_mul_f32 v33, v33, v72
    v_mul_f32 v34, v34, v72
    v_mul_f32 v35, v35, v72
    v_cvt_pk_bf16_f32 v28, v28, v29
    v_cvt_pk_bf16_f32 v29, v30, v31
    v_cvt_pk_bf16_f32 v30, v32, v33
    v_cvt_pk_bf16_f32 v31, v34, v35
    buffer_store_dwordx4 v[28:31], v0, s[12:15], s34 offen offset:2304 sc1
    v_fma_f32 v44, -v192, v176, v44
    v_fma_f32 v45, -v193, v176, v45
    v_fma_f32 v46, -v194, v176, v46
    v_fma_f32 v47, -v195, v176, v47
    v_fma_f32 v48, -v196, v176, v48
    v_fma_f32 v49, -v197, v176, v49
    v_fma_f32 v50, -v198, v176, v50
    v_fma_f32 v51, -v199, v176, v51
    v_fma_f32 v52, -v200, v176, v52
    v_fma_f32 v53, -v201, v176, v53
    v_fma_f32 v54, -v202, v176, v54
    v_fma_f32 v55, -v203, v176, v55
    v_fma_f32 v56, -v204, v176, v56
    v_fma_f32 v57, -v205, v176, v57
    v_fma_f32 v58, -v206, v176, v58
    v_fma_f32 v59, -v207, v176, v59
    v_mul_f32 v44, v44, v208
    v_mul_f32 v45, v45, v209
    v_mul_f32 v46, v46, v210
    v_mul_f32 v47, v47, v211
    v_mul_f32 v48, v48, v212
    v_mul_f32 v49, v49, v213
    v_mul_f32 v50, v50, v214
    v_mul_f32 v51, v51, v215
    v_mul_f32 v52, v52, v216
    v_mul_f32 v53, v53, v217
    v_mul_f32 v54, v54, v218
    v_mul_f32 v55, v55, v219
    v_mul_f32 v56, v56, v220
    v_mul_f32 v57, v57, v221
    v_mul_f32 v58, v58, v222
    v_mul_f32 v59, v59, v223
    v_cvt_pk_bf16_f32 v96, v44, v45
    v_cvt_pk_bf16_f32 v97, v46, v47
    v_cvt_pk_bf16_f32 v98, v48, v49
    v_cvt_pk_bf16_f32 v99, v50, v51
    v_cvt_pk_bf16_f32 v100, v52, v53
    v_cvt_pk_bf16_f32 v101, v54, v55
    v_cvt_pk_bf16_f32 v102, v56, v57
    v_cvt_pk_bf16_f32 v103, v58, v59
    buffer_store_dwordx4 v[96:99], v2, s[12:15], s34 offen offset:1152 sc1
    buffer_store_dwordx4 v[100:103], v2, s[12:15], s34 offen offset:1728 sc1
    v_mul_f32_dpp v80, v44, v6 quad_perm:[1,1,3,3] row_mask:0xf bank_mask:0xf
    v_mul_f32 v44, v44, v6
    v_cvt_pk_bf16_f32 v80, v44, v80
    v_mul_f32_dpp v81, v45, v6 quad_perm:[1,1,3,3] row_mask:0xf bank_mask:0xf
    v_mul_f32 v45, v45, v6
    v_cvt_pk_bf16_f32 v81, v45, v81
    v_mul_f32_dpp v82, v46, v6 quad_perm:[1,1,3,3] row_mask:0xf bank_mask:0xf
    v_mul_f32 v46, v46, v6
    v_cvt_pk_bf16_f32 v82, v46, v82
    v_mul_f32_dpp v83, v47, v6 quad_perm:[1,1,3,3] row_mask:0xf bank_mask:0xf
    v_mul_f32 v47, v47, v6
    v_cvt_pk_bf16_f32 v83, v47, v83
    buffer_store_dwordx4 v[80:83], v3, s[12:15], s34 offen offset:0 sc1
    v_mul_f32_dpp v84, v48, v6 quad_perm:[1,1,3,3] row_mask:0xf bank_mask:0xf
    v_mul_f32 v48, v48, v6
    v_cvt_pk_bf16_f32 v84, v48, v84
    v_mul_f32_dpp v85, v49, v6 quad_perm:[1,1,3,3] row_mask:0xf bank_mask:0xf
    v_mul_f32 v49, v49, v6
    v_cvt_pk_bf16_f32 v85, v49, v85
    v_mul_f32_dpp v86, v50, v6 quad_perm:[1,1,3,3] row_mask:0xf bank_mask:0xf
    v_mul_f32 v50, v50, v6
    v_cvt_pk_bf16_f32 v86, v50, v86
    v_mul_f32_dpp v87, v51, v6 quad_perm:[1,1,3,3] row_mask:0xf bank_mask:0xf
    v_mul_f32 v51, v51, v6
    v_cvt_pk_bf16_f32 v87, v51, v87
    buffer_store_dwordx4 v[84:87], v3, s[12:15], s34 offen offset:32 sc1
    v_mul_f32_dpp v88, v52, v6 quad_perm:[1,1,3,3] row_mask:0xf bank_mask:0xf
    v_mul_f32 v52, v52, v6
    v_cvt_pk_bf16_f32 v88, v52, v88
    v_mul_f32_dpp v89, v53, v6 quad_perm:[1,1,3,3] row_mask:0xf bank_mask:0xf
    v_mul_f32 v53, v53, v6
    v_cvt_pk_bf16_f32 v89, v53, v89
    v_mul_f32_dpp v90, v54, v6 quad_perm:[1,1,3,3] row_mask:0xf bank_mask:0xf
    v_mul_f32 v54, v54, v6
    v_cvt_pk_bf16_f32 v90, v54, v90
    v_mul_f32_dpp v91, v55, v6 quad_perm:[1,1,3,3] row_mask:0xf bank_mask:0xf
    v_mul_f32 v55, v55, v6
    v_cvt_pk_bf16_f32 v91, v55, v91
    buffer_store_dwordx4 v[88:91], v3, s[12:15], s34 offen offset:64 sc1
    v_mul_f32_dpp v92, v56, v6 quad_perm:[1,1,3,3] row_mask:0xf bank_mask:0xf
    v_mul_f32 v56, v56, v6
    v_cvt_pk_bf16_f32 v92, v56, v92
    v_mul_f32_dpp v93, v57, v6 quad_perm:[1,1,3,3] row_mask:0xf bank_mask:0xf
    v_mul_f32 v57, v57, v6
    v_cvt_pk_bf16_f32 v93, v57, v93
    v_mul_f32_dpp v94, v58, v6 quad_perm:[1,1,3,3] row_mask:0xf bank_mask:0xf
    v_mul_f32 v58, v58, v6
    v_cvt_pk_bf16_f32 v94, v58, v94
    v_mul_f32_dpp v95, v59, v6 quad_perm:[1,1,3,3] row_mask:0xf bank_mask:0xf
    v_mul_f32 v59, v59, v6
    v_cvt_pk_bf16_f32 v95, v59, v95
    buffer_store_dwordx4 v[92:95], v3, s[12:15], s34 offen offset:96 sc1
    buffer_load_dword v64, v63, s[12:15], s44 offen sc1
    s_waitcnt vmcnt(0) lgkmcnt(0)
    s_barrier
    s_cmp_lg_u32 s20, 0
    s_cbranch_scc1 L_s27
    v_mov_b32 v4, s38
    v_mov_b32 v5, 0
    s_mov_b64 exec, 1
    buffer_store_dword v4, v5, s[12:15], s42 offen sc1
    s_mov_b64 exec, -1
L_s27:
    s_add_u32 s33, s33, 2
    s_cmp_lt_u32 s33, 64
    s_cbranch_scc1 L_qw_loop
    s_add_u32 s32, s32, 1
    s_cmp_ge_u32 s32, 2
    s_cbranch_scc1 L_end
    s_add_u32 s16, s88, 6389760
    s_addc_u32 s17, s89, 0
    s_mov_b32 s18, 2359296
    s_mov_b32 s19, 0x20000
    s_branch L_qw_layer
L_bw:
    v_lshlrev_b32 v4, 7, v0
    s_mul_i32 s35, s21, 73728
    s_mov_b32 s28, s68
    s_mov_b32 s29, s69
    s_mov_b32 s30, 4718592
    s_mov_b32 s31, 0x20000
    s_mov_b32 s34, s35
    buffer_load_dword v5, v4, s[28:31], s34 offen
    s_add_u32 s34, s34, 32768
    s_waitcnt vmcnt(0)
    buffer_load_dword v5, v4, s[28:31], s34 offen
    s_add_u32 s34, s34, 32768
    s_waitcnt vmcnt(0)
    s_cmp_lg_u32 s20, 0
    s_cbranch_scc1 L_bw_pwQ
    buffer_load_dword v5, v4, s[28:31], s34 offen
    s_add_u32 s34, s34, 32768
    s_waitcnt vmcnt(0)
L_bw_pwQ:
    s_mov_b32 s28, s70
    s_mov_b32 s29, s71
    s_mov_b32 s30, 4718592
    s_mov_b32 s31, 0x20000
    s_mov_b32 s34, s35
    buffer_load_dword v5, v4, s[28:31], s34 offen
    s_add_u32 s34, s34, 32768
    s_waitcnt vmcnt(0)
    buffer_load_dword v5, v4, s[28:31], s34 offen
    s_add_u32 s34, s34, 32768
    s_waitcnt vmcnt(0)
    s_cmp_lg_u32 s20, 0
    s_cbranch_scc1 L_bw_pwK
    buffer_load_dword v5, v4, s[28:31], s34 offen
    s_add_u32 s34, s34, 32768
    s_waitcnt vmcnt(0)
L_bw_pwK:
    s_mov_b32 s28, s72
    s_mov_b32 s29, s73
    s_mov_b32 s30, 4718592
    s_mov_b32 s31, 0x20000
    s_mov_b32 s34, s35
    buffer_load_dword v5, v4, s[28:31], s34 offen
    s_add_u32 s34, s34, 32768
    s_waitcnt vmcnt(0)
    buffer_load_dword v5, v4, s[28:31], s34 offen
    s_add_u32 s34, s34, 32768
    s_waitcnt vmcnt(0)
    s_cmp_lg_u32 s20, 0
    s_cbranch_scc1 L_bw_pwV
    buffer_load_dword v5, v4, s[28:31], s34 offen
    s_add_u32 s34, s34, 32768
    s_waitcnt vmcnt(0)
L_bw_pwV:
    s_mov_b32 s28, s74
    s_mov_b32 s29, s75
    s_mov_b32 s30, 4718592
    s_mov_b32 s31, 0x20000
    s_mov_b32 s34, s35
    buffer_load_dword v5, v4, s[28:31], s34 offen
    s_add_u32 s34, s34, 32768
    s_waitcnt vmcnt(0)
    buffer_load_dword v5, v4, s[28:31], s34 offen
    s_add_u32 s34, s34, 32768
    s_waitcnt vmcnt(0)
    s_cmp_lg_u32 s20, 0
    s_cbranch_scc1 L_bw_pwO
    buffer_load_dword v5, v4, s[28:31], s34 offen
    s_add_u32 s34, s34, 32768
    s_waitcnt vmcnt(0)
L_bw_pwO:
L_i28:
    v_mov_b32 v4, 0
    global_load_dword v5, v4, s[86:87] offset:12 sc1
    global_load_dword v4, v4, s[86:87] offset:128 sc1
    s_add_u32 s37, s37, 1
    s_waitcnt vmcnt(0)
    v_min_u32 v5, 32, v5
    v_min_u32 v4, 224, v4
    v_add_u32 v5, v5, v4
    v_cmp_gt_u32 vcc, 256, v5
    s_nop 0
    s_cbranch_vccz L_i28_d
    s_sleep 4
    s_cmp_lt_u32 s37, 400000
    s_cbranch_scc1 L_i28
L_i28_d:
    s_mov_b32 s34, 395264
    s_mov_b32 s38, 1
    v_mov_b32 v4, 0
L_w29:
    buffer_load_dword v5, v4, s[12:15], s34 offen sc1
    s_add_u32 s37, s37, 1
    s_waitcnt vmcnt(0)
    v_cmp_gt_u32 vcc, s38, v5
    s_nop 0
    s_cbranch_vccz L_w29_d
    s_sleep 8
    s_cmp_lt_u32 s37, 400000
    s_cbranch_scc1 L_w29
L_w29_d:
    s_and_b32 s40, s21, 31
    s_lshr_b32 s41, s21, 5
    s_lshl_b32 s42, s21, 7
    s_add_u32 s43, s42, 446464
    s_add_u32 s42, s42, 438272
    s_mov_b32 s32, 0
    s_call_b64 s[72:73], L_bw_ip
    s_call_b64 s[72:73], L_bw_ia
    s_cmp_eq_u32 s48, 21
    s_cselect_b32 s48, 128, s48
    s_mov_b32 s49, s48
    s_add_u32 s16, s88, 1671168
    s_addc_u32 s17, s89, 0
    s_mov_b32 s18, 2359296
    s_mov_b32 s19, 0x20000
    s_add_u32 s24, s88, 4030464
    s_addc_u32 s25, s89, 0
    s_mov_b32 s26, 2359296
    s_mov_b32 s27, 0x20000
L_i30:
    v_mov_b32 v86, 0
    global_load_dword v87, v86, s[86:87] offset:12 sc1
    global_load_dword v86, v86, s[86:87] offset:128 sc1
    s_add_u32 s37, s37, 1
    s_waitcnt vmcnt(0)
    v_min_u32 v87, 32, v87
    v_min_u32 v86, 224, v86
    v_add_u32 v87, v87, v86
    v_cmp_gt_u32 vcc, 256, v87
    s_nop 0
    s_cbranch_vccz L_i30_d
    s_sleep 4
    s_cmp_lt_u32 s37, 400000
    s_cbranch_scc1 L_i30
L_i30_d:
    s_add_u32 s64, s41, 0
    s_mov_b32 s65, 2
    s_mov_b32 s66, 26
    s_add_u32 s67, s41, 0
    s_mov_b32 s33, 0
    s_mov_b32 s54, 0
    s_call_b64 s[72:73], L_bw_pass
    s_mov_b32 s74, 21
    s_mov_b32 s75, 104
    s_call_b64 s[72:73], L_bw_proj
    s_add_u32 s64, s41, 52
    s_mov_b32 s65, 2
    s_mov_b32 s66, 6
    s_add_u32 s67, s41, 52
    s_mov_b32 s33, 0
    s_mov_b32 s54, s67
    s_call_b64 s[50:51], L_bw_bulk
    s_call_b64 s[72:73], L_bw_pass
    s_mov_b32 s75, 128
    s_call_b64 s[72:73], L_bw_proj
    s_mov_b32 s32, 1
    s_mov_b32 s48, s49
    s_add_u32 s64, s41, 0
    s_mov_b32 s65, 2
    s_mov_b32 s66, 28
    s_add_u32 s67, s41, 0
    s_sub_u32 s66, s66, s41
    s_mov_b32 s33, 0
    s_mov_b32 s54, 0
    s_call_b64 s[72:73], L_bw_pass
L_bw_last:
    s_add_u32 s16, s88, 6389760
    s_addc_u32 s17, s89, 0
    s_mov_b32 s18, 2359296
    s_mov_b32 s19, 0x20000
    s_mov_b32 s24, s84
    s_mov_b32 s25, s85
    s_mov_b32 s26, 2359296
    s_mov_b32 s27, 0x20000
    s_mov_b32 s32, 1
    s_mov_b32 s74, 47
    s_mov_b32 s75, 128
    s_call_b64 s[72:73], L_bw_proj
    s_branch L_end
L_help:
    s_and_b32 s40, s21, 31
    s_lshr_b32 s41, s21, 5
    s_lshl_b32 s41, s41, 2
    s_lshr_b32 s41, 258, s41
    s_and_b32 s41, s41, 3
    s_lshl_b32 s42, s41, 5
    s_add_u32 s42, s42, s40
    s_lshl_b32 s42, s42, 7
    s_add_u32 s42, s42, 454656
    s_mov_b32 s32, 1
    s_call_b64 s[72:73], L_bw_ia
    s_add_u32 s64, s41, 55
    s_mov_b32 s65, 3
    s_mov_b32 s66, 3
    s_add_u32 s67, s41, 57
    s_mov_b32 s33, 0
    s_add_u32 s54, s41, 54
    s_call_b64 s[50:51], L_bw_bulk
    s_mov_b32 s54, s67
    s_call_b64 s[50:51], L_bw_bulk
    s_call_b64 s[72:73], L_bw_pass
    s_branch L_end
L_ww_team:
    s_waitcnt vmcnt(0) lgkmcnt(0)
    s_barrier
    s_mov_b32 s12, s88
    s_mov_b32 s13, s89
    s_mov_b32 s14, 130908160
    s_mov_b32 s15, 0x20000
    s_cmp_ge_u32 s21, 30
    s_cbranch_scc1 L_end
    s_add_u32 s21, s21, 48
L_ww_ow:
    s_add_u32 s21, s21, 63
    v_lshrrev_b32 v0, 4, v0
    s_lshl_b32 s34, s20, 6
    v_add_u32 v0, s34, v0
    s_call_b64 s[72:73], L_bw_ip
    s_branch L_bw_last
L_bw_pass:
    s_lshl_b32 s38, s32, 6
    s_add_u32 s38, s38, s54
    s_lshl_b32 s47, s38, 5
    s_add_u32 s47, s47, s40
    s_mul_i32 s47, s47, 3584
    s_add_u32 s47, s47, 13467648
    s_add_u32 s38, s38, 1
    s_and_b32 s55, s40, 28
    s_lshl_b32 s55, s55, 5
    s_add_u32 s55, s55, 430080
    s_lshl_b32 s100, s55, 1
    s_add_u32 s100, s100, 4096
    s_and_b32 s34, s54, 1
    s_lshl_b32 s34, s34, 12
    s_add_u32 s55, s55, s34
    s_mov_b32 s68, 0
    v_mov_b32 v106, 0
    s_mov_b32 s70, s67
    s_lshl_b32 s69, s32, 6
    s_add_u32 s69, s69, s64
    s_lshl_b32 s69, s69, 5
    s_add_u32 s69, s69, s40
    s_mul_i32 s69, s69, 3584
    s_add_u32 s69, s69, 13467648
L_bw_loop:
    s_cmp_gt_u32 s54, s33
    s_cbranch_scc0 L_bw_block
L_bw_have:
    s_add_u32 s44, s68, s3
    s_lshr_b32 s44, s44, 2
    s_sub_u32 s46, s20, s68
    s_add_u32 s46, s46, 3
    s_and_b32 s46, s46, 3
    s_mul_i32 s34, s33, 2304
    v_add_u32 v4, s34, v7
    v_add_u32 v5, s34, v1
    v_mad_u32_u24 v6, s33, v3, v2
    s_sub_u32 s36, s100, s55
    s_cmp_lg_u32 s101, 0
    s_waitcnt vmcnt(0) lgkmcnt(0)
    s_barrier
    ds_read_b128 v[56:59], v4 offset:0
    ds_read_b32 v60, v5 offset:0
    ds_read_b128 v[108:111], v6 offset:0
    ds_read_b128 v[112:115], v6 offset:576
    v_cmp_gt_u32 vcc, s38, v106
    buffer_load_dword v105, off, s[12:15], s55 sc1
    buffer_load_dword v106, off, s[12:15], s36 sc1
    s_cbranch_scc0 L_bw_nm
    s_call_b64 s[50:51], L_bw_mrg
L_bw_nm:
    s_cbranch_vccnz L_bw_nr
    s_call_b64 s[50:51], L_bw_req
L_bw_nr:
    s_mul_i32 s34, s46, 2304
    v_add_u32 v4, s34, v7
    v_add_u32 v5, s34, v1
    v_mad_u32_u24 v6, s46, v3, v2
    ds_read_b128 v[116:119], v4 offset:0
    ds_read_b32 v62, v5 offset:0
    v_mov_b64 v[64:65], 0
    v_mov_b64 v[66:67], 0
    v_mov_b64 v[68:69], 0
    v_mov_b64 v[70:71], 0
    v_mov_b64 v[72:73], 0
    v_mov_b64 v[74:75], 0
    s_waitcnt lgkmcnt(5)
    v_mfma_f32_32x32x16_bf16 v[8:23], v[56:59], a[128:131], 0
    s_waitcnt lgkmcnt(1)
    v_mfma_f32_32x32x16_bf16 v[24:39], v[116:119], v[80:83], 0
    ds_read_b128 v[116:119], v4 offset:9216
    v_mfma_f32_32x32x8_bf16 v[8:23], v[60:61], a[160:161], v[8:23]
    s_waitcnt lgkmcnt(1)
    v_mfma_f32_32x32x8_bf16 v[24:39], v[62:63], v[84:85], v[24:39]
    ds_read_b32 v62, v5 offset:9216
    s_cmp_eq_u32 s44, 0
    s_cbranch_scc1 L_bw_u
    s_nop 0
    v_exp_f32 v8, v8
    v_exp_f32 v9, v9
    v_exp_f32 v10, v10
    v_exp_f32 v11, v11
    v_exp_f32 v12, v12
    v_mfma_f32_32x32x16_bf16 v[40:55], v[56:59], a[132:135], 0
    v_exp_f32 v13, v13
    v_exp_f32 v14, v14
    v_exp_f32 v15, v15
    v_exp_f32 v16, v16
    v_exp_f32 v17, v17
    v_mfma_f32_32x32x8_bf16 v[40:55], v[60:61], a[162:163], v[40:55]
    v_exp_f32 v18, v18
    v_exp_f32 v19, v19
    v_exp_f32 v20, v20
    v_smfmac_f32_32x32x32_bf16 a[0:15], v[108:111], v[8:15], v93
    s_cmp_eq_u32 s44, 1
    v_exp_f32 v21, v21
    v_exp_f32 v22, v22
    v_exp_f32 v23, v23
    s_cbranch_scc1 L_bw_u0
    v_exp_f32 v40, v40
    v_exp_f32 v41, v41
    v_smfmac_f32_32x32x32_bf16 a[0:15], v[112:115], v[16:23], v93
    v_exp_f32 v42, v42
    v_exp_f32 v43, v43
    v_exp_f32 v44, v44
    v_mfma_f32_32x32x16_bf16 v[8:23], v[56:59], a[136:139], 0
    v_exp_f32 v45, v45
    v_exp_f32 v46, v46
    v_exp_f32 v47, v47
    v_exp_f32 v48, v48
    v_exp_f32 v49, v49
    v_mfma_f32_32x32x8_bf16 v[8:23], v[60:61], a[164:165], v[8:23]
    v_exp_f32 v50, v50
    v_exp_f32 v51, v51
    v_exp_f32 v52, v52
    v_smfmac_f32_32x32x32_bf16 a[16:31], v[108:111], v[40:47], v93
    s_cmp_eq_u32 s44, 2
    v_exp_f32 v53, v53
    v_exp_f32 v54, v54
    v_exp_f32 v55, v55
    s_cbranch_scc1 L_bw_u1
    v_exp_f32 v8, v8
    v_exp_f32 v9, v9
    v_smfmac_f32_32x32x32_bf16 a[16:31], v[112:115], v[48:55], v93
    v_exp_f32 v10, v10
    v_exp_f32 v11, v11
    v_exp_f32 v12, v12
    v_mfma_f32_32x32x16_bf16 v[40:55], v[56:59], a[140:143], 0
    v_exp_f32 v13, v13
    v_exp_f32 v14, v14
    v_exp_f32 v15, v15
    v_exp_f32 v16, v16
    v_exp_f32 v17, v17
    v_mfma_f32_32x32x8_bf16 v[40:55], v[60:61], a[166:167], v[40:55]
    v_exp_f32 v18, v18
    v_exp_f32 v19, v19
    v_exp_f32 v20, v20
    v_smfmac_f32_32x32x32_bf16 a[32:47], v[108:111], v[8:15], v93
    s_cmp_eq_u32 s44, 3
    v_exp_f32 v21, v21
    v_exp_f32 v22, v22
    v_exp_f32 v23, v23
    s_cbranch_scc1 L_bw_u2
    v_exp_f32 v40, v40
    v_exp_f32 v41, v41
    v_smfmac_f32_32x32x32_bf16 a[32:47], v[112:115], v[16:23], v93
    s_add_u32 s34, s33, 1
    s_cmp_gt_u32 s54, s34
    v_exp_f32 v42, v42
    v_exp_f32 v43, v43
    v_exp_f32 v44, v44
    v_mfma_f32_32x32x16_bf16 v[8:23], v[56:59], a[144:147], 0
    s_cbranch_scc0 L_bw_try
L_bw_np:
    v_exp_f32 v45, v45
    v_exp_f32 v46, v46
    v_exp_f32 v47, v47
    v_exp_f32 v48, v48
    v_exp_f32 v49, v49
    v_mfma_f32_32x32x8_bf16 v[8:23], v[60:61], a[168:169], v[8:23]
    v_exp_f32 v50, v50
    v_exp_f32 v51, v51
    v_exp_f32 v52, v52
    v_smfmac_f32_32x32x32_bf16 a[48:63], v[108:111], v[40:47], v93
    s_cmp_eq_u32 s44, 4
    v_exp_f32 v53, v53
    v_exp_f32 v54, v54
    v_exp_f32 v55, v55
    s_cbranch_scc1 L_bw_u3
    v_exp_f32 v8, v8
    v_exp_f32 v9, v9
    v_smfmac_f32_32x32x32_bf16 a[48:63], v[112:115], v[48:55], v93
    v_exp_f32 v10, v10
    v_exp_f32 v11, v11
    v_exp_f32 v12, v12
    v_mfma_f32_32x32x16_bf16 v[40:55], v[56:59], a[148:151], 0
    v_exp_f32 v13, v13
    v_exp_f32 v14, v14
    v_exp_f32 v15, v15
    v_exp_f32 v16, v16
    v_exp_f32 v17, v17
    v_mfma_f32_32x32x8_bf16 v[40:55], v[60:61], a[170:171], v[40:55]
    v_exp_f32 v18, v18
    v_exp_f32 v19, v19
    v_exp_f32 v20, v20
    v_smfmac_f32_32x32x32_bf16 a[64:79], v[108:111], v[8:15], v93
    s_cmp_eq_u32 s44, 5
    v_exp_f32 v21, v21
    v_exp_f32 v22, v22
    v_exp_f32 v23, v23
    s_cbranch_scc1 L_bw_u4
    v_exp_f32 v40, v40
    v_exp_f32 v41, v41
    v_smfmac_f32_32x32x32_bf16 a[64:79], v[112:115], v[16:23], v93
    v_exp_f32 v42, v42
    v_exp_f32 v43, v43
    v_exp_f32 v44, v44
    v_mfma_f32_32x32x16_bf16 v[8:23], v[56:59], a[152:155], 0
    v_exp_f32 v45, v45
    v_exp_f32 v46, v46
    v_exp_f32 v47, v47
    v_exp_f32 v48, v48
    v_exp_f32 v49, v49
    v_mfma_f32_32x32x8_bf16 v[8:23], v[60:61], a[172:173], v[8:23]
    v_exp_f32 v50, v50
    v_exp_f32 v51, v51
    v_exp_f32 v52, v52
    v_smfmac_f32_32x32x32_bf16 a[80:95], v[108:111], v[40:47], v93
    s_cmp_eq_u32 s44, 6
    v_exp_f32 v53, v53
    v_exp_f32 v54, v54
    v_exp_f32 v55, v55
    s_cbranch_scc1 L_bw_u5
    v_exp_f32 v8, v8
    v_exp_f32 v9, v9
    v_smfmac_f32_32x32x32_bf16 a[80:95], v[112:115], v[48:55], v93
    v_exp_f32 v10, v10
    v_exp_f32 v11, v11
    v_exp_f32 v12, v12
    v_mfma_f32_32x32x16_bf16 v[40:55], v[56:59], a[156:159], 0
    v_exp_f32 v13, v13
    v_exp_f32 v14, v14
    v_exp_f32 v15, v15
    v_exp_f32 v16, v16
    v_exp_f32 v17, v17
    v_mfma_f32_32x32x8_bf16 v[40:55], v[60:61], a[174:175], v[40:55]
    v_exp_f32 v18, v18
    v_exp_f32 v19, v19
    v_exp_f32 v20, v20
    v_smfmac_f32_32x32x32_bf16 a[96:111], v[108:111], v[8:15], v93
    s_cmp_eq_u32 s44, 7
    v_exp_f32 v21, v21
    v_exp_f32 v22, v22
    v_exp_f32 v23, v23
    s_cbranch_scc1 L_bw_u6
    v_exp_f32 v40, v40
    v_exp_f32 v41, v41
    v_smfmac_f32_32x32x32_bf16 a[96:111], v[112:115], v[16:23], v93
    v_exp_f32 v42, v42
    v_exp_f32 v43, v43
    v_exp_f32 v44, v44
    v_exp_f32 v45, v45
    v_exp_f32 v46, v46
    v_exp_f32 v47, v47
    v_exp_f32 v48, v48
    v_exp_f32 v49, v49
    v_exp_f32 v50, v50
    v_exp_f32 v51, v51
    v_exp_f32 v52, v52
    v_smfmac_f32_32x32x32_bf16 a[112:127], v[108:111], v[40:47], v93
    v_exp_f32 v53, v53
    v_exp_f32 v54, v54
    v_exp_f32 v55, v55
    s_nop 1
    v_smfmac_f32_32x32x32_bf16 a[112:127], v[112:115], v[48:55], v93
L_bw_n:
    s_cmp_lg_u32 s33, s67
    s_cbranch_scc1 L_bw_next
    s_add_u32 s68, s68, 1
    s_add_u32 s67, s67, 2
    s_cmp_eq_u32 s68, s66
    s_cselect_b32 s67, 64, s67
    s_cselect_b32 s70, 65, s70
    s_sub_u32 s45, s33, s46
    s_cbranch_scc1 L_bw_x
    s_lshr_b32 s45, s45, 2
    v_exp_f32 v24, v24
    v_exp_f32 v25, v25
L_bw_nl:
    ds_read_b128 v[112:115], v6 offset:576
    ds_read_b128 v[108:111], v6 offset:0
    v_exp_f32 v26, v26
    v_exp_f32 v27, v27
    v_exp_f32 v28, v28
    s_waitcnt lgkmcnt(2)
    v_mfma_f32_32x32x16_bf16 v[8:23], v[116:119], v[80:83], 0
    ds_read_b128 v[116:119], v4 offset:18432
    v_exp_f32 v29, v29
    v_exp_f32 v30, v30
    v_exp_f32 v31, v31
    v_exp_f32 v32, v32
    v_exp_f32 v33, v33
    v_mfma_f32_32x32x8_bf16 v[8:23], v[62:63], v[84:85], v[8:23]
    s_waitcnt lgkmcnt(1)
    v_exp_f32 v34, v34
    v_exp_f32 v35, v35
    v_exp_f32 v36, v36
    v_smfmac_f32_32x32x32_bf16 v[64:79], v[108:111], v[24:31], v93
    ds_read_b32 v62, v5 offset:18432
    s_sub_u32 s45, s45, 1
    v_exp_f32 v37, v37
    v_exp_f32 v38, v38
    v_exp_f32 v39, v39
    s_cbranch_scc1 L_bw_ne0
    v_exp_f32 v8, v8
    v_exp_f32 v9, v9
    v_smfmac_f32_32x32x32_bf16 v[64:79], v[112:115], v[32:39], v93
    ds_read_b128 v[112:115], v6 offset:9792
    ds_read_b128 v[108:111], v6 offset:9216
    v_add_u32 v6, v6, v104
    v_exp_f32 v10, v10
    v_exp_f32 v11, v11
    v_exp_f32 v12, v12
    s_waitcnt lgkmcnt(2)
    v_mfma_f32_32x32x16_bf16 v[24:39], v[116:119], v[80:83], 0
    ds_read_b128 v[116:119], v4 offset:27648
    v_exp_f32 v13, v13
    v_exp_f32 v14, v14
    v_exp_f32 v15, v15
    v_exp_f32 v16, v16
    v_exp_f32 v17, v17
    v_mfma_f32_32x32x8_bf16 v[24:39], v[62:63], v[84:85], v[24:39]
    s_waitcnt lgkmcnt(1)
    v_exp_f32 v18, v18
    v_exp_f32 v19, v19
    v_exp_f32 v20, v20
    v_smfmac_f32_32x32x32_bf16 v[64:79], v[108:111], v[8:15], v93
    ds_read_b32 v62, v5 offset:27648
    s_sub_u32 s45, s45, 1
    v_exp_f32 v21, v21
    v_exp_f32 v22, v22
    v_exp_f32 v23, v23
    s_cbranch_scc1 L_bw_ne1
    v_exp_f32 v24, v24
    v_exp_f32 v25, v25
    v_smfmac_f32_32x32x32_bf16 v[64:79], v[112:115], v[16:23], v93
    ds_read_b128 v[112:115], v6 offset:576
    ds_read_b128 v[108:111], v6 offset:0
    v_exp_f32 v26, v26
    v_exp_f32 v27, v27
    v_exp_f32 v28, v28
    s_waitcnt lgkmcnt(2)
    v_mfma_f32_32x32x16_bf16 v[8:23], v[116:119], v[80:83], 0
    ds_read_b128 v[116:119], v4 offset:36864
    v_exp_f32 v29, v29
    v_exp_f32 v30, v30
    v_exp_f32 v31, v31
    v_exp_f32 v32, v32
    v_exp_f32 v33, v33
    v_mfma_f32_32x32x8_bf16 v[8:23], v[62:63], v[84:85], v[8:23]
    s_waitcnt lgkmcnt(1)
    v_exp_f32 v34, v34
    v_exp_f32 v35, v35
    v_exp_f32 v36, v36
    v_smfmac_f32_32x32x32_bf16 v[64:79], v[108:111], v[24:31], v93
    ds_read_b32 v62, v5 offset:36864
    s_sub_u32 s45, s45, 1
    v_exp_f32 v37, v37
    v_exp_f32 v38, v38
    v_exp_f32 v39, v39
    s_cbranch_scc1 L_bw_ne0
    v_exp_f32 v8, v8
    v_exp_f32 v9, v9
    v_smfmac_f32_32x32x32_bf16 v[64:79], v[112:115], v[32:39], v93
    ds_read_b128 v[112:115], v6 offset:9792
    ds_read_b128 v[108:111], v6 offset:9216
    v_add_u32 v6, v6, v104
    v_exp_f32 v10, v10
    v_exp_f32 v11, v11
    v_exp_f32 v12, v12
    s_waitcnt lgkmcnt(2)
    v_mfma_f32_32x32x16_bf16 v[24:39], v[116:119], v[80:83], 0
    ds_read_b128 v[116:119], v4 offset:46080
    v_exp_f32 v13, v13
    v_exp_f32 v14, v14
    v_exp_f32 v15, v15
    v_exp_f32 v16, v16
    v_exp_f32 v17, v17
    v_mfma_f32_32x32x8_bf16 v[24:39], v[62:63], v[84:85], v[24:39]
    s_waitcnt lgkmcnt(1)
    v_exp_f32 v18, v18
    v_exp_f32 v19, v19
    v_exp_f32 v20, v20
    v_smfmac_f32_32x32x32_bf16 v[64:79], v[108:111], v[8:15], v93
    ds_read_b32 v62, v5 offset:46080
    s_sub_u32 s45, s45, 1
    v_add_u32 v4, 36864, v4
    v_add_u32 v5, 36864, v5
    v_exp_f32 v21, v21
    v_exp_f32 v22, v22
    v_exp_f32 v23, v23
    s_cbranch_scc1 L_bw_ne1
    v_exp_f32 v24, v24
    v_exp_f32 v25, v25
    v_smfmac_f32_32x32x32_bf16 v[64:79], v[112:115], v[16:23], v93
    s_add_u32 s34, s33, 1
    s_cmp_gt_u32 s54, s34
    s_cbranch_scc1 L_bw_nl
    s_waitcnt vmcnt(0)
    v_cmp_gt_u32 vcc, s38, v105
    buffer_load_dword v105, off, s[12:15], s55 sc1
    s_cbranch_vccnz L_bw_nl
    s_call_b64 s[50:51], L_bw_req
    s_branch L_bw_nl
L_bw_ne1:
    s_nop 0
    v_smfmac_f32_32x32x32_bf16 v[64:79], v[112:115], v[16:23], v93
    s_branch L_bw_x
L_bw_ne0:
    s_nop 0
    v_smfmac_f32_32x32x32_bf16 v[64:79], v[112:115], v[32:39], v93
L_bw_x:
    s_cmp_eq_u32 s46, 3
    s_cselect_b32 s101, 1, 0
    s_cbranch_scc1 L_bw_next
    s_mul_i32 s35, s46, 3072
    s_add_u32 s35, s35, 148480
    s_cmp_eq_u32 s46, 2
    s_cselect_b32 s34, 157696, s35
    v_add_u32 v86, s34, v0
    s_nop 3
    ds_write_b128 v86, v[64:67] offset:0
    ds_write_b128 v86, v[68:71] offset:1024
    ds_write_b128 v86, v[72:75] offset:2048
    s_branch L_bw_next
L_bw_u0:
    s_nop 0
    v_smfmac_f32_32x32x32_bf16 a[0:15], v[112:115], v[16:23], v93
    s_branch L_bw_n
L_bw_u1:
    s_nop 0
    v_smfmac_f32_32x32x32_bf16 a[16:31], v[112:115], v[48:55], v93
    s_branch L_bw_n
L_bw_u2:
    s_nop 0
    v_smfmac_f32_32x32x32_bf16 a[32:47], v[112:115], v[16:23], v93
    s_branch L_bw_n
L_bw_u3:
    s_nop 0
    v_smfmac_f32_32x32x32_bf16 a[48:63], v[112:115], v[48:55], v93
    s_branch L_bw_n
L_bw_u4:
    s_nop 0
    v_smfmac_f32_32x32x32_bf16 a[64:79], v[112:115], v[16:23], v93
    s_branch L_bw_n
L_bw_u5:
    s_nop 0
    v_smfmac_f32_32x32x32_bf16 a[80:95], v[112:115], v[48:55], v93
    s_branch L_bw_n
L_bw_u6:
    s_nop 0
    v_smfmac_f32_32x32x32_bf16 a[96:111], v[112:115], v[16:23], v93
    s_branch L_bw_n
L_bw_u:
    s_nop 9
    s_branch L_bw_n
L_bw_try:
    s_waitcnt vmcnt(0)
    v_cmp_gt_u32 vcc, s38, v105
    s_nop 0
    s_cbranch_vccnz L_bw_np
    s_call_b64 s[50:51], L_bw_req
    s_branch L_bw_np
L_bw_block:
    v_mov_b32 v86, 0
L_w31:
    buffer_load_dword v87, v86, s[12:15], s55 offen sc1
    s_add_u32 s37, s37, 1
    s_waitcnt vmcnt(0)
    v_cmp_gt_u32 vcc, s38, v87
    s_nop 0
    s_cbranch_vccz L_w31_d
    s_sleep 1
    s_cmp_lt_u32 s37, 400000
    s_cbranch_scc1 L_w31
L_w31_d:
    s_call_b64 s[50:51], L_bw_req
    s_branch L_bw_have
L_bw_next:
    s_add_u32 s33, s33, 1
    s_cmp_lt_u32 s33, 64
    s_cbranch_scc1 L_bw_loop
    s_waitcnt lgkmcnt(0)
    s_barrier
    s_nop 9
    s_cmp_lg_u32 s101, 0
    s_cbranch_scc0 L_bw_fm
    s_call_b64 s[50:51], L_bw_mrg
L_bw_fm:
    s_add_u32 s44, s68, s3
    s_lshr_b32 s44, s44, 2
    s_lshl_b32 s38, s32, 6
    s_add_u32 s38, s38, s64
    s_mul_i32 s34, s20, s65
    s_add_u32 s34, s34, s38
    s_lshl_b32 s34, s34, 5
    s_add_u32 s34, s34, s40
    s_mul_i32 s47, s34, 1152
    s_add_u32 s47, s47, 8749056
    s_mul_i32 s100, s65, 147456
    s_cmp_eq_u32 s44, 0
    s_cbranch_scc1 L_bw_fe
    v_accvgpr_read_b32 v64, a0
    v_accvgpr_read_b32 v65, a1
    v_accvgpr_read_b32 v66, a2
    v_accvgpr_read_b32 v67, a3
    v_accvgpr_read_b32 v68, a4
    v_accvgpr_read_b32 v69, a5
    v_accvgpr_read_b32 v70, a6
    v_accvgpr_read_b32 v71, a7
    v_accvgpr_read_b32 v72, a8
    v_accvgpr_read_b32 v73, a9
    v_accvgpr_read_b32 v74, a10
    v_mov_b32 v86, v74
    s_nop 1
    v_permlane32_swap_b32 v74, v86
    v_cmp_nlt_f32 vcc, s52, v74
    v_cmp_ngt_f32 s[34:35], s53, v74
    v_rcp_f32 v86, v74
    s_or_b64 vcc, vcc, s[34:35]
    s_cbranch_scc1 L_bw_g0
L_bw_f0:
    v_mul_f32 v64, v64, v86
    v_mul_f32 v65, v65, v86
    v_mul_f32 v66, v66, v86
    v_mul_f32 v67, v67, v86
    v_mul_f32 v68, v68, v86
    v_mul_f32 v69, v69, v86
    v_mul_f32 v70, v70, v86
    v_mul_f32 v71, v71, v86
    v_mul_f32 v72, v72, v86
    v_mul_f32 v73, v73, v86
    v_cvt_pk_bf16_f32 v8, v64, v65
    v_cvt_pk_bf16_f32 v9, v66, v67
    v_cvt_pk_bf16_f32 v10, v68, v69
    v_cvt_pk_bf16_f32 v11, v70, v71
    v_cvt_pk_bf16_f32 v12, v72, v73
    buffer_store_dwordx4 v[8:11], v0, s[12:15], s47 offen sc1
    buffer_store_dword v12, v92, s[12:15], s47 offen offset:1024 sc1
    s_add_u32 s47, s47, s100
    s_cmp_eq_u32 s44, 1
    s_cbranch_scc1 L_bw_fe
    v_accvgpr_read_b32 v64, a16
    v_accvgpr_read_b32 v65, a17
    v_accvgpr_read_b32 v66, a18
    v_accvgpr_read_b32 v67, a19
    v_accvgpr_read_b32 v68, a20
    v_accvgpr_read_b32 v69, a21
    v_accvgpr_read_b32 v70, a22
    v_accvgpr_read_b32 v71, a23
    v_accvgpr_read_b32 v72, a24
    v_accvgpr_read_b32 v73, a25
    v_accvgpr_read_b32 v74, a26
    v_mov_b32 v86, v74
    s_nop 1
    v_permlane32_swap_b32 v74, v86
    v_cmp_nlt_f32 vcc, s52, v74
    v_cmp_ngt_f32 s[34:35], s53, v74
    v_rcp_f32 v86, v74
    s_or_b64 vcc, vcc, s[34:35]
    s_cbranch_scc1 L_bw_g1
L_bw_f1:
    v_mul_f32 v64, v64, v86
    v_mul_f32 v65, v65, v86
    v_mul_f32 v66, v66, v86
    v_mul_f32 v67, v67, v86
    v_mul_f32 v68, v68, v86
    v_mul_f32 v69, v69, v86
    v_mul_f32 v70, v70, v86
    v_mul_f32 v71, v71, v86
    v_mul_f32 v72, v72, v86
    v_mul_f32 v73, v73, v86
    v_cvt_pk_bf16_f32 v16, v64, v65
    v_cvt_pk_bf16_f32 v17, v66, v67
    v_cvt_pk_bf16_f32 v18, v68, v69
    v_cvt_pk_bf16_f32 v19, v70, v71
    v_cvt_pk_bf16_f32 v20, v72, v73
    buffer_store_dwordx4 v[16:19], v0, s[12:15], s47 offen sc1
    buffer_store_dword v20, v92, s[12:15], s47 offen offset:1024 sc1
    s_add_u32 s47, s47, s100
    s_cmp_eq_u32 s44, 2
    s_cbranch_scc1 L_bw_fe
    v_accvgpr_read_b32 v64, a32
    v_accvgpr_read_b32 v65, a33
    v_accvgpr_read_b32 v66, a34
    v_accvgpr_read_b32 v67, a35
    v_accvgpr_read_b32 v68, a36
    v_accvgpr_read_b32 v69, a37
    v_accvgpr_read_b32 v70, a38
    v_accvgpr_read_b32 v71, a39
    v_accvgpr_read_b32 v72, a40
    v_accvgpr_read_b32 v73, a41
    v_accvgpr_read_b32 v74, a42
    v_mov_b32 v86, v74
    s_nop 1
    v_permlane32_swap_b32 v74, v86
    v_cmp_nlt_f32 vcc, s52, v74
    v_cmp_ngt_f32 s[34:35], s53, v74
    v_rcp_f32 v86, v74
    s_or_b64 vcc, vcc, s[34:35]
    s_cbranch_scc1 L_bw_g2
L_bw_f2:
    v_mul_f32 v64, v64, v86
    v_mul_f32 v65, v65, v86
    v_mul_f32 v66, v66, v86
    v_mul_f32 v67, v67, v86
    v_mul_f32 v68, v68, v86
    v_mul_f32 v69, v69, v86
    v_mul_f32 v70, v70, v86
    v_mul_f32 v71, v71, v86
    v_mul_f32 v72, v72, v86
    v_mul_f32 v73, v73, v86
    v_cvt_pk_bf16_f32 v8, v64, v65
    v_cvt_pk_bf16_f32 v9, v66, v67
    v_cvt_pk_bf16_f32 v10, v68, v69
    v_cvt_pk_bf16_f32 v11, v70, v71
    v_cvt_pk_bf16_f32 v12, v72, v73
    buffer_store_dwordx4 v[8:11], v0, s[12:15], s47 offen sc1
    buffer_store_dword v12, v92, s[12:15], s47 offen offset:1024 sc1
    s_add_u32 s47, s47, s100
    s_cmp_eq_u32 s44, 3
    s_cbranch_scc1 L_bw_fe
    v_accvgpr_read_b32 v64, a48
    v_accvgpr_read_b32 v65, a49
    v_accvgpr_read_b32 v66, a50
    v_accvgpr_read_b32 v67, a51
    v_accvgpr_read_b32 v68, a52
    v_accvgpr_read_b32 v69, a53
    v_accvgpr_read_b32 v70, a54
    v_accvgpr_read_b32 v71, a55
    v_accvgpr_read_b32 v72, a56
    v_accvgpr_read_b32 v73, a57
    v_accvgpr_read_b32 v74, a58
    v_mov_b32 v86, v74
    s_nop 1
    v_permlane32_swap_b32 v74, v86
    v_cmp_nlt_f32 vcc, s52, v74
    v_cmp_ngt_f32 s[34:35], s53, v74
    v_rcp_f32 v86, v74
    s_or_b64 vcc, vcc, s[34:35]
    s_cbranch_scc1 L_bw_g3
L_bw_f3:
    v_mul_f32 v64, v64, v86
    v_mul_f32 v65, v65, v86
    v_mul_f32 v66, v66, v86
    v_mul_f32 v67, v67, v86
    v_mul_f32 v68, v68, v86
    v_mul_f32 v69, v69, v86
    v_mul_f32 v70, v70, v86
    v_mul_f32 v71, v71, v86
    v_mul_f32 v72, v72, v86
    v_mul_f32 v73, v73, v86
    v_cvt_pk_bf16_f32 v16, v64, v65
    v_cvt_pk_bf16_f32 v17, v66, v67
    v_cvt_pk_bf16_f32 v18, v68, v69
    v_cvt_pk_bf16_f32 v19, v70, v71
    v_cvt_pk_bf16_f32 v20, v72, v73
    buffer_store_dwordx4 v[16:19], v0, s[12:15], s47 offen sc1
    buffer_store_dword v20, v92, s[12:15], s47 offen offset:1024 sc1
    s_add_u32 s47, s47, s100
    s_cmp_eq_u32 s44, 4
    s_cbranch_scc1 L_bw_fe
    v_accvgpr_read_b32 v64, a64
    v_accvgpr_read_b32 v65, a65
    v_accvgpr_read_b32 v66, a66
    v_accvgpr_read_b32 v67, a67
    v_accvgpr_read_b32 v68, a68
    v_accvgpr_read_b32 v69, a69
    v_accvgpr_read_b32 v70, a70
    v_accvgpr_read_b32 v71, a71
    v_accvgpr_read_b32 v72, a72
    v_accvgpr_read_b32 v73, a73
    v_accvgpr_read_b32 v74, a74
    v_mov_b32 v86, v74
    s_nop 1
    v_permlane32_swap_b32 v74, v86
    v_cmp_nlt_f32 vcc, s52, v74
    v_cmp_ngt_f32 s[34:35], s53, v74
    v_rcp_f32 v86, v74
    s_or_b64 vcc, vcc, s[34:35]
    s_cbranch_scc1 L_bw_g4
L_bw_f4:
    v_mul_f32 v64, v64, v86
    v_mul_f32 v65, v65, v86
    v_mul_f32 v66, v66, v86
    v_mul_f32 v67, v67, v86
    v_mul_f32 v68, v68, v86
    v_mul_f32 v69, v69, v86
    v_mul_f32 v70, v70, v86
    v_mul_f32 v71, v71, v86
    v_mul_f32 v72, v72, v86
    v_mul_f32 v73, v73, v86
    v_cvt_pk_bf16_f32 v8, v64, v65
    v_cvt_pk_bf16_f32 v9, v66, v67
    v_cvt_pk_bf16_f32 v10, v68, v69
    v_cvt_pk_bf16_f32 v11, v70, v71
    v_cvt_pk_bf16_f32 v12, v72, v73
    buffer_store_dwordx4 v[8:11], v0, s[12:15], s47 offen sc1
    buffer_store_dword v12, v92, s[12:15], s47 offen offset:1024 sc1
    s_add_u32 s47, s47, s100
    s_cmp_eq_u32 s44, 5
    s_cbranch_scc1 L_bw_fe
    v_accvgpr_read_b32 v64, a80
    v_accvgpr_read_b32 v65, a81
    v_accvgpr_read_b32 v66, a82
    v_accvgpr_read_b32 v67, a83
    v_accvgpr_read_b32 v68, a84
    v_accvgpr_read_b32 v69, a85
    v_accvgpr_read_b32 v70, a86
    v_accvgpr_read_b32 v71, a87
    v_accvgpr_read_b32 v72, a88
    v_accvgpr_read_b32 v73, a89
    v_accvgpr_read_b32 v74, a90
    v_mov_b32 v86, v74
    s_nop 1
    v_permlane32_swap_b32 v74, v86
    v_cmp_nlt_f32 vcc, s52, v74
    v_cmp_ngt_f32 s[34:35], s53, v74
    v_rcp_f32 v86, v74
    s_or_b64 vcc, vcc, s[34:35]
    s_cbranch_scc1 L_bw_g5
L_bw_f5:
    v_mul_f32 v64, v64, v86
    v_mul_f32 v65, v65, v86
    v_mul_f32 v66, v66, v86
    v_mul_f32 v67, v67, v86
    v_mul_f32 v68, v68, v86
    v_mul_f32 v69, v69, v86
    v_mul_f32 v70, v70, v86
    v_mul_f32 v71, v71, v86
    v_mul_f32 v72, v72, v86
    v_mul_f32 v73, v73, v86
    v_cvt_pk_bf16_f32 v16, v64, v65
    v_cvt_pk_bf16_f32 v17, v66, v67
    v_cvt_pk_bf16_f32 v18, v68, v69
    v_cvt_pk_bf16_f32 v19, v70, v71
    v_cvt_pk_bf16_f32 v20, v72, v73
    buffer_store_dwordx4 v[16:19], v0, s[12:15], s47 offen sc1
    buffer_store_dword v20, v92, s[12:15], s47 offen offset:1024 sc1
    s_add_u32 s47, s47, s100
    s_lshl_b32 s35, s65, 3
    s_add_u32 s35, s35, s38
    s_waitcnt vmcnt(8)
    s_barrier
    s_cmp_lg_u32 s20, 0
    s_cbranch_scc1 L_s32
    v_mov_b32 v86, s35
    v_mov_b32 v87, 0
    s_mov_b64 exec, 1
    buffer_store_dword v86, v87, s[12:15], s42 offen sc1
    s_mov_b64 exec, -1
L_s32:
    s_cmp_eq_u32 s44, 6
    s_cbranch_scc1 L_bw_fe
    v_accvgpr_read_b32 v64, a96
    v_accvgpr_read_b32 v65, a97
    v_accvgpr_read_b32 v66, a98
    v_accvgpr_read_b32 v67, a99
    v_accvgpr_read_b32 v68, a100
    v_accvgpr_read_b32 v69, a101
    v_accvgpr_read_b32 v70, a102
    v_accvgpr_read_b32 v71, a103
    v_accvgpr_read_b32 v72, a104
    v_accvgpr_read_b32 v73, a105
    v_accvgpr_read_b32 v74, a106
    v_mov_b32 v86, v74
    s_nop 1
    v_permlane32_swap_b32 v74, v86
    v_cmp_nlt_f32 vcc, s52, v74
    v_cmp_ngt_f32 s[34:35], s53, v74
    v_rcp_f32 v86, v74
    s_or_b64 vcc, vcc, s[34:35]
    s_cbranch_scc1 L_bw_g6
L_bw_f6:
    v_mul_f32 v64, v64, v86
    v_mul_f32 v65, v65, v86
    v_mul_f32 v66, v66, v86
    v_mul_f32 v67, v67, v86
    v_mul_f32 v68, v68, v86
    v_mul_f32 v69, v69, v86
    v_mul_f32 v70, v70, v86
    v_mul_f32 v71, v71, v86
    v_mul_f32 v72, v72, v86
    v_mul_f32 v73, v73, v86
    v_cvt_pk_bf16_f32 v8, v64, v65
    v_cvt_pk_bf16_f32 v9, v66, v67
    v_cvt_pk_bf16_f32 v10, v68, v69
    v_cvt_pk_bf16_f32 v11, v70, v71
    v_cvt_pk_bf16_f32 v12, v72, v73
    buffer_store_dwordx4 v[8:11], v0, s[12:15], s47 offen sc1
    buffer_store_dword v12, v92, s[12:15], s47 offen offset:1024 sc1
    s_add_u32 s47, s47, s100
    s_cmp_eq_u32 s44, 7
    s_cbranch_scc1 L_bw_fe
    v_accvgpr_read_b32 v64, a112
    v_accvgpr_read_b32 v65, a113
    v_accvgpr_read_b32 v66, a114
    v_accvgpr_read_b32 v67, a115
    v_accvgpr_read_b32 v68, a116
    v_accvgpr_read_b32 v69, a117
    v_accvgpr_read_b32 v70, a118
    v_accvgpr_read_b32 v71, a119
    v_accvgpr_read_b32 v72, a120
    v_accvgpr_read_b32 v73, a121
    v_accvgpr_read_b32 v74, a122
    v_mov_b32 v86, v74
    s_nop 1
    v_permlane32_swap_b32 v74, v86
    v_cmp_nlt_f32 vcc, s52, v74
    v_cmp_ngt_f32 s[34:35], s53, v74
    v_rcp_f32 v86, v74
    s_or_b64 vcc, vcc, s[34:35]
    s_cbranch_scc1 L_bw_g7
L_bw_f7:
    v_mul_f32 v64, v64, v86
    v_mul_f32 v65, v65, v86
    v_mul_f32 v66, v66, v86
    v_mul_f32 v67, v67, v86
    v_mul_f32 v68, v68, v86
    v_mul_f32 v69, v69, v86
    v_mul_f32 v70, v70, v86
    v_mul_f32 v71, v71, v86
    v_mul_f32 v72, v72, v86
    v_mul_f32 v73, v73, v86
    v_cvt_pk_bf16_f32 v16, v64, v65
    v_cvt_pk_bf16_f32 v17, v66, v67
    v_cvt_pk_bf16_f32 v18, v68, v69
    v_cvt_pk_bf16_f32 v19, v70, v71
    v_cvt_pk_bf16_f32 v20, v72, v73
    buffer_store_dwordx4 v[16:19], v0, s[12:15], s47 offen sc1
    buffer_store_dword v20, v92, s[12:15], s47 offen offset:1024 sc1
    s_add_u32 s47, s47, s100
L_bw_fe:
    s_mul_i32 s35, s65, s66
    s_add_u32 s35, s35, s38
    s_waitcnt vmcnt(0) lgkmcnt(0)
    s_barrier
    s_cmp_lg_u32 s20, 0
    s_cbranch_scc1 L_s33
    v_mov_b32 v86, s35
    v_mov_b32 v87, 0
    s_mov_b64 exec, 1
    buffer_store_dword v86, v87, s[12:15], s42 offen sc1
    s_mov_b64 exec, -1
L_s33:
    s_setpc_b64 s[72:73]
L_bw_g0:
    v_accvgpr_read_b32 v80, a128
    v_accvgpr_read_b32 v81, a129
    v_accvgpr_read_b32 v82, a130
    v_accvgpr_read_b32 v83, a131
    v_accvgpr_read_b32 v84, a160
    s_call_b64 s[50:51], L_bw_tm
    v_rcp_f32 v86, v74
    s_branch L_bw_f0
L_bw_g1:
    v_accvgpr_read_b32 v80, a132
    v_accvgpr_read_b32 v81, a133
    v_accvgpr_read_b32 v82, a134
    v_accvgpr_read_b32 v83, a135
    v_accvgpr_read_b32 v84, a162
    s_call_b64 s[50:51], L_bw_tm
    v_rcp_f32 v86, v74
    s_branch L_bw_f1
L_bw_g2:
    v_accvgpr_read_b32 v80, a136
    v_accvgpr_read_b32 v81, a137
    v_accvgpr_read_b32 v82, a138
    v_accvgpr_read_b32 v83, a139
    v_accvgpr_read_b32 v84, a164
    s_call_b64 s[50:51], L_bw_tm
    v_rcp_f32 v86, v74
    s_branch L_bw_f2
L_bw_g3:
    v_accvgpr_read_b32 v80, a140
    v_accvgpr_read_b32 v81, a141
    v_accvgpr_read_b32 v82, a142
    v_accvgpr_read_b32 v83, a143
    v_accvgpr_read_b32 v84, a166
    s_call_b64 s[50:51], L_bw_tm
    v_rcp_f32 v86, v74
    s_branch L_bw_f3
L_bw_g4:
    v_accvgpr_read_b32 v80, a144
    v_accvgpr_read_b32 v81, a145
    v_accvgpr_read_b32 v82, a146
    v_accvgpr_read_b32 v83, a147
    v_accvgpr_read_b32 v84, a168
    s_call_b64 s[50:51], L_bw_tm
    v_rcp_f32 v86, v74
    s_branch L_bw_f4
L_bw_g5:
    v_accvgpr_read_b32 v80, a148
    v_accvgpr_read_b32 v81, a149
    v_accvgpr_read_b32 v82, a150
    v_accvgpr_read_b32 v83, a151
    v_accvgpr_read_b32 v84, a170
    s_call_b64 s[50:51], L_bw_tm
    v_rcp_f32 v86, v74
    s_branch L_bw_f5
L_bw_g6:
    v_accvgpr_read_b32 v80, a152
    v_accvgpr_read_b32 v81, a153
    v_accvgpr_read_b32 v82, a154
    v_accvgpr_read_b32 v83, a155
    v_accvgpr_read_b32 v84, a172
    s_call_b64 s[50:51], L_bw_tm
    v_rcp_f32 v86, v74
    s_branch L_bw_f6
L_bw_g7:
    v_accvgpr_read_b32 v80, a156
    v_accvgpr_read_b32 v81, a157
    v_accvgpr_read_b32 v82, a158
    v_accvgpr_read_b32 v83, a159
    v_accvgpr_read_b32 v84, a174
    s_call_b64 s[50:51], L_bw_tm
    v_rcp_f32 v86, v74
    s_branch L_bw_f7
L_bw_tm:
    v_mov_b32 v88, 0xff800000
    s_mov_b32 s45, 0
L_bw_tm1:
    s_mul_i32 s34, s45, 2304
    v_add_u32 v4, s34, v7
    v_add_u32 v5, s34, v1
    v_mad_u32_u24 v6, s45, v3, v2
    ds_read_b128 v[56:59], v4 offset:0
    ds_read_b32 v60, v5 offset:0
    s_waitcnt lgkmcnt(1)
    v_mfma_f32_32x32x16_bf16 v[40:55], v[56:59], v[80:83], 0
    s_waitcnt lgkmcnt(0)
    s_nop 8
    v_mfma_f32_32x32x8_bf16 v[40:55], v[60:61], v[84:85], v[40:55]
    s_nop 11
    v_max3_f32 v88, v88, v40, v41
    v_max3_f32 v88, v88, v42, v43
    v_max3_f32 v88, v88, v44, v45
    v_max3_f32 v88, v88, v46, v47
    v_max3_f32 v88, v88, v48, v49
    v_max3_f32 v88, v88, v50, v51
    v_max3_f32 v88, v88, v52, v53
    v_max3_f32 v88, v88, v54, v55
    s_add_u32 s45, s45, 1
    s_cmp_lt_u32 s45, 64
    s_cbranch_scc1 L_bw_tm1
    v_mov_b32 v89, v88
    s_nop 1
    v_permlane32_swap_b32 v88, v89
    v_max_f32 v88, v88, v89
    s_mov_b32 s45, 0
    v_mov_b64 v[64:65], 0
    v_mov_b64 v[66:67], 0
    v_mov_b64 v[68:69], 0
    v_mov_b64 v[70:71], 0
    v_mov_b64 v[72:73], 0
    v_mov_b64 v[74:75], 0
    v_mov_b64 v[76:77], 0
    v_mov_b64 v[78:79], 0
L_bw_tm2:
    s_mul_i32 s34, s45, 2304
    v_add_u32 v4, s34, v7
    v_add_u32 v5, s34, v1
    v_mad_u32_u24 v6, s45, v3, v2
    ds_read_b128 v[56:59], v4 offset:0
    ds_read_b32 v60, v5 offset:0
    ds_read_b128 v[108:111], v6 offset:0
    ds_read_b128 v[112:115], v6 offset:576
    s_waitcnt lgkmcnt(3)
    v_mfma_f32_32x32x16_bf16 v[40:55], v[56:59], v[80:83], 0
    s_waitcnt lgkmcnt(2)
    s_nop 8
    v_mfma_f32_32x32x8_bf16 v[40:55], v[60:61], v[84:85], v[40:55]
    s_nop 11
    v_sub_f32 v40, v40, v88
    v_sub_f32 v41, v41, v88
    v_sub_f32 v42, v42, v88
    v_sub_f32 v43, v43, v88
    v_sub_f32 v44, v44, v88
    v_sub_f32 v45, v45, v88
    v_sub_f32 v46, v46, v88
    v_sub_f32 v47, v47, v88
    v_sub_f32 v48, v48, v88
    v_sub_f32 v49, v49, v88
    v_sub_f32 v50, v50, v88
    v_sub_f32 v51, v51, v88
    v_sub_f32 v52, v52, v88
    v_sub_f32 v53, v53, v88
    v_sub_f32 v54, v54, v88
    v_sub_f32 v55, v55, v88
    v_exp_f32 v40, v40
    v_exp_f32 v41, v41
    v_exp_f32 v42, v42
    v_exp_f32 v43, v43
    v_exp_f32 v44, v44
    v_exp_f32 v45, v45
    v_exp_f32 v46, v46
    v_exp_f32 v47, v47
    v_exp_f32 v48, v48
    v_exp_f32 v49, v49
    v_exp_f32 v50, v50
    v_exp_f32 v51, v51
    v_exp_f32 v52, v52
    v_exp_f32 v53, v53
    v_exp_f32 v54, v54
    v_exp_f32 v55, v55
    s_waitcnt lgkmcnt(1)
    v_smfmac_f32_32x32x32_bf16 v[64:79], v[108:111], v[40:47], v93
    s_waitcnt lgkmcnt(0)
    v_smfmac_f32_32x32x32_bf16 v[64:79], v[112:115], v[48:55], v93
    s_nop 7
    s_add_u32 s45, s45, 1
    s_cmp_lt_u32 s45, 64
    s_cbranch_scc1 L_bw_tm2
    s_nop 11
    v_mov_b32 v86, v74
    s_nop 1
    v_permlane32_swap_b32 v74, v86
    s_setpc_b64 s[50:51]
L_bw_req:
    s_lshl_b32 s34, s20, 10
    s_mul_i32 s35, s54, 2304
    s_cmp_eq_u32 s20, 3
    s_cbranch_scc1 L_bw_nd
    s_add_u32 m0, s34, s35
    s_add_u32 s34, s34, s47
    s_mov_b64 exec, s[22:23]
    buffer_load_dwordx4 v0, s[12:15], s34 offen sc1 lds
    s_mov_b64 exec, -1
L_bw_nd:
    s_cmp_lg_u32 s54, s70
    s_cbranch_scc1 L_bw_nq
    buffer_load_dwordx4 v[80:83], v0, s[12:15], s69 offen offset:2304 sc1
    buffer_load_dword v84, v92, s[12:15], s69 offen offset:3328 sc1
    s_mul_i32 s34, s65, 114688
    s_add_u32 s69, s69, s34
    s_add_u32 s70, s70, 2
L_bw_nq:
    s_add_u32 s54, s54, 1
    s_add_u32 s38, s38, 1
    s_add_u32 s47, s47, 114688
    s_sub_u32 s55, s100, s55
    s_cmp_eq_u32 s54, 64
    s_cselect_b32 s38, -1, s38
    s_setpc_b64 s[50:51]
L_bw_bulk:
    s_lshl_b32 s38, s32, 6
    s_add_u32 s38, s38, s54
    s_sub_u32 s38, s38, 1
    s_and_b32 s55, s40, 28
    s_lshl_b32 s55, s55, 5
    s_add_u32 s55, s55, 430080
    v_and_b32 v86, 16, v0
    v_lshlrev_b32 v86, 8, v86
L_w34:
    buffer_load_dword v87, v86, s[12:15], s55 offen sc1
    s_add_u32 s37, s37, 1
    s_waitcnt vmcnt(0)
    v_cmp_gt_u32 vcc, s38, v87
    s_nop 0
    s_cbranch_vccz L_w34_d
    s_sleep 1
    s_cmp_lt_u32 s37, 400000
    s_cbranch_scc1 L_w34
L_w34_d:
    s_add_u32 s33, s33, s20
    s_lshl_b32 s47, s32, 6
    s_add_u32 s47, s47, s33
    s_lshl_b32 s47, s47, 5
    s_add_u32 s47, s47, s40
    s_mul_i32 s47, s47, 3584
    s_add_u32 s47, s47, 13467648
L_bw_bl:
    s_cmp_ge_u32 s33, s54
    s_cbranch_scc1 L_bw_be
    s_mul_i32 m0, s33, 2304
    s_add_u32 s33, s33, 4
    buffer_load_dwordx4 v0, s[12:15], s47 offen sc1 lds
    buffer_load_dwordx4 v0, s[12:15], s47 offen offset:1024 sc1 lds
    s_mov_b64 exec, 0xffff
    buffer_load_dwordx4 v0, s[12:15], s47 offen offset:2048 sc1 lds
    s_mov_b64 exec, -1
    s_add_u32 s47, s47, 458752
    s_branch L_bw_bl
L_bw_be:
    s_mov_b32 s33, s54
    s_setpc_b64 s[50:51]
L_bw_mrg:
    v_add_u32 v86, 148480, v0
    ds_read_b128 v[8:11], v86 offset:0
    ds_read_b128 v[12:15], v86 offset:1024
    ds_read_b128 v[16:19], v86 offset:2048
    ds_read_b128 v[20:23], v86 offset:3072
    ds_read_b128 v[24:27], v86 offset:4096
    ds_read_b128 v[28:31], v86 offset:5120
    ds_read_b128 v[32:35], v86 offset:9216
    ds_read_b128 v[36:39], v86 offset:10240
    ds_read_b128 v[40:43], v86 offset:11264
    s_mov_b32 s101, 0
    s_sub_u32 s34, s68, 1
    s_lshr_b32 s34, s34, 2
    s_cmp_eq_u32 s34, 0
    s_cbranch_scc1 L_bw_o0
    s_cmp_eq_u32 s34, 1
    s_cbranch_scc1 L_bw_o1
    s_cmp_eq_u32 s34, 2
    s_cbranch_scc1 L_bw_o2
    s_cmp_eq_u32 s34, 3
    s_cbranch_scc1 L_bw_o3
    s_cmp_eq_u32 s34, 4
    s_cbranch_scc1 L_bw_o4
    s_cmp_eq_u32 s34, 5
    s_cbranch_scc1 L_bw_o5
    s_cmp_eq_u32 s34, 6
    s_cbranch_scc1 L_bw_o6
    v_accvgpr_write_b32 a156, v80
    v_accvgpr_write_b32 a157, v81
    v_accvgpr_write_b32 a158, v82
    v_accvgpr_write_b32 a159, v83
    v_accvgpr_write_b32 a174, v84
    s_waitcnt lgkmcnt(8)
    v_pk_add_f32 v[64:65], v[64:65], v[8:9]
    v_pk_add_f32 v[66:67], v[66:67], v[10:11]
    s_waitcnt lgkmcnt(7)
    v_pk_add_f32 v[68:69], v[68:69], v[12:13]
    v_pk_add_f32 v[70:71], v[70:71], v[14:15]
    s_waitcnt lgkmcnt(6)
    v_pk_add_f32 v[72:73], v[72:73], v[16:17]
    v_pk_add_f32 v[74:75], v[74:75], v[18:19]
    s_waitcnt lgkmcnt(5)
    v_pk_add_f32 v[64:65], v[64:65], v[20:21]
    v_pk_add_f32 v[66:67], v[66:67], v[22:23]
    s_waitcnt lgkmcnt(4)
    v_pk_add_f32 v[68:69], v[68:69], v[24:25]
    v_pk_add_f32 v[70:71], v[70:71], v[26:27]
    s_waitcnt lgkmcnt(3)
    v_pk_add_f32 v[72:73], v[72:73], v[28:29]
    v_pk_add_f32 v[74:75], v[74:75], v[30:31]
    s_waitcnt lgkmcnt(2)
    v_pk_add_f32 v[64:65], v[64:65], v[32:33]
    v_pk_add_f32 v[66:67], v[66:67], v[34:35]
    s_waitcnt lgkmcnt(1)
    v_pk_add_f32 v[68:69], v[68:69], v[36:37]
    v_pk_add_f32 v[70:71], v[70:71], v[38:39]
    s_waitcnt lgkmcnt(0)
    v_pk_add_f32 v[72:73], v[72:73], v[40:41]
    v_pk_add_f32 v[74:75], v[74:75], v[42:43]
    v_accvgpr_write_b32 a112, v64
    v_accvgpr_write_b32 a113, v65
    v_accvgpr_write_b32 a114, v66
    v_accvgpr_write_b32 a115, v67
    v_accvgpr_write_b32 a116, v68
    v_accvgpr_write_b32 a117, v69
    v_accvgpr_write_b32 a118, v70
    v_accvgpr_write_b32 a119, v71
    v_accvgpr_write_b32 a120, v72
    v_accvgpr_write_b32 a121, v73
    v_accvgpr_write_b32 a122, v74
    s_setpc_b64 s[50:51]
L_bw_o0:
    v_accvgpr_write_b32 a128, v80
    v_accvgpr_write_b32 a129, v81
    v_accvgpr_write_b32 a130, v82
    v_accvgpr_write_b32 a131, v83
    v_accvgpr_write_b32 a160, v84
    s_waitcnt lgkmcnt(8)
    v_pk_add_f32 v[64:65], v[64:65], v[8:9]
    v_pk_add_f32 v[66:67], v[66:67], v[10:11]
    s_waitcnt lgkmcnt(7)
    v_pk_add_f32 v[68:69], v[68:69], v[12:13]
    v_pk_add_f32 v[70:71], v[70:71], v[14:15]
    s_waitcnt lgkmcnt(6)
    v_pk_add_f32 v[72:73], v[72:73], v[16:17]
    v_pk_add_f32 v[74:75], v[74:75], v[18:19]
    s_waitcnt lgkmcnt(5)
    v_pk_add_f32 v[64:65], v[64:65], v[20:21]
    v_pk_add_f32 v[66:67], v[66:67], v[22:23]
    s_waitcnt lgkmcnt(4)
    v_pk_add_f32 v[68:69], v[68:69], v[24:25]
    v_pk_add_f32 v[70:71], v[70:71], v[26:27]
    s_waitcnt lgkmcnt(3)
    v_pk_add_f32 v[72:73], v[72:73], v[28:29]
    v_pk_add_f32 v[74:75], v[74:75], v[30:31]
    s_waitcnt lgkmcnt(2)
    v_pk_add_f32 v[64:65], v[64:65], v[32:33]
    v_pk_add_f32 v[66:67], v[66:67], v[34:35]
    s_waitcnt lgkmcnt(1)
    v_pk_add_f32 v[68:69], v[68:69], v[36:37]
    v_pk_add_f32 v[70:71], v[70:71], v[38:39]
    s_waitcnt lgkmcnt(0)
    v_pk_add_f32 v[72:73], v[72:73], v[40:41]
    v_pk_add_f32 v[74:75], v[74:75], v[42:43]
    v_accvgpr_write_b32 a0, v64
    v_accvgpr_write_b32 a1, v65
    v_accvgpr_write_b32 a2, v66
    v_accvgpr_write_b32 a3, v67
    v_accvgpr_write_b32 a4, v68
    v_accvgpr_write_b32 a5, v69
    v_accvgpr_write_b32 a6, v70
    v_accvgpr_write_b32 a7, v71
    v_accvgpr_write_b32 a8, v72
    v_accvgpr_write_b32 a9, v73
    v_accvgpr_write_b32 a10, v74
    s_setpc_b64 s[50:51]
L_bw_o1:
    v_accvgpr_write_b32 a132, v80
    v_accvgpr_write_b32 a133, v81
    v_accvgpr_write_b32 a134, v82
    v_accvgpr_write_b32 a135, v83
    v_accvgpr_write_b32 a162, v84
    s_waitcnt lgkmcnt(8)
    v_pk_add_f32 v[64:65], v[64:65], v[8:9]
    v_pk_add_f32 v[66:67], v[66:67], v[10:11]
    s_waitcnt lgkmcnt(7)
    v_pk_add_f32 v[68:69], v[68:69], v[12:13]
    v_pk_add_f32 v[70:71], v[70:71], v[14:15]
    s_waitcnt lgkmcnt(6)
    v_pk_add_f32 v[72:73], v[72:73], v[16:17]
    v_pk_add_f32 v[74:75], v[74:75], v[18:19]
    s_waitcnt lgkmcnt(5)
    v_pk_add_f32 v[64:65], v[64:65], v[20:21]
    v_pk_add_f32 v[66:67], v[66:67], v[22:23]
    s_waitcnt lgkmcnt(4)
    v_pk_add_f32 v[68:69], v[68:69], v[24:25]
    v_pk_add_f32 v[70:71], v[70:71], v[26:27]
    s_waitcnt lgkmcnt(3)
    v_pk_add_f32 v[72:73], v[72:73], v[28:29]
    v_pk_add_f32 v[74:75], v[74:75], v[30:31]
    s_waitcnt lgkmcnt(2)
    v_pk_add_f32 v[64:65], v[64:65], v[32:33]
    v_pk_add_f32 v[66:67], v[66:67], v[34:35]
    s_waitcnt lgkmcnt(1)
    v_pk_add_f32 v[68:69], v[68:69], v[36:37]
    v_pk_add_f32 v[70:71], v[70:71], v[38:39]
    s_waitcnt lgkmcnt(0)
    v_pk_add_f32 v[72:73], v[72:73], v[40:41]
    v_pk_add_f32 v[74:75], v[74:75], v[42:43]
    v_accvgpr_write_b32 a16, v64
    v_accvgpr_write_b32 a17, v65
    v_accvgpr_write_b32 a18, v66
    v_accvgpr_write_b32 a19, v67
    v_accvgpr_write_b32 a20, v68
    v_accvgpr_write_b32 a21, v69
    v_accvgpr_write_b32 a22, v70
    v_accvgpr_write_b32 a23, v71
    v_accvgpr_write_b32 a24, v72
    v_accvgpr_write_b32 a25, v73
    v_accvgpr_write_b32 a26, v74
    s_setpc_b64 s[50:51]
L_bw_o2:
    v_accvgpr_write_b32 a136, v80
    v_accvgpr_write_b32 a137, v81
    v_accvgpr_write_b32 a138, v82
    v_accvgpr_write_b32 a139, v83
    v_accvgpr_write_b32 a164, v84
    s_waitcnt lgkmcnt(8)
    v_pk_add_f32 v[64:65], v[64:65], v[8:9]
    v_pk_add_f32 v[66:67], v[66:67], v[10:11]
    s_waitcnt lgkmcnt(7)
    v_pk_add_f32 v[68:69], v[68:69], v[12:13]
    v_pk_add_f32 v[70:71], v[70:71], v[14:15]
    s_waitcnt lgkmcnt(6)
    v_pk_add_f32 v[72:73], v[72:73], v[16:17]
    v_pk_add_f32 v[74:75], v[74:75], v[18:19]
    s_waitcnt lgkmcnt(5)
    v_pk_add_f32 v[64:65], v[64:65], v[20:21]
    v_pk_add_f32 v[66:67], v[66:67], v[22:23]
    s_waitcnt lgkmcnt(4)
    v_pk_add_f32 v[68:69], v[68:69], v[24:25]
    v_pk_add_f32 v[70:71], v[70:71], v[26:27]
    s_waitcnt lgkmcnt(3)
    v_pk_add_f32 v[72:73], v[72:73], v[28:29]
    v_pk_add_f32 v[74:75], v[74:75], v[30:31]
    s_waitcnt lgkmcnt(2)
    v_pk_add_f32 v[64:65], v[64:65], v[32:33]
    v_pk_add_f32 v[66:67], v[66:67], v[34:35]
    s_waitcnt lgkmcnt(1)
    v_pk_add_f32 v[68:69], v[68:69], v[36:37]
    v_pk_add_f32 v[70:71], v[70:71], v[38:39]
    s_waitcnt lgkmcnt(0)
    v_pk_add_f32 v[72:73], v[72:73], v[40:41]
    v_pk_add_f32 v[74:75], v[74:75], v[42:43]
    v_accvgpr_write_b32 a32, v64
    v_accvgpr_write_b32 a33, v65
    v_accvgpr_write_b32 a34, v66
    v_accvgpr_write_b32 a35, v67
    v_accvgpr_write_b32 a36, v68
    v_accvgpr_write_b32 a37, v69
    v_accvgpr_write_b32 a38, v70
    v_accvgpr_write_b32 a39, v71
    v_accvgpr_write_b32 a40, v72
    v_accvgpr_write_b32 a41, v73
    v_accvgpr_write_b32 a42, v74
    s_setpc_b64 s[50:51]
L_bw_o3:
    v_accvgpr_write_b32 a140, v80
    v_accvgpr_write_b32 a141, v81
    v_accvgpr_write_b32 a142, v82
    v_accvgpr_write_b32 a143, v83
    v_accvgpr_write_b32 a166, v84
    s_waitcnt lgkmcnt(8)
    v_pk_add_f32 v[64:65], v[64:65], v[8:9]
    v_pk_add_f32 v[66:67], v[66:67], v[10:11]
    s_waitcnt lgkmcnt(7)
    v_pk_add_f32 v[68:69], v[68:69], v[12:13]
    v_pk_add_f32 v[70:71], v[70:71], v[14:15]
    s_waitcnt lgkmcnt(6)
    v_pk_add_f32 v[72:73], v[72:73], v[16:17]
    v_pk_add_f32 v[74:75], v[74:75], v[18:19]
    s_waitcnt lgkmcnt(5)
    v_pk_add_f32 v[64:65], v[64:65], v[20:21]
    v_pk_add_f32 v[66:67], v[66:67], v[22:23]
    s_waitcnt lgkmcnt(4)
    v_pk_add_f32 v[68:69], v[68:69], v[24:25]
    v_pk_add_f32 v[70:71], v[70:71], v[26:27]
    s_waitcnt lgkmcnt(3)
    v_pk_add_f32 v[72:73], v[72:73], v[28:29]
    v_pk_add_f32 v[74:75], v[74:75], v[30:31]
    s_waitcnt lgkmcnt(2)
    v_pk_add_f32 v[64:65], v[64:65], v[32:33]
    v_pk_add_f32 v[66:67], v[66:67], v[34:35]
    s_waitcnt lgkmcnt(1)
    v_pk_add_f32 v[68:69], v[68:69], v[36:37]
    v_pk_add_f32 v[70:71], v[70:71], v[38:39]
    s_waitcnt lgkmcnt(0)
    v_pk_add_f32 v[72:73], v[72:73], v[40:41]
    v_pk_add_f32 v[74:75], v[74:75], v[42:43]
    v_accvgpr_write_b32 a48, v64
    v_accvgpr_write_b32 a49, v65
    v_accvgpr_write_b32 a50, v66
    v_accvgpr_write_b32 a51, v67
    v_accvgpr_write_b32 a52, v68
    v_accvgpr_write_b32 a53, v69
    v_accvgpr_write_b32 a54, v70
    v_accvgpr_write_b32 a55, v71
    v_accvgpr_write_b32 a56, v72
    v_accvgpr_write_b32 a57, v73
    v_accvgpr_write_b32 a58, v74
    s_setpc_b64 s[50:51]
L_bw_o4:
    v_accvgpr_write_b32 a144, v80
    v_accvgpr_write_b32 a145, v81
    v_accvgpr_write_b32 a146, v82
    v_accvgpr_write_b32 a147, v83
    v_accvgpr_write_b32 a168, v84
    s_waitcnt lgkmcnt(8)
    v_pk_add_f32 v[64:65], v[64:65], v[8:9]
    v_pk_add_f32 v[66:67], v[66:67], v[10:11]
    s_waitcnt lgkmcnt(7)
    v_pk_add_f32 v[68:69], v[68:69], v[12:13]
    v_pk_add_f32 v[70:71], v[70:71], v[14:15]
    s_waitcnt lgkmcnt(6)
    v_pk_add_f32 v[72:73], v[72:73], v[16:17]
    v_pk_add_f32 v[74:75], v[74:75], v[18:19]
    s_waitcnt lgkmcnt(5)
    v_pk_add_f32 v[64:65], v[64:65], v[20:21]
    v_pk_add_f32 v[66:67], v[66:67], v[22:23]
    s_waitcnt lgkmcnt(4)
    v_pk_add_f32 v[68:69], v[68:69], v[24:25]
    v_pk_add_f32 v[70:71], v[70:71], v[26:27]
    s_waitcnt lgkmcnt(3)
    v_pk_add_f32 v[72:73], v[72:73], v[28:29]
    v_pk_add_f32 v[74:75], v[74:75], v[30:31]
    s_waitcnt lgkmcnt(2)
    v_pk_add_f32 v[64:65], v[64:65], v[32:33]
    v_pk_add_f32 v[66:67], v[66:67], v[34:35]
    s_waitcnt lgkmcnt(1)
    v_pk_add_f32 v[68:69], v[68:69], v[36:37]
    v_pk_add_f32 v[70:71], v[70:71], v[38:39]
    s_waitcnt lgkmcnt(0)
    v_pk_add_f32 v[72:73], v[72:73], v[40:41]
    v_pk_add_f32 v[74:75], v[74:75], v[42:43]
    v_accvgpr_write_b32 a64, v64
    v_accvgpr_write_b32 a65, v65
    v_accvgpr_write_b32 a66, v66
    v_accvgpr_write_b32 a67, v67
    v_accvgpr_write_b32 a68, v68
    v_accvgpr_write_b32 a69, v69
    v_accvgpr_write_b32 a70, v70
    v_accvgpr_write_b32 a71, v71
    v_accvgpr_write_b32 a72, v72
    v_accvgpr_write_b32 a73, v73
    v_accvgpr_write_b32 a74, v74
    s_setpc_b64 s[50:51]
L_bw_o5:
    v_accvgpr_write_b32 a148, v80
    v_accvgpr_write_b32 a149, v81
    v_accvgpr_write_b32 a150, v82
    v_accvgpr_write_b32 a151, v83
    v_accvgpr_write_b32 a170, v84
    s_waitcnt lgkmcnt(8)
    v_pk_add_f32 v[64:65], v[64:65], v[8:9]
    v_pk_add_f32 v[66:67], v[66:67], v[10:11]
    s_waitcnt lgkmcnt(7)
    v_pk_add_f32 v[68:69], v[68:69], v[12:13]
    v_pk_add_f32 v[70:71], v[70:71], v[14:15]
    s_waitcnt lgkmcnt(6)
    v_pk_add_f32 v[72:73], v[72:73], v[16:17]
    v_pk_add_f32 v[74:75], v[74:75], v[18:19]
    s_waitcnt lgkmcnt(5)
    v_pk_add_f32 v[64:65], v[64:65], v[20:21]
    v_pk_add_f32 v[66:67], v[66:67], v[22:23]
    s_waitcnt lgkmcnt(4)
    v_pk_add_f32 v[68:69], v[68:69], v[24:25]
    v_pk_add_f32 v[70:71], v[70:71], v[26:27]
    s_waitcnt lgkmcnt(3)
    v_pk_add_f32 v[72:73], v[72:73], v[28:29]
    v_pk_add_f32 v[74:75], v[74:75], v[30:31]
    s_waitcnt lgkmcnt(2)
    v_pk_add_f32 v[64:65], v[64:65], v[32:33]
    v_pk_add_f32 v[66:67], v[66:67], v[34:35]
    s_waitcnt lgkmcnt(1)
    v_pk_add_f32 v[68:69], v[68:69], v[36:37]
    v_pk_add_f32 v[70:71], v[70:71], v[38:39]
    s_waitcnt lgkmcnt(0)
    v_pk_add_f32 v[72:73], v[72:73], v[40:41]
    v_pk_add_f32 v[74:75], v[74:75], v[42:43]
    v_accvgpr_write_b32 a80, v64
    v_accvgpr_write_b32 a81, v65
    v_accvgpr_write_b32 a82, v66
    v_accvgpr_write_b32 a83, v67
    v_accvgpr_write_b32 a84, v68
    v_accvgpr_write_b32 a85, v69
    v_accvgpr_write_b32 a86, v70
    v_accvgpr_write_b32 a87, v71
    v_accvgpr_write_b32 a88, v72
    v_accvgpr_write_b32 a89, v73
    v_accvgpr_write_b32 a90, v74
    s_setpc_b64 s[50:51]
L_bw_o6:
    v_accvgpr_write_b32 a152, v80
    v_accvgpr_write_b32 a153, v81
    v_accvgpr_write_b32 a154, v82
    v_accvgpr_write_b32 a155, v83
    v_accvgpr_write_b32 a172, v84
    s_waitcnt lgkmcnt(8)
    v_pk_add_f32 v[64:65], v[64:65], v[8:9]
    v_pk_add_f32 v[66:67], v[66:67], v[10:11]
    s_waitcnt lgkmcnt(7)
    v_pk_add_f32 v[68:69], v[68:69], v[12:13]
    v_pk_add_f32 v[70:71], v[70:71], v[14:15]
    s_waitcnt lgkmcnt(6)
    v_pk_add_f32 v[72:73], v[72:73], v[16:17]
    v_pk_add_f32 v[74:75], v[74:75], v[18:19]
    s_waitcnt lgkmcnt(5)
    v_pk_add_f32 v[64:65], v[64:65], v[20:21]
    v_pk_add_f32 v[66:67], v[66:67], v[22:23]
    s_waitcnt lgkmcnt(4)
    v_pk_add_f32 v[68:69], v[68:69], v[24:25]
    v_pk_add_f32 v[70:71], v[70:71], v[26:27]
    s_waitcnt lgkmcnt(3)
    v_pk_add_f32 v[72:73], v[72:73], v[28:29]
    v_pk_add_f32 v[74:75], v[74:75], v[30:31]
    s_waitcnt lgkmcnt(2)
    v_pk_add_f32 v[64:65], v[64:65], v[32:33]
    v_pk_add_f32 v[66:67], v[66:67], v[34:35]
    s_waitcnt lgkmcnt(1)
    v_pk_add_f32 v[68:69], v[68:69], v[36:37]
    v_pk_add_f32 v[70:71], v[70:71], v[38:39]
    s_waitcnt lgkmcnt(0)
    v_pk_add_f32 v[72:73], v[72:73], v[40:41]
    v_pk_add_f32 v[74:75], v[74:75], v[42:43]
    v_accvgpr_write_b32 a96, v64
    v_accvgpr_write_b32 a97, v65
    v_accvgpr_write_b32 a98, v66
    v_accvgpr_write_b32 a99, v67
    v_accvgpr_write_b32 a100, v68
    v_accvgpr_write_b32 a101, v69
    v_accvgpr_write_b32 a102, v70
    v_accvgpr_write_b32 a103, v71
    v_accvgpr_write_b32 a104, v72
    v_accvgpr_write_b32 a105, v73
    v_accvgpr_write_b32 a106, v74
    s_setpc_b64 s[50:51]
L_bw_proj:
    s_cmp_ge_u32 s48, s75
    s_cbranch_scc1 L_bw_pe
    s_mov_b32 s54, s48
    s_mov_b32 s44, 12288
    s_mov_b32 s68, 12288
    v_lshlrev_b32 v76, 3, v0
    v_and_b32 v76, 4095, v76
    s_mul_i32 s46, s48, 18432
    s_lshr_b32 s34, s54, 1
    s_lshl_b32 s38, s32, 6
    s_add_u32 s38, s38, s34
    s_mul_i32 s47, s38, 36864
    s_add_u32 s47, s47, 8749056
    s_add_u32 s38, s38, 1
    s_and_b32 s55, s34, 1
    s_lshl_b32 s55, s55, 12
    s_add_u32 s55, s55, 438272
    s_cmp_le_u32 s38, 119
    s_cbranch_scc1 L_pa35
    s_sub_u32 s34, s34, 55
    s_mul_i32 s35, s34, 21846
    s_lshr_b32 s35, s35, 16
    s_mul_i32 s35, s35, 3
    s_sub_u32 s55, s34, s35
    s_lshl_b32 s55, s55, 12
    s_add_u32 s55, s55, 454656
L_pa35:
    s_cmp_ge_u32 s54, s75
    s_cselect_b32 s38, -1, s38
    s_cselect_b32 s55, 393216, s55
L_bw_pl:
    s_cmp_gt_u32 s54, s48
    s_cbranch_scc1 L_bw_ph
    v_mov_b32 v86, v76
L_w36:
    buffer_load_dword v87, v86, s[12:15], s55 offen sc1
    s_add_u32 s37, s37, 1
    s_waitcnt vmcnt(0)
    v_cmp_gt_u32 vcc, s38, v87
    s_nop 0
    s_cbranch_vccz L_w36_d
    s_sleep 1
    s_cmp_lt_u32 s37, 400000
    s_cbranch_scc1 L_w36
L_w36_d:
    s_call_b64 s[50:51], L_bw_preq
    buffer_load_dword v105, v76, s[12:15], s55 offen sc1
    buffer_load_dwordx4 v[48:51], v98, s[16:19], s46 offen sc1
    buffer_load_dwordx4 v[52:55], v99, s[16:19], s46 offen sc1
    s_waitcnt vmcnt(0)
L_bw_ph:
    v_add_u32 v77, s68, v0
    s_add_u32 s68, s68, 18432
    s_cmp_eq_u32 s68, 67584
    s_cselect_b32 s68, 12288, s68
    s_mul_i32 s67, s74, 18432
    s_add_u32 s67, s67, s46
    s_waitcnt vmcnt(2)
    s_barrier
    ds_read_b128 v[32:35], v77 offset:0
    ds_read_b128 v[36:39], v77 offset:1024
    ds_read_b128 v[40:43], v77 offset:2048
    v_cmp_gt_u32 vcc, s38, v105
    v_mov_b32 v64, v48
    v_mov_b32 v65, v49
    v_mov_b32 v66, v50
    v_mov_b32 v67, v51
    v_mov_b32 v68, v52
    v_mov_b32 v69, v53
    v_mov_b32 v70, v54
    v_mov_b32 v71, v55
    s_cbranch_vccnz L_bw_pn
    s_call_b64 s[50:51], L_bw_preq
L_bw_pn:
    buffer_load_dword v105, v76, s[12:15], s55 offen sc1
    buffer_load_dwordx4 v[48:51], v98, s[16:19], s67 offen sc1
    buffer_load_dwordx4 v[52:55], v99, s[16:19], s67 offen sc1
    s_waitcnt lgkmcnt(2)
    v_mfma_f32_16x16x32_bf16 v[8:11], a[176:179], v[32:35], 0
    ds_read_b128 v[44:47], v77 offset:3072
    v_mfma_f32_16x16x32_bf16 v[12:15], a[180:183], v[32:35], 0
    v_mfma_f32_16x16x32_bf16 v[16:19], a[184:187], v[32:35], 0
    s_waitcnt lgkmcnt(2)
    v_mfma_f32_16x16x32_bf16 v[8:11], a[188:191], v[36:39], v[8:11]
    ds_read_b128 v[32:35], v77 offset:4096
    v_mfma_f32_16x16x32_bf16 v[12:15], a[192:195], v[36:39], v[12:15]
    v_mfma_f32_16x16x32_bf16 v[16:19], a[196:199], v[36:39], v[16:19]
    s_waitcnt lgkmcnt(2)
    v_mfma_f32_16x16x32_bf16 v[8:11], a[200:203], v[40:43], v[8:11]
    ds_read_b128 v[36:39], v77 offset:5120
    v_mfma_f32_16x16x32_bf16 v[12:15], a[204:207], v[40:43], v[12:15]
    v_mfma_f32_16x16x32_bf16 v[16:19], a[208:211], v[40:43], v[16:19]
    s_waitcnt lgkmcnt(2)
    v_mfma_f32_16x16x32_bf16 v[8:11], a[212:215], v[44:47], v[8:11]
    ds_read_b128 v[40:43], v77 offset:6144
    v_mfma_f32_16x16x32_bf16 v[12:15], a[216:219], v[44:47], v[12:15]
    v_mfma_f32_16x16x32_bf16 v[16:19], a[220:223], v[44:47], v[16:19]
    s_waitcnt lgkmcnt(2)
    v_mfma_f32_16x16x32_bf16 v[8:11], a[224:227], v[32:35], v[8:11]
    ds_read_b128 v[44:47], v77 offset:7168
    v_mfma_f32_16x16x32_bf16 v[12:15], a[228:231], v[32:35], v[12:15]
    v_mfma_f32_16x16x32_bf16 v[16:19], a[232:235], v[32:35], v[16:19]
    s_waitcnt lgkmcnt(2)
    v_mfma_f32_16x16x32_bf16 v[8:11], a[236:239], v[36:39], v[8:11]
    ds_read_b128 v[32:35], v77 offset:8192
    v_mfma_f32_16x16x32_bf16 v[12:15], a[240:243], v[36:39], v[12:15]
    v_mfma_f32_16x16x32_bf16 v[16:19], a[244:247], v[36:39], v[16:19]
    s_waitcnt lgkmcnt(2)
    v_mfma_f32_16x16x32_bf16 v[8:11], a[248:251], v[40:43], v[8:11]
    ds_read_b128 v[36:39], v77 offset:9216
    v_mfma_f32_16x16x32_bf16 v[12:15], a[252:255], v[40:43], v[12:15]
    v_mfma_f32_16x16x32_bf16 v[16:19], v[120:123], v[40:43], v[16:19]
    s_waitcnt lgkmcnt(2)
    v_mfma_f32_16x16x32_bf16 v[8:11], v[124:127], v[44:47], v[8:11]
    ds_read_b128 v[40:43], v77 offset:10240
    v_mfma_f32_16x16x32_bf16 v[12:15], v[128:131], v[44:47], v[12:15]
    v_mfma_f32_16x16x32_bf16 v[16:19], v[132:135], v[44:47], v[16:19]
    s_waitcnt lgkmcnt(2)
    v_mfma_f32_16x16x32_bf16 v[8:11], v[136:139], v[32:35], v[8:11]
    ds_read_b128 v[44:47], v77 offset:11264
    v_mfma_f32_16x16x32_bf16 v[12:15], v[140:143], v[32:35], v[12:15]
    v_mfma_f32_16x16x32_bf16 v[16:19], v[144:147], v[32:35], v[16:19]
    s_waitcnt lgkmcnt(2)
    v_mfma_f32_16x16x32_bf16 v[8:11], v[148:151], v[36:39], v[8:11]
    ds_read_b128 v[32:35], v77 offset:12288
    v_mfma_f32_16x16x32_bf16 v[12:15], v[152:155], v[36:39], v[12:15]
    v_mfma_f32_16x16x32_bf16 v[16:19], v[156:159], v[36:39], v[16:19]
    s_waitcnt lgkmcnt(2)
    v_mfma_f32_16x16x32_bf16 v[8:11], v[160:163], v[40:43], v[8:11]
    ds_read_b128 v[36:39], v77 offset:13312
    v_mfma_f32_16x16x32_bf16 v[12:15], v[164:167], v[40:43], v[12:15]
    v_mfma_f32_16x16x32_bf16 v[16:19], v[168:171], v[40:43], v[16:19]
    s_waitcnt lgkmcnt(2)
    v_mfma_f32_16x16x32_bf16 v[8:11], v[172:175], v[44:47], v[8:11]
    ds_read_b128 v[40:43], v77 offset:14336
    v_mfma_f32_16x16x32_bf16 v[12:15], v[176:179], v[44:47], v[12:15]
    v_mfma_f32_16x16x32_bf16 v[16:19], v[180:183], v[44:47], v[16:19]
    s_waitcnt lgkmcnt(2)
    v_mfma_f32_16x16x32_bf16 v[8:11], v[184:187], v[32:35], v[8:11]
    ds_read_b128 v[44:47], v77 offset:15360
    v_mfma_f32_16x16x32_bf16 v[12:15], v[188:191], v[32:35], v[12:15]
    v_mfma_f32_16x16x32_bf16 v[16:19], v[192:195], v[32:35], v[16:19]
    s_waitcnt lgkmcnt(2)
    v_mfma_f32_16x16x32_bf16 v[8:11], v[196:199], v[36:39], v[8:11]
    ds_read_b128 v[32:35], v77 offset:16384
    v_mfma_f32_16x16x32_bf16 v[12:15], v[200:203], v[36:39], v[12:15]
    v_mfma_f32_16x16x32_bf16 v[16:19], v[204:207], v[36:39], v[16:19]
    s_waitcnt lgkmcnt(2)
    v_mfma_f32_16x16x32_bf16 v[8:11], v[208:211], v[40:43], v[8:11]
    ds_read_b128 v[36:39], v77 offset:17408
    v_mfma_f32_16x16x32_bf16 v[12:15], v[212:215], v[40:43], v[12:15]
    v_mfma_f32_16x16x32_bf16 v[16:19], v[216:219], v[40:43], v[16:19]
    s_waitcnt lgkmcnt(2)
    v_mfma_f32_16x16x32_bf16 v[8:11], v[220:223], v[44:47], v[8:11]
    v_mfma_f32_16x16x32_bf16 v[12:15], v[224:227], v[44:47], v[12:15]
    v_mfma_f32_16x16x32_bf16 v[16:19], v[228:231], v[44:47], v[16:19]
    s_waitcnt lgkmcnt(1)
    v_mfma_f32_16x16x32_bf16 v[8:11], v[232:235], v[32:35], v[8:11]
    v_mfma_f32_16x16x32_bf16 v[12:15], v[236:239], v[32:35], v[12:15]
    v_mfma_f32_16x16x32_bf16 v[16:19], v[240:243], v[32:35], v[16:19]
    s_waitcnt lgkmcnt(0)
    v_mfma_f32_16x16x32_bf16 v[8:11], v[244:247], v[36:39], v[8:11]
    v_mfma_f32_16x16x32_bf16 v[12:15], v[248:251], v[36:39], v[12:15]
    v_mfma_f32_16x16x32_bf16 v[16:19], v[252:255], v[36:39], v[16:19]
    s_mul_i32 s34, s20, 3072
    v_add_u32 v86, s34, v0
    v_lshlrev_b32 v32, 16, v64
    v_and_b32 v33, 0xffff0000, v64
    v_lshlrev_b32 v34, 16, v65
    v_and_b32 v35, 0xffff0000, v65
    v_lshlrev_b32 v36, 16, v66
    v_and_b32 v37, 0xffff0000, v66
    v_lshlrev_b32 v38, 16, v67
    v_and_b32 v39, 0xffff0000, v67
    ds_write_b128 v86, v[8:11] offset:0
    ds_write_b128 v86, v[12:15] offset:1024
    ds_write_b128 v86, v[16:19] offset:2048
    v_lshlrev_b32 v40, 16, v68
    v_and_b32 v41, 0xffff0000, v68
    v_lshlrev_b32 v42, 16, v69
    v_and_b32 v43, 0xffff0000, v69
    v_lshlrev_b32 v44, 16, v70
    v_and_b32 v45, 0xffff0000, v70
    v_lshlrev_b32 v46, 16, v71
    v_and_b32 v47, 0xffff0000, v71
    s_waitcnt lgkmcnt(0)
    s_barrier
    ds_read_b128 v[8:11], v94 offset:0
    ds_read_b128 v[12:15], v94 offset:256
    ds_read_b128 v[16:19], v95 offset:0
    ds_read_b128 v[20:23], v95 offset:256
    s_add_u32 s34, s48, s74
    s_cmp_gt_u32 s54, s34
    s_cbranch_scc1 L_bw_pm
    s_waitcnt vmcnt(0)
    v_cmp_gt_u32 vcc, s38, v105
    s_nop 0
    s_cbranch_vccnz L_bw_pm
    s_call_b64 s[50:51], L_bw_preq
    buffer_load_dword v105, v76, s[12:15], s55 offen sc1
L_bw_pm:
    s_waitcnt lgkmcnt(3)
    v_pk_add_f32 v[8:9], v[8:9], v[32:33]
    v_cvt_pk_bf16_f32 v64, v8, v9
    v_pk_add_f32 v[10:11], v[10:11], v[34:35]
    v_cvt_pk_bf16_f32 v65, v10, v11
    s_waitcnt lgkmcnt(2)
    v_pk_add_f32 v[12:13], v[12:13], v[36:37]
    v_cvt_pk_bf16_f32 v66, v12, v13
    v_pk_add_f32 v[14:15], v[14:15], v[38:39]
    v_cvt_pk_bf16_f32 v67, v14, v15
    buffer_store_dwordx4 v[64:67], v98, s[24:27], s46 offen sc1
    s_waitcnt lgkmcnt(1)
    v_pk_add_f32 v[16:17], v[16:17], v[40:41]
    v_cvt_pk_bf16_f32 v68, v16, v17
    v_pk_add_f32 v[18:19], v[18:19], v[42:43]
    v_cvt_pk_bf16_f32 v69, v18, v19
    s_waitcnt lgkmcnt(0)
    v_pk_add_f32 v[20:21], v[20:21], v[44:45]
    v_cvt_pk_bf16_f32 v70, v20, v21
    v_pk_add_f32 v[22:23], v[22:23], v[46:47]
    v_cvt_pk_bf16_f32 v71, v22, v23
    buffer_store_dwordx4 v[68:71], v99, s[24:27], s46 offen sc1
    s_add_u32 s45, s48, 1
    s_add_u32 s48, s48, s74
    s_mov_b32 s46, s67
    s_cmp_lg_u32 s32, 0
    s_cbranch_scc1 L_bw_pq
    s_waitcnt vmcnt(0) lgkmcnt(0)
    s_barrier
    s_cmp_lg_u32 s20, 0
    s_cbranch_scc1 L_s37
    v_mov_b32 v86, s45
    v_mov_b32 v87, 0
    s_mov_b64 exec, 1
    buffer_store_dword v86, v87, s[12:15], s43 offen sc1
    s_mov_b64 exec, -1
L_s37:
L_bw_pq:
    s_cmp_lt_u32 s48, s75
    s_cbranch_scc1 L_bw_pl
L_bw_pe:
    s_setpc_b64 s[72:73]
L_bw_preq:
    s_and_b32 s100, s54, 1
    s_lshl_b32 s35, s100, 8
    s_mul_i32 s34, s20, 9216
    s_add_u32 s34, s34, s35
    s_add_u32 s34, s34, s47
    s_lshl_b32 s36, s20, 12
    s_add_u32 s36, s36, s44
    s_add_u32 m0, s36, 0
    s_add_u32 s35, s34, 0
    buffer_load_dwordx4 v102, s[12:15], s35 offen sc1 lds
    s_add_u32 m0, s36, 1024
    s_add_u32 s35, s34, 2304
    buffer_load_dwordx4 v102, s[12:15], s35 offen sc1 lds
    s_add_u32 m0, s36, 2048
    s_add_u32 s35, s34, 4608
    buffer_load_dwordx4 v102, s[12:15], s35 offen sc1 lds
    s_add_u32 m0, s36, 3072
    s_add_u32 s35, s34, 6912
    buffer_load_dwordx4 v102, s[12:15], s35 offen sc1 lds
    s_lshl_b32 s35, s100, 6
    s_mul_i32 s34, s20, 4608
    s_add_u32 s34, s34, s35
    s_add_u32 s34, s34, s47
    s_lshl_b32 s36, s20, 8
    s_add_u32 s36, s36, s44
    s_add_u32 m0, s36, 16384
    s_add_u32 s35, s34, 0
    buffer_load_dword v103, s[12:15], s35 offen sc1 lds
    s_add_u32 m0, s36, 17408
    s_add_u32 s35, s34, 18432
    buffer_load_dword v103, s[12:15], s35 offen sc1 lds
    s_add_u32 s54, s54, s74
    s_add_u32 s44, s44, 18432
    s_cmp_eq_u32 s44, 67584
    s_cselect_b32 s44, 12288, s44
    s_lshr_b32 s34, s54, 1
    s_lshl_b32 s38, s32, 6
    s_add_u32 s38, s38, s34
    s_mul_i32 s47, s38, 36864
    s_add_u32 s47, s47, 8749056
    s_add_u32 s38, s38, 1
    s_and_b32 s55, s34, 1
    s_lshl_b32 s55, s55, 12
    s_add_u32 s55, s55, 438272
    s_cmp_le_u32 s38, 119
    s_cbranch_scc1 L_pa38
    s_sub_u32 s34, s34, 55
    s_mul_i32 s35, s34, 21846
    s_lshr_b32 s35, s35, 16
    s_mul_i32 s35, s35, 3
    s_sub_u32 s55, s34, s35
    s_lshl_b32 s55, s55, 12
    s_add_u32 s55, s55, 454656
L_pa38:
    s_cmp_ge_u32 s54, s75
    s_cselect_b32 s38, -1, s38
    s_cselect_b32 s55, 393216, s55
    s_setpc_b64 s[50:51]
L_bw_ip:
    s_mul_i32 s48, s21, 21846
    s_lshr_b32 s48, s48, 16
    s_mul_i32 s34, s48, 3
    s_sub_u32 s49, s21, s34
    s_mul_i32 s35, s49, 384
    s_mul_i32 s34, s20, 96
    s_add_u32 s35, s35, s34
    s_mov_b32 s28, s82
    s_mov_b32 s29, s83
    s_mov_b32 s30, 663552
    s_mov_b32 s31, 0x20000
    v_and_b32 v4, 63, v0
    v_add_u32 v4, 0, v4
    v_mul_u32_u24 v5, 10923, v4
    v_lshrrev_b32 v5, 16, v5
    v_mul_u32_u24 v6, 6, v5
    v_sub_u32 v4, v4, v6
    v_bfe_u32 v6, v5, 3, 1
    v_mul_u32_u24 v6, 18, v6
    v_lshrrev_b32 v7, 4, v5
    v_lshl_add_u32 v6, v7, 3, v6
    v_and_b32 v5, 7, v5
    v_add_u32 v5, v5, v6
    v_mul_u32_u24 v5, 1152, v5
    v_lshl_add_u32 v5, v4, 4, v5
    v_add_u32 v8, s35, v5
    v_and_b32 v4, 63, v0
    v_add_u32 v4, 64, v4
    v_mul_u32_u24 v5, 10923, v4
    v_lshrrev_b32 v5, 16, v5
    v_mul_u32_u24 v6, 6, v5
    v_sub_u32 v4, v4, v6
    v_bfe_u32 v6, v5, 3, 1
    v_mul_u32_u24 v6, 18, v6
    v_lshrrev_b32 v7, 4, v5
    v_lshl_add_u32 v6, v7, 3, v6
    v_and_b32 v5, 7, v5
    v_add_u32 v5, v5, v6
    v_mul_u32_u24 v5, 1152, v5
    v_lshl_add_u32 v5, v4, 4, v5
    v_add_u32 v9, s35, v5
    v_and_b32 v4, 63, v0
    v_add_u32 v4, 128, v4
    v_mul_u32_u24 v5, 10923, v4
    v_lshrrev_b32 v5, 16, v5
    v_mul_u32_u24 v6, 6, v5
    v_sub_u32 v4, v4, v6
    v_bfe_u32 v6, v5, 3, 1
    v_mul_u32_u24 v6, 18, v6
    v_lshrrev_b32 v7, 4, v5
    v_lshl_add_u32 v6, v7, 3, v6
    v_and_b32 v5, 7, v5
    v_add_u32 v5, v5, v6
    v_mul_u32_u24 v5, 1152, v5
    v_lshl_add_u32 v5, v4, 4, v5
    v_add_u32 v10, s35, v5
    v_and_b32 v4, 63, v0
    v_add_u32 v4, 0, v4
    v_mul_u32_u24 v5, 10923, v4
    v_lshrrev_b32 v5, 16, v5
    v_mul_u32_u24 v6, 6, v5
    v_sub_u32 v4, v4, v6
    v_and_b32 v6, 12, v5
    v_lshrrev_b32 v7, 4, v5
    v_lshl_add_u32 v6, v7, 1, v6
    v_bfe_u32 v7, v5, 1, 1
    v_add_u32 v6, v6, v7
    v_mul_u32_u24 v6, 18, v6
    v_and_b32 v5, 1, v5
    v_add3_u32 v5, v5, v6, 16
    v_mul_u32_u24 v5, 1152, v5
    v_lshl_add_u32 v5, v4, 4, v5
    v_add_u32 v12, s35, v5
    v_and_b32 v4, 63, v0
    v_add_u32 v4, 64, v4
    v_mul_u32_u24 v5, 10923, v4
    v_lshrrev_b32 v5, 16, v5
    v_mul_u32_u24 v6, 6, v5
    v_sub_u32 v4, v4, v6
    v_and_b32 v6, 12, v5
    v_lshrrev_b32 v7, 4, v5
    v_lshl_add_u32 v6, v7, 1, v6
    v_bfe_u32 v7, v5, 1, 1
    v_add_u32 v6, v6, v7
    v_mul_u32_u24 v6, 18, v6
    v_and_b32 v5, 1, v5
    v_add3_u32 v5, v5, v6, 16
    v_mul_u32_u24 v5, 1152, v5
    v_lshl_add_u32 v5, v4, 4, v5
    v_add_u32 v13, s35, v5
    v_and_b32 v4, 63, v0
    v_add_u32 v4, 128, v4
    v_mul_u32_u24 v5, 10923, v4
    v_lshrrev_b32 v5, 16, v5
    v_mul_u32_u24 v6, 6, v5
    v_sub_u32 v4, v4, v6
    v_and_b32 v6, 12, v5
    v_lshrrev_b32 v7, 4, v5
    v_lshl_add_u32 v6, v7, 1, v6
    v_bfe_u32 v7, v5, 1, 1
    v_add_u32 v6, v6, v7
    v_mul_u32_u24 v6, 18, v6
    v_and_b32 v5, 1, v5
    v_add3_u32 v5, v5, v6, 16
    v_mul_u32_u24 v5, 1152, v5
    v_lshl_add_u32 v5, v4, 4, v5
    v_add_u32 v14, s35, v5
    s_mul_i32 s36, s20, 36864
    v_and_b32 v4, 63, v0
    v_lshrrev_b32 v5, 2, v4
    v_mul_u32_u24 v5, 96, v5
    v_and_b32 v4, 3, v4
    v_lshl_add_u32 v5, v4, 3, v5
    v_add_u32 v16, s36, v5
    s_mov_b32 s34, 0
    s_add_u32 m0, s36, 0
    s_nop 0
    buffer_load_dwordx4 v8, s[28:31], s34 offen lds
    s_add_u32 m0, s36, 1024
    s_nop 0
    buffer_load_dwordx4 v9, s[28:31], s34 offen lds
    s_add_u32 m0, s36, 2048
    s_nop 0
    buffer_load_dwordx4 v10, s[28:31], s34 offen lds
    s_mov_b32 s34, 41472
    s_add_u32 m0, s36, 3072
    s_nop 0
    buffer_load_dwordx4 v8, s[28:31], s34 offen lds
    s_add_u32 m0, s36, 4096
    s_nop 0
    buffer_load_dwordx4 v9, s[28:31], s34 offen lds
    s_add_u32 m0, s36, 5120
    s_nop 0
    buffer_load_dwordx4 v10, s[28:31], s34 offen lds
    s_mov_b32 s34, 82944
    s_add_u32 m0, s36, 6144
    s_nop 0
    buffer_load_dwordx4 v8, s[28:31], s34 offen lds
    s_add_u32 m0, s36, 7168
    s_nop 0
    buffer_load_dwordx4 v9, s[28:31], s34 offen lds
    s_add_u32 m0, s36, 8192
    s_nop 0
    buffer_load_dwordx4 v10, s[28:31], s34 offen lds
    s_mov_b32 s34, 124416
    s_add_u32 m0, s36, 9216
    s_nop 0
    buffer_load_dwordx4 v8, s[28:31], s34 offen lds
    s_add_u32 m0, s36, 10240
    s_nop 0
    buffer_load_dwordx4 v9, s[28:31], s34 offen lds
    s_add_u32 m0, s36, 11264
    s_nop 0
    buffer_load_dwordx4 v10, s[28:31], s34 offen lds
    s_mov_b32 s34, 165888
    s_add_u32 m0, s36, 12288
    s_nop 0
    buffer_load_dwordx4 v8, s[28:31], s34 offen lds
    s_add_u32 m0, s36, 13312
    s_nop 0
    buffer_load_dwordx4 v9, s[28:31], s34 offen lds
    s_add_u32 m0, s36, 14336
    s_nop 0
    buffer_load_dwordx4 v10, s[28:31], s34 offen lds
    s_mov_b32 s34, 207360
    s_add_u32 m0, s36, 15360
    s_nop 0
    buffer_load_dwordx4 v8, s[28:31], s34 offen lds
    s_add_u32 m0, s36, 16384
    s_nop 0
    buffer_load_dwordx4 v9, s[28:31], s34 offen lds
    s_add_u32 m0, s36, 17408
    s_nop 0
    buffer_load_dwordx4 v10, s[28:31], s34 offen lds
    s_mov_b32 s34, 248832
    s_add_u32 m0, s36, 18432
    s_nop 0
    buffer_load_dwordx4 v8, s[28:31], s34 offen lds
    s_add_u32 m0, s36, 19456
    s_nop 0
    buffer_load_dwordx4 v9, s[28:31], s34 offen lds
    s_add_u32 m0, s36, 20480
    s_nop 0
    buffer_load_dwordx4 v10, s[28:31], s34 offen lds
    s_mov_b32 s34, 290304
    s_add_u32 m0, s36, 21504
    s_nop 0
    buffer_load_dwordx4 v8, s[28:31], s34 offen lds
    s_add_u32 m0, s36, 22528
    s_nop 0
    buffer_load_dwordx4 v9, s[28:31], s34 offen lds
    s_add_u32 m0, s36, 23552
    s_nop 0
    buffer_load_dwordx4 v10, s[28:31], s34 offen lds
    s_mov_b32 s34, 331776
    s_add_u32 m0, s36, 24576
    s_nop 0
    buffer_load_dwordx4 v8, s[28:31], s34 offen lds
    s_add_u32 m0, s36, 25600
    s_nop 0
    buffer_load_dwordx4 v9, s[28:31], s34 offen lds
    s_add_u32 m0, s36, 26624
    s_nop 0
    buffer_load_dwordx4 v10, s[28:31], s34 offen lds
    s_mov_b32 s34, 373248
    s_add_u32 m0, s36, 27648
    s_nop 0
    buffer_load_dwordx4 v8, s[28:31], s34 offen lds
    s_add_u32 m0, s36, 28672
    s_nop 0
    buffer_load_dwordx4 v9, s[28:31], s34 offen lds
    s_add_u32 m0, s36, 29696
    s_nop 0
    buffer_load_dwordx4 v10, s[28:31], s34 offen lds
    s_mov_b32 s34, 414720
    s_add_u32 m0, s36, 30720
    s_nop 0
    buffer_load_dwordx4 v8, s[28:31], s34 offen lds
    s_add_u32 m0, s36, 31744
    s_nop 0
    buffer_load_dwordx4 v9, s[28:31], s34 offen lds
    s_add_u32 m0, s36, 32768
    s_nop 0
    buffer_load_dwordx4 v10, s[28:31], s34 offen lds
    s_mov_b32 s34, 456192
    s_add_u32 m0, s36, 33792
    s_nop 0
    buffer_load_dwordx4 v8, s[28:31], s34 offen lds
    s_add_u32 m0, s36, 34816
    s_nop 0
    buffer_load_dwordx4 v9, s[28:31], s34 offen lds
    s_add_u32 m0, s36, 35840
    s_nop 0
    buffer_load_dwordx4 v10, s[28:31], s34 offen lds
    s_waitcnt vmcnt(33) lgkmcnt(0)
    ds_read_b64_tr_b16 a[176:177], v16 offset:0
    ds_read_b64_tr_b16 a[178:179], v16 offset:1536
    ds_read_b64_tr_b16 a[180:181], v16 offset:32
    ds_read_b64_tr_b16 a[182:183], v16 offset:1568
    ds_read_b64_tr_b16 a[184:185], v16 offset:64
    ds_read_b64_tr_b16 a[186:187], v16 offset:1600
    s_waitcnt vmcnt(30) lgkmcnt(0)
    s_mov_b32 s34, 497664
    s_add_u32 m0, s36, 0
    s_nop 0
    buffer_load_dwordx4 v8, s[28:31], s34 offen lds
    s_add_u32 m0, s36, 1024
    s_nop 0
    buffer_load_dwordx4 v9, s[28:31], s34 offen lds
    s_add_u32 m0, s36, 2048
    s_nop 0
    buffer_load_dwordx4 v10, s[28:31], s34 offen lds
    ds_read_b64_tr_b16 a[188:189], v16 offset:3072
    ds_read_b64_tr_b16 a[190:191], v16 offset:4608
    ds_read_b64_tr_b16 a[192:193], v16 offset:3104
    ds_read_b64_tr_b16 a[194:195], v16 offset:4640
    ds_read_b64_tr_b16 a[196:197], v16 offset:3136
    ds_read_b64_tr_b16 a[198:199], v16 offset:4672
    s_waitcnt vmcnt(30) lgkmcnt(0)
    s_mov_b32 s34, 539136
    s_add_u32 m0, s36, 3072
    s_nop 0
    buffer_load_dwordx4 v8, s[28:31], s34 offen lds
    s_add_u32 m0, s36, 4096
    s_nop 0
    buffer_load_dwordx4 v9, s[28:31], s34 offen lds
    s_add_u32 m0, s36, 5120
    s_nop 0
    buffer_load_dwordx4 v10, s[28:31], s34 offen lds
    ds_read_b64_tr_b16 a[200:201], v16 offset:6144
    ds_read_b64_tr_b16 a[202:203], v16 offset:7680
    ds_read_b64_tr_b16 a[204:205], v16 offset:6176
    ds_read_b64_tr_b16 a[206:207], v16 offset:7712
    ds_read_b64_tr_b16 a[208:209], v16 offset:6208
    ds_read_b64_tr_b16 a[210:211], v16 offset:7744
    s_waitcnt vmcnt(30) lgkmcnt(0)
    s_mov_b32 s34, 580608
    s_add_u32 m0, s36, 6144
    s_nop 0
    buffer_load_dwordx4 v8, s[28:31], s34 offen lds
    s_add_u32 m0, s36, 7168
    s_nop 0
    buffer_load_dwordx4 v9, s[28:31], s34 offen lds
    s_add_u32 m0, s36, 8192
    s_nop 0
    buffer_load_dwordx4 v10, s[28:31], s34 offen lds
    ds_read_b64_tr_b16 a[212:213], v16 offset:9216
    ds_read_b64_tr_b16 a[214:215], v16 offset:10752
    ds_read_b64_tr_b16 a[216:217], v16 offset:9248
    ds_read_b64_tr_b16 a[218:219], v16 offset:10784
    ds_read_b64_tr_b16 a[220:221], v16 offset:9280
    ds_read_b64_tr_b16 a[222:223], v16 offset:10816
    s_waitcnt vmcnt(30) lgkmcnt(0)
    s_mov_b32 s34, 622080
    s_add_u32 m0, s36, 9216
    s_nop 0
    buffer_load_dwordx4 v8, s[28:31], s34 offen lds
    s_add_u32 m0, s36, 10240
    s_nop 0
    buffer_load_dwordx4 v9, s[28:31], s34 offen lds
    s_add_u32 m0, s36, 11264
    s_nop 0
    buffer_load_dwordx4 v10, s[28:31], s34 offen lds
    ds_read_b64_tr_b16 a[224:225], v16 offset:12288
    ds_read_b64_tr_b16 a[226:227], v16 offset:13824
    ds_read_b64_tr_b16 a[228:229], v16 offset:12320
    ds_read_b64_tr_b16 a[230:231], v16 offset:13856
    ds_read_b64_tr_b16 a[232:233], v16 offset:12352
    ds_read_b64_tr_b16 a[234:235], v16 offset:13888
    s_waitcnt vmcnt(30) lgkmcnt(0)
    s_mov_b32 s34, 0
    s_add_u32 m0, s36, 12288
    s_nop 0
    buffer_load_dwordx4 v12, s[28:31], s34 offen lds
    s_add_u32 m0, s36, 13312
    s_nop 0
    buffer_load_dwordx4 v13, s[28:31], s34 offen lds
    s_add_u32 m0, s36, 14336
    s_nop 0
    buffer_load_dwordx4 v14, s[28:31], s34 offen lds
    ds_read_b64_tr_b16 a[236:237], v16 offset:15360
    ds_read_b64_tr_b16 a[238:239], v16 offset:16896
    ds_read_b64_tr_b16 a[240:241], v16 offset:15392
    ds_read_b64_tr_b16 a[242:243], v16 offset:16928
    ds_read_b64_tr_b16 a[244:245], v16 offset:15424
    ds_read_b64_tr_b16 a[246:247], v16 offset:16960
    s_waitcnt vmcnt(30) lgkmcnt(0)
    s_mov_b32 s34, 331776
    s_add_u32 m0, s36, 15360
    s_nop 0
    buffer_load_dwordx4 v12, s[28:31], s34 offen lds
    s_add_u32 m0, s36, 16384
    s_nop 0
    buffer_load_dwordx4 v13, s[28:31], s34 offen lds
    s_add_u32 m0, s36, 17408
    s_nop 0
    buffer_load_dwordx4 v14, s[28:31], s34 offen lds
    ds_read_b64_tr_b16 a[248:249], v16 offset:18432
    ds_read_b64_tr_b16 a[250:251], v16 offset:19968
    ds_read_b64_tr_b16 a[252:253], v16 offset:18464
    ds_read_b64_tr_b16 a[254:255], v16 offset:20000
    ds_read_b64_tr_b16 v[120:121], v16 offset:18496
    ds_read_b64_tr_b16 v[122:123], v16 offset:20032
    s_waitcnt vmcnt(30) lgkmcnt(0)
    ds_read_b64_tr_b16 v[124:125], v16 offset:21504
    ds_read_b64_tr_b16 v[126:127], v16 offset:23040
    ds_read_b64_tr_b16 v[128:129], v16 offset:21536
    ds_read_b64_tr_b16 v[130:131], v16 offset:23072
    ds_read_b64_tr_b16 v[132:133], v16 offset:21568
    ds_read_b64_tr_b16 v[134:135], v16 offset:23104
    s_waitcnt vmcnt(27) lgkmcnt(0)
    ds_read_b64_tr_b16 v[136:137], v16 offset:24576
    ds_read_b64_tr_b16 v[138:139], v16 offset:26112
    ds_read_b64_tr_b16 v[140:141], v16 offset:24608
    ds_read_b64_tr_b16 v[142:143], v16 offset:26144
    ds_read_b64_tr_b16 v[144:145], v16 offset:24640
    ds_read_b64_tr_b16 v[146:147], v16 offset:26176
    s_waitcnt vmcnt(24) lgkmcnt(0)
    ds_read_b64_tr_b16 v[148:149], v16 offset:27648
    ds_read_b64_tr_b16 v[150:151], v16 offset:29184
    ds_read_b64_tr_b16 v[152:153], v16 offset:27680
    ds_read_b64_tr_b16 v[154:155], v16 offset:29216
    ds_read_b64_tr_b16 v[156:157], v16 offset:27712
    ds_read_b64_tr_b16 v[158:159], v16 offset:29248
    s_waitcnt vmcnt(21) lgkmcnt(0)
    ds_read_b64_tr_b16 v[160:161], v16 offset:30720
    ds_read_b64_tr_b16 v[162:163], v16 offset:32256
    ds_read_b64_tr_b16 v[164:165], v16 offset:30752
    ds_read_b64_tr_b16 v[166:167], v16 offset:32288
    ds_read_b64_tr_b16 v[168:169], v16 offset:30784
    ds_read_b64_tr_b16 v[170:171], v16 offset:32320
    s_waitcnt vmcnt(18) lgkmcnt(0)
    ds_read_b64_tr_b16 v[172:173], v16 offset:33792
    ds_read_b64_tr_b16 v[174:175], v16 offset:35328
    ds_read_b64_tr_b16 v[176:177], v16 offset:33824
    ds_read_b64_tr_b16 v[178:179], v16 offset:35360
    ds_read_b64_tr_b16 v[180:181], v16 offset:33856
    ds_read_b64_tr_b16 v[182:183], v16 offset:35392
    s_waitcnt vmcnt(15) lgkmcnt(0)
    ds_read_b64_tr_b16 v[184:185], v16 offset:0
    ds_read_b64_tr_b16 v[186:187], v16 offset:1536
    ds_read_b64_tr_b16 v[188:189], v16 offset:32
    ds_read_b64_tr_b16 v[190:191], v16 offset:1568
    ds_read_b64_tr_b16 v[192:193], v16 offset:64
    ds_read_b64_tr_b16 v[194:195], v16 offset:1600
    s_waitcnt vmcnt(12) lgkmcnt(0)
    ds_read_b64_tr_b16 v[196:197], v16 offset:3072
    ds_read_b64_tr_b16 v[198:199], v16 offset:4608
    ds_read_b64_tr_b16 v[200:201], v16 offset:3104
    ds_read_b64_tr_b16 v[202:203], v16 offset:4640
    ds_read_b64_tr_b16 v[204:205], v16 offset:3136
    ds_read_b64_tr_b16 v[206:207], v16 offset:4672
    s_waitcnt vmcnt(9) lgkmcnt(0)
    ds_read_b64_tr_b16 v[208:209], v16 offset:6144
    ds_read_b64_tr_b16 v[210:211], v16 offset:7680
    ds_read_b64_tr_b16 v[212:213], v16 offset:6176
    ds_read_b64_tr_b16 v[214:215], v16 offset:7712
    ds_read_b64_tr_b16 v[216:217], v16 offset:6208
    ds_read_b64_tr_b16 v[218:219], v16 offset:7744
    s_waitcnt vmcnt(6) lgkmcnt(0)
    ds_read_b64_tr_b16 v[220:221], v16 offset:9216
    ds_read_b64_tr_b16 v[222:223], v16 offset:10752
    ds_read_b64_tr_b16 v[224:225], v16 offset:9248
    ds_read_b64_tr_b16 v[226:227], v16 offset:10784
    ds_read_b64_tr_b16 v[228:229], v16 offset:9280
    ds_read_b64_tr_b16 v[230:231], v16 offset:10816
    s_waitcnt vmcnt(3) lgkmcnt(0)
    ds_read_b64_tr_b16 v[232:233], v16 offset:12288
    ds_read_b64_tr_b16 v[234:235], v16 offset:13824
    ds_read_b64_tr_b16 v[236:237], v16 offset:12320
    ds_read_b64_tr_b16 v[238:239], v16 offset:13856
    ds_read_b64_tr_b16 v[240:241], v16 offset:12352
    ds_read_b64_tr_b16 v[242:243], v16 offset:13888
    s_waitcnt vmcnt(0) lgkmcnt(0)
    ds_read_b64_tr_b16 v[244:245], v16 offset:15360
    ds_read_b64_tr_b16 v[246:247], v16 offset:16896
    ds_read_b64_tr_b16 v[248:249], v16 offset:15392
    ds_read_b64_tr_b16 v[250:251], v16 offset:16928
    ds_read_b64_tr_b16 v[252:253], v16 offset:15424
    ds_read_b64_tr_b16 v[254:255], v16 offset:16960
    s_waitcnt lgkmcnt(0)
    s_barrier
    v_add_u32 v8, 0, v0
    v_mul_u32_u24 v9, 2731, v8
    v_lshrrev_b32 v9, 16, v9
    v_mul_u32_u24 v10, 24, v9
    v_sub_u32 v8, v8, v10
    v_mul_u32_u24 v10, 1152, v9
    v_lshl_add_u32 v10, v8, 4, v10
    s_mul_i32 s34, s49, 384
    v_add_u32 v10, s34, v10
    v_mov_b32 v11, 1073741824
    v_cmp_gt_u32 vcc, 16, v9
    s_nop 1
    v_cndmask_b32 v98, v11, v10, vcc
    v_lshlrev_b32 v10, 9, v8
    v_and_b32 v9, 15, v9
    v_lshl_add_u32 v10, v9, 4, v10
    v_add_u32 v94, 0, v10
    v_add_u32 v8, 256, v0
    v_mul_u32_u24 v9, 2731, v8
    v_lshrrev_b32 v9, 16, v9
    v_mul_u32_u24 v10, 24, v9
    v_sub_u32 v8, v8, v10
    v_mul_u32_u24 v10, 1152, v9
    v_lshl_add_u32 v10, v8, 4, v10
    s_mul_i32 s34, s49, 384
    v_add_u32 v10, s34, v10
    v_mov_b32 v11, 1073741824
    v_cmp_gt_u32 vcc, 16, v9
    s_nop 1
    v_cndmask_b32 v99, v11, v10, vcc
    v_lshlrev_b32 v10, 9, v8
    v_and_b32 v9, 15, v9
    v_lshl_add_u32 v10, v9, 4, v10
    v_add_u32 v95, 0, v10
    v_and_b32 v8, 63, v0
    v_lshrrev_b32 v10, 5, v8
    v_mul_u32_u24 v11, 1152, v10
    v_bfe_u32 v13, v8, 4, 1
    v_lshl_add_u32 v11, v13, 9, v11
    v_and_b32 v13, 15, v8
    v_lshl_add_u32 v102, v13, 4, v11
    v_and_b32 v11, 3, v8
    v_mul_u32_u24 v11, 1152, v11
    v_and_b32 v13, 60, v8
    v_add_u32 v11, v11, v13
    v_add_u32 v103, 1024, v11
    v_lshlrev_b32 v0, 4, v8
    s_setpc_b64 s[72:73]
L_bw_ia:
    v_lshrrev_b32 v8, 4, v0
    v_and_b32 v9, 31, v8
    v_lshrrev_b32 v10, 5, v8
    v_lshlrev_b32 v11, 2, v9
    v_and_b32 v14, 0x33, v8
    v_bfe_u32 v15, v8, 2, 1
    v_lshl_add_u32 v14, v15, 3, v14
    v_bfe_u32 v15, v8, 3, 1
    v_lshl_add_u32 v14, v15, 2, v14
    v_lshlrev_b32 v7, 4, v14
    v_and_b32 v14, 31, v14
    v_lshlrev_b32 v14, 2, v14
    v_add_u32 v1, 1024, v14
    v_mov_b32 v93, 0xdddd
    s_cmp_eq_u32 s20, 2
    s_cselect_b64 s[22:23], 0xffff, -1
    s_sub_u32 s3, 3, s20
    s_mov_b32 s101, 0
    s_mov_b32 s52, 0x17800000
    s_mov_b32 s53, 0x67800000
    v_mov_b32 v12, 1073741824
    v_cmp_gt_u32 vcc, 32, v8
    s_nop 1
    v_cndmask_b32 v92, v12, v11, vcc
    v_mul_u32_u24 v11, 18, v10
    v_add_u32 v11, v11, v9
    v_lshlrev_b32 v11, 4, v11
    v_add_u32 v11, 1152, v11
    v_mov_b32 v12, 147456
    v_mov_b32 v13, 2304
    v_cmp_gt_u32 vcc, 18, v9
    s_nop 1
    v_cndmask_b32 v2, v12, v11, vcc
    v_cndmask_b32 v3, 0, v13, vcc
    v_lshlrev_b32 v104, 3, v3
    v_mov_b32 v16, s39
    v_mov_b32 v17, s39
    v_mov_b32 v18, s39
    v_mov_b32 v19, s39
    ds_write_b128 v12, v[16:19]
    ds_write_b128 v12, v[16:19] offset:576
    ds_write_b128 v12, v[16:19] offset:9216
    ds_write_b128 v12, v[16:19] offset:9792
    v_mov_b32 v61, 0
    v_mov_b32 v85, 0
    v_mov_b32 v63, 0
    v_accvgpr_write_b32 a161, 0
    v_accvgpr_write_b32 a163, 0
    v_accvgpr_write_b32 a165, 0
    v_accvgpr_write_b32 a167, 0
    v_accvgpr_write_b32 a169, 0
    v_accvgpr_write_b32 a171, 0
    v_accvgpr_write_b32 a173, 0
    v_accvgpr_write_b32 a175, 0
    s_waitcnt lgkmcnt(0)
    s_setpc_b64 s[72:73]
L_end:
    s_waitcnt vmcnt(0)
s_endpgm
.section .rodata,"a"
.p2align 6
.amdhsa_kernel interleave_layers__memory_aug_recurrent_mem_tr__softmax_full_mha__prompt_kernel
  .amdhsa_next_free_vgpr 512
  .amdhsa_next_free_sgpr 102
  .amdhsa_accum_offset 256
  .amdhsa_group_segment_fixed_size 0
  .amdhsa_kernarg_size 104
  .amdhsa_user_sgpr_count 2
  .amdhsa_user_sgpr_kernarg_segment_ptr 1
  .amdhsa_system_sgpr_workgroup_id_x 1
.end_amdhsa_kernel
```
